```python
import torch

def _softmax(x, axis=-1):
    return torch.softmax(x, dim=axis)

def _gelu(x):
    return torch.nn.functional.gelu(x, approximate='tanh')

def _silu(x):
    return torch.nn.functional.silu(x)

def _sigmoid(x):
    return torch.sigmoid(x)

def _layernorm(x, axis=-1, eps=1e-05):
    m = x.mean(dim=axis, keepdim=True)
    v = x.var(dim=axis, keepdim=True, unbiased=False)
    return (x - m) / torch.sqrt(v + eps)

def _scatter_add(tgt, idx, src, axis=0):
    return tgt.clone().index_add_(axis, idx, src)

def _segment_sum(src, seg, n):
    out = torch.zeros((n,) + src.shape[1:], dtype=src.dtype)
    return out.index_add_(0, seg, src)

def _pad(x, pw):
    flat = tuple((v for pair in reversed(pw) for v in pair))
    return torch.nn.functional.pad(x, flat)
kernel_name = 'standalone__autoregressive_conv_wavenet__speech'

def setup_inputs():

    _w = lambda a: (lambda t: t.to(torch.bfloat16) if t.is_floating_point() else t)(torch.as_tensor(a))
    B, T, D, K = (2, 16000, 144, 15)
    return {'x': _w((lambda *s: torch.randn(*s, dtype=torch.bfloat16) * 0.1)(B, T, D)), 'w': _w((lambda *s: torch.randn(*s, dtype=torch.bfloat16) * 0.1)(K, D, 2 * D)), 'w_o': _w((lambda *s: torch.randn(*s, dtype=torch.bfloat16) * 0.05)(D, D))}

def reference(x, w, w_o):
    B, T, D = x.shape
    K = w.shape[0]
    dil = 2
    pad = (K - 1) * dil
    xp = _pad(x, ((0, 0), (pad, 0), (0, 0)))
    h = torch.einsum('btc,cd->btd', xp[:, pad:pad + T, :], w[0])
    for i in range(1, K):
        off = pad - i * dil
        h = h + torch.einsum('btc,cd->btd', xp[:, off:off + T, :], w[i])
    f = h[..., :D].clone()
    g = h[..., D:].clone()
    z = torch.tanh(f) * _sigmoid(g)
    return z @ w_o
```

```asm
; @launch grid=(256,1,1) block=(512,1,1) lds=163840
.amdgcn_target "amdgcn-amd-amdhsa--gfx950"
.text
.globl standalone__autoregressive_conv_wavenet__speech_kernel
.p2align 8
.type standalone__autoregressive_conv_wavenet__speech_kernel,@function
standalone__autoregressive_conv_wavenet__speech_kernel:
    s_getpc_b64 s[62:63]
    s_load_dwordx8 s[4:11], s[0:1], 0
    s_load_dwordx4 s[12:15], s[0:1], 32
    v_lshrrev_b32 v1, 6, v0
    s_cmp_lt_u32 s2, 56
    s_cbranch_scc1 L_hent
    v_readfirstlane_b32 s36, v1
    s_lshr_b32 s3, s2, 8
    s_cbranch_scc1 L_exit
    v_and_b32 v0, 63, v0
    s_sub_u32 s37, s2, 56
    s_and_b32 s3, s2, 7
    s_mul_i32 s3, s3, 25
    s_lshr_b32 s37, s37, 3
    s_add_u32 s37, s37, s3
    v_lshrrev_b32 v2, 3, v0
    v_bfe_u32 v3, v0, 2, 1
    v_and_b32 v4, 3, v0
    s_cmp_ge_u32 s37, 100
    s_cselect_b32 s41, 100, 0
    s_cselect_b32 s42, 4608000, 0
    v_mul_u32_u24 v2, 5760, v2
    v_mul_u32_u24 v3, 288, v3
    s_sub_u32 s41, s37, s41
    s_mul_i32 s39, s41, 46080
    s_sub_u32 s39, s39, 8640
    v_lshl_add_u32 v2, v4, 4, v2
    v_add_u32 v2, v2, v3
    s_mov_b32 s18, 4608000
    s_mov_b32 s19, 0x20000
    s_cmp_lt_u32 s36, 4
    s_cselect_b32 s43, 1, 2
    s_cselect_b32 s44, 1, 0
    s_lshl_b32 s44, 5760, s44
    s_add_u32 s43, s43, s36
    s_mul_i32 s43, s43, 576
    s_add_u32 s43, s43, s39
    v_add_u32 v3, s43, v2
    v_add_u32 v4, s44, v3
    s_sub_u32 s38, s36, 4
    s_and_b32 s45, s36, 1
    s_mul_i32 m0, s38, 4608
    s_lshl_b32 s41, s45, 5
    v_lshlrev_b32 v5, 4, v0
    v_xor_b32 v5, s41, v5
    s_mov_b32 s22, 1244160
    s_mov_b32 s23, s19
    s_lshl3_add_u32 s43, s45, s39
    s_addk_i32 s43, 5760
    v_add_u32 v14, s43, v2
    v_add_u32 v15, 5760, v14
    s_cmp_lt_u32 s38, 2
    s_cbranch_scc1 L_dent
    s_setprio 3
    s_waitcnt lgkmcnt(0)
    s_add_u32 s16, s4, s42
    s_addc_u32 s17, s5, 0
    s_cmp_lt_u32 s36, 4
    buffer_load_dwordx4 v[44:47], v3, s[16:19], 0 offen
    buffer_load_dwordx4 v[52:55], v4, s[16:19], 0 offen
    s_cbranch_scc1 L_cent
    buffer_load_dwordx2 v[168:169], v14, s[16:19], 0 offen
    buffer_load_dwordx2 v[190:191], v15, s[16:19], 0 offen
L_dent:
    s_waitcnt lgkmcnt(0)
    s_mov_b32 s20, s6
    s_mov_b32 s21, s7
    s_add_u32 s16, s4, s42
    s_addc_u32 s17, s5, 0
    s_cmp_lt_u32 s38, 2
    buffer_load_dwordx4 v5, s[20:23], m0 offen offset:0 lds
    buffer_load_dwordx4 v5, s[20:23], m0 offen offset:1024 lds
    buffer_load_dwordx4 v5, s[20:23], m0 offen offset:2048 lds
    buffer_load_dwordx4 v5, s[20:23], m0 offen offset:3072 lds
    buffer_load_dwordx4 v5, s[20:23], m0 offen offset:3584 lds
    s_setprio 3
    s_cbranch_scc1 L_loader
    s_branch L_xf
L_hent:
    s_lshr_b32 s3, s2, 3
    v_lshrrev_b32 v2, 2, v0
    s_lshl_b32 s3, s3, 7
    v_add_lshl_u32 v2, v2, s3, 7
    v_min_u32 v2, L_code_end-standalone__autoregressive_conv_wavenet__speech_kernel-8, v2
    global_load_dword v50, v2, s[62:63]
    s_branch L_prod
L_cent:
    s_setprio 0
L_entry_end:
L_compute:
    v_lshrrev_b32 v12, 4, v0
    v_bfe_u32 v13, v0, 2, 2
    v_lshl_add_u32 v17, v12, 2, v13
    v_lshl_add_u32 v13, v12, 3, v13
    v_mul_u32_u24 v13, 576, v13
    v_mul_u32_u24 v17, 576, v17
    v_and_b32 v14, 3, v0
    v_lshl_add_u32 v13, v14, 3, v13
    v_lshl_add_u32 v17, v14, 3, v17
    v_and_b32 v14, 1, v12
    v_lshlrev_b32 v15, 5, v14
    v_add_u32 v1, v13, v15
    v_sub_u32 v2, v13, v15
    v_add_u32 v3, 55296, v1
    v_add_u32 v4, 55296, v2
    v_and_b32 v15, 32, v0
    v_add_u32 v18, v17, v15
    v_sub_u32 v19, v17, v15
    v_and_b32 v13, 15, v0
    v_lshlrev_b32 v15, 1, v12
    v_xor_b32 v15, v15, v13
    v_lshl_add_u32 v15, v12, 4, v15
    v_lshlrev_b32 v15, 4, v15
    v_add_u32 v5, 111616, v15
    v_lshrrev_b32 v12, 1, v12
    v_lshlrev_b32 v15, 1, v12
    v_xor_b32 v15, v15, v13
    v_lshl_add_u32 v15, v12, 4, v15
    v_lshlrev_b32 v15, 4, v15
    v_lshl_add_u32 v15, v14, 3, v15
    v_add_u32 v6, 92160, v15
    s_mov_b32 s50, 0xbfb8aa3b
    s_mov_b32 s51, 0xbfb8aa3b
    s_mov_b32 s52, 0xbf38aa3b
    s_mov_b32 s53, 0xbf38aa3b
    s_mov_b32 s56, 0x3f800000
    s_mov_b32 s57, 0x3f800000
    s_mov_b32 s58, 0xc0000000
    s_mov_b32 s59, 0xc0000000
    s_mov_b32 s60, 0x40000000
    s_mov_b32 s61, 0x40000000
    s_cmp_eq_u32 s36, 0
    s_cselect_b32 s54, s50, s52
    s_mov_b32 s55, s54
    s_mov_b32 s28, 0x4038aa3b
    s_mov_b32 s29, 0x4038aa3b
    s_mov_b32 s30, 0x3fb8aa3b
    s_mov_b32 s31, 0x3fb8aa3b
    s_cselect_b32 s32, s28, s30
    s_mov_b32 s33, s32
    v_mov_b32 v7, 0xc1c00000
    s_mov_b32 s66, 0x4b000000
    s_mov_b32 s67, 0x4b000000
    s_mov_b32 s46, 0x0
    s_mov_b32 s47, 0x0
    s_cselect_b32 s48, s46, 0
    s_cselect_b32 s49, s47, 0
    v_lshlrev_b32 v13, 3, v0
    v_lshlrev_b32 v14, 4, v0
    s_lshl_b32 s41, s36, 10
    v_add_u32 v12, s41, v14
    s_lshr_b32 s42, s36, 1
    s_and_b32 s43, s36, 1
    s_lshl_b32 s41, s42, 10
    s_lshl_b32 s44, s43, 3
    s_add_u32 s41, s41, s44
    s_add_u32 s41, s41, 98304
    v_add_u32 v15, s41, v14
    s_mul_i32 s41, s42, 4608
    s_lshl_b32 s44, s43, 2
    s_add_u32 s41, s41, s44
    s_add_u32 s41, s41, 40960
    v_add_u32 v16, s41, v13
    s_lshl_b32 s41, s36, 11
    s_add_u32 s41, s41, 98304
    v_add_u32 v14, s41, v14
    s_mul_i32 s41, s36, 9216
    s_add_u32 s41, s41, 4096
    v_add_u32 v13, s41, v13
    s_mov_b32 s84, s46
    s_mov_b32 s85, s46
    s_mov_b32 s86, s47
    s_mov_b32 s87, s47
    s_mov_b32 s88, s48
    s_mov_b32 s89, s48
    s_mov_b32 s90, s49
    s_mov_b32 s91, s49
    v_mov_b64 v[72:73], s[84:85]
    v_mov_b64 v[74:75], s[84:85]
    v_mov_b64 v[76:77], s[86:87]
    v_mov_b64 v[78:79], s[86:87]
    v_mov_b64 v[80:81], s[84:85]
    v_mov_b64 v[82:83], s[84:85]
    v_mov_b64 v[84:85], s[86:87]
    v_mov_b64 v[86:87], s[86:87]
    v_mov_b64 v[88:89], s[84:85]
    v_mov_b64 v[90:91], s[84:85]
    v_mov_b64 v[92:93], s[86:87]
    v_mov_b64 v[94:95], s[86:87]
    v_mov_b64 v[96:97], s[84:85]
    v_mov_b64 v[98:99], s[84:85]
    v_mov_b64 v[100:101], s[86:87]
    v_mov_b64 v[102:103], s[86:87]
    v_mov_b64 v[104:105], s[84:85]
    v_mov_b64 v[106:107], s[84:85]
    v_mov_b64 v[108:109], s[86:87]
    v_mov_b64 v[110:111], s[86:87]
    v_mov_b64 v[112:113], 0
    v_mov_b64 v[114:115], 0
    v_mov_b64 v[116:117], 0
    v_mov_b64 v[118:119], 0
    v_mov_b64 v[120:121], 0
    v_mov_b64 v[122:123], 0
    v_mov_b64 v[124:125], 0
    v_mov_b64 v[126:127], 0
    v_mov_b64 v[128:129], 0
    v_mov_b64 v[130:131], 0
    v_mov_b64 v[132:133], 0
    v_mov_b64 v[134:135], 0
    v_mov_b64 v[136:137], 0
    v_mov_b64 v[138:139], 0
    v_mov_b64 v[140:141], 0
    v_mov_b64 v[142:143], 0
    v_mov_b64 v[144:145], 0
    v_mov_b64 v[146:147], 0
    v_mov_b64 v[148:149], 0
    v_mov_b64 v[150:151], 0
    v_mov_b64 v[152:153], s[84:85]
    v_mov_b64 v[154:155], s[84:85]
    v_mov_b64 v[156:157], s[86:87]
    v_mov_b64 v[158:159], s[86:87]
    v_mov_b64 v[160:161], s[84:85]
    v_mov_b64 v[162:163], s[84:85]
    v_mov_b64 v[164:165], s[86:87]
    v_mov_b64 v[166:167], s[86:87]
    v_mov_b64 v[168:169], s[84:85]
    v_mov_b64 v[170:171], s[84:85]
    v_mov_b64 v[172:173], s[86:87]
    v_mov_b64 v[174:175], s[86:87]
    v_mov_b64 v[176:177], s[84:85]
    v_mov_b64 v[178:179], s[84:85]
    v_mov_b64 v[180:181], s[86:87]
    v_mov_b64 v[182:183], s[86:87]
    v_mov_b64 v[184:185], s[84:85]
    v_mov_b64 v[186:187], s[84:85]
    v_mov_b64 v[188:189], s[86:87]
    v_mov_b64 v[190:191], s[86:87]
    v_mov_b64 v[192:193], 0
    v_mov_b64 v[194:195], 0
    v_mov_b64 v[196:197], 0
    v_mov_b64 v[198:199], 0
    v_mov_b64 v[200:201], 0
    v_mov_b64 v[202:203], 0
    v_mov_b64 v[204:205], 0
    v_mov_b64 v[206:207], 0
    v_mov_b64 v[208:209], 0
    v_mov_b64 v[210:211], 0
    v_mov_b64 v[212:213], 0
    v_mov_b64 v[214:215], 0
    v_mov_b64 v[216:217], 0
    v_mov_b64 v[218:219], 0
    v_mov_b64 v[220:221], 0
    v_mov_b64 v[222:223], 0
    v_mov_b64 v[224:225], 0
    v_mov_b64 v[226:227], 0
    v_mov_b64 v[228:229], 0
    v_mov_b64 v[230:231], 0
    v_mov_b64 v[232:233], s[84:85]
    v_mov_b64 v[234:235], s[84:85]
    v_mov_b64 v[236:237], s[86:87]
    v_mov_b64 v[238:239], s[86:87]
    v_mov_b64 v[240:241], 0
    v_mov_b64 v[242:243], 0
    v_mov_b64 v[244:245], 0
    v_mov_b64 v[246:247], 0
    v_mov_b64 v[248:249], s[88:89]
    v_mov_b64 v[250:251], s[88:89]
    v_mov_b64 v[252:253], s[90:91]
    v_mov_b64 v[254:255], s[90:91]
    v_lshrrev_b32 v36, 2, v0
    v_and_b32 v37, 3, v0
    v_lshlrev_b32 v38, 1, v37
    v_xor_b32 v36, v36, v38
    v_lshl_add_u32 v36, v37, 4, v36
    v_lshlrev_b32 v36, 4, v36
    s_lshl_b32 s41, s36, 10
    s_sub_u32 s41, 115712, s41
    v_add_u32 v34, s41, v36
    s_mov_b32 s65, 0xffff0000
    s_lshl_b32 s41, s36, 11
    s_add_u32 s41, s41, 131072
    v_lshl_add_u32 v35, v0, 4, s41
    s_waitcnt vmcnt(0)
    ds_write_b128 v35, v[44:47]
    v_mov_b32_dpp v48, v44 row_shl:8 row_mask:0xf bank_mask:0x3
    v_mov_b32_dpp v49, v45 row_shl:8 row_mask:0xf bank_mask:0x3
    v_mov_b32_dpp v50, v46 row_shl:8 row_mask:0xf bank_mask:0x3
    v_mov_b32_dpp v51, v47 row_shl:8 row_mask:0xf bank_mask:0x3
    v_mov_b32_dpp v48, v52 row_shr:8 row_mask:0xf bank_mask:0xc
    v_mov_b32_dpp v49, v53 row_shr:8 row_mask:0xf bank_mask:0xc
    v_mov_b32_dpp v50, v54 row_shr:8 row_mask:0xf bank_mask:0xc
    v_mov_b32_dpp v51, v55 row_shr:8 row_mask:0xf bank_mask:0xc
    v_lshlrev_b32 v56, 16, v48
    v_and_b32 v57, s65, v48
    v_lshlrev_b32 v58, 16, v52
    v_and_b32 v59, s65, v52
    ds_write_b128 v35, v[48:51] offset:1024
    v_lshlrev_b32 v60, 16, v49
    v_and_b32 v61, s65, v49
    v_lshlrev_b32 v62, 16, v53
    v_and_b32 v63, s65, v53
    v_lshlrev_b32 v64, 16, v50
    v_and_b32 v65, s65, v50
    v_lshlrev_b32 v66, 16, v54
    v_and_b32 v67, s65, v54
    v_lshlrev_b32 v68, 16, v51
    v_and_b32 v69, s65, v51
    v_lshlrev_b32 v70, 16, v55
    v_and_b32 v71, s65, v55
    v_sub_f32 v56, v56, v58
    v_sub_f32 v57, v57, v59
    v_sub_f32 v60, v60, v62
    v_sub_f32 v61, v61, v63
    v_sub_f32 v64, v64, v66
    v_sub_f32 v65, v65, v67
    v_sub_f32 v68, v68, v70
    v_sub_f32 v69, v69, v71
    v_cvt_pk_bf16_f32 v20, v56, v57
    v_cvt_pk_bf16_f32 v21, v60, v61
    v_cvt_pk_bf16_f32 v22, v64, v65
    v_cvt_pk_bf16_f32 v23, v68, v69
    ds_write_b128 v34, v[20:23]
    s_waitcnt lgkmcnt(0)
    s_cmp_eq_u32 s36, 1
    s_cbranch_scc1 L_cw1
    s_cmp_eq_u32 s36, 2
    s_cbranch_scc1 L_cw2
    s_cmp_eq_u32 s36, 3
    s_cbranch_scc1 L_cw3
    s_branch L_cw0
L_prod:
    v_readfirstlane_b32 s36, v1
    v_and_b32 v0, 63, v0
    s_lshr_b32 s44, s2, 3
    s_lshl_b32 s41, s36, 6
    v_add_u32 v40, s41, v0
    v_and_b32 v41, 255, v40
    v_mul_u32_u24 v41, 7, v41
    v_add_u32 v41, s44, v41
    v_min_u32 v41, 1439, v41
    v_mul_u32_u24 v42, 29128, v41
    v_lshrrev_b32 v42, 22, v42
    v_mul_u32_u24 v43, 64512, v42
    v_lshl_add_u32 v41, v41, 7, v43
    v_cmp_le_u32 vcc, 5, v42
    v_mov_b32 v43, 0
    v_mov_b32 v44, 414720
    v_cndmask_b32 v43, v43, v44, vcc
    v_add_u32 v41, v41, v43
    s_mul_i32 s3, s2, 464
    v_add_u32 v1, s3, v40
    s_add_u32 s3, s3, 464
    s_min_u32 s3, s3, 25920
    v_cmp_gt_u32 vcc, s3, v1
    v_lshlrev_b32 v1, 4, v1
    v_mov_b32 v2, 0x80000000
    v_cndmask_b32 v1, v2, v1, vcc
    s_mov_b32 s65, 0xffff0000
    s_mov_b32 s41, 414720
    s_mov_b32 s42, 829440
    s_waitcnt lgkmcnt(0)
    s_mov_b32 s20, s6
    s_mov_b32 s21, s7
    s_mov_b32 s22, 1244160
    s_mov_b32 s23, 0x20000
    s_cmp_ge_u32 s36, 4
    s_cbranch_scc1 L_sk5001
    buffer_load_dword v50, v41, s[20:23], 0 offen
L_sk5001:
    s_mov_b32 s24, s14
    s_mov_b32 s25, s15
    s_mov_b32 s26, 829440
    s_mov_b32 s27, 0x20000
    s_mov_b32 s16, s4
    s_mov_b32 s17, s5
    s_mov_b32 s18, 9216000
    s_mov_b32 s19, 0x20000
    s_mov_b32 s32, s8
    s_mov_b32 s33, s9
    s_mov_b32 s34, 41472
    s_mov_b32 s35, 0x20000
    v_mul_u32_u24 v42, 7, v40
    v_add_u32 v42, s44, v42
    v_mul_u32_u24 v43, 10923, v42
    v_lshrrev_b32 v43, 20, v43
    v_mul_u32_u24 v44, 96, v43
    v_sub_u32 v44, v42, v44
    v_cmp_gt_u32 vcc, 2400, v42
    v_mul_u32_u24 v43, 46080, v43
    v_lshrrev_b32 v45, 1, v44
    v_mul_u32_u24 v45, 1152, v45
    v_add_u32 v43, v43, v45
    s_and_b32 s43, s2, 7
    s_mul_i32 s43, s43, 1152000
    s_sub_u32 s43, s43, 9216
    v_add_u32 v43, s43, v43
    v_and_b32 v44, 1, v44
    v_lshl_add_u32 v45, v44, 8, v43
    v_add_u32 v45, 384, v45
    v_cndmask_b32 v45, v2, v45, vcc
    v_mul_u32_u24 v44, 896, v44
    v_add_u32 v46, v43, v44
    v_add_u32 v46, 128, v46
    v_cndmask_b32 v46, v2, v46, vcc
    s_mul_i32 s43, s44, 47
    v_min_u32 v47, 46, v40
    v_add_u32 v47, s43, v47
    v_lshlrev_b32 v47, 7, v47
    s_mul_i32 s43, s44, 926
    v_add_u32 v48, s43, v40
    v_min_u32 v49, 413, v40
    v_add_u32 v49, s43, v49
    v_lshlrev_b32 v48, 7, v48
    v_lshlrev_b32 v49, 7, v49
    v_add_u32 v49, 0x10000, v49
    s_lshr_b32 s43, s36, 2
    s_mul_i32 s43, s43, 18432
    s_add_u32 s43, s43, 18432
    s_add_u32 s44, s43, 36864
    buffer_load_dword v50, v45, s[16:19], 0 offen
    s_barrier
    s_cmp_ge_u32 s36, 4
    s_cbranch_scc1 L_sk5002
    s_mov_b32 s3, 18432
    buffer_load_dword v50, v41, s[20:23], s3 offen
L_sk5002:
    s_barrier
    buffer_load_dword v50, v46, s[16:19], 0 offen
    s_barrier
    buffer_load_dwordx4 v[4:7], v1, s[20:23], 0 offen
    buffer_load_dwordx4 v[8:11], v1, s[20:23], s41 offen
    buffer_load_dwordx4 v[12:15], v1, s[20:23], s42 offen
    s_waitcnt vmcnt(0)
    v_lshlrev_b32 v24, 16, v4
    v_and_b32 v25, s65, v4
    v_lshlrev_b32 v26, 16, v8
    v_and_b32 v27, s65, v8
    v_lshlrev_b32 v28, 16, v12
    v_and_b32 v29, s65, v12
    v_add_f32 v24, v24, v28
    v_add_f32 v25, v25, v29
    v_add_f32 v28, v24, v26
    v_add_f32 v29, v25, v27
    v_sub_f32 v24, v24, v26
    v_sub_f32 v25, v25, v27
    v_cvt_pk_bf16_f32 v16, v28, v29
    v_cvt_pk_bf16_f32 v20, v24, v25
    v_lshlrev_b32 v24, 16, v5
    v_and_b32 v25, s65, v5
    v_lshlrev_b32 v26, 16, v9
    v_and_b32 v27, s65, v9
    v_lshlrev_b32 v28, 16, v13
    v_and_b32 v29, s65, v13
    v_add_f32 v24, v24, v28
    v_add_f32 v25, v25, v29
    v_add_f32 v28, v24, v26
    v_add_f32 v29, v25, v27
    v_sub_f32 v24, v24, v26
    v_sub_f32 v25, v25, v27
    v_cvt_pk_bf16_f32 v17, v28, v29
    v_cvt_pk_bf16_f32 v21, v24, v25
    v_lshlrev_b32 v24, 16, v6
    v_and_b32 v25, s65, v6
    v_lshlrev_b32 v26, 16, v10
    v_and_b32 v27, s65, v10
    v_lshlrev_b32 v28, 16, v14
    v_and_b32 v29, s65, v14
    v_add_f32 v24, v24, v28
    v_add_f32 v25, v25, v29
    v_add_f32 v28, v24, v26
    v_add_f32 v29, v25, v27
    v_sub_f32 v24, v24, v26
    v_sub_f32 v25, v25, v27
    v_cvt_pk_bf16_f32 v18, v28, v29
    v_cvt_pk_bf16_f32 v22, v24, v25
    v_lshlrev_b32 v24, 16, v7
    v_and_b32 v25, s65, v7
    v_lshlrev_b32 v26, 16, v11
    v_and_b32 v27, s65, v11
    v_lshlrev_b32 v28, 16, v15
    v_and_b32 v29, s65, v15
    v_add_f32 v24, v24, v28
    v_add_f32 v25, v25, v29
    v_add_f32 v28, v24, v26
    v_add_f32 v29, v25, v27
    v_sub_f32 v24, v24, v26
    v_sub_f32 v25, v25, v27
    v_cvt_pk_bf16_f32 v19, v28, v29
    v_cvt_pk_bf16_f32 v23, v24, v25
    buffer_store_dwordx4 v[16:19], v1, s[24:27], 0 offen sc1
    buffer_store_dwordx4 v[20:23], v1, s[24:27], s41 offen sc1
    s_waitcnt vmcnt(0)
    s_barrier
    v_mov_b32 v1, 0
    v_mov_b32 v2, 1
    s_cmp_lg_u32 s36, 0
    s_cbranch_scc1 L_pnoat
    s_mov_b64 exec, 1
    global_atomic_add v3, v1, v2, s[12:13] sc0 sc1
    s_mov_b64 exec, -1
    s_waitcnt vmcnt(0)
L_pnoat:
    s_cmp_ge_u32 s36, 4
    s_cbranch_scc1 L_sk5003
    s_mov_b32 s3, 36864
    buffer_load_dword v50, v41, s[20:23], s3 offen
L_sk5003:
    buffer_load_dword v50, v47, s[32:35], 0 offen
    buffer_load_dword v50, v41, s[20:23], s44 offen
    s_cmp_lg_u32 s36, 0
    s_cbranch_scc1 L_pwait
    s_waitcnt vmcnt(0)
L_ppoll:
L_ppoll2:
    global_load_dword v3, v1, s[12:13] sc1
    s_waitcnt vmcnt(0)
    v_readfirstlane_b32 s41, v3
    s_nop 0
    s_cmp_lt_u32 s41, 56
    s_cbranch_scc1 L_ppoll2
L_pwait:
    s_barrier
    buffer_load_dword v50, v48, s[24:27], 0 offen sc1
    buffer_load_dword v50, v49, s[24:27], 0 offen sc1
    s_waitcnt vmcnt(0)
L_exit:
    s_endpgm
.p2align 6
L_loader:
    s_mul_i32 s46, s45, 9216
    v_lshrrev_b32 v29, 2, v0
    v_and_b32 v31, 3, v0
    s_mul_i32 s43, s45, 96
    v_add_u32 v48, s43, v29
    v_add_u32 v49, 16, v48
    v_add_u32 v50, 32, v48
    v_add_u32 v51, 48, v48
    v_add_u32 v52, 64, v48
    v_add_u32 v53, 80, v48
    v_mul_u32_u24 v64, 6554, v48
    v_mul_u32_u24 v65, 6554, v49
    v_mul_u32_u24 v66, 6554, v50
    v_mul_u32_u24 v67, 6554, v51
    v_mul_u32_u24 v68, 6554, v52
    v_mul_u32_u24 v69, 6554, v53
    v_lshrrev_b32 v64, 16, v64
    v_lshrrev_b32 v65, 16, v65
    v_lshrrev_b32 v66, 16, v66
    v_lshrrev_b32 v67, 16, v67
    v_lshrrev_b32 v68, 16, v68
    v_lshrrev_b32 v69, 16, v69
    v_and_b32 v64, 2, v64
    v_and_b32 v65, 2, v65
    v_and_b32 v66, 2, v66
    v_and_b32 v67, 2, v67
    v_and_b32 v68, 2, v68
    v_and_b32 v69, 2, v69
    v_xor_b32 v48, v48, v64
    v_xor_b32 v49, v49, v65
    v_xor_b32 v50, v50, v66
    v_xor_b32 v51, v51, v67
    v_xor_b32 v52, v52, v68
    v_xor_b32 v53, v53, v69
    v_mul_u32_u24 v48, 288, v48
    v_mul_u32_u24 v49, 288, v49
    v_mul_u32_u24 v50, 288, v50
    v_mul_u32_u24 v51, 288, v51
    v_mul_u32_u24 v52, 288, v52
    v_mul_u32_u24 v53, 288, v53
    v_lshl_add_u32 v48, v31, 4, v48
    v_lshl_add_u32 v49, v31, 4, v49
    v_lshl_add_u32 v50, v31, 4, v50
    v_lshl_add_u32 v51, v31, 4, v51
    v_lshl_add_u32 v52, v31, 4, v52
    v_lshl_add_u32 v53, v31, 4, v53
    v_add_u32 v48, s39, v48
    v_add_u32 v49, s39, v49
    v_add_u32 v50, s39, v50
    v_add_u32 v51, s39, v51
    v_add_u32 v52, s39, v52
    v_add_u32 v53, s39, v53
    s_mul_i32 s95, s45, 6144
    s_add_u32 s95, s95, 131072
    v_lshl_add_u32 v60, v0, 4, s46
    s_lshr_b32 s41, s46, 4
    v_add_u32 v61, s41, v0
    v_mul_u32_u24 v61, 3641, v61
    v_mov_b32 v62, v61
    v_lshrrev_b32 v62, 15, v62
    v_and_b32 v62, 32, v62
    v_xor_b32 v32, v60, v62
    s_add_u32 m0, s46, 18432
    s_mov_b32 s49, 82944
    buffer_load_dwordx4 v32, s[20:23], s49 offen lds
    v_add_u32 v62, 233024, v61
    v_lshrrev_b32 v62, 15, v62
    v_and_b32 v62, 32, v62
    v_xor_b32 v33, v60, v62
    buffer_load_dwordx4 v33, s[20:23], s49 offen offset:1024 lds
    v_add_u32 v62, 466048, v61
    v_lshrrev_b32 v62, 15, v62
    v_and_b32 v62, 32, v62
    v_xor_b32 v34, v60, v62
    buffer_load_dwordx4 v34, s[20:23], s49 offen offset:2048 lds
    v_add_u32 v62, 699072, v61
    v_lshrrev_b32 v62, 15, v62
    v_and_b32 v62, 32, v62
    v_xor_b32 v35, v60, v62
    buffer_load_dwordx4 v35, s[20:23], s49 offen offset:3072 lds
    v_add_u32 v62, 932096, v61
    v_lshrrev_b32 v62, 15, v62
    v_and_b32 v62, 32, v62
    v_add_u32 v60, 4096, v60
    v_xor_b32 v36, v60, v62
    s_add_u32 m0, s46, 22528
    s_nop 0
    buffer_load_dwordx4 v36, s[20:23], s49 offen lds
    v_add_u32 v62, 1165120, v61
    v_lshrrev_b32 v62, 15, v62
    v_and_b32 v62, 32, v62
    v_xor_b32 v37, v60, v62
    buffer_load_dwordx4 v37, s[20:23], s49 offen offset:1024 lds
    v_add_u32 v62, 1398144, v61
    v_lshrrev_b32 v62, 15, v62
    v_and_b32 v62, 32, v62
    v_xor_b32 v38, v60, v62
    buffer_load_dwordx4 v38, s[20:23], s49 offen offset:2048 lds
    v_add_u32 v62, 1631168, v61
    v_lshrrev_b32 v62, 15, v62
    v_and_b32 v62, 32, v62
    v_xor_b32 v39, v60, v62
    buffer_load_dwordx4 v39, s[20:23], s49 offen offset:3072 lds
    v_add_u32 v62, 1864192, v61
    v_lshrrev_b32 v62, 15, v62
    v_and_b32 v62, 32, v62
    v_add_u32 v60, 4096, v60
    v_xor_b32 v40, v60, v62
    s_add_u32 m0, s46, 26624
    s_nop 0
    buffer_load_dwordx4 v40, s[20:23], s49 offen lds
    s_add_u32 m0, s46, 36864
    s_mov_b32 s49, 165888
    buffer_load_dwordx4 v32, s[20:23], s49 offen lds
    buffer_load_dwordx4 v33, s[20:23], s49 offen offset:1024 lds
    buffer_load_dwordx4 v34, s[20:23], s49 offen offset:2048 lds
    buffer_load_dwordx4 v35, s[20:23], s49 offen offset:3072 lds
    s_add_u32 m0, s46, 40960
    s_nop 0
    buffer_load_dwordx4 v36, s[20:23], s49 offen lds
    buffer_load_dwordx4 v37, s[20:23], s49 offen offset:1024 lds
    buffer_load_dwordx4 v38, s[20:23], s49 offen offset:2048 lds
    buffer_load_dwordx4 v39, s[20:23], s49 offen offset:3072 lds
    s_add_u32 m0, s46, 45056
    s_nop 0
    buffer_load_dwordx4 v40, s[20:23], s49 offen lds
    s_waitcnt vmcnt(18)
    s_setprio 0
    s_barrier
    s_add_u32 m0, s46, 55296
    s_mov_b32 s49, 248832
    buffer_load_dwordx4 v32, s[20:23], s49 offen lds
    buffer_load_dwordx4 v33, s[20:23], s49 offen offset:1024 lds
    buffer_load_dwordx4 v34, s[20:23], s49 offen offset:2048 lds
    buffer_load_dwordx4 v35, s[20:23], s49 offen offset:3072 lds
    s_add_u32 m0, s46, 59392
    s_nop 0
    buffer_load_dwordx4 v36, s[20:23], s49 offen lds
    buffer_load_dwordx4 v37, s[20:23], s49 offen offset:1024 lds
    buffer_load_dwordx4 v38, s[20:23], s49 offen offset:2048 lds
    buffer_load_dwordx4 v39, s[20:23], s49 offen offset:3072 lds
    s_add_u32 m0, s46, 63488
    s_nop 0
    buffer_load_dwordx4 v40, s[20:23], s49 offen lds
    s_waitcnt vmcnt(18)
    s_barrier
    s_add_u32 m0, s46, 73728
    s_mov_b32 s49, 331776
    buffer_load_dwordx4 v32, s[20:23], s49 offen lds
    buffer_load_dwordx4 v33, s[20:23], s49 offen offset:1024 lds
    buffer_load_dwordx4 v34, s[20:23], s49 offen offset:2048 lds
    buffer_load_dwordx4 v35, s[20:23], s49 offen offset:3072 lds
    s_add_u32 m0, s46, 77824
    s_nop 0
    buffer_load_dwordx4 v36, s[20:23], s49 offen lds
    buffer_load_dwordx4 v37, s[20:23], s49 offen offset:1024 lds
    buffer_load_dwordx4 v38, s[20:23], s49 offen offset:2048 lds
    buffer_load_dwordx4 v39, s[20:23], s49 offen offset:3072 lds
    s_add_u32 m0, s46, 81920
    s_nop 0
    buffer_load_dwordx4 v40, s[20:23], s49 offen lds
    s_add_u32 m0, s95, 12288
    s_movk_i32 s49, 64
    buffer_load_dwordx4 v48, s[16:19], s49 offen lds
    s_add_u32 m0, s95, 13312
    s_nop 0
    buffer_load_dwordx4 v49, s[16:19], s49 offen lds
    s_waitcnt vmcnt(20)
    s_barrier
    s_add_u32 m0, s46, 0
    s_mov_b32 s49, 829440
    buffer_load_dwordx4 v32, s[20:23], s49 offen lds
    s_mov_b32 s24, s14
    buffer_load_dwordx4 v33, s[20:23], s49 offen offset:1024 lds
    buffer_load_dwordx4 v34, s[20:23], s49 offen offset:2048 lds
    buffer_load_dwordx4 v35, s[20:23], s49 offen offset:3072 lds
    s_add_u32 m0, s46, 4096
    s_nop 0
    buffer_load_dwordx4 v36, s[20:23], s49 offen lds
    buffer_load_dwordx4 v37, s[20:23], s49 offen offset:1024 lds
    s_mov_b32 s25, s15
    buffer_load_dwordx4 v38, s[20:23], s49 offen offset:2048 lds
    buffer_load_dwordx4 v39, s[20:23], s49 offen offset:3072 lds
    s_add_u32 m0, s46, 8192
    s_nop 0
    buffer_load_dwordx4 v40, s[20:23], s49 offen lds
    s_add_u32 m0, s95, 14336
    s_movk_i32 s49, 64
    buffer_load_dwordx4 v50, s[16:19], s49 offen lds
    s_add_u32 m0, s95, 15360
    s_nop 0
    buffer_load_dwordx4 v51, s[16:19], s49 offen lds
    s_waitcnt vmcnt(22)
    s_barrier
    s_add_u32 m0, s46, 18432
    s_mov_b32 s49, 912384
    buffer_load_dwordx4 v32, s[20:23], s49 offen lds
    s_mov_b32 s26, 829440
    buffer_load_dwordx4 v33, s[20:23], s49 offen offset:1024 lds
    buffer_load_dwordx4 v34, s[20:23], s49 offen offset:2048 lds
    buffer_load_dwordx4 v35, s[20:23], s49 offen offset:3072 lds
    s_add_u32 m0, s46, 22528
    s_nop 0
    buffer_load_dwordx4 v36, s[20:23], s49 offen lds
    buffer_load_dwordx4 v37, s[20:23], s49 offen offset:1024 lds
    s_mov_b32 s27, 0x20000
    buffer_load_dwordx4 v38, s[20:23], s49 offen offset:2048 lds
    buffer_load_dwordx4 v39, s[20:23], s49 offen offset:3072 lds
    s_add_u32 m0, s46, 26624
    s_nop 0
    buffer_load_dwordx4 v40, s[20:23], s49 offen lds
    s_add_u32 m0, s95, 16384
    s_movk_i32 s49, 64
    buffer_load_dwordx4 v52, s[16:19], s49 offen lds
    s_add_u32 m0, s95, 17408
    s_nop 0
    buffer_load_dwordx4 v53, s[16:19], s49 offen lds
    s_waitcnt vmcnt(24)
    s_barrier
    s_add_u32 m0, s46, 36864
    s_mov_b32 s49, 995328
    buffer_load_dwordx4 v32, s[20:23], s49 offen lds
    s_mov_b32 s32, s8
    buffer_load_dwordx4 v33, s[20:23], s49 offen offset:1024 lds
    buffer_load_dwordx4 v34, s[20:23], s49 offen offset:2048 lds
    buffer_load_dwordx4 v35, s[20:23], s49 offen offset:3072 lds
    s_add_u32 m0, s46, 40960
    s_nop 0
    buffer_load_dwordx4 v36, s[20:23], s49 offen lds
    s_mov_b32 s33, s9
    buffer_load_dwordx4 v37, s[20:23], s49 offen offset:1024 lds
    buffer_load_dwordx4 v38, s[20:23], s49 offen offset:2048 lds
    buffer_load_dwordx4 v39, s[20:23], s49 offen offset:3072 lds
    s_add_u32 m0, s46, 45056
    s_nop 0
    buffer_load_dwordx4 v40, s[20:23], s49 offen lds
    s_waitcnt vmcnt(22)
    s_barrier
    s_add_u32 m0, s46, 55296
    s_mov_b32 s49, 1078272
    buffer_load_dwordx4 v32, s[20:23], s49 offen lds
    s_mov_b32 s34, 41472
    buffer_load_dwordx4 v33, s[20:23], s49 offen offset:1024 lds
    buffer_load_dwordx4 v34, s[20:23], s49 offen offset:2048 lds
    buffer_load_dwordx4 v35, s[20:23], s49 offen offset:3072 lds
    s_add_u32 m0, s46, 59392
    s_nop 0
    buffer_load_dwordx4 v36, s[20:23], s49 offen lds
    s_mov_b32 s35, 0x20000
    buffer_load_dwordx4 v37, s[20:23], s49 offen offset:1024 lds
    buffer_load_dwordx4 v38, s[20:23], s49 offen offset:2048 lds
    buffer_load_dwordx4 v39, s[20:23], s49 offen offset:3072 lds
    s_add_u32 m0, s46, 63488
    s_nop 0
    buffer_load_dwordx4 v40, s[20:23], s49 offen lds
    s_waitcnt vmcnt(20)
    s_waitcnt vmcnt(18)
    s_barrier
    s_add_u32 m0, s46, 73728
    s_mov_b32 s49, 1161216
    buffer_load_dwordx4 v32, s[20:23], s49 offen lds
    s_mul_i32 s41, s37, 46080
    buffer_load_dwordx4 v33, s[20:23], s49 offen offset:1024 lds
    buffer_load_dwordx4 v34, s[20:23], s49 offen offset:2048 lds
    buffer_load_dwordx4 v35, s[20:23], s49 offen offset:3072 lds
    s_add_u32 m0, s46, 77824
    s_nop 0
    buffer_load_dwordx4 v36, s[20:23], s49 offen lds
    buffer_load_dwordx4 v37, s[20:23], s49 offen offset:1024 lds
    s_add_u32 s28, s10, s41
    s_addc_u32 s29, s11, 0
    buffer_load_dwordx4 v38, s[20:23], s49 offen offset:2048 lds
    buffer_load_dwordx4 v39, s[20:23], s49 offen offset:3072 lds
    s_add_u32 m0, s46, 81920
    s_nop 0
    buffer_load_dwordx4 v40, s[20:23], s49 offen lds
    s_add_u32 m0, s95, 0
    s_movk_i32 s49, 128
    buffer_load_dwordx4 v48, s[16:19], s49 offen lds
    s_add_u32 m0, s95, 1024
    s_nop 0
    buffer_load_dwordx4 v49, s[16:19], s49 offen lds
    s_waitcnt vmcnt(20)
    s_barrier
    s_add_u32 m0, s46, 0
    s_mov_b32 s49, 18432
    buffer_load_dwordx4 v32, s[20:23], s49 offen lds
    s_mov_b32 s30, 46080
    buffer_load_dwordx4 v33, s[20:23], s49 offen offset:1024 lds
    buffer_load_dwordx4 v34, s[20:23], s49 offen offset:2048 lds
    buffer_load_dwordx4 v35, s[20:23], s49 offen offset:3072 lds
    s_add_u32 m0, s46, 4096
    s_nop 0
    buffer_load_dwordx4 v36, s[20:23], s49 offen lds
    s_mov_b32 s31, 0x20000
    buffer_load_dwordx4 v37, s[20:23], s49 offen offset:1024 lds
    buffer_load_dwordx4 v38, s[20:23], s49 offen offset:2048 lds
    buffer_load_dwordx4 v39, s[20:23], s49 offen offset:3072 lds
    s_add_u32 m0, s46, 8192
    s_nop 0
    buffer_load_dwordx4 v40, s[20:23], s49 offen lds
    s_add_u32 m0, s95, 2048
    s_movk_i32 s49, 128
    buffer_load_dwordx4 v50, s[16:19], s49 offen lds
    s_waitcnt vmcnt(21)
    s_barrier
    s_add_u32 m0, s46, 18432
    s_mov_b32 s49, 101376
    buffer_load_dwordx4 v32, s[20:23], s49 offen lds
    s_add_u32 s90, s45, 1
    buffer_load_dwordx4 v33, s[20:23], s49 offen offset:1024 lds
    buffer_load_dwordx4 v34, s[20:23], s49 offen offset:2048 lds
    buffer_load_dwordx4 v35, s[20:23], s49 offen offset:3072 lds
    s_add_u32 m0, s46, 22528
    s_nop 0
    buffer_load_dwordx4 v36, s[20:23], s49 offen lds
    s_mul_i32 s90, s90, 73728
    buffer_load_dwordx4 v37, s[20:23], s49 offen offset:1024 lds
    buffer_load_dwordx4 v38, s[20:23], s49 offen offset:2048 lds
    buffer_load_dwordx4 v39, s[20:23], s49 offen offset:3072 lds
    s_add_u32 m0, s46, 26624
    s_nop 0
    buffer_load_dwordx4 v40, s[20:23], s49 offen lds
    s_add_u32 m0, s95, 3072
    s_movk_i32 s49, 128
    buffer_load_dwordx4 v51, s[16:19], s49 offen lds
    s_waitcnt vmcnt(22)
    s_barrier
    s_add_u32 m0, s46, 36864
    s_mov_b32 s49, 184320
    buffer_load_dwordx4 v32, s[20:23], s49 offen lds
    s_lshl_b32 s47, s45, 12
    buffer_load_dwordx4 v33, s[20:23], s49 offen offset:1024 lds
    buffer_load_dwordx4 v34, s[20:23], s49 offen offset:2048 lds
    buffer_load_dwordx4 v35, s[20:23], s49 offen offset:3072 lds
    s_add_u32 m0, s46, 40960
    s_nop 0
    buffer_load_dwordx4 v36, s[20:23], s49 offen lds
    v_mov_b32 v21, 0
    buffer_load_dwordx4 v37, s[20:23], s49 offen offset:1024 lds
    buffer_load_dwordx4 v38, s[20:23], s49 offen offset:2048 lds
    buffer_load_dwordx4 v39, s[20:23], s49 offen offset:3072 lds
    s_add_u32 m0, s46, 45056
    s_nop 0
    buffer_load_dwordx4 v40, s[20:23], s49 offen lds
    s_add_u32 m0, s95, 4096
    s_movk_i32 s49, 128
    buffer_load_dwordx4 v52, s[16:19], s49 offen lds
    s_waitcnt vmcnt(21)
    s_barrier
    s_add_u32 m0, s46, 55296
    s_mov_b32 s49, 267264
    buffer_load_dwordx4 v32, s[20:23], s49 offen lds
    v_lshl_add_u32 v60, v0, 4, s47
    buffer_load_dwordx4 v33, s[20:23], s49 offen offset:1024 lds
    buffer_load_dwordx4 v34, s[20:23], s49 offen offset:2048 lds
    buffer_load_dwordx4 v35, s[20:23], s49 offen offset:3072 lds
    s_add_u32 m0, s46, 59392
    s_nop 0
    buffer_load_dwordx4 v36, s[20:23], s49 offen lds
    s_lshr_b32 s41, s47, 4
    buffer_load_dwordx4 v37, s[20:23], s49 offen offset:1024 lds
    buffer_load_dwordx4 v38, s[20:23], s49 offen offset:2048 lds
    buffer_load_dwordx4 v39, s[20:23], s49 offen offset:3072 lds
    s_add_u32 m0, s46, 63488
    s_nop 0
    buffer_load_dwordx4 v40, s[20:23], s49 offen lds
    s_add_u32 m0, s95, 5120
    s_movk_i32 s49, 128
    buffer_load_dwordx4 v53, s[16:19], s49 offen lds
    s_waitcnt vmcnt(21)
    s_barrier
    s_add_u32 m0, s46, 73728
    s_mov_b32 s49, 350208
    buffer_load_dwordx4 v32, s[20:23], s49 offen lds
    v_add_u32 v61, s41, v0
    buffer_load_dwordx4 v33, s[20:23], s49 offen offset:1024 lds
    buffer_load_dwordx4 v34, s[20:23], s49 offen offset:2048 lds
    buffer_load_dwordx4 v35, s[20:23], s49 offen offset:3072 lds
    s_add_u32 m0, s46, 77824
    s_nop 0
    buffer_load_dwordx4 v36, s[20:23], s49 offen lds
    v_mul_u32_u24 v61, 3641, v61
    buffer_load_dwordx4 v37, s[20:23], s49 offen offset:1024 lds
    buffer_load_dwordx4 v38, s[20:23], s49 offen offset:2048 lds
    buffer_load_dwordx4 v39, s[20:23], s49 offen offset:3072 lds
    s_add_u32 m0, s46, 81920
    s_nop 0
    buffer_load_dwordx4 v40, s[20:23], s49 offen lds
    s_add_u32 m0, s95, 12288
    s_movk_i32 s49, 192
    buffer_load_dwordx4 v48, s[16:19], s49 offen lds
    s_waitcnt vmcnt(21)
    s_barrier
    s_add_u32 m0, s46, 0
    s_mov_b32 s49, 847872
    buffer_load_dwordx4 v32, s[20:23], s49 offen lds
    v_mov_b32 v62, v61
    buffer_load_dwordx4 v33, s[20:23], s49 offen offset:1024 lds
    buffer_load_dwordx4 v34, s[20:23], s49 offen offset:2048 lds
    buffer_load_dwordx4 v35, s[20:23], s49 offen offset:3072 lds
    s_add_u32 m0, s46, 4096
    s_nop 0
    buffer_load_dwordx4 v36, s[20:23], s49 offen lds
    v_lshrrev_b32 v62, 15, v62
    buffer_load_dwordx4 v37, s[20:23], s49 offen offset:1024 lds
    buffer_load_dwordx4 v38, s[20:23], s49 offen offset:2048 lds
    buffer_load_dwordx4 v39, s[20:23], s49 offen offset:3072 lds
    s_add_u32 m0, s46, 8192
    s_nop 0
    buffer_load_dwordx4 v40, s[20:23], s49 offen lds
    s_add_u32 m0, s95, 13312
    s_movk_i32 s49, 192
    buffer_load_dwordx4 v49, s[16:19], s49 offen lds
    s_waitcnt vmcnt(21)
    s_waitcnt vmcnt(20)
    s_barrier
    s_add_u32 m0, s46, 18432
    s_mov_b32 s49, 930816
    buffer_load_dwordx4 v32, s[20:23], s49 offen lds
    v_and_b32 v62, 32, v62
    buffer_load_dwordx4 v33, s[20:23], s49 offen offset:1024 lds
    buffer_load_dwordx4 v34, s[20:23], s49 offen offset:2048 lds
    buffer_load_dwordx4 v35, s[20:23], s49 offen offset:3072 lds
    s_add_u32 m0, s46, 22528
    s_nop 0
    buffer_load_dwordx4 v36, s[20:23], s49 offen lds
    v_xor_b32 v42, v60, v62
    buffer_load_dwordx4 v37, s[20:23], s49 offen offset:1024 lds
    buffer_load_dwordx4 v38, s[20:23], s49 offen offset:2048 lds
    buffer_load_dwordx4 v39, s[20:23], s49 offen offset:3072 lds
    s_add_u32 m0, s46, 26624
    s_nop 0
    buffer_load_dwordx4 v40, s[20:23], s49 offen lds
    s_add_u32 m0, s95, 14336
    s_movk_i32 s49, 192
    buffer_load_dwordx4 v50, s[16:19], s49 offen lds
    s_waitcnt vmcnt(21)
    s_barrier
    s_add_u32 m0, s46, 36864
    s_mov_b32 s49, 1013760
    buffer_load_dwordx4 v32, s[20:23], s49 offen lds
    v_add_u32 v62, 233024, v61
    buffer_load_dwordx4 v33, s[20:23], s49 offen offset:1024 lds
    buffer_load_dwordx4 v34, s[20:23], s49 offen offset:2048 lds
    buffer_load_dwordx4 v35, s[20:23], s49 offen offset:3072 lds
    s_add_u32 m0, s46, 40960
    s_nop 0
    buffer_load_dwordx4 v36, s[20:23], s49 offen lds
    v_lshrrev_b32 v62, 15, v62
    buffer_load_dwordx4 v37, s[20:23], s49 offen offset:1024 lds
    buffer_load_dwordx4 v38, s[20:23], s49 offen offset:2048 lds
    buffer_load_dwordx4 v39, s[20:23], s49 offen offset:3072 lds
    s_add_u32 m0, s46, 45056
    s_nop 0
    buffer_load_dwordx4 v40, s[20:23], s49 offen lds
    s_waitcnt vmcnt(20)
    s_barrier
    s_add_u32 m0, s46, 55296
    s_mov_b32 s49, 1096704
    buffer_load_dwordx4 v32, s[20:23], s49 offen lds
    v_and_b32 v62, 32, v62
    buffer_load_dwordx4 v33, s[20:23], s49 offen offset:1024 lds
    buffer_load_dwordx4 v34, s[20:23], s49 offen offset:2048 lds
    buffer_load_dwordx4 v35, s[20:23], s49 offen offset:3072 lds
    s_add_u32 m0, s46, 59392
    s_nop 0
    buffer_load_dwordx4 v36, s[20:23], s49 offen lds
    v_xor_b32 v43, v60, v62
    buffer_load_dwordx4 v37, s[20:23], s49 offen offset:1024 lds
    buffer_load_dwordx4 v38, s[20:23], s49 offen offset:2048 lds
    buffer_load_dwordx4 v39, s[20:23], s49 offen offset:3072 lds
    s_add_u32 m0, s46, 63488
    s_nop 0
    buffer_load_dwordx4 v40, s[20:23], s49 offen lds
    s_add_u32 m0, s95, 15360
    s_movk_i32 s49, 192
    buffer_load_dwordx4 v51, s[16:19], s49 offen lds
    s_waitcnt vmcnt(20)
    s_barrier
    s_add_u32 m0, s46, 73728
    s_mov_b32 s49, 1179648
    buffer_load_dwordx4 v32, s[20:23], s49 offen lds
    v_add_u32 v62, 466048, v61
    buffer_load_dwordx4 v33, s[20:23], s49 offen offset:1024 lds
    buffer_load_dwordx4 v34, s[20:23], s49 offen offset:2048 lds
    buffer_load_dwordx4 v35, s[20:23], s49 offen offset:3072 lds
    s_add_u32 m0, s46, 77824
    s_nop 0
    buffer_load_dwordx4 v36, s[20:23], s49 offen lds
    v_lshrrev_b32 v62, 15, v62
    buffer_load_dwordx4 v37, s[20:23], s49 offen offset:1024 lds
    buffer_load_dwordx4 v38, s[20:23], s49 offen offset:2048 lds
    buffer_load_dwordx4 v39, s[20:23], s49 offen offset:3072 lds
    s_add_u32 m0, s46, 81920
    s_nop 0
    buffer_load_dwordx4 v40, s[20:23], s49 offen lds
    s_add_u32 m0, s95, 16384
    s_movk_i32 s49, 192
    buffer_load_dwordx4 v52, s[16:19], s49 offen lds
    s_waitcnt vmcnt(20)
    s_barrier
    s_add_u32 m0, s46, 0
    s_mov_b32 s49, 36864
    buffer_load_dwordx4 v32, s[20:23], s49 offen lds
    v_and_b32 v62, 32, v62
    buffer_load_dwordx4 v33, s[20:23], s49 offen offset:1024 lds
    buffer_load_dwordx4 v34, s[20:23], s49 offen offset:2048 lds
    buffer_load_dwordx4 v35, s[20:23], s49 offen offset:3072 lds
    s_add_u32 m0, s46, 4096
    s_nop 0
    buffer_load_dwordx4 v36, s[20:23], s49 offen lds
    v_xor_b32 v44, v60, v62
    buffer_load_dwordx4 v37, s[20:23], s49 offen offset:1024 lds
    buffer_load_dwordx4 v38, s[20:23], s49 offen offset:2048 lds
    buffer_load_dwordx4 v39, s[20:23], s49 offen offset:3072 lds
    s_add_u32 m0, s46, 8192
    s_nop 0
    buffer_load_dwordx4 v40, s[20:23], s49 offen lds
    s_add_u32 m0, s95, 17408
    s_movk_i32 s49, 192
    buffer_load_dwordx4 v53, s[16:19], s49 offen lds
    s_waitcnt vmcnt(21)
    s_barrier
    s_add_u32 m0, s46, 18432
    s_mov_b32 s49, 119808
    buffer_load_dwordx4 v32, s[20:23], s49 offen lds
    v_add_u32 v62, 699072, v61
    buffer_load_dwordx4 v33, s[20:23], s49 offen offset:1024 lds
    buffer_load_dwordx4 v34, s[20:23], s49 offen offset:2048 lds
    buffer_load_dwordx4 v35, s[20:23], s49 offen offset:3072 lds
    s_add_u32 m0, s46, 22528
    s_nop 0
    buffer_load_dwordx4 v36, s[20:23], s49 offen lds
    v_lshrrev_b32 v62, 15, v62
    buffer_load_dwordx4 v37, s[20:23], s49 offen offset:1024 lds
    buffer_load_dwordx4 v38, s[20:23], s49 offen offset:2048 lds
    buffer_load_dwordx4 v39, s[20:23], s49 offen offset:3072 lds
    s_add_u32 m0, s46, 26624
    s_nop 0
    buffer_load_dwordx4 v40, s[20:23], s49 offen lds
    s_waitcnt vmcnt(20)
    s_barrier
    s_add_u32 m0, s46, 36864
    s_mov_b32 s49, 202752
    buffer_load_dwordx4 v32, s[20:23], s49 offen lds
    v_and_b32 v62, 32, v62
    buffer_load_dwordx4 v33, s[20:23], s49 offen offset:1024 lds
    buffer_load_dwordx4 v34, s[20:23], s49 offen offset:2048 lds
    buffer_load_dwordx4 v35, s[20:23], s49 offen offset:3072 lds
    s_add_u32 m0, s46, 40960
    s_nop 0
    buffer_load_dwordx4 v36, s[20:23], s49 offen lds
    v_xor_b32 v45, v60, v62
    buffer_load_dwordx4 v37, s[20:23], s49 offen offset:1024 lds
    buffer_load_dwordx4 v38, s[20:23], s49 offen offset:2048 lds
    buffer_load_dwordx4 v39, s[20:23], s49 offen offset:3072 lds
    s_add_u32 m0, s46, 45056
    s_nop 0
    buffer_load_dwordx4 v40, s[20:23], s49 offen lds
    s_add_u32 m0, s95, 0
    s_movk_i32 s49, 256
    buffer_load_dwordx4 v48, s[16:19], s49 offen lds
    s_waitcnt vmcnt(20)
    s_barrier
    s_add_u32 m0, s46, 55296
    s_mov_b32 s49, 285696
    buffer_load_dwordx4 v32, s[20:23], s49 offen lds
    v_add_u32 v62, 932096, v61
    buffer_load_dwordx4 v33, s[20:23], s49 offen offset:1024 lds
    buffer_load_dwordx4 v34, s[20:23], s49 offen offset:2048 lds
    buffer_load_dwordx4 v35, s[20:23], s49 offen offset:3072 lds
    s_add_u32 m0, s46, 59392
    s_nop 0
    buffer_load_dwordx4 v36, s[20:23], s49 offen lds
    v_lshrrev_b32 v62, 15, v62
    buffer_load_dwordx4 v37, s[20:23], s49 offen offset:1024 lds
    buffer_load_dwordx4 v38, s[20:23], s49 offen offset:2048 lds
    buffer_load_dwordx4 v39, s[20:23], s49 offen offset:3072 lds
    s_add_u32 m0, s46, 63488
    s_nop 0
    buffer_load_dwordx4 v40, s[20:23], s49 offen lds
    s_add_u32 m0, s95, 1024
    s_movk_i32 s49, 256
    buffer_load_dwordx4 v49, s[16:19], s49 offen lds
    s_waitcnt vmcnt(20)
    s_barrier
    s_add_u32 m0, s46, 73728
    s_mov_b32 s49, 368640
    buffer_load_dwordx4 v32, s[20:23], s49 offen lds
    v_and_b32 v62, 32, v62
    buffer_load_dwordx4 v33, s[20:23], s49 offen offset:1024 lds
    buffer_load_dwordx4 v34, s[20:23], s49 offen offset:2048 lds
    buffer_load_dwordx4 v35, s[20:23], s49 offen offset:3072 lds
    s_add_u32 m0, s46, 77824
    s_nop 0
    buffer_load_dwordx4 v36, s[20:23], s49 offen lds
    v_add_u32 v60, 4096, v60
    buffer_load_dwordx4 v37, s[20:23], s49 offen offset:1024 lds
    buffer_load_dwordx4 v38, s[20:23], s49 offen offset:2048 lds
    buffer_load_dwordx4 v39, s[20:23], s49 offen offset:3072 lds
    s_add_u32 m0, s46, 81920
    s_nop 0
    buffer_load_dwordx4 v40, s[20:23], s49 offen lds
    s_waitcnt vmcnt(20)
    s_barrier
    s_add_u32 m0, s46, 0
    s_mov_b32 s49, 866304
    buffer_load_dwordx4 v32, s[20:23], s49 offen lds
    v_xor_b32 v46, v60, v62
    buffer_load_dwordx4 v33, s[20:23], s49 offen offset:1024 lds
    buffer_load_dwordx4 v34, s[20:23], s49 offen offset:2048 lds
    buffer_load_dwordx4 v35, s[20:23], s49 offen offset:3072 lds
    s_add_u32 m0, s46, 4096
    s_nop 0
    buffer_load_dwordx4 v36, s[20:23], s49 offen lds
    buffer_load_dwordx4 v37, s[20:23], s49 offen offset:1024 lds
    buffer_load_dwordx4 v38, s[20:23], s49 offen offset:2048 lds
    buffer_load_dwordx4 v39, s[20:23], s49 offen offset:3072 lds
    s_add_u32 m0, s46, 8192
    s_nop 0
    buffer_load_dwordx4 v40, s[20:23], s49 offen lds
    s_add_u32 m0, s95, 2048
    s_movk_i32 s49, 256
    buffer_load_dwordx4 v50, s[16:19], s49 offen lds
    s_waitcnt vmcnt(20)
    s_barrier
    s_add_u32 m0, s46, 18432
    s_mov_b32 s49, 949248
    buffer_load_dwordx4 v32, s[20:23], s49 offen lds
    buffer_load_dwordx4 v33, s[20:23], s49 offen offset:1024 lds
    buffer_load_dwordx4 v34, s[20:23], s49 offen offset:2048 lds
    buffer_load_dwordx4 v35, s[20:23], s49 offen offset:3072 lds
    s_add_u32 m0, s46, 22528
    s_nop 0
    buffer_load_dwordx4 v36, s[20:23], s49 offen lds
    buffer_load_dwordx4 v37, s[20:23], s49 offen offset:1024 lds
    buffer_load_dwordx4 v38, s[20:23], s49 offen offset:2048 lds
    buffer_load_dwordx4 v39, s[20:23], s49 offen offset:3072 lds
    s_add_u32 m0, s46, 26624
    s_nop 0
    buffer_load_dwordx4 v40, s[20:23], s49 offen lds
    s_add_u32 m0, s95, 3072
    s_movk_i32 s49, 256
    buffer_load_dwordx4 v51, s[16:19], s49 offen lds
    s_waitcnt vmcnt(20)
    s_barrier
    s_add_u32 m0, s46, 36864
    s_mov_b32 s49, 1032192
    buffer_load_dwordx4 v32, s[20:23], s49 offen lds
    buffer_load_dwordx4 v33, s[20:23], s49 offen offset:1024 lds
    buffer_load_dwordx4 v34, s[20:23], s49 offen offset:2048 lds
    buffer_load_dwordx4 v35, s[20:23], s49 offen offset:3072 lds
    s_add_u32 m0, s46, 40960
    s_nop 0
    buffer_load_dwordx4 v36, s[20:23], s49 offen lds
    buffer_load_dwordx4 v37, s[20:23], s49 offen offset:1024 lds
    buffer_load_dwordx4 v38, s[20:23], s49 offen offset:2048 lds
    buffer_load_dwordx4 v39, s[20:23], s49 offen offset:3072 lds
    s_add_u32 m0, s46, 45056
    s_nop 0
    buffer_load_dwordx4 v40, s[20:23], s49 offen lds
    s_waitcnt vmcnt(20)
    s_barrier
    s_add_u32 m0, s46, 55296
    s_mov_b32 s49, 1115136
    buffer_load_dwordx4 v32, s[20:23], s49 offen lds
    buffer_load_dwordx4 v33, s[20:23], s49 offen offset:1024 lds
    buffer_load_dwordx4 v34, s[20:23], s49 offen offset:2048 lds
    buffer_load_dwordx4 v35, s[20:23], s49 offen offset:3072 lds
    s_add_u32 m0, s46, 59392
    s_nop 0
    buffer_load_dwordx4 v36, s[20:23], s49 offen lds
    buffer_load_dwordx4 v37, s[20:23], s49 offen offset:1024 lds
    buffer_load_dwordx4 v38, s[20:23], s49 offen offset:2048 lds
    buffer_load_dwordx4 v39, s[20:23], s49 offen offset:3072 lds
    s_add_u32 m0, s46, 63488
    s_nop 0
    buffer_load_dwordx4 v40, s[20:23], s49 offen lds
    s_add_u32 m0, s95, 4096
    s_movk_i32 s49, 256
    buffer_load_dwordx4 v52, s[16:19], s49 offen lds
    s_waitcnt vmcnt(20)
    s_barrier
    s_add_u32 m0, s46, 73728
    s_mov_b32 s49, 1198080
    buffer_load_dwordx4 v32, s[20:23], s49 offen lds
    buffer_load_dwordx4 v33, s[20:23], s49 offen offset:1024 lds
    buffer_load_dwordx4 v34, s[20:23], s49 offen offset:2048 lds
    buffer_load_dwordx4 v35, s[20:23], s49 offen offset:3072 lds
    s_add_u32 m0, s46, 77824
    s_nop 0
    buffer_load_dwordx4 v36, s[20:23], s49 offen lds
    buffer_load_dwordx4 v37, s[20:23], s49 offen offset:1024 lds
    buffer_load_dwordx4 v38, s[20:23], s49 offen offset:2048 lds
    buffer_load_dwordx4 v39, s[20:23], s49 offen offset:3072 lds
    s_add_u32 m0, s46, 81920
    s_nop 0
    buffer_load_dwordx4 v40, s[20:23], s49 offen lds
    s_add_u32 m0, s95, 5120
    s_movk_i32 s49, 256
    buffer_load_dwordx4 v53, s[16:19], s49 offen lds
    s_waitcnt vmcnt(20)
    s_barrier
    s_add_u32 m0, s46, 0
    s_mov_b32 s49, 55296
    buffer_load_dwordx4 v32, s[20:23], s49 offen lds
    buffer_load_dwordx4 v33, s[20:23], s49 offen offset:1024 lds
    buffer_load_dwordx4 v34, s[20:23], s49 offen offset:2048 lds
    buffer_load_dwordx4 v35, s[20:23], s49 offen offset:3072 lds
    s_add_u32 m0, s46, 4096
    s_nop 0
    buffer_load_dwordx4 v36, s[20:23], s49 offen lds
    buffer_load_dwordx4 v37, s[20:23], s49 offen offset:1024 lds
    buffer_load_dwordx4 v38, s[20:23], s49 offen offset:2048 lds
    buffer_load_dwordx4 v39, s[20:23], s49 offen offset:3072 lds
    s_add_u32 m0, s46, 8192
    s_nop 0
    buffer_load_dwordx4 v40, s[20:23], s49 offen lds
    s_waitcnt vmcnt(20)
    s_barrier
    s_add_u32 m0, s46, 18432
    s_mov_b32 s49, 138240
    buffer_load_dwordx4 v32, s[20:23], s49 offen lds
    buffer_load_dwordx4 v33, s[20:23], s49 offen offset:1024 lds
    buffer_load_dwordx4 v34, s[20:23], s49 offen offset:2048 lds
    buffer_load_dwordx4 v35, s[20:23], s49 offen offset:3072 lds
    s_add_u32 m0, s46, 22528
    s_nop 0
    buffer_load_dwordx4 v36, s[20:23], s49 offen lds
    buffer_load_dwordx4 v37, s[20:23], s49 offen offset:1024 lds
    buffer_load_dwordx4 v38, s[20:23], s49 offen offset:2048 lds
    buffer_load_dwordx4 v39, s[20:23], s49 offen offset:3072 lds
    s_add_u32 m0, s46, 26624
    s_nop 0
    buffer_load_dwordx4 v40, s[20:23], s49 offen lds
    s_waitcnt vmcnt(19)
    s_barrier
    s_add_u32 m0, s46, 36864
    s_mov_b32 s49, 221184
    buffer_load_dwordx4 v32, s[20:23], s49 offen lds
    buffer_load_dwordx4 v33, s[20:23], s49 offen offset:1024 lds
    buffer_load_dwordx4 v34, s[20:23], s49 offen offset:2048 lds
    buffer_load_dwordx4 v35, s[20:23], s49 offen offset:3072 lds
    s_add_u32 m0, s46, 40960
    s_nop 0
    buffer_load_dwordx4 v36, s[20:23], s49 offen lds
    buffer_load_dwordx4 v37, s[20:23], s49 offen offset:1024 lds
    buffer_load_dwordx4 v38, s[20:23], s49 offen offset:2048 lds
    buffer_load_dwordx4 v39, s[20:23], s49 offen offset:3072 lds
    s_add_u32 m0, s46, 45056
    s_nop 0
    buffer_load_dwordx4 v40, s[20:23], s49 offen lds
    s_waitcnt vmcnt(18)
    s_barrier
    s_add_u32 m0, s46, 55296
    s_mov_b32 s49, 304128
    buffer_load_dwordx4 v32, s[20:23], s49 offen lds
    buffer_load_dwordx4 v33, s[20:23], s49 offen offset:1024 lds
    buffer_load_dwordx4 v34, s[20:23], s49 offen offset:2048 lds
    buffer_load_dwordx4 v35, s[20:23], s49 offen offset:3072 lds
    s_add_u32 m0, s46, 59392
    s_nop 0
    buffer_load_dwordx4 v36, s[20:23], s49 offen lds
    buffer_load_dwordx4 v37, s[20:23], s49 offen offset:1024 lds
    buffer_load_dwordx4 v38, s[20:23], s49 offen offset:2048 lds
    buffer_load_dwordx4 v39, s[20:23], s49 offen offset:3072 lds
    s_add_u32 m0, s46, 63488
    s_nop 0
    buffer_load_dwordx4 v40, s[20:23], s49 offen lds
    s_waitcnt vmcnt(18)
    s_barrier
    s_add_u32 m0, s46, 73728
    s_mov_b32 s49, 387072
    buffer_load_dwordx4 v32, s[20:23], s49 offen lds
    buffer_load_dwordx4 v33, s[20:23], s49 offen offset:1024 lds
    buffer_load_dwordx4 v34, s[20:23], s49 offen offset:2048 lds
    buffer_load_dwordx4 v35, s[20:23], s49 offen offset:3072 lds
    s_add_u32 m0, s46, 77824
    s_nop 0
    buffer_load_dwordx4 v36, s[20:23], s49 offen lds
    buffer_load_dwordx4 v37, s[20:23], s49 offen offset:1024 lds
    buffer_load_dwordx4 v38, s[20:23], s49 offen offset:2048 lds
    buffer_load_dwordx4 v39, s[20:23], s49 offen offset:3072 lds
    s_add_u32 m0, s46, 81920
    s_nop 0
    buffer_load_dwordx4 v40, s[20:23], s49 offen lds
    s_waitcnt vmcnt(18)
    s_barrier
    s_add_u32 m0, s46, 0
    s_mov_b32 s49, 884736
    buffer_load_dwordx4 v32, s[20:23], s49 offen lds
    buffer_load_dwordx4 v33, s[20:23], s49 offen offset:1024 lds
    buffer_load_dwordx4 v34, s[20:23], s49 offen offset:2048 lds
    buffer_load_dwordx4 v35, s[20:23], s49 offen offset:3072 lds
    s_add_u32 m0, s46, 4096
    s_nop 0
    buffer_load_dwordx4 v36, s[20:23], s49 offen lds
    buffer_load_dwordx4 v37, s[20:23], s49 offen offset:1024 lds
    buffer_load_dwordx4 v38, s[20:23], s49 offen offset:2048 lds
    buffer_load_dwordx4 v39, s[20:23], s49 offen offset:3072 lds
    s_add_u32 m0, s46, 8192
    s_nop 0
    buffer_load_dwordx4 v40, s[20:23], s49 offen lds
    s_waitcnt vmcnt(18)
    s_barrier
    s_add_u32 m0, s46, 18432
    s_mov_b32 s49, 967680
    buffer_load_dwordx4 v32, s[20:23], s49 offen lds
    buffer_load_dwordx4 v33, s[20:23], s49 offen offset:1024 lds
    buffer_load_dwordx4 v34, s[20:23], s49 offen offset:2048 lds
    buffer_load_dwordx4 v35, s[20:23], s49 offen offset:3072 lds
    s_add_u32 m0, s46, 22528
    s_nop 0
    buffer_load_dwordx4 v36, s[20:23], s49 offen lds
    buffer_load_dwordx4 v37, s[20:23], s49 offen offset:1024 lds
    buffer_load_dwordx4 v38, s[20:23], s49 offen offset:2048 lds
    buffer_load_dwordx4 v39, s[20:23], s49 offen offset:3072 lds
    s_add_u32 m0, s46, 26624
    s_nop 0
    buffer_load_dwordx4 v40, s[20:23], s49 offen lds
    global_load_dword v22, v21, s[12:13] sc1
    s_waitcnt vmcnt(19)
    s_barrier
    s_add_u32 m0, s46, 36864
    s_mov_b32 s49, 1050624
    buffer_load_dwordx4 v32, s[20:23], s49 offen lds
    buffer_load_dwordx4 v33, s[20:23], s49 offen offset:1024 lds
    buffer_load_dwordx4 v34, s[20:23], s49 offen offset:2048 lds
    buffer_load_dwordx4 v35, s[20:23], s49 offen offset:3072 lds
    s_add_u32 m0, s46, 40960
    s_nop 0
    buffer_load_dwordx4 v36, s[20:23], s49 offen lds
    buffer_load_dwordx4 v37, s[20:23], s49 offen offset:1024 lds
    buffer_load_dwordx4 v38, s[20:23], s49 offen offset:2048 lds
    buffer_load_dwordx4 v39, s[20:23], s49 offen offset:3072 lds
    s_add_u32 m0, s46, 45056
    s_nop 0
    buffer_load_dwordx4 v40, s[20:23], s49 offen lds
    s_waitcnt vmcnt(19)
    s_barrier
    s_add_u32 m0, s46, 55296
    s_mov_b32 s49, 1133568
    buffer_load_dwordx4 v32, s[20:23], s49 offen lds
    buffer_load_dwordx4 v33, s[20:23], s49 offen offset:1024 lds
    buffer_load_dwordx4 v34, s[20:23], s49 offen offset:2048 lds
    buffer_load_dwordx4 v35, s[20:23], s49 offen offset:3072 lds
    s_add_u32 m0, s46, 59392
    s_nop 0
    buffer_load_dwordx4 v36, s[20:23], s49 offen lds
    buffer_load_dwordx4 v37, s[20:23], s49 offen offset:1024 lds
    buffer_load_dwordx4 v38, s[20:23], s49 offen offset:2048 lds
    buffer_load_dwordx4 v39, s[20:23], s49 offen offset:3072 lds
    s_add_u32 m0, s46, 63488
    s_nop 0
    buffer_load_dwordx4 v40, s[20:23], s49 offen lds
    s_waitcnt vmcnt(19)
    s_barrier
    s_add_u32 m0, s46, 73728
    s_mov_b32 s49, 1216512
    buffer_load_dwordx4 v32, s[20:23], s49 offen lds
    buffer_load_dwordx4 v33, s[20:23], s49 offen offset:1024 lds
    buffer_load_dwordx4 v34, s[20:23], s49 offen offset:2048 lds
    buffer_load_dwordx4 v35, s[20:23], s49 offen offset:3072 lds
    s_add_u32 m0, s46, 77824
    s_nop 0
    buffer_load_dwordx4 v36, s[20:23], s49 offen lds
    buffer_load_dwordx4 v37, s[20:23], s49 offen offset:1024 lds
    buffer_load_dwordx4 v38, s[20:23], s49 offen offset:2048 lds
    buffer_load_dwordx4 v39, s[20:23], s49 offen offset:3072 lds
    s_add_u32 m0, s46, 81920
    s_nop 0
    buffer_load_dwordx4 v40, s[20:23], s49 offen lds
    s_waitcnt vmcnt(18)
    s_barrier
    s_add_u32 m0, s46, 0
    s_add_u32 s49, s90, 0
    buffer_load_dwordx4 v32, s[20:23], s49 offen lds
    buffer_load_dwordx4 v33, s[20:23], s49 offen offset:1024 lds
    buffer_load_dwordx4 v34, s[20:23], s49 offen offset:2048 lds
    buffer_load_dwordx4 v35, s[20:23], s49 offen offset:3072 lds
    s_add_u32 m0, s46, 4096
    s_nop 0
    buffer_load_dwordx4 v36, s[20:23], s49 offen lds
    buffer_load_dwordx4 v37, s[20:23], s49 offen offset:1024 lds
    buffer_load_dwordx4 v38, s[20:23], s49 offen offset:2048 lds
    buffer_load_dwordx4 v39, s[20:23], s49 offen offset:3072 lds
    s_add_u32 m0, s46, 8192
    s_nop 0
    buffer_load_dwordx4 v40, s[20:23], s49 offen lds
    s_waitcnt vmcnt(18)
    v_readfirstlane_b32 s41, v22
    s_nop 0
    s_cmp_lt_u32 s41, 56
    s_cbranch_scc1 L_spin
L_gok:
    s_barrier
    s_add_u32 m0, s46, 18432
    s_add_u32 s49, s90, 165888
    buffer_load_dwordx4 v32, s[20:23], s49 offen lds
    buffer_load_dwordx4 v33, s[20:23], s49 offen offset:1024 lds
    buffer_load_dwordx4 v34, s[20:23], s49 offen offset:2048 lds
    buffer_load_dwordx4 v35, s[20:23], s49 offen offset:3072 lds
    s_add_u32 m0, s46, 22528
    s_nop 0
    buffer_load_dwordx4 v36, s[20:23], s49 offen lds
    buffer_load_dwordx4 v37, s[20:23], s49 offen offset:1024 lds
    buffer_load_dwordx4 v38, s[20:23], s49 offen offset:2048 lds
    buffer_load_dwordx4 v39, s[20:23], s49 offen offset:3072 lds
    s_add_u32 m0, s46, 26624
    s_nop 0
    buffer_load_dwordx4 v40, s[20:23], s49 offen lds
    s_waitcnt vmcnt(18)
    s_barrier
    s_add_u32 m0, s47, 36864
    s_mov_b32 s49, 405504
    buffer_load_dwordx4 v42, s[20:23], s49 offen lds
    buffer_load_dwordx4 v43, s[20:23], s49 offen offset:1024 lds
    buffer_load_dwordx4 v44, s[20:23], s49 offen offset:2048 lds
    buffer_load_dwordx4 v45, s[20:23], s49 offen offset:3072 lds
    s_add_u32 m0, s47, 40960
    s_nop 0
    buffer_load_dwordx4 v46, s[20:23], s49 offen lds
    s_waitcnt vmcnt(14)
    s_barrier
    s_add_u32 m0, s46, 55296
    s_add_u32 s49, s90, 829440
    buffer_load_dwordx4 v32, s[20:23], s49 offen lds
    buffer_load_dwordx4 v33, s[20:23], s49 offen offset:1024 lds
    buffer_load_dwordx4 v34, s[20:23], s49 offen offset:2048 lds
    buffer_load_dwordx4 v35, s[20:23], s49 offen offset:3072 lds
    s_add_u32 m0, s46, 59392
    s_nop 0
    buffer_load_dwordx4 v36, s[20:23], s49 offen lds
    buffer_load_dwordx4 v37, s[20:23], s49 offen offset:1024 lds
    buffer_load_dwordx4 v38, s[20:23], s49 offen offset:2048 lds
    buffer_load_dwordx4 v39, s[20:23], s49 offen offset:3072 lds
    s_add_u32 m0, s46, 63488
    s_nop 0
    buffer_load_dwordx4 v40, s[20:23], s49 offen lds
    s_waitcnt vmcnt(14)
    s_barrier
    s_add_u32 m0, s46, 73728
    s_add_u32 s49, s90, 995328
    buffer_load_dwordx4 v32, s[20:23], s49 offen lds
    buffer_load_dwordx4 v33, s[20:23], s49 offen offset:1024 lds
    buffer_load_dwordx4 v34, s[20:23], s49 offen offset:2048 lds
    buffer_load_dwordx4 v35, s[20:23], s49 offen offset:3072 lds
    s_add_u32 m0, s46, 77824
    s_nop 0
    buffer_load_dwordx4 v36, s[20:23], s49 offen lds
    buffer_load_dwordx4 v37, s[20:23], s49 offen offset:1024 lds
    buffer_load_dwordx4 v38, s[20:23], s49 offen offset:2048 lds
    buffer_load_dwordx4 v39, s[20:23], s49 offen offset:3072 lds
    s_add_u32 m0, s46, 81920
    s_nop 0
    buffer_load_dwordx4 v40, s[20:23], s49 offen lds
    s_waitcnt vmcnt(18)
    s_barrier
    s_add_u32 m0, s47, 0
    s_mov_b32 s49, 1234944
    buffer_load_dwordx4 v42, s[20:23], s49 offen lds
    buffer_load_dwordx4 v43, s[20:23], s49 offen offset:1024 lds
    buffer_load_dwordx4 v44, s[20:23], s49 offen offset:2048 lds
    buffer_load_dwordx4 v45, s[20:23], s49 offen offset:3072 lds
    s_add_u32 m0, s47, 4096
    s_nop 0
    buffer_load_dwordx4 v46, s[20:23], s49 offen lds
    s_waitcnt vmcnt(14)
    s_barrier
    s_add_u32 m0, s46, 18432
    s_mov_b32 s49, 0
    buffer_load_dwordx4 v32, s[24:27], s49 offen sc1 lds
    buffer_load_dwordx4 v33, s[24:27], s49 offen offset:1024 sc1 lds
    buffer_load_dwordx4 v34, s[24:27], s49 offen offset:2048 sc1 lds
    buffer_load_dwordx4 v35, s[24:27], s49 offen offset:3072 sc1 lds
    s_add_u32 m0, s46, 22528
    s_nop 0
    buffer_load_dwordx4 v36, s[24:27], s49 offen sc1 lds
    buffer_load_dwordx4 v37, s[24:27], s49 offen offset:1024 sc1 lds
    buffer_load_dwordx4 v38, s[24:27], s49 offen offset:2048 sc1 lds
    buffer_load_dwordx4 v39, s[24:27], s49 offen offset:3072 sc1 lds
    s_add_u32 m0, s46, 26624
    s_nop 0
    buffer_load_dwordx4 v40, s[24:27], s49 offen sc1 lds
    s_waitcnt vmcnt(14)
    s_barrier
    s_add_u32 m0, s46, 36864
    s_mov_b32 s49, 82944
    buffer_load_dwordx4 v32, s[24:27], s49 offen sc1 lds
    buffer_load_dwordx4 v33, s[24:27], s49 offen offset:1024 sc1 lds
    buffer_load_dwordx4 v34, s[24:27], s49 offen offset:2048 sc1 lds
    buffer_load_dwordx4 v35, s[24:27], s49 offen offset:3072 sc1 lds
    s_add_u32 m0, s46, 40960
    s_nop 0
    buffer_load_dwordx4 v36, s[24:27], s49 offen sc1 lds
    buffer_load_dwordx4 v37, s[24:27], s49 offen offset:1024 sc1 lds
    buffer_load_dwordx4 v38, s[24:27], s49 offen offset:2048 sc1 lds
    buffer_load_dwordx4 v39, s[24:27], s49 offen offset:3072 sc1 lds
    s_add_u32 m0, s46, 45056
    s_nop 0
    buffer_load_dwordx4 v40, s[24:27], s49 offen sc1 lds
    s_waitcnt vmcnt(18)
    s_barrier
    s_add_u32 m0, s46, 55296
    s_mov_b32 s49, 165888
    buffer_load_dwordx4 v32, s[24:27], s49 offen sc1 lds
    buffer_load_dwordx4 v33, s[24:27], s49 offen offset:1024 sc1 lds
    buffer_load_dwordx4 v34, s[24:27], s49 offen offset:2048 sc1 lds
    buffer_load_dwordx4 v35, s[24:27], s49 offen offset:3072 sc1 lds
    s_add_u32 m0, s46, 59392
    s_nop 0
    buffer_load_dwordx4 v36, s[24:27], s49 offen sc1 lds
    buffer_load_dwordx4 v37, s[24:27], s49 offen offset:1024 sc1 lds
    buffer_load_dwordx4 v38, s[24:27], s49 offen offset:2048 sc1 lds
    buffer_load_dwordx4 v39, s[24:27], s49 offen offset:3072 sc1 lds
    s_add_u32 m0, s46, 63488
    s_nop 0
    buffer_load_dwordx4 v40, s[24:27], s49 offen sc1 lds
    s_waitcnt vmcnt(18)
    s_barrier
    s_add_u32 m0, s46, 73728
    s_mov_b32 s49, 248832
    buffer_load_dwordx4 v32, s[24:27], s49 offen sc1 lds
    buffer_load_dwordx4 v33, s[24:27], s49 offen offset:1024 sc1 lds
    buffer_load_dwordx4 v34, s[24:27], s49 offen offset:2048 sc1 lds
    buffer_load_dwordx4 v35, s[24:27], s49 offen offset:3072 sc1 lds
    s_add_u32 m0, s46, 77824
    s_nop 0
    buffer_load_dwordx4 v36, s[24:27], s49 offen sc1 lds
    buffer_load_dwordx4 v37, s[24:27], s49 offen offset:1024 sc1 lds
    buffer_load_dwordx4 v38, s[24:27], s49 offen offset:2048 sc1 lds
    buffer_load_dwordx4 v39, s[24:27], s49 offen offset:3072 sc1 lds
    s_add_u32 m0, s46, 81920
    s_nop 0
    buffer_load_dwordx4 v40, s[24:27], s49 offen sc1 lds
    s_waitcnt vmcnt(18)
    s_barrier
    s_add_u32 m0, s46, 0
    s_mov_b32 s49, 331776
    buffer_load_dwordx4 v32, s[24:27], s49 offen sc1 lds
    buffer_load_dwordx4 v33, s[24:27], s49 offen offset:1024 sc1 lds
    buffer_load_dwordx4 v34, s[24:27], s49 offen offset:2048 sc1 lds
    buffer_load_dwordx4 v35, s[24:27], s49 offen offset:3072 sc1 lds
    s_add_u32 m0, s46, 4096
    s_nop 0
    buffer_load_dwordx4 v36, s[24:27], s49 offen sc1 lds
    buffer_load_dwordx4 v37, s[24:27], s49 offen offset:1024 sc1 lds
    buffer_load_dwordx4 v38, s[24:27], s49 offen offset:2048 sc1 lds
    buffer_load_dwordx4 v39, s[24:27], s49 offen offset:3072 sc1 lds
    s_add_u32 m0, s46, 8192
    s_nop 0
    buffer_load_dwordx4 v40, s[24:27], s49 offen sc1 lds
    s_waitcnt vmcnt(18)
    s_barrier
    s_add_u32 m0, s46, 18432
    s_mov_b32 s49, 414720
    buffer_load_dwordx4 v32, s[24:27], s49 offen sc1 lds
    buffer_load_dwordx4 v33, s[24:27], s49 offen offset:1024 sc1 lds
    buffer_load_dwordx4 v34, s[24:27], s49 offen offset:2048 sc1 lds
    buffer_load_dwordx4 v35, s[24:27], s49 offen offset:3072 sc1 lds
    s_add_u32 m0, s46, 22528
    s_nop 0
    buffer_load_dwordx4 v36, s[24:27], s49 offen sc1 lds
    buffer_load_dwordx4 v37, s[24:27], s49 offen offset:1024 sc1 lds
    buffer_load_dwordx4 v38, s[24:27], s49 offen offset:2048 sc1 lds
    buffer_load_dwordx4 v39, s[24:27], s49 offen offset:3072 sc1 lds
    s_add_u32 m0, s46, 26624
    s_nop 0
    buffer_load_dwordx4 v40, s[24:27], s49 offen sc1 lds
    s_waitcnt vmcnt(18)
    s_barrier
    s_add_u32 m0, s46, 36864
    s_mov_b32 s49, 497664
    buffer_load_dwordx4 v32, s[24:27], s49 offen sc1 lds
    buffer_load_dwordx4 v33, s[24:27], s49 offen offset:1024 sc1 lds
    buffer_load_dwordx4 v34, s[24:27], s49 offen offset:2048 sc1 lds
    buffer_load_dwordx4 v35, s[24:27], s49 offen offset:3072 sc1 lds
    s_add_u32 m0, s46, 40960
    s_nop 0
    buffer_load_dwordx4 v36, s[24:27], s49 offen sc1 lds
    buffer_load_dwordx4 v37, s[24:27], s49 offen offset:1024 sc1 lds
    buffer_load_dwordx4 v38, s[24:27], s49 offen offset:2048 sc1 lds
    buffer_load_dwordx4 v39, s[24:27], s49 offen offset:3072 sc1 lds
    s_add_u32 m0, s46, 45056
    s_nop 0
    buffer_load_dwordx4 v40, s[24:27], s49 offen sc1 lds
    s_waitcnt vmcnt(18)
    s_barrier
    s_add_u32 m0, s46, 55296
    s_mov_b32 s49, 580608
    buffer_load_dwordx4 v32, s[24:27], s49 offen sc1 lds
    buffer_load_dwordx4 v33, s[24:27], s49 offen offset:1024 sc1 lds
    buffer_load_dwordx4 v34, s[24:27], s49 offen offset:2048 sc1 lds
    buffer_load_dwordx4 v35, s[24:27], s49 offen offset:3072 sc1 lds
    s_add_u32 m0, s46, 59392
    s_nop 0
    buffer_load_dwordx4 v36, s[24:27], s49 offen sc1 lds
    buffer_load_dwordx4 v37, s[24:27], s49 offen offset:1024 sc1 lds
    buffer_load_dwordx4 v38, s[24:27], s49 offen offset:2048 sc1 lds
    buffer_load_dwordx4 v39, s[24:27], s49 offen offset:3072 sc1 lds
    s_add_u32 m0, s46, 63488
    s_nop 0
    buffer_load_dwordx4 v40, s[24:27], s49 offen sc1 lds
    s_waitcnt vmcnt(18)
    s_barrier
    s_add_u32 m0, s46, 73728
    s_mov_b32 s49, 663552
    buffer_load_dwordx4 v32, s[24:27], s49 offen sc1 lds
    buffer_load_dwordx4 v33, s[24:27], s49 offen offset:1024 sc1 lds
    buffer_load_dwordx4 v34, s[24:27], s49 offen offset:2048 sc1 lds
    buffer_load_dwordx4 v35, s[24:27], s49 offen offset:3072 sc1 lds
    s_add_u32 m0, s46, 77824
    s_nop 0
    buffer_load_dwordx4 v36, s[24:27], s49 offen sc1 lds
    buffer_load_dwordx4 v37, s[24:27], s49 offen offset:1024 sc1 lds
    buffer_load_dwordx4 v38, s[24:27], s49 offen offset:2048 sc1 lds
    buffer_load_dwordx4 v39, s[24:27], s49 offen offset:3072 sc1 lds
    s_add_u32 m0, s46, 81920
    s_nop 0
    buffer_load_dwordx4 v40, s[24:27], s49 offen sc1 lds
    s_waitcnt vmcnt(18)
    s_barrier
    s_add_u32 m0, s46, 0
    s_mov_b32 s49, 746496
    buffer_load_dwordx4 v32, s[24:27], s49 offen sc1 lds
    buffer_load_dwordx4 v33, s[24:27], s49 offen offset:1024 sc1 lds
    buffer_load_dwordx4 v34, s[24:27], s49 offen offset:2048 sc1 lds
    buffer_load_dwordx4 v35, s[24:27], s49 offen offset:3072 sc1 lds
    s_add_u32 m0, s46, 4096
    s_nop 0
    buffer_load_dwordx4 v36, s[24:27], s49 offen sc1 lds
    buffer_load_dwordx4 v37, s[24:27], s49 offen offset:1024 sc1 lds
    buffer_load_dwordx4 v38, s[24:27], s49 offen offset:2048 sc1 lds
    buffer_load_dwordx4 v39, s[24:27], s49 offen offset:3072 sc1 lds
    s_add_u32 m0, s46, 8192
    s_nop 0
    buffer_load_dwordx4 v40, s[24:27], s49 offen sc1 lds
    s_waitcnt vmcnt(18)
    s_barrier
    s_add_u32 m0, s46, 18432
    s_mov_b32 s49, 18432
    buffer_load_dwordx4 v32, s[24:27], s49 offen sc1 lds
    buffer_load_dwordx4 v33, s[24:27], s49 offen offset:1024 sc1 lds
    buffer_load_dwordx4 v34, s[24:27], s49 offen offset:2048 sc1 lds
    buffer_load_dwordx4 v35, s[24:27], s49 offen offset:3072 sc1 lds
    s_add_u32 m0, s46, 22528
    s_nop 0
    buffer_load_dwordx4 v36, s[24:27], s49 offen sc1 lds
    buffer_load_dwordx4 v37, s[24:27], s49 offen offset:1024 sc1 lds
    buffer_load_dwordx4 v38, s[24:27], s49 offen offset:2048 sc1 lds
    buffer_load_dwordx4 v39, s[24:27], s49 offen offset:3072 sc1 lds
    s_add_u32 m0, s46, 26624
    s_nop 0
    buffer_load_dwordx4 v40, s[24:27], s49 offen sc1 lds
    s_waitcnt vmcnt(18)
    s_barrier
    s_add_u32 m0, s46, 36864
    s_mov_b32 s49, 101376
    buffer_load_dwordx4 v32, s[24:27], s49 offen sc1 lds
    buffer_load_dwordx4 v33, s[24:27], s49 offen offset:1024 sc1 lds
    buffer_load_dwordx4 v34, s[24:27], s49 offen offset:2048 sc1 lds
    buffer_load_dwordx4 v35, s[24:27], s49 offen offset:3072 sc1 lds
    s_add_u32 m0, s46, 40960
    s_nop 0
    buffer_load_dwordx4 v36, s[24:27], s49 offen sc1 lds
    buffer_load_dwordx4 v37, s[24:27], s49 offen offset:1024 sc1 lds
    buffer_load_dwordx4 v38, s[24:27], s49 offen offset:2048 sc1 lds
    buffer_load_dwordx4 v39, s[24:27], s49 offen offset:3072 sc1 lds
    s_add_u32 m0, s46, 45056
    s_nop 0
    buffer_load_dwordx4 v40, s[24:27], s49 offen sc1 lds
    s_waitcnt vmcnt(18)
    s_barrier
    s_add_u32 m0, s46, 55296
    s_mov_b32 s49, 184320
    buffer_load_dwordx4 v32, s[24:27], s49 offen sc1 lds
    buffer_load_dwordx4 v33, s[24:27], s49 offen offset:1024 sc1 lds
    buffer_load_dwordx4 v34, s[24:27], s49 offen offset:2048 sc1 lds
    buffer_load_dwordx4 v35, s[24:27], s49 offen offset:3072 sc1 lds
    s_add_u32 m0, s46, 59392
    s_nop 0
    buffer_load_dwordx4 v36, s[24:27], s49 offen sc1 lds
    buffer_load_dwordx4 v37, s[24:27], s49 offen offset:1024 sc1 lds
    buffer_load_dwordx4 v38, s[24:27], s49 offen offset:2048 sc1 lds
    buffer_load_dwordx4 v39, s[24:27], s49 offen offset:3072 sc1 lds
    s_add_u32 m0, s46, 63488
    s_nop 0
    buffer_load_dwordx4 v40, s[24:27], s49 offen sc1 lds
    s_waitcnt vmcnt(18)
    s_barrier
    s_add_u32 m0, s46, 73728
    s_mov_b32 s49, 267264
    buffer_load_dwordx4 v32, s[24:27], s49 offen sc1 lds
    buffer_load_dwordx4 v33, s[24:27], s49 offen offset:1024 sc1 lds
    buffer_load_dwordx4 v34, s[24:27], s49 offen offset:2048 sc1 lds
    buffer_load_dwordx4 v35, s[24:27], s49 offen offset:3072 sc1 lds
    s_add_u32 m0, s46, 77824
    s_nop 0
    buffer_load_dwordx4 v36, s[24:27], s49 offen sc1 lds
    buffer_load_dwordx4 v37, s[24:27], s49 offen offset:1024 sc1 lds
    buffer_load_dwordx4 v38, s[24:27], s49 offen offset:2048 sc1 lds
    buffer_load_dwordx4 v39, s[24:27], s49 offen offset:3072 sc1 lds
    s_add_u32 m0, s46, 81920
    s_nop 0
    buffer_load_dwordx4 v40, s[24:27], s49 offen sc1 lds
    s_waitcnt vmcnt(18)
    s_barrier
    s_add_u32 m0, s46, 0
    s_mov_b32 s49, 350208
    buffer_load_dwordx4 v32, s[24:27], s49 offen sc1 lds
    buffer_load_dwordx4 v33, s[24:27], s49 offen offset:1024 sc1 lds
    buffer_load_dwordx4 v34, s[24:27], s49 offen offset:2048 sc1 lds
    buffer_load_dwordx4 v35, s[24:27], s49 offen offset:3072 sc1 lds
    s_add_u32 m0, s46, 4096
    s_nop 0
    buffer_load_dwordx4 v36, s[24:27], s49 offen sc1 lds
    buffer_load_dwordx4 v37, s[24:27], s49 offen offset:1024 sc1 lds
    buffer_load_dwordx4 v38, s[24:27], s49 offen offset:2048 sc1 lds
    buffer_load_dwordx4 v39, s[24:27], s49 offen offset:3072 sc1 lds
    s_add_u32 m0, s46, 8192
    s_nop 0
    buffer_load_dwordx4 v40, s[24:27], s49 offen sc1 lds
    s_waitcnt vmcnt(18)
    s_barrier
    s_add_u32 m0, s46, 18432
    s_mov_b32 s49, 433152
    buffer_load_dwordx4 v32, s[24:27], s49 offen sc1 lds
    buffer_load_dwordx4 v33, s[24:27], s49 offen offset:1024 sc1 lds
    buffer_load_dwordx4 v34, s[24:27], s49 offen offset:2048 sc1 lds
    buffer_load_dwordx4 v35, s[24:27], s49 offen offset:3072 sc1 lds
    s_add_u32 m0, s46, 22528
    s_nop 0
    buffer_load_dwordx4 v36, s[24:27], s49 offen sc1 lds
    buffer_load_dwordx4 v37, s[24:27], s49 offen offset:1024 sc1 lds
    buffer_load_dwordx4 v38, s[24:27], s49 offen offset:2048 sc1 lds
    buffer_load_dwordx4 v39, s[24:27], s49 offen offset:3072 sc1 lds
    s_add_u32 m0, s46, 26624
    s_nop 0
    buffer_load_dwordx4 v40, s[24:27], s49 offen sc1 lds
    s_waitcnt vmcnt(18)
    s_barrier
    s_add_u32 m0, s46, 36864
    s_mov_b32 s49, 516096
    buffer_load_dwordx4 v32, s[24:27], s49 offen sc1 lds
    buffer_load_dwordx4 v33, s[24:27], s49 offen offset:1024 sc1 lds
    buffer_load_dwordx4 v34, s[24:27], s49 offen offset:2048 sc1 lds
    buffer_load_dwordx4 v35, s[24:27], s49 offen offset:3072 sc1 lds
    s_add_u32 m0, s46, 40960
    s_nop 0
    buffer_load_dwordx4 v36, s[24:27], s49 offen sc1 lds
    buffer_load_dwordx4 v37, s[24:27], s49 offen offset:1024 sc1 lds
    buffer_load_dwordx4 v38, s[24:27], s49 offen offset:2048 sc1 lds
    buffer_load_dwordx4 v39, s[24:27], s49 offen offset:3072 sc1 lds
    s_add_u32 m0, s46, 45056
    s_nop 0
    buffer_load_dwordx4 v40, s[24:27], s49 offen sc1 lds
    s_waitcnt vmcnt(18)
    s_barrier
    s_add_u32 m0, s46, 55296
    s_mov_b32 s49, 599040
    buffer_load_dwordx4 v32, s[24:27], s49 offen sc1 lds
    buffer_load_dwordx4 v33, s[24:27], s49 offen offset:1024 sc1 lds
    buffer_load_dwordx4 v34, s[24:27], s49 offen offset:2048 sc1 lds
    buffer_load_dwordx4 v35, s[24:27], s49 offen offset:3072 sc1 lds
    s_add_u32 m0, s46, 59392
    s_nop 0
    buffer_load_dwordx4 v36, s[24:27], s49 offen sc1 lds
    buffer_load_dwordx4 v37, s[24:27], s49 offen offset:1024 sc1 lds
    buffer_load_dwordx4 v38, s[24:27], s49 offen offset:2048 sc1 lds
    buffer_load_dwordx4 v39, s[24:27], s49 offen offset:3072 sc1 lds
    s_add_u32 m0, s46, 63488
    s_nop 0
    buffer_load_dwordx4 v40, s[24:27], s49 offen sc1 lds
    s_waitcnt vmcnt(18)
    s_barrier
    s_add_u32 m0, s46, 73728
    s_mov_b32 s49, 681984
    buffer_load_dwordx4 v32, s[24:27], s49 offen sc1 lds
    buffer_load_dwordx4 v33, s[24:27], s49 offen offset:1024 sc1 lds
    buffer_load_dwordx4 v34, s[24:27], s49 offen offset:2048 sc1 lds
    buffer_load_dwordx4 v35, s[24:27], s49 offen offset:3072 sc1 lds
    s_add_u32 m0, s46, 77824
    s_nop 0
    buffer_load_dwordx4 v36, s[24:27], s49 offen sc1 lds
    buffer_load_dwordx4 v37, s[24:27], s49 offen offset:1024 sc1 lds
    buffer_load_dwordx4 v38, s[24:27], s49 offen offset:2048 sc1 lds
    buffer_load_dwordx4 v39, s[24:27], s49 offen offset:3072 sc1 lds
    s_add_u32 m0, s46, 81920
    s_nop 0
    buffer_load_dwordx4 v40, s[24:27], s49 offen sc1 lds
    s_waitcnt vmcnt(18)
    s_barrier
    s_add_u32 m0, s46, 0
    s_mov_b32 s49, 764928
    buffer_load_dwordx4 v32, s[24:27], s49 offen sc1 lds
    buffer_load_dwordx4 v33, s[24:27], s49 offen offset:1024 sc1 lds
    buffer_load_dwordx4 v34, s[24:27], s49 offen offset:2048 sc1 lds
    buffer_load_dwordx4 v35, s[24:27], s49 offen offset:3072 sc1 lds
    s_add_u32 m0, s46, 4096
    s_nop 0
    buffer_load_dwordx4 v36, s[24:27], s49 offen sc1 lds
    buffer_load_dwordx4 v37, s[24:27], s49 offen offset:1024 sc1 lds
    buffer_load_dwordx4 v38, s[24:27], s49 offen offset:2048 sc1 lds
    buffer_load_dwordx4 v39, s[24:27], s49 offen offset:3072 sc1 lds
    s_add_u32 m0, s46, 8192
    s_nop 0
    buffer_load_dwordx4 v40, s[24:27], s49 offen sc1 lds
    s_waitcnt vmcnt(18)
    s_barrier
    s_add_u32 m0, s46, 18432
    s_mov_b32 s49, 36864
    buffer_load_dwordx4 v32, s[24:27], s49 offen sc1 lds
    buffer_load_dwordx4 v33, s[24:27], s49 offen offset:1024 sc1 lds
    buffer_load_dwordx4 v34, s[24:27], s49 offen offset:2048 sc1 lds
    buffer_load_dwordx4 v35, s[24:27], s49 offen offset:3072 sc1 lds
    s_add_u32 m0, s46, 22528
    s_nop 0
    buffer_load_dwordx4 v36, s[24:27], s49 offen sc1 lds
    buffer_load_dwordx4 v37, s[24:27], s49 offen offset:1024 sc1 lds
    buffer_load_dwordx4 v38, s[24:27], s49 offen offset:2048 sc1 lds
    buffer_load_dwordx4 v39, s[24:27], s49 offen offset:3072 sc1 lds
    s_add_u32 m0, s46, 26624
    s_nop 0
    buffer_load_dwordx4 v40, s[24:27], s49 offen sc1 lds
    s_waitcnt vmcnt(18)
    s_barrier
    s_add_u32 m0, s46, 36864
    s_mov_b32 s49, 119808
    buffer_load_dwordx4 v32, s[24:27], s49 offen sc1 lds
    buffer_load_dwordx4 v33, s[24:27], s49 offen offset:1024 sc1 lds
    buffer_load_dwordx4 v34, s[24:27], s49 offen offset:2048 sc1 lds
    buffer_load_dwordx4 v35, s[24:27], s49 offen offset:3072 sc1 lds
    s_add_u32 m0, s46, 40960
    s_nop 0
    buffer_load_dwordx4 v36, s[24:27], s49 offen sc1 lds
    buffer_load_dwordx4 v37, s[24:27], s49 offen offset:1024 sc1 lds
    buffer_load_dwordx4 v38, s[24:27], s49 offen offset:2048 sc1 lds
    buffer_load_dwordx4 v39, s[24:27], s49 offen offset:3072 sc1 lds
    s_add_u32 m0, s46, 45056
    s_nop 0
    buffer_load_dwordx4 v40, s[24:27], s49 offen sc1 lds
    s_waitcnt vmcnt(18)
    s_barrier
    s_add_u32 m0, s46, 55296
    s_mov_b32 s49, 202752
    buffer_load_dwordx4 v32, s[24:27], s49 offen sc1 lds
    buffer_load_dwordx4 v33, s[24:27], s49 offen offset:1024 sc1 lds
    buffer_load_dwordx4 v34, s[24:27], s49 offen offset:2048 sc1 lds
    buffer_load_dwordx4 v35, s[24:27], s49 offen offset:3072 sc1 lds
    s_add_u32 m0, s46, 59392
    s_nop 0
    buffer_load_dwordx4 v36, s[24:27], s49 offen sc1 lds
    buffer_load_dwordx4 v37, s[24:27], s49 offen offset:1024 sc1 lds
    buffer_load_dwordx4 v38, s[24:27], s49 offen offset:2048 sc1 lds
    buffer_load_dwordx4 v39, s[24:27], s49 offen offset:3072 sc1 lds
    s_add_u32 m0, s46, 63488
    s_nop 0
    buffer_load_dwordx4 v40, s[24:27], s49 offen sc1 lds
    s_waitcnt vmcnt(18)
    s_barrier
    s_add_u32 m0, s46, 73728
    s_mov_b32 s49, 285696
    buffer_load_dwordx4 v32, s[24:27], s49 offen sc1 lds
    buffer_load_dwordx4 v33, s[24:27], s49 offen offset:1024 sc1 lds
    buffer_load_dwordx4 v34, s[24:27], s49 offen offset:2048 sc1 lds
    buffer_load_dwordx4 v35, s[24:27], s49 offen offset:3072 sc1 lds
    s_add_u32 m0, s46, 77824
    s_nop 0
    buffer_load_dwordx4 v36, s[24:27], s49 offen sc1 lds
    buffer_load_dwordx4 v37, s[24:27], s49 offen offset:1024 sc1 lds
    buffer_load_dwordx4 v38, s[24:27], s49 offen offset:2048 sc1 lds
    buffer_load_dwordx4 v39, s[24:27], s49 offen offset:3072 sc1 lds
    s_add_u32 m0, s46, 81920
    s_nop 0
    buffer_load_dwordx4 v40, s[24:27], s49 offen sc1 lds
    s_waitcnt vmcnt(18)
    s_barrier
    s_add_u32 m0, s46, 0
    s_mov_b32 s49, 368640
    buffer_load_dwordx4 v32, s[24:27], s49 offen sc1 lds
    buffer_load_dwordx4 v33, s[24:27], s49 offen offset:1024 sc1 lds
    buffer_load_dwordx4 v34, s[24:27], s49 offen offset:2048 sc1 lds
    buffer_load_dwordx4 v35, s[24:27], s49 offen offset:3072 sc1 lds
    s_add_u32 m0, s46, 4096
    s_nop 0
    buffer_load_dwordx4 v36, s[24:27], s49 offen sc1 lds
    buffer_load_dwordx4 v37, s[24:27], s49 offen offset:1024 sc1 lds
    buffer_load_dwordx4 v38, s[24:27], s49 offen offset:2048 sc1 lds
    buffer_load_dwordx4 v39, s[24:27], s49 offen offset:3072 sc1 lds
    s_add_u32 m0, s46, 8192
    s_nop 0
    buffer_load_dwordx4 v40, s[24:27], s49 offen sc1 lds
    s_waitcnt vmcnt(18)
    s_barrier
    s_add_u32 m0, s46, 18432
    s_mov_b32 s49, 451584
    buffer_load_dwordx4 v32, s[24:27], s49 offen sc1 lds
    buffer_load_dwordx4 v33, s[24:27], s49 offen offset:1024 sc1 lds
    buffer_load_dwordx4 v34, s[24:27], s49 offen offset:2048 sc1 lds
    buffer_load_dwordx4 v35, s[24:27], s49 offen offset:3072 sc1 lds
    s_add_u32 m0, s46, 22528
    s_nop 0
    buffer_load_dwordx4 v36, s[24:27], s49 offen sc1 lds
    buffer_load_dwordx4 v37, s[24:27], s49 offen offset:1024 sc1 lds
    buffer_load_dwordx4 v38, s[24:27], s49 offen offset:2048 sc1 lds
    buffer_load_dwordx4 v39, s[24:27], s49 offen offset:3072 sc1 lds
    s_add_u32 m0, s46, 26624
    s_nop 0
    buffer_load_dwordx4 v40, s[24:27], s49 offen sc1 lds
    s_waitcnt vmcnt(18)
    s_barrier
    s_add_u32 m0, s46, 36864
    s_mov_b32 s49, 534528
    buffer_load_dwordx4 v32, s[24:27], s49 offen sc1 lds
    buffer_load_dwordx4 v33, s[24:27], s49 offen offset:1024 sc1 lds
    buffer_load_dwordx4 v34, s[24:27], s49 offen offset:2048 sc1 lds
    buffer_load_dwordx4 v35, s[24:27], s49 offen offset:3072 sc1 lds
    s_add_u32 m0, s46, 40960
    s_nop 0
    buffer_load_dwordx4 v36, s[24:27], s49 offen sc1 lds
    buffer_load_dwordx4 v37, s[24:27], s49 offen offset:1024 sc1 lds
    buffer_load_dwordx4 v38, s[24:27], s49 offen offset:2048 sc1 lds
    buffer_load_dwordx4 v39, s[24:27], s49 offen offset:3072 sc1 lds
    s_add_u32 m0, s46, 45056
    s_nop 0
    buffer_load_dwordx4 v40, s[24:27], s49 offen sc1 lds
    s_waitcnt vmcnt(18)
    s_barrier
    s_add_u32 m0, s46, 55296
    s_mov_b32 s49, 617472
    buffer_load_dwordx4 v32, s[24:27], s49 offen sc1 lds
    buffer_load_dwordx4 v33, s[24:27], s49 offen offset:1024 sc1 lds
    buffer_load_dwordx4 v34, s[24:27], s49 offen offset:2048 sc1 lds
    buffer_load_dwordx4 v35, s[24:27], s49 offen offset:3072 sc1 lds
    s_add_u32 m0, s46, 59392
    s_nop 0
    buffer_load_dwordx4 v36, s[24:27], s49 offen sc1 lds
    buffer_load_dwordx4 v37, s[24:27], s49 offen offset:1024 sc1 lds
    buffer_load_dwordx4 v38, s[24:27], s49 offen offset:2048 sc1 lds
    buffer_load_dwordx4 v39, s[24:27], s49 offen offset:3072 sc1 lds
    s_add_u32 m0, s46, 63488
    s_nop 0
    buffer_load_dwordx4 v40, s[24:27], s49 offen sc1 lds
    s_waitcnt vmcnt(18)
    s_barrier
    s_add_u32 m0, s46, 73728
    s_mov_b32 s49, 700416
    buffer_load_dwordx4 v32, s[24:27], s49 offen sc1 lds
    buffer_load_dwordx4 v33, s[24:27], s49 offen offset:1024 sc1 lds
    buffer_load_dwordx4 v34, s[24:27], s49 offen offset:2048 sc1 lds
    buffer_load_dwordx4 v35, s[24:27], s49 offen offset:3072 sc1 lds
    s_add_u32 m0, s46, 77824
    s_nop 0
    buffer_load_dwordx4 v36, s[24:27], s49 offen sc1 lds
    buffer_load_dwordx4 v37, s[24:27], s49 offen offset:1024 sc1 lds
    buffer_load_dwordx4 v38, s[24:27], s49 offen offset:2048 sc1 lds
    buffer_load_dwordx4 v39, s[24:27], s49 offen offset:3072 sc1 lds
    s_add_u32 m0, s46, 81920
    s_nop 0
    buffer_load_dwordx4 v40, s[24:27], s49 offen sc1 lds
    s_waitcnt vmcnt(18)
    s_barrier
    s_add_u32 m0, s46, 0
    s_mov_b32 s49, 783360
    buffer_load_dwordx4 v32, s[24:27], s49 offen sc1 lds
    buffer_load_dwordx4 v33, s[24:27], s49 offen offset:1024 sc1 lds
    buffer_load_dwordx4 v34, s[24:27], s49 offen offset:2048 sc1 lds
    buffer_load_dwordx4 v35, s[24:27], s49 offen offset:3072 sc1 lds
    s_add_u32 m0, s46, 4096
    s_nop 0
    buffer_load_dwordx4 v36, s[24:27], s49 offen sc1 lds
    buffer_load_dwordx4 v37, s[24:27], s49 offen offset:1024 sc1 lds
    buffer_load_dwordx4 v38, s[24:27], s49 offen offset:2048 sc1 lds
    buffer_load_dwordx4 v39, s[24:27], s49 offen offset:3072 sc1 lds
    s_add_u32 m0, s46, 8192
    s_nop 0
    buffer_load_dwordx4 v40, s[24:27], s49 offen sc1 lds
    s_waitcnt vmcnt(18)
    s_barrier
    s_add_u32 m0, s46, 18432
    s_mov_b32 s49, 55296
    buffer_load_dwordx4 v32, s[24:27], s49 offen sc1 lds
    buffer_load_dwordx4 v33, s[24:27], s49 offen offset:1024 sc1 lds
    buffer_load_dwordx4 v34, s[24:27], s49 offen offset:2048 sc1 lds
    buffer_load_dwordx4 v35, s[24:27], s49 offen offset:3072 sc1 lds
    s_add_u32 m0, s46, 22528
    s_nop 0
    buffer_load_dwordx4 v36, s[24:27], s49 offen sc1 lds
    buffer_load_dwordx4 v37, s[24:27], s49 offen offset:1024 sc1 lds
    buffer_load_dwordx4 v38, s[24:27], s49 offen offset:2048 sc1 lds
    buffer_load_dwordx4 v39, s[24:27], s49 offen offset:3072 sc1 lds
    s_add_u32 m0, s46, 26624
    s_nop 0
    buffer_load_dwordx4 v40, s[24:27], s49 offen sc1 lds
    s_waitcnt vmcnt(18)
    s_barrier
    s_add_u32 m0, s46, 36864
    s_mov_b32 s49, 138240
    buffer_load_dwordx4 v32, s[24:27], s49 offen sc1 lds
    buffer_load_dwordx4 v33, s[24:27], s49 offen offset:1024 sc1 lds
    buffer_load_dwordx4 v34, s[24:27], s49 offen offset:2048 sc1 lds
    buffer_load_dwordx4 v35, s[24:27], s49 offen offset:3072 sc1 lds
    s_add_u32 m0, s46, 40960
    s_nop 0
    buffer_load_dwordx4 v36, s[24:27], s49 offen sc1 lds
    buffer_load_dwordx4 v37, s[24:27], s49 offen offset:1024 sc1 lds
    buffer_load_dwordx4 v38, s[24:27], s49 offen offset:2048 sc1 lds
    buffer_load_dwordx4 v39, s[24:27], s49 offen offset:3072 sc1 lds
    s_add_u32 m0, s46, 45056
    s_nop 0
    buffer_load_dwordx4 v40, s[24:27], s49 offen sc1 lds
    s_waitcnt vmcnt(18)
    s_barrier
    s_add_u32 m0, s46, 55296
    s_mov_b32 s49, 221184
    buffer_load_dwordx4 v32, s[24:27], s49 offen sc1 lds
    buffer_load_dwordx4 v33, s[24:27], s49 offen offset:1024 sc1 lds
    buffer_load_dwordx4 v34, s[24:27], s49 offen offset:2048 sc1 lds
    buffer_load_dwordx4 v35, s[24:27], s49 offen offset:3072 sc1 lds
    s_add_u32 m0, s46, 59392
    s_nop 0
    buffer_load_dwordx4 v36, s[24:27], s49 offen sc1 lds
    buffer_load_dwordx4 v37, s[24:27], s49 offen offset:1024 sc1 lds
    buffer_load_dwordx4 v38, s[24:27], s49 offen offset:2048 sc1 lds
    buffer_load_dwordx4 v39, s[24:27], s49 offen offset:3072 sc1 lds
    s_add_u32 m0, s46, 63488
    s_nop 0
    buffer_load_dwordx4 v40, s[24:27], s49 offen sc1 lds
    s_waitcnt vmcnt(18)
    s_barrier
    s_add_u32 m0, s46, 73728
    s_mov_b32 s49, 304128
    buffer_load_dwordx4 v32, s[24:27], s49 offen sc1 lds
    buffer_load_dwordx4 v33, s[24:27], s49 offen offset:1024 sc1 lds
    buffer_load_dwordx4 v34, s[24:27], s49 offen offset:2048 sc1 lds
    buffer_load_dwordx4 v35, s[24:27], s49 offen offset:3072 sc1 lds
    s_add_u32 m0, s46, 77824
    s_nop 0
    buffer_load_dwordx4 v36, s[24:27], s49 offen sc1 lds
    buffer_load_dwordx4 v37, s[24:27], s49 offen offset:1024 sc1 lds
    buffer_load_dwordx4 v38, s[24:27], s49 offen offset:2048 sc1 lds
    buffer_load_dwordx4 v39, s[24:27], s49 offen offset:3072 sc1 lds
    s_add_u32 m0, s46, 81920
    s_nop 0
    buffer_load_dwordx4 v40, s[24:27], s49 offen sc1 lds
    s_waitcnt vmcnt(18)
    s_barrier
    s_add_u32 m0, s46, 0
    s_mov_b32 s49, 387072
    buffer_load_dwordx4 v32, s[24:27], s49 offen sc1 lds
    buffer_load_dwordx4 v33, s[24:27], s49 offen offset:1024 sc1 lds
    buffer_load_dwordx4 v34, s[24:27], s49 offen offset:2048 sc1 lds
    buffer_load_dwordx4 v35, s[24:27], s49 offen offset:3072 sc1 lds
    s_add_u32 m0, s46, 4096
    s_nop 0
    buffer_load_dwordx4 v36, s[24:27], s49 offen sc1 lds
    buffer_load_dwordx4 v37, s[24:27], s49 offen offset:1024 sc1 lds
    buffer_load_dwordx4 v38, s[24:27], s49 offen offset:2048 sc1 lds
    buffer_load_dwordx4 v39, s[24:27], s49 offen offset:3072 sc1 lds
    s_add_u32 m0, s46, 8192
    s_nop 0
    buffer_load_dwordx4 v40, s[24:27], s49 offen sc1 lds
    s_waitcnt vmcnt(18)
    s_barrier
    s_add_u32 m0, s46, 18432
    s_mov_b32 s49, 470016
    buffer_load_dwordx4 v32, s[24:27], s49 offen sc1 lds
    buffer_load_dwordx4 v33, s[24:27], s49 offen offset:1024 sc1 lds
    buffer_load_dwordx4 v34, s[24:27], s49 offen offset:2048 sc1 lds
    buffer_load_dwordx4 v35, s[24:27], s49 offen offset:3072 sc1 lds
    s_add_u32 m0, s46, 22528
    s_nop 0
    buffer_load_dwordx4 v36, s[24:27], s49 offen sc1 lds
    buffer_load_dwordx4 v37, s[24:27], s49 offen offset:1024 sc1 lds
    buffer_load_dwordx4 v38, s[24:27], s49 offen offset:2048 sc1 lds
    buffer_load_dwordx4 v39, s[24:27], s49 offen offset:3072 sc1 lds
    s_add_u32 m0, s46, 26624
    s_nop 0
    buffer_load_dwordx4 v40, s[24:27], s49 offen sc1 lds
    s_waitcnt vmcnt(18)
    s_barrier
    s_add_u32 m0, s46, 36864
    s_mov_b32 s49, 552960
    buffer_load_dwordx4 v32, s[24:27], s49 offen sc1 lds
    buffer_load_dwordx4 v33, s[24:27], s49 offen offset:1024 sc1 lds
    buffer_load_dwordx4 v34, s[24:27], s49 offen offset:2048 sc1 lds
    buffer_load_dwordx4 v35, s[24:27], s49 offen offset:3072 sc1 lds
    s_add_u32 m0, s46, 40960
    s_nop 0
    buffer_load_dwordx4 v36, s[24:27], s49 offen sc1 lds
    buffer_load_dwordx4 v37, s[24:27], s49 offen offset:1024 sc1 lds
    buffer_load_dwordx4 v38, s[24:27], s49 offen offset:2048 sc1 lds
    buffer_load_dwordx4 v39, s[24:27], s49 offen offset:3072 sc1 lds
    s_add_u32 m0, s46, 45056
    s_nop 0
    buffer_load_dwordx4 v40, s[24:27], s49 offen sc1 lds
    s_waitcnt vmcnt(18)
    s_barrier
    s_add_u32 m0, s46, 55296
    s_mov_b32 s49, 635904
    buffer_load_dwordx4 v32, s[24:27], s49 offen sc1 lds
    buffer_load_dwordx4 v33, s[24:27], s49 offen offset:1024 sc1 lds
    buffer_load_dwordx4 v34, s[24:27], s49 offen offset:2048 sc1 lds
    buffer_load_dwordx4 v35, s[24:27], s49 offen offset:3072 sc1 lds
    s_add_u32 m0, s46, 59392
    s_nop 0
    buffer_load_dwordx4 v36, s[24:27], s49 offen sc1 lds
    buffer_load_dwordx4 v37, s[24:27], s49 offen offset:1024 sc1 lds
    buffer_load_dwordx4 v38, s[24:27], s49 offen offset:2048 sc1 lds
    buffer_load_dwordx4 v39, s[24:27], s49 offen offset:3072 sc1 lds
    s_add_u32 m0, s46, 63488
    s_nop 0
    buffer_load_dwordx4 v40, s[24:27], s49 offen sc1 lds
    s_waitcnt vmcnt(18)
    s_barrier
    s_add_u32 m0, s46, 73728
    s_mov_b32 s49, 718848
    buffer_load_dwordx4 v32, s[24:27], s49 offen sc1 lds
    buffer_load_dwordx4 v33, s[24:27], s49 offen offset:1024 sc1 lds
    buffer_load_dwordx4 v34, s[24:27], s49 offen offset:2048 sc1 lds
    buffer_load_dwordx4 v35, s[24:27], s49 offen offset:3072 sc1 lds
    s_add_u32 m0, s46, 77824
    s_nop 0
    buffer_load_dwordx4 v36, s[24:27], s49 offen sc1 lds
    buffer_load_dwordx4 v37, s[24:27], s49 offen offset:1024 sc1 lds
    buffer_load_dwordx4 v38, s[24:27], s49 offen offset:2048 sc1 lds
    buffer_load_dwordx4 v39, s[24:27], s49 offen offset:3072 sc1 lds
    s_add_u32 m0, s46, 81920
    s_nop 0
    buffer_load_dwordx4 v40, s[24:27], s49 offen sc1 lds
    s_waitcnt vmcnt(18)
    s_barrier
    s_add_u32 m0, s46, 0
    s_mov_b32 s49, 801792
    buffer_load_dwordx4 v32, s[24:27], s49 offen sc1 lds
    buffer_load_dwordx4 v33, s[24:27], s49 offen offset:1024 sc1 lds
    buffer_load_dwordx4 v34, s[24:27], s49 offen offset:2048 sc1 lds
    buffer_load_dwordx4 v35, s[24:27], s49 offen offset:3072 sc1 lds
    s_add_u32 m0, s46, 4096
    s_nop 0
    buffer_load_dwordx4 v36, s[24:27], s49 offen sc1 lds
    buffer_load_dwordx4 v37, s[24:27], s49 offen offset:1024 sc1 lds
    buffer_load_dwordx4 v38, s[24:27], s49 offen offset:2048 sc1 lds
    buffer_load_dwordx4 v39, s[24:27], s49 offen offset:3072 sc1 lds
    s_add_u32 m0, s46, 8192
    s_nop 0
    buffer_load_dwordx4 v40, s[24:27], s49 offen sc1 lds
    s_waitcnt vmcnt(18)
    s_barrier
    s_add_u32 m0, s46, 18432
    s_add_u32 s49, s90, 0
    buffer_load_dwordx4 v32, s[24:27], s49 offen sc1 lds
    buffer_load_dwordx4 v33, s[24:27], s49 offen offset:1024 sc1 lds
    buffer_load_dwordx4 v34, s[24:27], s49 offen offset:2048 sc1 lds
    buffer_load_dwordx4 v35, s[24:27], s49 offen offset:3072 sc1 lds
    s_add_u32 m0, s46, 22528
    s_nop 0
    buffer_load_dwordx4 v36, s[24:27], s49 offen sc1 lds
    buffer_load_dwordx4 v37, s[24:27], s49 offen offset:1024 sc1 lds
    buffer_load_dwordx4 v38, s[24:27], s49 offen offset:2048 sc1 lds
    buffer_load_dwordx4 v39, s[24:27], s49 offen offset:3072 sc1 lds
    s_add_u32 m0, s46, 26624
    s_nop 0
    buffer_load_dwordx4 v40, s[24:27], s49 offen sc1 lds
    s_waitcnt vmcnt(18)
    s_barrier
    s_add_u32 m0, s46, 36864
    s_add_u32 s49, s90, 165888
    buffer_load_dwordx4 v32, s[24:27], s49 offen sc1 lds
    buffer_load_dwordx4 v33, s[24:27], s49 offen offset:1024 sc1 lds
    buffer_load_dwordx4 v34, s[24:27], s49 offen offset:2048 sc1 lds
    buffer_load_dwordx4 v35, s[24:27], s49 offen offset:3072 sc1 lds
    s_add_u32 m0, s46, 40960
    s_nop 0
    buffer_load_dwordx4 v36, s[24:27], s49 offen sc1 lds
    buffer_load_dwordx4 v37, s[24:27], s49 offen offset:1024 sc1 lds
    buffer_load_dwordx4 v38, s[24:27], s49 offen offset:2048 sc1 lds
    buffer_load_dwordx4 v39, s[24:27], s49 offen offset:3072 sc1 lds
    s_add_u32 m0, s46, 45056
    s_nop 0
    buffer_load_dwordx4 v40, s[24:27], s49 offen sc1 lds
    s_waitcnt vmcnt(18)
    s_barrier
    s_add_u32 m0, s47, 55296
    s_mov_b32 s49, 405504
    buffer_load_dwordx4 v42, s[24:27], s49 offen sc1 lds
    v_lshlrev_b32 v29, 4, v0
    buffer_load_dwordx4 v43, s[24:27], s49 offen offset:1024 sc1 lds
    buffer_load_dwordx4 v44, s[24:27], s49 offen offset:2048 sc1 lds
    s_lshl_b32 s44, s38, 10
    buffer_load_dwordx4 v45, s[24:27], s49 offen offset:3072 sc1 lds
    s_add_u32 m0, s47, 59392
    s_nop 0
    buffer_load_dwordx4 v46, s[24:27], s49 offen sc1 lds
    s_waitcnt vmcnt(14)
    s_barrier
    s_add_u32 m0, s46, 73728
    s_add_u32 s49, s90, 414720
    buffer_load_dwordx4 v32, s[24:27], s49 offen sc1 lds
    s_lshr_b32 s41, s38, 1
    s_and_b32 s42, s38, 1
    buffer_load_dwordx4 v33, s[24:27], s49 offen offset:1024 sc1 lds
    s_mul_i32 s43, s41, 4608
    v_lshlrev_b32 v166, 4, v0
    buffer_load_dwordx4 v34, s[24:27], s49 offen offset:2048 sc1 lds
    v_add_u32 v216, s43, v166
    s_add_u32 s43, s43, 4096
    buffer_load_dwordx4 v35, s[24:27], s49 offen offset:3072 sc1 lds
    v_lshlrev_b32 v166, 3, v0
    s_add_u32 m0, s46, 77824
    s_nop 0
    buffer_load_dwordx4 v36, s[24:27], s49 offen sc1 lds
    v_add_u32 v217, s43, v166
    s_mul_i32 s42, s42, 160
    buffer_load_dwordx4 v37, s[24:27], s49 offen offset:1024 sc1 lds
    v_lshrrev_b32 v166, 2, v0
    v_mul_u32_u24 v166, 288, v166
    buffer_load_dwordx4 v38, s[24:27], s49 offen offset:2048 sc1 lds
    v_and_b32 v167, 3, v0
    v_lshl_add_u32 v166, v167, 3, v166
    buffer_load_dwordx4 v39, s[24:27], s49 offen offset:3072 sc1 lds
    s_add_u32 s43, s42, 121856
    s_add_u32 m0, s46, 81920
    s_nop 0
    buffer_load_dwordx4 v40, s[24:27], s49 offen sc1 lds
    s_waitcnt vmcnt(14)
    s_barrier
    s_add_u32 m0, s46, 0
    s_add_u32 s49, s90, 580608
    buffer_load_dwordx4 v32, s[24:27], s49 offen sc1 lds
    v_add_u32 v218, s43, v166
    v_and_b32 v166, 15, v0
    buffer_load_dwordx4 v33, s[24:27], s49 offen offset:1024 sc1 lds
    v_mul_u32_u24 v166, 304, v166
    buffer_load_dwordx4 v34, s[24:27], s49 offen offset:2048 sc1 lds
    v_lshrrev_b32 v167, 4, v0
    buffer_load_dwordx4 v35, s[24:27], s49 offen offset:3072 sc1 lds
    v_lshl_add_u32 v166, v167, 3, v166
    s_mul_i32 s43, s41, 4864
    s_add_u32 m0, s46, 4096
    s_nop 0
    buffer_load_dwordx4 v36, s[24:27], s49 offen sc1 lds
    s_add_u32 s43, s43, s42
    buffer_load_dwordx4 v37, s[24:27], s49 offen offset:1024 sc1 lds
    s_add_u32 s43, s43, 46080
    buffer_load_dwordx4 v38, s[24:27], s49 offen offset:2048 sc1 lds
    v_add_u32 v219, s43, v166
    buffer_load_dwordx4 v39, s[24:27], s49 offen offset:3072 sc1 lds
    s_lshl_b32 s41, s38, 6
    s_add_u32 s41, s41, 0
    s_add_u32 m0, s46, 8192
    s_nop 0
    buffer_load_dwordx4 v40, s[24:27], s49 offen sc1 lds
    v_add_u32 v166, s41, v0
    s_add_u32 m0, s44, 121856
    s_add_u32 s49, s44, 0
    buffer_load_dwordx4 v29, s[32:35], s49 offen lds
    v_mul_u32_u24 v167, 3641, v166
    s_add_u32 m0, s44, 125952
    s_add_u32 s49, s44, 4096
    buffer_load_dwordx4 v29, s[32:35], s49 offen lds
    v_lshrrev_b32 v167, 16, v167
    s_add_u32 m0, s44, 130048
    s_add_u32 s49, s44, 8192
    buffer_load_dwordx4 v29, s[32:35], s49 offen lds
    s_waitcnt vmcnt(21)
    s_barrier
    s_add_u32 m0, s47, 18432
    s_mov_b32 s49, 820224
    buffer_load_dwordx4 v42, s[24:27], s49 offen sc1 lds
    v_mul_u32_u24 v168, 18, v167
    v_sub_u32 v166, v166, v168
    buffer_load_dwordx4 v43, s[24:27], s49 offen offset:1024 sc1 lds
    v_lshlrev_b32 v166, 4, v166
    v_mul_u32_u24 v168, 304, v167
    buffer_load_dwordx4 v44, s[24:27], s49 offen offset:2048 sc1 lds
    v_add_u32 v168, v168, v166
    v_add_u32 v220, 46080, v168
    buffer_load_dwordx4 v45, s[24:27], s49 offen offset:3072 sc1 lds
    v_bfe_u32 v168, v167, 1, 3
    s_add_u32 m0, s47, 22528
    s_nop 0
    buffer_load_dwordx4 v46, s[24:27], s49 offen sc1 lds
    v_mul_u32_u24 v168, 20, v168
    v_lshrrev_b32 v169, 4, v167
    s_add_u32 m0, s44, 134144
    s_add_u32 s49, s44, 12288
    buffer_load_dwordx4 v29, s[32:35], s49 offen lds
    v_mul_u32_u24 v169, 10, v169
    v_add_u32 v168, v168, v169
    s_add_u32 m0, s44, 138240
    s_add_u32 s49, s44, 16384
    buffer_load_dwordx4 v29, s[32:35], s49 offen lds
    v_and_b32 v169, 1, v167
    v_add_u32 v168, v168, v169
    s_add_u32 m0, s44, 142336
    s_add_u32 s49, s44, 20480
    buffer_load_dwordx4 v29, s[32:35], s49 offen lds
    v_mul_u32_u24 v168, 288, v168
    s_add_u32 m0, s44, 146432
    s_add_u32 s49, s44, 24576
    buffer_load_dwordx4 v29, s[32:35], s49 offen lds
    s_waitcnt vmcnt(21)
    s_barrier
    s_add_u32 m0, s44, 150528
    s_add_u32 s49, s44, 28672
    buffer_load_dwordx4 v29, s[32:35], s49 offen lds
    v_add_u32 v223, v168, v166
    s_lshl_b32 s41, s38, 6
    s_add_u32 s41, s41, 256
    v_add_u32 v166, s41, v0
    v_mul_u32_u24 v167, 3641, v166
    s_add_u32 m0, s44, 154624
    s_add_u32 s49, s44, 32768
    buffer_load_dwordx4 v29, s[32:35], s49 offen lds
    v_lshrrev_b32 v167, 16, v167
    v_mul_u32_u24 v168, 18, v167
    v_sub_u32 v166, v166, v168
    v_lshlrev_b32 v166, 4, v166
    v_mul_u32_u24 v168, 304, v167
    s_add_u32 m0, s44, 158720
    s_add_u32 s49, s44, 36864
    buffer_load_dwordx4 v29, s[32:35], s49 offen lds
    v_add_u32 v168, v168, v166
    v_add_u32 v221, 46080, v168
    v_bfe_u32 v168, v167, 1, 3
    v_mul_u32_u24 v168, 20, v168
    s_add_u32 m0, s44, 162816
    s_add_u32 s49, s44, 40960
    s_cmp_eq_u32 s38, 0
    s_cbranch_scc0 L_sk1
    buffer_load_dwordx4 v29, s[32:35], s49 offen lds
L_sk1:
    s_waitcnt vmcnt(15)
    s_barrier
    v_lshrrev_b32 v169, 4, v167
    v_mul_u32_u24 v169, 10, v169
    v_add_u32 v168, v168, v169
    v_and_b32 v169, 1, v167
    v_add_u32 v168, v168, v169
    v_mul_u32_u24 v168, 288, v168
    v_add_u32 v224, v168, v166
    s_mov_b32 s41, 512
    v_add_u32 v166, s41, v0
    v_mul_u32_u24 v167, 3641, v166
    v_lshrrev_b32 v167, 16, v167
    v_mul_u32_u24 v168, 18, v167
    v_sub_u32 v166, v166, v168
    s_waitcnt vmcnt(7)
    s_barrier
    v_lshlrev_b32 v166, 4, v166
    v_mul_u32_u24 v168, 304, v167
    v_add_u32 v168, v168, v166
    v_add_u32 v222, 46080, v168
    v_bfe_u32 v168, v167, 1, 3
    v_mul_u32_u24 v168, 20, v168
    v_lshrrev_b32 v169, 4, v167
    v_mul_u32_u24 v169, 10, v169
    v_add_u32 v168, v168, v169
    v_and_b32 v169, 1, v167
    v_add_u32 v168, v168, v169
    v_mul_u32_u24 v168, 288, v168
    v_add_u32 v225, v168, v166
    s_waitcnt vmcnt(0)
    s_barrier
    s_branch L_lepi
.p2align 6
L_xf:
    s_mul_i32 s42, s45, 576
    s_lshl3_add_u32 s41, s45, s39
    s_add_u32 s42, s42, s39
    v_add_u32 v3, s42, v2
    v_add_u32 v2, s41, v2
    v_add_u32 v16, 3456, v3
    buffer_load_dwordx4 v[32:35], v16, s[16:19], 0 offen
    v_add_u32 v17, 9216, v3
    buffer_load_dwordx4 v[40:43], v17, s[16:19], 0 offen
    v_add_u32 v18, 2880, v2
    buffer_load_dwordx2 v[188:189], v18, s[16:19], 0 offen
    v_add_u32 v19, 8640, v2
    buffer_load_dwordx2 v[170:171], v19, s[16:19], 0 offen
    v_lshrrev_b32 v29, 2, v0
    v_and_b32 v31, 3, v0
    s_mov_b32 s65, 0xffff0000
    v_lshlrev_b32 v167, 1, v31
    v_xor_b32 v166, v29, v167
    v_lshl_add_u32 v166, v31, 4, v166
    v_lshlrev_b32 v166, 4, v166
    s_lshl_b32 s41, s38, 10
    s_sub_u32 s41, 91136, s41
    v_add_u32 v25, s41, v166
    s_lshl_b32 s41, s45, 3
    s_add_u32 s42, s41, 92160
    v_add_u32 v27, s42, v166
    v_and_b32 v167, 2, v31
    v_lshlrev_b32 v167, 9, v167
    v_sub_u32 v28, v27, v167
    v_sub_u32 v26, v25, v167
    v_lshrrev_b32 v196, 3, v0
    v_mul_u32_u24 v197, 1280, v196
    v_and_b32 v198, 7, v0
    v_lshl_add_u32 v197, v198, 4, v197
    v_and_b32 v196, 1, v196
    v_lshlrev_b32 v196, 7, v196
    v_xor_b32 v198, 0x80, v196
    s_lshl_b32 s41, s45, 7
    s_add_u32 s41, s41, 131200
    v_add_u32 v199, s41, v197
    s_and_b32 s41, s45, 1
    s_lshl_b32 s41, s41, 1
    s_sub_u32 s41, s41, 1
    v_mul_i32_i24 v196, s41, v196
    v_mul_i32_i24 v198, s41, v198
    v_add_u32 v6, v199, v196
    v_sub_u32 v7, v199, v196
    v_add_u32 v8, v199, v198
    v_sub_u32 v9, v199, v198
    s_lshl_b32 s43, s45, 1
    v_lshrrev_b32 v196, 3, v0
    v_mul_u32_u24 v197, 1280, v196
    v_and_b32 v198, 7, v0
    v_lshl_add_u32 v197, v198, 4, v197
    v_and_b32 v196, 1, v196
    v_lshlrev_b32 v196, 7, v196
    v_xor_b32 v198, 0x80, v196
    s_lshl_b32 s41, s43, 2
    s_add_u32 s41, s41, 131072
    v_add_u32 v199, s41, v197
    v_sub_u32 v10, v199, v196
    v_add_u32 v11, v199, v198
    v_sub_u32 v12, v199, v198
    v_add_u32 v13, v199, v196
    s_lshl_b32 s41, s43, 7
    s_add_u32 s41, s41, 131200
    v_add_u32 v199, s41, v197
    s_and_b32 s41, s43, 1
    s_lshl_b32 s41, s41, 1
    s_sub_u32 s41, s41, 1
    v_mul_i32_i24 v196, s41, v196
    v_mul_i32_i24 v198, s41, v198
    s_mov_b32 s32, s8
    s_mov_b32 s33, s9
    s_mov_b32 s34, 41472
    s_mov_b32 s35, 0x20000
    s_mul_i32 s41, s37, 46080
    s_add_u32 s28, s10, s41
    s_addc_u32 s29, s11, 0
    s_mov_b32 s30, 46080
    s_mov_b32 s31, 0x20000
    s_lshl_b32 s41, s45, 11
    s_add_u32 s41, s41, 131072
    v_lshl_add_u32 v24, v0, 4, s41
    s_waitcnt vmcnt(11)
    v_lshlrev_b32 v192, 16, v44
    v_and_b32 v193, s65, v44
    v_lshlrev_b32 v194, 16, v52
    v_and_b32 v195, s65, v52
    v_lshlrev_b32 v198, 16, v45
    v_and_b32 v199, s65, v45
    v_lshlrev_b32 v200, 16, v53
    v_and_b32 v201, s65, v53
    v_sub_f32 v210, v192, v194
    v_sub_f32 v211, v193, v195
    v_lshlrev_b32 v204, 16, v46
    v_and_b32 v205, s65, v46
    v_lshlrev_b32 v206, 16, v54
    v_and_b32 v207, s65, v54
    v_sub_f32 v218, v198, v200
    v_sub_f32 v219, v199, v201
    v_cvt_pk_bf16_f32 v234, v210, v211
    v_lshlrev_b32 v192, 16, v47
    v_and_b32 v193, s65, v47
    v_lshlrev_b32 v194, 16, v55
    v_and_b32 v195, s65, v55
    v_sub_f32 v210, v204, v206
    v_sub_f32 v211, v205, v207
    v_cvt_pk_bf16_f32 v235, v218, v219
    v_sub_f32 v218, v192, v194
    v_sub_f32 v219, v193, v195
    v_cvt_pk_bf16_f32 v236, v210, v211
    v_cvt_pk_bf16_f32 v237, v218, v219
    ds_write_b128 v25, v[234:237] offset:29696
    s_waitcnt vmcnt(9)
    v_lshlrev_b32 v192, 16, v168
    v_and_b32 v193, s65, v168
    v_lshlrev_b32 v194, 16, v190
    v_and_b32 v195, s65, v190
    v_lshlrev_b32 v198, 16, v169
    v_and_b32 v199, s65, v169
    v_lshlrev_b32 v200, 16, v191
    v_and_b32 v201, s65, v191
    v_sub_f32 v210, v192, v194
    v_sub_f32 v211, v193, v195
    v_sub_f32 v218, v198, v200
    v_sub_f32 v219, v199, v201
    v_cvt_pk_bf16_f32 v242, v210, v211
    v_cvt_pk_bf16_f32 v243, v218, v219
    ds_write_b64 v27, v[242:243] offset:24576
    s_waitcnt vmcnt(4)
    s_waitcnt lgkmcnt(0)
    s_setprio 0
    s_barrier
    ds_read_b128 v[140:143], v24 offset:4096
    ds_read_b128 v[48:51], v24 offset:5120
    s_waitcnt vmcnt(2)
    v_lshlrev_b32 v192, 16, v32
    v_and_b32 v193, s65, v32
    v_lshlrev_b32 v194, 16, v40
    v_and_b32 v195, s65, v40
    v_lshlrev_b32 v198, 16, v33
    v_and_b32 v199, s65, v33
    v_lshlrev_b32 v200, 16, v41
    v_and_b32 v201, s65, v41
    v_sub_f32 v210, v192, v194
    v_sub_f32 v211, v193, v195
    v_lshlrev_b32 v204, 16, v34
    v_and_b32 v205, s65, v34
    v_lshlrev_b32 v206, 16, v42
    v_and_b32 v207, s65, v42
    v_sub_f32 v218, v198, v200
    v_sub_f32 v219, v199, v201
    v_cvt_pk_bf16_f32 v226, v210, v211
    v_lshlrev_b32 v192, 16, v35
    v_and_b32 v193, s65, v35
    v_lshlrev_b32 v194, 16, v43
    v_and_b32 v195, s65, v43
    v_sub_f32 v210, v204, v206
    v_sub_f32 v211, v205, v207
    v_cvt_pk_bf16_f32 v227, v218, v219
    v_sub_f32 v218, v192, v194
    v_sub_f32 v219, v193, v195
    v_cvt_pk_bf16_f32 v228, v210, v211
    v_cvt_pk_bf16_f32 v229, v218, v219
    s_barrier
    ds_write_b128 v25, v[226:229] offset:31744
    ds_read_b128 v[128:131], v24 offset:0
    ds_read_b128 v[36:39], v24 offset:1024
    s_waitcnt vmcnt(0)
    v_lshlrev_b32 v192, 16, v188
    v_and_b32 v193, s65, v188
    v_lshlrev_b32 v194, 16, v170
    v_and_b32 v195, s65, v170
    v_lshlrev_b32 v198, 16, v189
    v_and_b32 v199, s65, v189
    v_lshlrev_b32 v200, 16, v171
    v_and_b32 v201, s65, v171
    v_sub_f32 v210, v192, v194
    v_sub_f32 v211, v193, v195
    v_sub_f32 v218, v198, v200
    v_sub_f32 v219, v199, v201
    v_cvt_pk_bf16_f32 v242, v210, v211
    v_cvt_pk_bf16_f32 v243, v218, v219
    s_waitcnt lgkmcnt(3)
    v_lshlrev_b32 v192, 16, v140
    v_and_b32 v193, s65, v140
    v_lshlrev_b32 v194, 16, v48
    v_and_b32 v195, s65, v48
    v_lshlrev_b32 v198, 16, v141
    v_and_b32 v199, s65, v141
    v_lshlrev_b32 v200, 16, v49
    v_and_b32 v201, s65, v49
    v_sub_f32 v210, v192, v194
    s_barrier
    ds_write_b64 v27, v[242:243] offset:29696
    v_sub_f32 v211, v193, v195
    v_lshlrev_b32 v204, 16, v142
    v_and_b32 v205, s65, v142
    v_lshlrev_b32 v206, 16, v50
    v_and_b32 v207, s65, v50
    v_sub_f32 v218, v198, v200
    v_sub_f32 v219, v199, v201
    v_cvt_pk_bf16_f32 v234, v210, v211
    v_lshlrev_b32 v192, 16, v143
    v_and_b32 v193, s65, v143
    v_lshlrev_b32 v194, 16, v51
    v_and_b32 v195, s65, v51
    v_sub_f32 v210, v204, v206
    v_sub_f32 v211, v205, v207
    v_cvt_pk_bf16_f32 v235, v218, v219
    v_sub_f32 v218, v192, v194
    v_sub_f32 v219, v193, v195
    v_cvt_pk_bf16_f32 v236, v210, v211
    v_cvt_pk_bf16_f32 v237, v218, v219
    s_waitcnt lgkmcnt(1)
    v_lshlrev_b32 v192, 16, v128
    v_and_b32 v193, s65, v128
    v_lshlrev_b32 v194, 16, v36
    v_and_b32 v195, s65, v36
    s_barrier
    ds_write_b128 v25, v[234:237] offset:34816
    v_lshlrev_b32 v198, 16, v129
    v_and_b32 v199, s65, v129
    v_lshlrev_b32 v200, 16, v37
    v_and_b32 v201, s65, v37
    v_sub_f32 v210, v192, v194
    v_sub_f32 v211, v193, v195
    v_lshlrev_b32 v204, 16, v130
    v_and_b32 v205, s65, v130
    v_lshlrev_b32 v206, 16, v38
    v_and_b32 v207, s65, v38
    v_sub_f32 v218, v198, v200
    v_sub_f32 v219, v199, v201
    v_cvt_pk_bf16_f32 v238, v210, v211
    v_lshlrev_b32 v192, 16, v131
    v_and_b32 v193, s65, v131
    v_lshlrev_b32 v194, 16, v39
    v_and_b32 v195, s65, v39
    v_sub_f32 v210, v204, v206
    v_sub_f32 v211, v205, v207
    v_cvt_pk_bf16_f32 v239, v218, v219
    v_sub_f32 v218, v192, v194
    v_sub_f32 v219, v193, v195
    v_cvt_pk_bf16_f32 v240, v210, v211
    v_cvt_pk_bf16_f32 v241, v218, v219
    s_barrier
    ds_write_b128 v25, v[238:241] offset:36864
    s_waitcnt lgkmcnt(2)
    s_barrier
    s_waitcnt lgkmcnt(1)
    s_barrier
    ds_read_b128 v[60:63], v8 offset:13568
    ds_read_b128 v[156:159], v6 offset:14848
    ds_read_b128 v[72:75], v8 offset:13824
    ds_read_b128 v[164:167], v6 offset:15104
    s_waitcnt lgkmcnt(2)
    v_lshlrev_b32 v192, 16, v60
    v_and_b32 v193, s65, v60
    v_lshlrev_b32 v194, 16, v156
    v_and_b32 v195, s65, v156
    v_lshlrev_b32 v198, 16, v61
    v_and_b32 v199, s65, v61
    v_lshlrev_b32 v200, 16, v157
    v_and_b32 v201, s65, v157
    v_sub_f32 v210, v192, v194
    v_sub_f32 v211, v193, v195
    v_lshlrev_b32 v204, 16, v62
    v_and_b32 v205, s65, v62
    v_lshlrev_b32 v206, 16, v158
    v_and_b32 v207, s65, v158
    v_sub_f32 v218, v198, v200
    v_sub_f32 v219, v199, v201
    v_cvt_pk_bf16_f32 v226, v210, v211
    v_lshlrev_b32 v192, 16, v63
    v_and_b32 v193, s65, v63
    v_lshlrev_b32 v194, 16, v159
    v_and_b32 v195, s65, v159
    v_sub_f32 v210, v204, v206
    v_sub_f32 v211, v205, v207
    v_cvt_pk_bf16_f32 v227, v218, v219
    v_sub_f32 v218, v192, v194
    v_sub_f32 v219, v193, v195
    v_cvt_pk_bf16_f32 v228, v210, v211
    v_cvt_pk_bf16_f32 v229, v218, v219
    s_barrier
    ds_write_b128 v25, v[226:229] offset:7168
    ds_read_b64 v[172:173], v11 offset:13568
    ds_read_b64 v[190:191], v13 offset:14848
    ds_read_b64 v[188:189], v10 offset:12928
    ds_read_b64 v[174:175], v12 offset:14208
    s_waitcnt lgkmcnt(5)
    v_lshlrev_b32 v192, 16, v72
    v_and_b32 v193, s65, v72
    v_lshlrev_b32 v194, 16, v164
    v_and_b32 v195, s65, v164
    v_lshlrev_b32 v198, 16, v73
    v_and_b32 v199, s65, v73
    v_lshlrev_b32 v200, 16, v165
    v_and_b32 v201, s65, v165
    v_sub_f32 v210, v192, v194
    v_sub_f32 v211, v193, v195
    v_lshlrev_b32 v204, 16, v74
    v_and_b32 v205, s65, v74
    v_lshlrev_b32 v206, 16, v166
    v_and_b32 v207, s65, v166
    v_sub_f32 v218, v198, v200
    v_sub_f32 v219, v199, v201
    v_cvt_pk_bf16_f32 v234, v210, v211
    v_lshlrev_b32 v192, 16, v75
    v_and_b32 v193, s65, v75
    v_lshlrev_b32 v194, 16, v167
    v_and_b32 v195, s65, v167
    v_sub_f32 v210, v204, v206
    v_sub_f32 v211, v205, v207
    v_cvt_pk_bf16_f32 v235, v218, v219
    v_sub_f32 v218, v192, v194
    v_sub_f32 v219, v193, v195
    v_cvt_pk_bf16_f32 v236, v210, v211
    v_cvt_pk_bf16_f32 v237, v218, v219
    s_barrier
    ds_write_b128 v25, v[234:237] offset:5120
    ds_read_b128 v[68:71], v7 offset:13184
    ds_read_b128 v[76:79], v9 offset:14464
    ds_read_b128 v[56:59], v7 offset:12928
    ds_read_b128 v[64:67], v9 offset:14208
    s_waitcnt lgkmcnt(5)
    v_lshlrev_b32 v192, 16, v172
    v_and_b32 v193, s65, v172
    v_lshlrev_b32 v194, 16, v190
    v_and_b32 v195, s65, v190
    v_lshlrev_b32 v196, 16, v188
    v_and_b32 v197, s65, v188
    v_lshlrev_b32 v198, 16, v174
    v_and_b32 v199, s65, v174
    v_lshlrev_b32 v200, 16, v173
    v_and_b32 v201, s65, v173
    v_lshlrev_b32 v202, 16, v191
    v_and_b32 v203, s65, v191
    v_lshlrev_b32 v204, 16, v189
    v_and_b32 v205, s65, v189
    v_lshlrev_b32 v206, 16, v175
    v_and_b32 v207, s65, v175
    v_sub_f32 v210, v192, v194
    v_sub_f32 v211, v193, v195
    v_sub_f32 v212, v196, v198
    v_sub_f32 v213, v197, v199
    v_sub_f32 v218, v200, v202
    v_sub_f32 v219, v201, v203
    v_sub_f32 v220, v204, v206
    v_sub_f32 v221, v205, v207
    v_cvt_pk_bf16_f32 v242, v210, v211
    v_cvt_pk_bf16_f32 v244, v212, v213
    v_cvt_pk_bf16_f32 v243, v218, v219
    v_cvt_pk_bf16_f32 v245, v220, v221
    s_barrier
    ds_write2st64_b64 v27, v[242:243], v[244:245] offset0:10 offset1:20
    s_waitcnt lgkmcnt(3)
    v_lshlrev_b32 v192, 16, v68
    v_and_b32 v193, s65, v68
    v_lshlrev_b32 v194, 16, v76
    v_and_b32 v195, s65, v76
    v_lshlrev_b32 v198, 16, v69
    v_and_b32 v199, s65, v69
    v_lshlrev_b32 v200, 16, v77
    v_and_b32 v201, s65, v77
    v_sub_f32 v210, v192, v194
    v_sub_f32 v211, v193, v195
    v_lshlrev_b32 v204, 16, v70
    v_and_b32 v205, s65, v70
    v_lshlrev_b32 v206, 16, v78
    v_and_b32 v207, s65, v78
    v_sub_f32 v218, v198, v200
    v_sub_f32 v219, v199, v201
    v_cvt_pk_bf16_f32 v234, v210, v211
    v_lshlrev_b32 v192, 16, v71
    v_and_b32 v193, s65, v71
    v_lshlrev_b32 v194, 16, v79
    v_and_b32 v195, s65, v79
    v_sub_f32 v210, v204, v206
    v_sub_f32 v211, v205, v207
    v_cvt_pk_bf16_f32 v235, v218, v219
    v_sub_f32 v218, v192, v194
    v_sub_f32 v219, v193, v195
    v_cvt_pk_bf16_f32 v236, v210, v211
    v_cvt_pk_bf16_f32 v237, v218, v219
    s_waitcnt lgkmcnt(0)
    s_barrier
    ds_write_b128 v25, v[234:237] offset:10240
    ds_read_b128 v[152:155], v6 offset:12288
    ds_read_b128 v[160:163], v6 offset:12544
    v_lshlrev_b32 v192, 16, v56
    v_and_b32 v193, s65, v56
    v_lshlrev_b32 v194, 16, v64
    v_and_b32 v195, s65, v64
    v_lshlrev_b32 v198, 16, v57
    v_and_b32 v199, s65, v57
    v_lshlrev_b32 v200, 16, v65
    v_and_b32 v201, s65, v65
    v_sub_f32 v210, v192, v194
    v_sub_f32 v211, v193, v195
    v_lshlrev_b32 v204, 16, v58
    v_and_b32 v205, s65, v58
    v_lshlrev_b32 v206, 16, v66
    v_and_b32 v207, s65, v66
    v_sub_f32 v218, v198, v200
    v_sub_f32 v219, v199, v201
    v_cvt_pk_bf16_f32 v226, v210, v211
    v_lshlrev_b32 v192, 16, v59
    v_and_b32 v193, s65, v59
    v_lshlrev_b32 v194, 16, v67
    v_and_b32 v195, s65, v67
    v_sub_f32 v210, v204, v206
    v_sub_f32 v211, v205, v207
    v_cvt_pk_bf16_f32 v227, v218, v219
    v_sub_f32 v218, v192, v194
    v_sub_f32 v219, v193, v195
    v_cvt_pk_bf16_f32 v228, v210, v211
    v_cvt_pk_bf16_f32 v229, v218, v219
    s_waitcnt lgkmcnt(0)
    s_barrier
    ds_write_b128 v25, v[226:229] offset:12288
    v_lshlrev_b32 v192, 16, v152
    v_and_b32 v193, s65, v152
    v_lshlrev_b32 v194, 16, v60
    v_and_b32 v195, s65, v60
    v_lshlrev_b32 v198, 16, v153
    v_and_b32 v199, s65, v153
    v_lshlrev_b32 v200, 16, v61
    v_and_b32 v201, s65, v61
    v_sub_f32 v210, v192, v194
    v_sub_f32 v211, v193, v195
    v_lshlrev_b32 v204, 16, v154
    v_and_b32 v205, s65, v154
    v_lshlrev_b32 v206, 16, v62
    v_and_b32 v207, s65, v62
    v_sub_f32 v218, v198, v200
    v_sub_f32 v219, v199, v201
    v_cvt_pk_bf16_f32 v230, v210, v211
    v_lshlrev_b32 v192, 16, v155
    v_and_b32 v193, s65, v155
    v_lshlrev_b32 v194, 16, v63
    v_and_b32 v195, s65, v63
    v_sub_f32 v210, v204, v206
    v_sub_f32 v211, v205, v207
    v_cvt_pk_bf16_f32 v231, v218, v219
    v_sub_f32 v218, v192, v194
    v_sub_f32 v219, v193, v195
    v_cvt_pk_bf16_f32 v232, v210, v211
    v_cvt_pk_bf16_f32 v233, v218, v219
    s_barrier
    ds_write_b128 v25, v[230:233] offset:17408
    v_lshlrev_b32 v192, 16, v160
    v_and_b32 v193, s65, v160
    v_lshlrev_b32 v194, 16, v72
    v_and_b32 v195, s65, v72
    v_lshlrev_b32 v198, 16, v161
    v_and_b32 v199, s65, v161
    v_lshlrev_b32 v200, 16, v73
    v_and_b32 v201, s65, v73
    v_sub_f32 v210, v192, v194
    v_sub_f32 v211, v193, v195
    v_lshlrev_b32 v204, 16, v162
    v_and_b32 v205, s65, v162
    v_lshlrev_b32 v206, 16, v74
    v_and_b32 v207, s65, v74
    v_sub_f32 v218, v198, v200
    v_sub_f32 v219, v199, v201
    v_cvt_pk_bf16_f32 v238, v210, v211
    v_lshlrev_b32 v192, 16, v163
    v_and_b32 v193, s65, v163
    v_lshlrev_b32 v194, 16, v75
    v_and_b32 v195, s65, v75
    v_sub_f32 v210, v204, v206
    v_sub_f32 v211, v205, v207
    v_cvt_pk_bf16_f32 v239, v218, v219
    v_sub_f32 v218, v192, v194
    v_sub_f32 v219, v193, v195
    v_cvt_pk_bf16_f32 v240, v210, v211
    v_cvt_pk_bf16_f32 v241, v218, v219
    s_waitcnt lgkmcnt(1)
    s_barrier
    ds_read_b128 v[84:87], v8 offset:1280
    ds_read_b128 v[156:159], v6 offset:2560
    ds_read_b128 v[152:155], v6 offset:0
    s_waitcnt lgkmcnt(0)
    v_lshlrev_b32 v192, 16, v152
    v_and_b32 v193, s65, v152
    v_lshlrev_b32 v194, 16, v84
    v_and_b32 v195, s65, v84
    v_lshlrev_b32 v196, 16, v156
    v_and_b32 v197, s65, v156
    v_lshlrev_b32 v198, 16, v153
    v_and_b32 v199, s65, v153
    v_lshlrev_b32 v200, 16, v85
    v_and_b32 v201, s65, v85
    v_lshlrev_b32 v202, 16, v157
    v_and_b32 v203, s65, v157
    v_sub_f32 v210, v194, v196
    v_sub_f32 v211, v195, v197
    v_sub_f32 v212, v192, v194
    v_sub_f32 v213, v193, v195
    v_lshlrev_b32 v204, 16, v154
    v_and_b32 v205, s65, v154
    v_lshlrev_b32 v206, 16, v86
    v_and_b32 v207, s65, v86
    v_lshlrev_b32 v208, 16, v158
    v_and_b32 v209, s65, v158
    v_sub_f32 v218, v200, v202
    v_sub_f32 v219, v201, v203
    v_sub_f32 v220, v198, v200
    v_sub_f32 v221, v199, v201
    s_barrier
    ds_write_b128 v25, v[238:241] offset:15360
    ds_read_b128 v[96:99], v8 offset:1536
    ds_read_b128 v[164:167], v6 offset:2816
    ds_read_b128 v[160:163], v6 offset:256
    v_cvt_pk_bf16_f32 v226, v210, v211
    v_cvt_pk_bf16_f32 v230, v212, v213
    v_lshlrev_b32 v192, 16, v155
    v_and_b32 v193, s65, v155
    v_lshlrev_b32 v194, 16, v87
    v_and_b32 v195, s65, v87
    v_lshlrev_b32 v196, 16, v159
    v_and_b32 v197, s65, v159
    v_sub_f32 v210, v206, v208
    v_sub_f32 v211, v207, v209
    v_sub_f32 v212, v204, v206
    v_sub_f32 v213, v205, v207
    v_cvt_pk_bf16_f32 v227, v218, v219
    v_cvt_pk_bf16_f32 v231, v220, v221
    v_sub_f32 v218, v194, v196
    v_sub_f32 v219, v195, v197
    v_sub_f32 v220, v192, v194
    v_sub_f32 v221, v193, v195
    v_cvt_pk_bf16_f32 v228, v210, v211
    v_cvt_pk_bf16_f32 v232, v212, v213
    v_cvt_pk_bf16_f32 v229, v218, v219
    v_cvt_pk_bf16_f32 v233, v220, v221
    s_waitcnt lgkmcnt(0)
    v_lshlrev_b32 v192, 16, v160
    v_and_b32 v193, s65, v160
    s_barrier
    ds_write_b128 v25, v[226:229] offset:26624
    ds_read_b64 v[176:177], v11 offset:1280
    ds_read_b64 v[190:191], v13 offset:2560
    ds_read_b64 v[188:189], v10 offset:640
    v_lshlrev_b32 v194, 16, v96
    v_and_b32 v195, s65, v96
    v_lshlrev_b32 v196, 16, v164
    v_and_b32 v197, s65, v164
    v_lshlrev_b32 v198, 16, v161
    v_and_b32 v199, s65, v161
    v_lshlrev_b32 v200, 16, v97
    v_and_b32 v201, s65, v97
    v_lshlrev_b32 v202, 16, v165
    v_and_b32 v203, s65, v165
    v_sub_f32 v210, v194, v196
    v_sub_f32 v211, v195, v197
    v_sub_f32 v212, v192, v194
    v_sub_f32 v213, v193, v195
    v_lshlrev_b32 v204, 16, v162
    v_and_b32 v205, s65, v162
    v_lshlrev_b32 v206, 16, v98
    v_and_b32 v207, s65, v98
    v_lshlrev_b32 v208, 16, v166
    v_and_b32 v209, s65, v166
    v_sub_f32 v218, v200, v202
    v_sub_f32 v219, v201, v203
    v_sub_f32 v220, v198, v200
    v_sub_f32 v221, v199, v201
    v_cvt_pk_bf16_f32 v234, v210, v211
    v_cvt_pk_bf16_f32 v238, v212, v213
    s_barrier
    ds_write_b128 v25, v[230:233] offset:36864
    ds_read_b64 v[178:179], v12 offset:1920
    ds_read_b128 v[92:95], v7 offset:896
    ds_read_b128 v[100:103], v9 offset:2176
    v_lshlrev_b32 v192, 16, v163
    v_and_b32 v193, s65, v163
    v_lshlrev_b32 v194, 16, v99
    v_and_b32 v195, s65, v99
    v_lshlrev_b32 v196, 16, v167
    v_and_b32 v197, s65, v167
    v_sub_f32 v210, v206, v208
    v_sub_f32 v211, v207, v209
    v_sub_f32 v212, v204, v206
    v_sub_f32 v213, v205, v207
    v_cvt_pk_bf16_f32 v235, v218, v219
    v_cvt_pk_bf16_f32 v239, v220, v221
    v_sub_f32 v218, v194, v196
    v_sub_f32 v219, v195, v197
    v_sub_f32 v220, v192, v194
    v_sub_f32 v221, v193, v195
    v_cvt_pk_bf16_f32 v236, v210, v211
    v_cvt_pk_bf16_f32 v240, v212, v213
    v_cvt_pk_bf16_f32 v237, v218, v219
    v_cvt_pk_bf16_f32 v241, v220, v221
    s_waitcnt lgkmcnt(2)
    v_lshlrev_b32 v192, 16, v176
    v_and_b32 v193, s65, v176
    v_lshlrev_b32 v194, 16, v190
    s_barrier
    ds_write_b128 v25, v[234:237] offset:24576
    ds_read_b128 v[80:83], v7 offset:640
    ds_read_b128 v[88:91], v9 offset:1920
    v_and_b32 v195, s65, v190
    v_lshlrev_b32 v196, 16, v188
    v_and_b32 v197, s65, v188
    v_lshlrev_b32 v198, 16, v178
    v_and_b32 v199, s65, v178
    v_lshlrev_b32 v200, 16, v177
    v_and_b32 v201, s65, v177
    v_lshlrev_b32 v202, 16, v191
    v_and_b32 v203, s65, v191
    v_lshlrev_b32 v204, 16, v189
    v_and_b32 v205, s65, v189
    v_lshlrev_b32 v206, 16, v179
    v_and_b32 v207, s65, v179
    v_sub_f32 v210, v192, v194
    v_sub_f32 v211, v193, v195
    v_sub_f32 v212, v196, v198
    v_sub_f32 v213, v197, v199
    v_sub_f32 v218, v200, v202
    v_sub_f32 v219, v201, v203
    v_sub_f32 v220, v204, v206
    v_sub_f32 v221, v205, v207
    v_cvt_pk_bf16_f32 v242, v210, v211
    v_cvt_pk_bf16_f32 v244, v212, v213
    v_cvt_pk_bf16_f32 v243, v218, v219
    v_cvt_pk_bf16_f32 v245, v220, v221
    s_waitcnt lgkmcnt(0)
    s_barrier
    ds_write2st64_b64 v27, v[242:243], v[244:245] offset0:48 offset1:58
    v_lshlrev_b32 v192, 16, v92
    v_and_b32 v193, s65, v92
    v_lshlrev_b32 v194, 16, v100
    v_and_b32 v195, s65, v100
    v_lshlrev_b32 v198, 16, v93
    v_and_b32 v199, s65, v93
    v_lshlrev_b32 v200, 16, v101
    v_and_b32 v201, s65, v101
    v_sub_f32 v210, v192, v194
    v_sub_f32 v211, v193, v195
    v_lshlrev_b32 v204, 16, v94
    v_and_b32 v205, s65, v94
    v_lshlrev_b32 v206, 16, v102
    v_and_b32 v207, s65, v102
    v_sub_f32 v218, v198, v200
    v_sub_f32 v219, v199, v201
    v_cvt_pk_bf16_f32 v234, v210, v211
    v_lshlrev_b32 v192, 16, v95
    v_and_b32 v193, s65, v95
    v_lshlrev_b32 v194, 16, v103
    v_and_b32 v195, s65, v103
    v_sub_f32 v210, v204, v206
    v_sub_f32 v211, v205, v207
    s_barrier
    ds_write_b128 v25, v[238:241] offset:34816
    v_cvt_pk_bf16_f32 v235, v218, v219
    v_sub_f32 v218, v192, v194
    v_sub_f32 v219, v193, v195
    v_cvt_pk_bf16_f32 v236, v210, v211
    v_cvt_pk_bf16_f32 v237, v218, v219
    v_lshlrev_b32 v192, 16, v80
    v_and_b32 v193, s65, v80
    v_lshlrev_b32 v194, 16, v88
    v_and_b32 v195, s65, v88
    v_lshlrev_b32 v198, 16, v81
    v_and_b32 v199, s65, v81
    v_lshlrev_b32 v200, 16, v89
    v_and_b32 v201, s65, v89
    v_sub_f32 v210, v192, v194
    v_sub_f32 v211, v193, v195
    v_lshlrev_b32 v204, 16, v82
    v_and_b32 v205, s65, v82
    v_lshlrev_b32 v206, 16, v90
    v_and_b32 v207, s65, v90
    v_sub_f32 v218, v198, v200
    v_sub_f32 v219, v199, v201
    v_cvt_pk_bf16_f32 v226, v210, v211
    s_waitcnt lgkmcnt(1)
    s_barrier
    ds_write_b128 v25, v[234:237] offset:29696
    v_lshlrev_b32 v192, 16, v83
    v_and_b32 v193, s65, v83
    v_lshlrev_b32 v194, 16, v91
    v_and_b32 v195, s65, v91
    v_sub_f32 v210, v204, v206
    v_sub_f32 v211, v205, v207
    v_cvt_pk_bf16_f32 v227, v218, v219
    v_sub_f32 v218, v192, v194
    v_sub_f32 v219, v193, v195
    v_cvt_pk_bf16_f32 v228, v210, v211
    v_cvt_pk_bf16_f32 v229, v218, v219
    s_waitcnt lgkmcnt(0)
    s_barrier
    ds_read_b128 v[108:111], v8 offset:13568
    ds_read_b128 v[156:159], v6 offset:14848
    ds_read_b128 v[152:155], v6 offset:12288
    s_waitcnt lgkmcnt(0)
    v_lshlrev_b32 v192, 16, v152
    v_and_b32 v193, s65, v152
    v_lshlrev_b32 v194, 16, v108
    v_and_b32 v195, s65, v108
    v_lshlrev_b32 v196, 16, v156
    v_and_b32 v197, s65, v156
    v_lshlrev_b32 v198, 16, v153
    v_and_b32 v199, s65, v153
    v_lshlrev_b32 v200, 16, v109
    v_and_b32 v201, s65, v109
    v_lshlrev_b32 v202, 16, v157
    v_and_b32 v203, s65, v157
    v_sub_f32 v210, v194, v196
    v_sub_f32 v211, v195, v197
    v_sub_f32 v212, v192, v194
    v_sub_f32 v213, v193, v195
    v_lshlrev_b32 v204, 16, v154
    v_and_b32 v205, s65, v154
    v_lshlrev_b32 v206, 16, v110
    v_and_b32 v207, s65, v110
    v_lshlrev_b32 v208, 16, v158
    v_and_b32 v209, s65, v158
    v_sub_f32 v218, v200, v202
    s_barrier
    ds_write_b128 v25, v[226:229] offset:31744
    ds_read_b128 v[120:123], v8 offset:13824
    ds_read_b128 v[164:167], v6 offset:15104
    ds_read_b128 v[160:163], v6 offset:12544
    v_sub_f32 v219, v201, v203
    v_sub_f32 v220, v198, v200
    v_sub_f32 v221, v199, v201
    v_cvt_pk_bf16_f32 v226, v210, v211
    v_cvt_pk_bf16_f32 v230, v212, v213
    v_lshlrev_b32 v192, 16, v155
    v_and_b32 v193, s65, v155
    v_lshlrev_b32 v194, 16, v111
    v_and_b32 v195, s65, v111
    v_lshlrev_b32 v196, 16, v159
    v_and_b32 v197, s65, v159
    v_sub_f32 v210, v206, v208
    v_sub_f32 v211, v207, v209
    v_sub_f32 v212, v204, v206
    v_sub_f32 v213, v205, v207
    v_cvt_pk_bf16_f32 v227, v218, v219
    v_cvt_pk_bf16_f32 v231, v220, v221
    v_sub_f32 v218, v194, v196
    v_sub_f32 v219, v195, v197
    v_sub_f32 v220, v192, v194
    v_sub_f32 v221, v193, v195
    v_cvt_pk_bf16_f32 v228, v210, v211
    v_cvt_pk_bf16_f32 v232, v212, v213
    v_cvt_pk_bf16_f32 v229, v218, v219
    s_waitcnt lgkmcnt(3)
    s_barrier
    ds_read_b64 v[180:181], v11 offset:13568
    ds_read_b64 v[190:191], v13 offset:14848
    ds_read_b64 v[188:189], v10 offset:12928
    v_cvt_pk_bf16_f32 v233, v220, v221
    s_waitcnt lgkmcnt(3)
    v_lshlrev_b32 v192, 16, v160
    v_and_b32 v193, s65, v160
    v_lshlrev_b32 v194, 16, v120
    v_and_b32 v195, s65, v120
    v_lshlrev_b32 v196, 16, v164
    v_and_b32 v197, s65, v164
    v_lshlrev_b32 v198, 16, v161
    v_and_b32 v199, s65, v161
    v_lshlrev_b32 v200, 16, v121
    v_and_b32 v201, s65, v121
    v_lshlrev_b32 v202, 16, v165
    v_and_b32 v203, s65, v165
    v_sub_f32 v210, v194, v196
    v_sub_f32 v211, v195, v197
    v_sub_f32 v212, v192, v194
    v_sub_f32 v213, v193, v195
    v_lshlrev_b32 v204, 16, v162
    v_and_b32 v205, s65, v162
    v_lshlrev_b32 v206, 16, v122
    v_and_b32 v207, s65, v122
    s_barrier
    ds_write_b128 v25, v[226:229] offset:7168
    ds_read_b64 v[182:183], v12 offset:14208
    ds_read_b128 v[116:119], v7 offset:13184
    ds_read_b128 v[124:127], v9 offset:14464
    v_lshlrev_b32 v208, 16, v166
    v_and_b32 v209, s65, v166
    v_sub_f32 v218, v200, v202
    v_sub_f32 v219, v201, v203
    v_sub_f32 v220, v198, v200
    v_sub_f32 v221, v199, v201
    v_cvt_pk_bf16_f32 v234, v210, v211
    v_cvt_pk_bf16_f32 v238, v212, v213
    v_lshlrev_b32 v192, 16, v163
    v_and_b32 v193, s65, v163
    v_lshlrev_b32 v194, 16, v123
    v_and_b32 v195, s65, v123
    v_lshlrev_b32 v196, 16, v167
    v_and_b32 v197, s65, v167
    v_sub_f32 v210, v206, v208
    v_sub_f32 v211, v207, v209
    v_sub_f32 v212, v204, v206
    v_sub_f32 v213, v205, v207
    v_cvt_pk_bf16_f32 v235, v218, v219
    v_cvt_pk_bf16_f32 v239, v220, v221
    v_sub_f32 v218, v194, v196
    v_sub_f32 v219, v195, v197
    v_sub_f32 v220, v192, v194
    v_sub_f32 v221, v193, v195
    s_barrier
    ds_write_b128 v25, v[230:233] offset:17408
    ds_read_b128 v[104:107], v7 offset:12928
    ds_read_b128 v[112:115], v9 offset:14208
    v_cvt_pk_bf16_f32 v236, v210, v211
    v_cvt_pk_bf16_f32 v240, v212, v213
    v_cvt_pk_bf16_f32 v237, v218, v219
    v_cvt_pk_bf16_f32 v241, v220, v221
    s_waitcnt lgkmcnt(5)
    v_lshlrev_b32 v192, 16, v180
    v_and_b32 v193, s65, v180
    v_lshlrev_b32 v194, 16, v190
    v_and_b32 v195, s65, v190
    v_lshlrev_b32 v196, 16, v188
    v_and_b32 v197, s65, v188
    v_lshlrev_b32 v198, 16, v182
    v_and_b32 v199, s65, v182
    v_lshlrev_b32 v200, 16, v181
    v_and_b32 v201, s65, v181
    v_lshlrev_b32 v202, 16, v191
    v_and_b32 v203, s65, v191
    v_lshlrev_b32 v204, 16, v189
    v_and_b32 v205, s65, v189
    v_lshlrev_b32 v206, 16, v183
    v_and_b32 v207, s65, v183
    v_sub_f32 v210, v192, v194
    s_waitcnt lgkmcnt(0)
    s_barrier
    ds_write_b128 v25, v[234:237] offset:5120
    v_sub_f32 v211, v193, v195
    v_sub_f32 v212, v196, v198
    v_sub_f32 v213, v197, v199
    v_sub_f32 v218, v200, v202
    v_sub_f32 v219, v201, v203
    v_sub_f32 v220, v204, v206
    v_sub_f32 v221, v205, v207
    v_cvt_pk_bf16_f32 v242, v210, v211
    v_cvt_pk_bf16_f32 v244, v212, v213
    v_cvt_pk_bf16_f32 v243, v218, v219
    v_cvt_pk_bf16_f32 v245, v220, v221
    v_lshlrev_b32 v192, 16, v116
    v_and_b32 v193, s65, v116
    v_lshlrev_b32 v194, 16, v124
    v_and_b32 v195, s65, v124
    v_lshlrev_b32 v198, 16, v117
    v_and_b32 v199, s65, v117
    v_lshlrev_b32 v200, 16, v125
    v_and_b32 v201, s65, v125
    v_sub_f32 v210, v192, v194
    v_sub_f32 v211, v193, v195
    v_lshlrev_b32 v204, 16, v118
    s_barrier
    ds_write2st64_b64 v27, v[242:243], v[244:245] offset0:10 offset1:20
    v_and_b32 v205, s65, v118
    v_lshlrev_b32 v206, 16, v126
    v_and_b32 v207, s65, v126
    v_sub_f32 v218, v198, v200
    v_sub_f32 v219, v199, v201
    v_cvt_pk_bf16_f32 v234, v210, v211
    v_lshlrev_b32 v192, 16, v119
    v_and_b32 v193, s65, v119
    v_lshlrev_b32 v194, 16, v127
    v_and_b32 v195, s65, v127
    v_sub_f32 v210, v204, v206
    v_sub_f32 v211, v205, v207
    v_cvt_pk_bf16_f32 v235, v218, v219
    v_sub_f32 v218, v192, v194
    v_sub_f32 v219, v193, v195
    v_cvt_pk_bf16_f32 v236, v210, v211
    v_cvt_pk_bf16_f32 v237, v218, v219
    v_lshlrev_b32 v192, 16, v104
    v_and_b32 v193, s65, v104
    v_lshlrev_b32 v194, 16, v112
    v_and_b32 v195, s65, v112
    v_lshlrev_b32 v198, 16, v105
    s_barrier
    ds_write_b128 v25, v[234:237] offset:10240
    v_and_b32 v199, s65, v105
    v_lshlrev_b32 v200, 16, v113
    v_and_b32 v201, s65, v113
    v_sub_f32 v210, v192, v194
    v_sub_f32 v211, v193, v195
    v_lshlrev_b32 v204, 16, v106
    v_and_b32 v205, s65, v106
    v_lshlrev_b32 v206, 16, v114
    v_and_b32 v207, s65, v114
    v_sub_f32 v218, v198, v200
    v_sub_f32 v219, v199, v201
    v_cvt_pk_bf16_f32 v226, v210, v211
    v_lshlrev_b32 v192, 16, v107
    v_and_b32 v193, s65, v107
    v_lshlrev_b32 v194, 16, v115
    v_and_b32 v195, s65, v115
    v_sub_f32 v210, v204, v206
    v_sub_f32 v211, v205, v207
    v_cvt_pk_bf16_f32 v227, v218, v219
    v_sub_f32 v218, v192, v194
    v_sub_f32 v219, v193, v195
    v_cvt_pk_bf16_f32 v228, v210, v211
    v_cvt_pk_bf16_f32 v229, v218, v219
    s_barrier
    ds_write_b128 v25, v[226:229] offset:12288
    v_and_b32 v30, 2, v0
    v_lshlrev_b32 v30, 4, v30
    v_sub_u32 v6, v6, v30
    v_sub_u32 v7, v7, v30
    v_sub_u32 v8, v8, v30
    v_sub_u32 v9, v9, v30
    v_sub_u32 v10, v10, v30
    v_sub_u32 v11, v11, v30
    v_sub_u32 v12, v12, v30
    v_sub_u32 v13, v13, v30
    s_waitcnt lgkmcnt(2)
    s_barrier
    ds_read_b128 v[132:135], v8 offset:1280
    ds_read_b128 v[156:159], v6 offset:2560
    ds_read_b128 v[152:155], v6 offset:0
    s_waitcnt lgkmcnt(0)
    v_lshlrev_b32 v192, 16, v152
    v_and_b32 v193, s65, v152
    v_lshlrev_b32 v194, 16, v132
    v_and_b32 v195, s65, v132
    v_lshlrev_b32 v196, 16, v156
    v_and_b32 v197, s65, v156
    v_lshlrev_b32 v198, 16, v153
    v_and_b32 v199, s65, v153
    v_lshlrev_b32 v200, 16, v133
    v_and_b32 v201, s65, v133
    v_lshlrev_b32 v202, 16, v157
    v_and_b32 v203, s65, v157
    v_sub_f32 v210, v194, v196
    v_sub_f32 v211, v195, v197
    v_sub_f32 v212, v192, v194
    v_sub_f32 v213, v193, v195
    v_lshlrev_b32 v204, 16, v154
    v_and_b32 v205, s65, v154
    v_lshlrev_b32 v206, 16, v134
    v_and_b32 v207, s65, v134
    v_lshlrev_b32 v208, 16, v158
    v_and_b32 v209, s65, v158
    v_sub_f32 v218, v200, v202
    v_sub_f32 v219, v201, v203
    v_sub_f32 v220, v198, v200
    v_sub_f32 v221, v199, v201
    s_barrier
    ds_write_b128 v25, v[238:241] offset:15360
    ds_read_b128 v[144:147], v8 offset:1536
    ds_read_b128 v[164:167], v6 offset:2816
    ds_read_b128 v[160:163], v6 offset:256
    v_cvt_pk_bf16_f32 v226, v210, v211
    v_cvt_pk_bf16_f32 v230, v212, v213
    v_lshlrev_b32 v192, 16, v155
    v_and_b32 v193, s65, v155
    v_lshlrev_b32 v194, 16, v135
    v_and_b32 v195, s65, v135
    v_lshlrev_b32 v196, 16, v159
    v_and_b32 v197, s65, v159
    v_sub_f32 v210, v206, v208
    v_sub_f32 v211, v207, v209
    v_sub_f32 v212, v204, v206
    v_sub_f32 v213, v205, v207
    v_cvt_pk_bf16_f32 v227, v218, v219
    v_cvt_pk_bf16_f32 v231, v220, v221
    v_sub_f32 v218, v194, v196
    v_sub_f32 v219, v195, v197
    v_sub_f32 v220, v192, v194
    v_sub_f32 v221, v193, v195
    v_cvt_pk_bf16_f32 v228, v210, v211
    v_cvt_pk_bf16_f32 v232, v212, v213
    v_cvt_pk_bf16_f32 v229, v218, v219
    v_cvt_pk_bf16_f32 v233, v220, v221
    s_waitcnt lgkmcnt(0)
    v_lshlrev_b32 v192, 16, v160
    v_and_b32 v193, s65, v160
    s_barrier
    ds_write_b128 v26, v[226:229] offset:26624
    ds_read_b64 v[184:185], v11 offset:1280
    ds_read_b64 v[190:191], v13 offset:2560
    ds_read_b64 v[188:189], v10 offset:640
    v_lshlrev_b32 v194, 16, v144
    v_and_b32 v195, s65, v144
    v_lshlrev_b32 v196, 16, v164
    v_and_b32 v197, s65, v164
    v_lshlrev_b32 v198, 16, v161
    v_and_b32 v199, s65, v161
    v_lshlrev_b32 v200, 16, v145
    v_and_b32 v201, s65, v145
    v_lshlrev_b32 v202, 16, v165
    v_and_b32 v203, s65, v165
    v_sub_f32 v210, v194, v196
    v_sub_f32 v211, v195, v197
    v_sub_f32 v212, v192, v194
    v_sub_f32 v213, v193, v195
    v_lshlrev_b32 v204, 16, v162
    v_and_b32 v205, s65, v162
    v_lshlrev_b32 v206, 16, v146
    v_and_b32 v207, s65, v146
    v_lshlrev_b32 v208, 16, v166
    v_and_b32 v209, s65, v166
    v_sub_f32 v218, v200, v202
    v_sub_f32 v219, v201, v203
    v_sub_f32 v220, v198, v200
    v_sub_f32 v221, v199, v201
    v_cvt_pk_bf16_f32 v234, v210, v211
    v_cvt_pk_bf16_f32 v238, v212, v213
    s_barrier
    ds_write_b128 v26, v[230:233] offset:36864
    ds_read_b64 v[186:187], v12 offset:1920
    ds_read_b128 v[128:131], v7 offset:640
    ds_read_b128 v[136:139], v9 offset:1920
    v_lshlrev_b32 v192, 16, v163
    v_and_b32 v193, s65, v163
    v_lshlrev_b32 v194, 16, v147
    v_and_b32 v195, s65, v147
    v_lshlrev_b32 v196, 16, v167
    v_and_b32 v197, s65, v167
    v_sub_f32 v210, v206, v208
    v_sub_f32 v211, v207, v209
    v_sub_f32 v212, v204, v206
    v_sub_f32 v213, v205, v207
    v_cvt_pk_bf16_f32 v235, v218, v219
    v_cvt_pk_bf16_f32 v239, v220, v221
    v_sub_f32 v218, v194, v196
    v_sub_f32 v219, v195, v197
    v_sub_f32 v220, v192, v194
    v_sub_f32 v221, v193, v195
    v_cvt_pk_bf16_f32 v236, v210, v211
    v_cvt_pk_bf16_f32 v240, v212, v213
    v_cvt_pk_bf16_f32 v237, v218, v219
    v_cvt_pk_bf16_f32 v241, v220, v221
    s_waitcnt lgkmcnt(2)
    v_lshlrev_b32 v192, 16, v184
    v_and_b32 v193, s65, v184
    v_lshlrev_b32 v194, 16, v190
    s_barrier
    ds_write_b128 v26, v[234:237] offset:24576
    ds_read_b128 v[140:143], v7 offset:896
    ds_read_b128 v[148:151], v9 offset:2176
    v_and_b32 v195, s65, v190
    v_lshlrev_b32 v196, 16, v188
    v_and_b32 v197, s65, v188
    v_lshlrev_b32 v198, 16, v186
    v_and_b32 v199, s65, v186
    v_lshlrev_b32 v200, 16, v185
    v_and_b32 v201, s65, v185
    v_lshlrev_b32 v202, 16, v191
    v_and_b32 v203, s65, v191
    v_lshlrev_b32 v204, 16, v189
    v_and_b32 v205, s65, v189
    v_lshlrev_b32 v206, 16, v187
    v_and_b32 v207, s65, v187
    v_sub_f32 v210, v192, v194
    v_sub_f32 v211, v193, v195
    v_sub_f32 v212, v196, v198
    v_sub_f32 v213, v197, v199
    v_sub_f32 v218, v200, v202
    v_sub_f32 v219, v201, v203
    v_sub_f32 v220, v204, v206
    v_sub_f32 v221, v205, v207
    v_cvt_pk_bf16_f32 v242, v210, v211
    v_cvt_pk_bf16_f32 v244, v212, v213
    v_cvt_pk_bf16_f32 v243, v218, v219
    v_cvt_pk_bf16_f32 v245, v220, v221
    s_waitcnt lgkmcnt(0)
    s_barrier
    ds_write_b128 v26, v[238:241] offset:34816
    v_lshlrev_b32 v192, 16, v128
    v_and_b32 v193, s65, v128
    v_lshlrev_b32 v194, 16, v136
    v_and_b32 v195, s65, v136
    v_lshlrev_b32 v198, 16, v129
    v_and_b32 v199, s65, v129
    v_lshlrev_b32 v200, 16, v137
    v_and_b32 v201, s65, v137
    v_sub_f32 v210, v192, v194
    v_sub_f32 v211, v193, v195
    v_lshlrev_b32 v204, 16, v130
    v_and_b32 v205, s65, v130
    v_lshlrev_b32 v206, 16, v138
    v_and_b32 v207, s65, v138
    v_sub_f32 v218, v198, v200
    v_sub_f32 v219, v199, v201
    v_cvt_pk_bf16_f32 v226, v210, v211
    v_lshlrev_b32 v192, 16, v131
    v_and_b32 v193, s65, v131
    v_lshlrev_b32 v194, 16, v139
    v_and_b32 v195, s65, v139
    v_sub_f32 v210, v204, v206
    s_barrier
    ds_write2st64_b64 v28, v[242:243], v[244:245] offset0:48 offset1:58
    v_sub_f32 v211, v205, v207
    v_cvt_pk_bf16_f32 v227, v218, v219
    v_sub_f32 v218, v192, v194
    v_sub_f32 v219, v193, v195
    v_cvt_pk_bf16_f32 v228, v210, v211
    v_cvt_pk_bf16_f32 v229, v218, v219
    v_lshlrev_b32 v192, 16, v140
    v_and_b32 v193, s65, v140
    v_lshlrev_b32 v194, 16, v148
    v_and_b32 v195, s65, v148
    v_lshlrev_b32 v198, 16, v141
    v_and_b32 v199, s65, v141
    v_lshlrev_b32 v200, 16, v149
    v_and_b32 v201, s65, v149
    v_sub_f32 v210, v192, v194
    v_sub_f32 v211, v193, v195
    v_lshlrev_b32 v204, 16, v142
    v_and_b32 v205, s65, v142
    v_lshlrev_b32 v206, 16, v150
    v_and_b32 v207, s65, v150
    v_sub_f32 v218, v198, v200
    s_barrier
    ds_write_b128 v26, v[226:229] offset:31744
    v_sub_f32 v219, v199, v201
    v_cvt_pk_bf16_f32 v234, v210, v211
    v_lshlrev_b32 v192, 16, v143
    v_and_b32 v193, s65, v143
    v_lshlrev_b32 v194, 16, v151
    v_and_b32 v195, s65, v151
    v_sub_f32 v210, v204, v206
    v_sub_f32 v211, v205, v207
    v_cvt_pk_bf16_f32 v235, v218, v219
    v_sub_f32 v218, v192, v194
    v_sub_f32 v219, v193, v195
    v_cvt_pk_bf16_f32 v236, v210, v211
    v_cvt_pk_bf16_f32 v237, v218, v219
    v_lshlrev_b32 v192, 16, v36
    v_and_b32 v193, s65, v36
    v_lshlrev_b32 v194, 16, v40
    v_and_b32 v195, s65, v40
    v_lshlrev_b32 v198, 16, v37
    v_and_b32 v199, s65, v37
    v_lshlrev_b32 v200, 16, v41
    v_and_b32 v201, s65, v41
    v_add_f32 v210, v192, v194
    s_barrier
    ds_write_b128 v26, v[234:237] offset:29696
    v_add_f32 v211, v193, v195
    v_sub_f32 v212, v194, v192
    v_sub_f32 v213, v195, v193
    v_lshlrev_b32 v204, 16, v38
    v_and_b32 v205, s65, v38
    v_lshlrev_b32 v206, 16, v42
    v_and_b32 v207, s65, v42
    v_add_f32 v218, v198, v200
    v_add_f32 v219, v199, v201
    v_sub_f32 v220, v200, v198
    v_sub_f32 v221, v201, v199
    v_cvt_pk_bf16_f32 v226, v210, v211
    v_cvt_pk_bf16_f32 v230, v212, v213
    v_lshlrev_b32 v192, 16, v39
    v_and_b32 v193, s65, v39
    v_lshlrev_b32 v194, 16, v43
    v_and_b32 v195, s65, v43
    v_add_f32 v210, v204, v206
    v_add_f32 v211, v205, v207
    v_sub_f32 v212, v206, v204
    v_sub_f32 v213, v207, v205
    v_cvt_pk_bf16_f32 v227, v218, v219
    v_cvt_pk_bf16_f32 v231, v220, v221
    s_barrier
    v_add_f32 v218, v192, v194
    v_add_f32 v219, v193, v195
    v_sub_f32 v220, v194, v192
    v_sub_f32 v221, v195, v193
    v_cvt_pk_bf16_f32 v228, v210, v211
    v_cvt_pk_bf16_f32 v232, v212, v213
    v_cvt_pk_bf16_f32 v229, v218, v219
    v_cvt_pk_bf16_f32 v233, v220, v221
    v_lshlrev_b32 v192, 16, v48
    v_and_b32 v193, s65, v48
    v_lshlrev_b32 v194, 16, v52
    v_and_b32 v195, s65, v52
    v_lshlrev_b32 v198, 16, v49
    v_and_b32 v199, s65, v49
    v_lshlrev_b32 v200, 16, v53
    v_and_b32 v201, s65, v53
    v_add_f32 v210, v192, v194
    v_add_f32 v211, v193, v195
    v_sub_f32 v212, v194, v192
    v_sub_f32 v213, v195, v193
    v_lshlrev_b32 v204, 16, v50
    s_waitcnt lgkmcnt(0)
    s_barrier
    ds_write_b128 v25, v[226:229] offset:7168
    v_and_b32 v205, s65, v50
    v_lshlrev_b32 v206, 16, v54
    v_and_b32 v207, s65, v54
    v_add_f32 v218, v198, v200
    v_add_f32 v219, v199, v201
    v_sub_f32 v220, v200, v198
    v_sub_f32 v221, v201, v199
    v_cvt_pk_bf16_f32 v234, v210, v211
    v_cvt_pk_bf16_f32 v238, v212, v213
    v_lshlrev_b32 v192, 16, v51
    v_and_b32 v193, s65, v51
    v_lshlrev_b32 v194, 16, v55
    v_and_b32 v195, s65, v55
    v_add_f32 v210, v204, v206
    v_add_f32 v211, v205, v207
    v_sub_f32 v212, v206, v204
    v_sub_f32 v213, v207, v205
    v_cvt_pk_bf16_f32 v235, v218, v219
    v_cvt_pk_bf16_f32 v239, v220, v221
    v_add_f32 v218, v192, v194
    v_add_f32 v219, v193, v195
    v_sub_f32 v220, v194, v192
    v_sub_f32 v221, v195, v193
    s_barrier
    ds_write_b128 v25, v[230:233] offset:16384
    v_cvt_pk_bf16_f32 v236, v210, v211
    v_cvt_pk_bf16_f32 v240, v212, v213
    v_cvt_pk_bf16_f32 v237, v218, v219
    v_cvt_pk_bf16_f32 v241, v220, v221
    v_lshlrev_b32 v192, 16, v168
    v_and_b32 v193, s65, v168
    v_lshlrev_b32 v194, 16, v170
    v_and_b32 v195, s65, v170
    v_lshlrev_b32 v198, 16, v169
    v_and_b32 v199, s65, v169
    v_lshlrev_b32 v200, 16, v171
    v_and_b32 v201, s65, v171
    v_add_f32 v210, v192, v194
    v_add_f32 v211, v193, v195
    v_sub_f32 v212, v194, v192
    v_sub_f32 v213, v195, v193
    v_add_f32 v218, v198, v200
    v_add_f32 v219, v199, v201
    v_sub_f32 v220, v200, v198
    v_sub_f32 v221, v201, v199
    v_cvt_pk_bf16_f32 v242, v210, v211
    s_barrier
    ds_write_b128 v25, v[234:237] offset:5120
    v_cvt_pk_bf16_f32 v244, v212, v213
    v_cvt_pk_bf16_f32 v243, v218, v219
    v_cvt_pk_bf16_f32 v245, v220, v221
    v_lshlrev_b32 v192, 16, v32
    v_and_b32 v193, s65, v32
    v_lshlrev_b32 v194, 16, v36
    v_and_b32 v195, s65, v36
    v_lshlrev_b32 v198, 16, v33
    v_and_b32 v199, s65, v33
    v_lshlrev_b32 v200, 16, v37
    v_and_b32 v201, s65, v37
    v_add_f32 v210, v192, v194
    v_add_f32 v211, v193, v195
    v_sub_f32 v212, v194, v192
    v_sub_f32 v213, v195, v193
    v_lshlrev_b32 v204, 16, v34
    v_and_b32 v205, s65, v34
    v_lshlrev_b32 v206, 16, v38
    v_and_b32 v207, s65, v38
    v_add_f32 v218, v198, v200
    v_add_f32 v219, v199, v201
    s_barrier
    ds_write2st64_b64 v27, v[242:243], v[244:245] offset0:10 offset1:28
    v_sub_f32 v220, v200, v198
    v_sub_f32 v221, v201, v199
    v_cvt_pk_bf16_f32 v226, v210, v211
    v_cvt_pk_bf16_f32 v230, v212, v213
    v_lshlrev_b32 v192, 16, v35
    v_and_b32 v193, s65, v35
    v_lshlrev_b32 v194, 16, v39
    v_and_b32 v195, s65, v39
    v_add_f32 v210, v204, v206
    v_add_f32 v211, v205, v207
    v_sub_f32 v212, v206, v204
    v_sub_f32 v213, v207, v205
    v_cvt_pk_bf16_f32 v227, v218, v219
    v_cvt_pk_bf16_f32 v231, v220, v221
    v_add_f32 v218, v192, v194
    v_add_f32 v219, v193, v195
    v_sub_f32 v220, v194, v192
    v_sub_f32 v221, v195, v193
    v_cvt_pk_bf16_f32 v228, v210, v211
    v_cvt_pk_bf16_f32 v232, v212, v213
    v_cvt_pk_bf16_f32 v229, v218, v219
    v_cvt_pk_bf16_f32 v233, v220, v221
    s_barrier
    ds_write_b128 v25, v[238:241] offset:14336
    v_lshlrev_b32 v192, 16, v44
    v_and_b32 v193, s65, v44
    v_lshlrev_b32 v194, 16, v48
    v_and_b32 v195, s65, v48
    v_lshlrev_b32 v198, 16, v45
    v_and_b32 v199, s65, v45
    v_lshlrev_b32 v200, 16, v49
    v_and_b32 v201, s65, v49
    v_add_f32 v210, v192, v194
    v_add_f32 v211, v193, v195
    v_sub_f32 v212, v194, v192
    v_sub_f32 v213, v195, v193
    v_lshlrev_b32 v204, 16, v46
    v_and_b32 v205, s65, v46
    v_lshlrev_b32 v206, 16, v50
    v_and_b32 v207, s65, v50
    v_add_f32 v218, v198, v200
    v_add_f32 v219, v199, v201
    v_sub_f32 v220, v200, v198
    v_sub_f32 v221, v201, v199
    s_barrier
    ds_write_b128 v25, v[226:229] offset:12288
    v_cvt_pk_bf16_f32 v234, v210, v211
    v_cvt_pk_bf16_f32 v238, v212, v213
    v_lshlrev_b32 v192, 16, v47
    v_and_b32 v193, s65, v47
    v_lshlrev_b32 v194, 16, v51
    v_and_b32 v195, s65, v51
    v_add_f32 v210, v204, v206
    v_add_f32 v211, v205, v207
    v_sub_f32 v212, v206, v204
    v_sub_f32 v213, v207, v205
    v_cvt_pk_bf16_f32 v235, v218, v219
    v_cvt_pk_bf16_f32 v239, v220, v221
    v_add_f32 v218, v192, v194
    v_add_f32 v219, v193, v195
    v_sub_f32 v220, v194, v192
    v_sub_f32 v221, v195, v193
    v_cvt_pk_bf16_f32 v236, v210, v211
    v_cvt_pk_bf16_f32 v240, v212, v213
    v_cvt_pk_bf16_f32 v237, v218, v219
    v_cvt_pk_bf16_f32 v241, v220, v221
    s_waitcnt lgkmcnt(2)
    s_barrier
    ds_write_b128 v25, v[234:237] offset:10240
    v_lshlrev_b32 v192, 16, v60
    v_and_b32 v193, s65, v60
    v_lshlrev_b32 v194, 16, v64
    v_and_b32 v195, s65, v64
    v_lshlrev_b32 v198, 16, v61
    v_and_b32 v199, s65, v61
    v_lshlrev_b32 v200, 16, v65
    v_and_b32 v201, s65, v65
    v_add_f32 v210, v192, v194
    v_add_f32 v211, v193, v195
    v_sub_f32 v212, v194, v192
    v_sub_f32 v213, v195, v193
    v_lshlrev_b32 v204, 16, v62
    v_and_b32 v205, s65, v62
    v_lshlrev_b32 v206, 16, v66
    v_and_b32 v207, s65, v66
    v_add_f32 v218, v198, v200
    v_add_f32 v219, v199, v201
    v_sub_f32 v220, v200, v198
    v_sub_f32 v221, v201, v199
    v_cvt_pk_bf16_f32 v226, v210, v211
    s_waitcnt lgkmcnt(0)
    s_barrier
    ds_write_b128 v25, v[230:233] offset:21504
    v_cvt_pk_bf16_f32 v230, v212, v213
    v_lshlrev_b32 v192, 16, v63
    v_and_b32 v193, s65, v63
    v_lshlrev_b32 v194, 16, v67
    v_and_b32 v195, s65, v67
    v_add_f32 v210, v204, v206
    v_add_f32 v211, v205, v207
    v_sub_f32 v212, v206, v204
    v_sub_f32 v213, v207, v205
    v_cvt_pk_bf16_f32 v227, v218, v219
    v_cvt_pk_bf16_f32 v231, v220, v221
    v_add_f32 v218, v192, v194
    v_add_f32 v219, v193, v195
    v_sub_f32 v220, v194, v192
    v_sub_f32 v221, v195, v193
    v_cvt_pk_bf16_f32 v228, v210, v211
    v_cvt_pk_bf16_f32 v232, v212, v213
    v_cvt_pk_bf16_f32 v229, v218, v219
    v_cvt_pk_bf16_f32 v233, v220, v221
    s_barrier
    ds_write_b128 v25, v[238:241] offset:19456
    v_lshlrev_b32 v192, 16, v72
    v_and_b32 v193, s65, v72
    v_lshlrev_b32 v194, 16, v76
    v_and_b32 v195, s65, v76
    v_lshlrev_b32 v198, 16, v73
    v_and_b32 v199, s65, v73
    v_lshlrev_b32 v200, 16, v77
    v_and_b32 v201, s65, v77
    v_add_f32 v210, v192, v194
    v_add_f32 v211, v193, v195
    v_sub_f32 v212, v194, v192
    v_sub_f32 v213, v195, v193
    v_lshlrev_b32 v204, 16, v74
    v_and_b32 v205, s65, v74
    v_lshlrev_b32 v206, 16, v78
    v_and_b32 v207, s65, v78
    v_add_f32 v218, v198, v200
    v_add_f32 v219, v199, v201
    v_sub_f32 v220, v200, v198
    v_sub_f32 v221, v201, v199
    v_cvt_pk_bf16_f32 v234, v210, v211
    s_barrier
    ds_write_b128 v25, v[226:229] offset:26624
    v_cvt_pk_bf16_f32 v238, v212, v213
    v_lshlrev_b32 v192, 16, v75
    v_and_b32 v193, s65, v75
    v_lshlrev_b32 v194, 16, v79
    v_and_b32 v195, s65, v79
    v_add_f32 v210, v204, v206
    v_add_f32 v211, v205, v207
    v_sub_f32 v212, v206, v204
    v_sub_f32 v213, v207, v205
    v_cvt_pk_bf16_f32 v235, v218, v219
    v_cvt_pk_bf16_f32 v239, v220, v221
    v_add_f32 v218, v192, v194
    v_add_f32 v219, v193, v195
    v_sub_f32 v220, v194, v192
    v_sub_f32 v221, v195, v193
    v_cvt_pk_bf16_f32 v236, v210, v211
    v_cvt_pk_bf16_f32 v240, v212, v213
    v_cvt_pk_bf16_f32 v237, v218, v219
    v_cvt_pk_bf16_f32 v241, v220, v221
    s_barrier
    ds_write_b128 v25, v[234:237] offset:24576
    v_lshlrev_b32 v192, 16, v172
    v_and_b32 v193, s65, v172
    v_lshlrev_b32 v194, 16, v174
    v_and_b32 v195, s65, v174
    v_lshlrev_b32 v198, 16, v173
    v_and_b32 v199, s65, v173
    v_lshlrev_b32 v200, 16, v175
    v_and_b32 v201, s65, v175
    v_add_f32 v210, v192, v194
    v_add_f32 v211, v193, v195
    v_sub_f32 v212, v194, v192
    v_sub_f32 v213, v195, v193
    v_add_f32 v218, v198, v200
    v_add_f32 v219, v199, v201
    v_sub_f32 v220, v200, v198
    v_sub_f32 v221, v201, v199
    v_cvt_pk_bf16_f32 v242, v210, v211
    v_cvt_pk_bf16_f32 v244, v212, v213
    v_cvt_pk_bf16_f32 v243, v218, v219
    v_cvt_pk_bf16_f32 v245, v220, v221
    s_barrier
    ds_write2st64_b64 v27, v[242:243], v[244:245] offset0:48 offset1:66
    v_lshlrev_b32 v192, 16, v56
    v_and_b32 v193, s65, v56
    v_lshlrev_b32 v194, 16, v60
    v_and_b32 v195, s65, v60
    v_lshlrev_b32 v198, 16, v57
    v_and_b32 v199, s65, v57
    v_lshlrev_b32 v200, 16, v61
    v_and_b32 v201, s65, v61
    v_add_f32 v210, v192, v194
    v_add_f32 v211, v193, v195
    v_sub_f32 v212, v194, v192
    v_sub_f32 v213, v195, v193
    v_lshlrev_b32 v204, 16, v58
    v_and_b32 v205, s65, v58
    v_lshlrev_b32 v206, 16, v62
    v_and_b32 v207, s65, v62
    v_add_f32 v218, v198, v200
    v_add_f32 v219, v199, v201
    v_sub_f32 v220, v200, v198
    v_sub_f32 v221, v201, v199
    v_cvt_pk_bf16_f32 v226, v210, v211
    s_waitcnt lgkmcnt(3)
    s_barrier
    ds_write_b128 v25, v[230:233] offset:35840
    v_cvt_pk_bf16_f32 v230, v212, v213
    v_lshlrev_b32 v192, 16, v59
    v_and_b32 v193, s65, v59
    v_lshlrev_b32 v194, 16, v63
    v_and_b32 v195, s65, v63
    v_add_f32 v210, v204, v206
    v_add_f32 v211, v205, v207
    v_sub_f32 v212, v206, v204
    v_sub_f32 v213, v207, v205
    v_cvt_pk_bf16_f32 v227, v218, v219
    v_cvt_pk_bf16_f32 v231, v220, v221
    v_add_f32 v218, v192, v194
    v_add_f32 v219, v193, v195
    v_sub_f32 v220, v194, v192
    v_sub_f32 v221, v195, v193
    v_cvt_pk_bf16_f32 v228, v210, v211
    v_cvt_pk_bf16_f32 v232, v212, v213
    v_cvt_pk_bf16_f32 v229, v218, v219
    v_cvt_pk_bf16_f32 v233, v220, v221
    s_barrier
    ds_write_b128 v25, v[226:229] offset:31744
    v_lshlrev_b32 v192, 16, v68
    v_and_b32 v193, s65, v68
    v_lshlrev_b32 v194, 16, v72
    v_and_b32 v195, s65, v72
    v_lshlrev_b32 v198, 16, v69
    v_and_b32 v199, s65, v69
    v_lshlrev_b32 v200, 16, v73
    v_and_b32 v201, s65, v73
    v_add_f32 v210, v192, v194
    v_add_f32 v211, v193, v195
    v_sub_f32 v212, v194, v192
    v_sub_f32 v213, v195, v193
    v_lshlrev_b32 v204, 16, v70
    v_and_b32 v205, s65, v70
    v_lshlrev_b32 v206, 16, v74
    v_and_b32 v207, s65, v74
    v_add_f32 v218, v198, v200
    v_add_f32 v219, v199, v201
    v_sub_f32 v220, v200, v198
    v_sub_f32 v221, v201, v199
    v_cvt_pk_bf16_f32 v234, v210, v211
    s_barrier
    ds_write_b128 v25, v[238:241] offset:33792
    v_cvt_pk_bf16_f32 v238, v212, v213
    v_lshlrev_b32 v192, 16, v71
    v_and_b32 v193, s65, v71
    v_lshlrev_b32 v194, 16, v75
    v_and_b32 v195, s65, v75
    v_add_f32 v210, v204, v206
    v_add_f32 v211, v205, v207
    v_sub_f32 v212, v206, v204
    v_sub_f32 v213, v207, v205
    v_cvt_pk_bf16_f32 v235, v218, v219
    v_cvt_pk_bf16_f32 v239, v220, v221
    v_add_f32 v218, v192, v194
    v_add_f32 v219, v193, v195
    v_sub_f32 v220, v194, v192
    v_sub_f32 v221, v195, v193
    v_cvt_pk_bf16_f32 v236, v210, v211
    v_cvt_pk_bf16_f32 v240, v212, v213
    v_cvt_pk_bf16_f32 v237, v218, v219
    v_cvt_pk_bf16_f32 v241, v220, v221
    s_barrier
    ds_write_b128 v25, v[234:237] offset:29696
    v_lshlrev_b32 v192, 16, v84
    v_and_b32 v193, s65, v84
    v_lshlrev_b32 v194, 16, v88
    v_and_b32 v195, s65, v88
    v_lshlrev_b32 v198, 16, v85
    v_and_b32 v199, s65, v85
    v_lshlrev_b32 v200, 16, v89
    v_and_b32 v201, s65, v89
    v_add_f32 v210, v192, v194
    v_add_f32 v211, v193, v195
    v_sub_f32 v212, v194, v192
    v_sub_f32 v213, v195, v193
    v_lshlrev_b32 v204, 16, v86
    v_and_b32 v205, s65, v86
    v_lshlrev_b32 v206, 16, v90
    v_and_b32 v207, s65, v90
    v_add_f32 v218, v198, v200
    v_add_f32 v219, v199, v201
    v_sub_f32 v220, v200, v198
    v_sub_f32 v221, v201, v199
    s_waitcnt lgkmcnt(4)
    s_barrier
    ds_write_b128 v25, v[230:233] offset:40960
    v_cvt_pk_bf16_f32 v226, v210, v211
    v_cvt_pk_bf16_f32 v230, v212, v213
    v_lshlrev_b32 v192, 16, v87
    v_and_b32 v193, s65, v87
    v_lshlrev_b32 v194, 16, v91
    v_and_b32 v195, s65, v91
    v_add_f32 v210, v204, v206
    v_add_f32 v211, v205, v207
    v_sub_f32 v212, v206, v204
    v_sub_f32 v213, v207, v205
    v_cvt_pk_bf16_f32 v227, v218, v219
    v_cvt_pk_bf16_f32 v231, v220, v221
    v_add_f32 v218, v192, v194
    v_add_f32 v219, v193, v195
    v_sub_f32 v220, v194, v192
    v_sub_f32 v221, v195, v193
    v_cvt_pk_bf16_f32 v228, v210, v211
    v_cvt_pk_bf16_f32 v232, v212, v213
    v_cvt_pk_bf16_f32 v229, v218, v219
    v_cvt_pk_bf16_f32 v233, v220, v221
    s_waitcnt lgkmcnt(1)
    s_barrier
    ds_write_b128 v25, v[238:241] offset:38912
    v_lshlrev_b32 v192, 16, v96
    v_and_b32 v193, s65, v96
    v_lshlrev_b32 v194, 16, v100
    v_and_b32 v195, s65, v100
    v_lshlrev_b32 v198, 16, v97
    v_and_b32 v199, s65, v97
    v_lshlrev_b32 v200, 16, v101
    v_and_b32 v201, s65, v101
    v_add_f32 v210, v192, v194
    v_add_f32 v211, v193, v195
    v_sub_f32 v212, v194, v192
    v_sub_f32 v213, v195, v193
    v_lshlrev_b32 v204, 16, v98
    v_and_b32 v205, s65, v98
    v_lshlrev_b32 v206, 16, v102
    v_and_b32 v207, s65, v102
    v_add_f32 v218, v198, v200
    v_add_f32 v219, v199, v201
    s_barrier
    ds_write_b128 v25, v[226:229] offset:7168
    v_sub_f32 v220, v200, v198
    v_sub_f32 v221, v201, v199
    v_cvt_pk_bf16_f32 v234, v210, v211
    v_cvt_pk_bf16_f32 v238, v212, v213
    v_lshlrev_b32 v192, 16, v99
    v_and_b32 v193, s65, v99
    v_lshlrev_b32 v194, 16, v103
    v_and_b32 v195, s65, v103
    v_add_f32 v210, v204, v206
    v_add_f32 v211, v205, v207
    v_sub_f32 v212, v206, v204
    v_sub_f32 v213, v207, v205
    v_cvt_pk_bf16_f32 v235, v218, v219
    v_cvt_pk_bf16_f32 v239, v220, v221
    v_add_f32 v218, v192, v194
    v_add_f32 v219, v193, v195
    v_sub_f32 v220, v194, v192
    v_sub_f32 v221, v195, v193
    v_cvt_pk_bf16_f32 v236, v210, v211
    v_cvt_pk_bf16_f32 v240, v212, v213
    s_barrier
    ds_write_b128 v25, v[230:233] offset:16384
    v_cvt_pk_bf16_f32 v237, v218, v219
    v_cvt_pk_bf16_f32 v241, v220, v221
    v_lshlrev_b32 v192, 16, v176
    v_and_b32 v193, s65, v176
    v_lshlrev_b32 v194, 16, v178
    v_and_b32 v195, s65, v178
    v_lshlrev_b32 v198, 16, v177
    v_and_b32 v199, s65, v177
    v_lshlrev_b32 v200, 16, v179
    v_and_b32 v201, s65, v179
    v_add_f32 v210, v192, v194
    v_add_f32 v211, v193, v195
    v_sub_f32 v212, v194, v192
    v_sub_f32 v213, v195, v193
    v_add_f32 v218, v198, v200
    v_add_f32 v219, v199, v201
    v_sub_f32 v220, v200, v198
    v_sub_f32 v221, v201, v199
    s_barrier
    ds_write_b128 v25, v[234:237] offset:5120
    v_cvt_pk_bf16_f32 v242, v210, v211
    v_cvt_pk_bf16_f32 v244, v212, v213
    v_cvt_pk_bf16_f32 v243, v218, v219
    v_cvt_pk_bf16_f32 v245, v220, v221
    v_lshlrev_b32 v192, 16, v80
    v_and_b32 v193, s65, v80
    v_lshlrev_b32 v194, 16, v84
    v_and_b32 v195, s65, v84
    v_lshlrev_b32 v198, 16, v81
    v_and_b32 v199, s65, v81
    v_lshlrev_b32 v200, 16, v85
    v_and_b32 v201, s65, v85
    v_add_f32 v210, v192, v194
    v_add_f32 v211, v193, v195
    v_sub_f32 v212, v194, v192
    v_sub_f32 v213, v195, v193
    v_lshlrev_b32 v204, 16, v82
    v_and_b32 v205, s65, v82
    v_lshlrev_b32 v206, 16, v86
    s_barrier
    ds_write2st64_b64 v27, v[242:243], v[244:245] offset0:10 offset1:28
    v_and_b32 v207, s65, v86
    v_add_f32 v218, v198, v200
    v_add_f32 v219, v199, v201
    v_sub_f32 v220, v200, v198
    v_sub_f32 v221, v201, v199
    v_cvt_pk_bf16_f32 v226, v210, v211
    v_cvt_pk_bf16_f32 v230, v212, v213
    v_lshlrev_b32 v192, 16, v83
    v_and_b32 v193, s65, v83
    v_lshlrev_b32 v194, 16, v87
    v_and_b32 v195, s65, v87
    v_add_f32 v210, v204, v206
    v_add_f32 v211, v205, v207
    v_sub_f32 v212, v206, v204
    v_sub_f32 v213, v207, v205
    v_cvt_pk_bf16_f32 v227, v218, v219
    v_cvt_pk_bf16_f32 v231, v220, v221
    v_add_f32 v218, v192, v194
    v_add_f32 v219, v193, v195
    v_sub_f32 v220, v194, v192
    s_waitcnt lgkmcnt(4)
    s_barrier
    ds_write_b128 v25, v[238:241] offset:14336
    v_sub_f32 v221, v195, v193
    v_cvt_pk_bf16_f32 v228, v210, v211
    v_cvt_pk_bf16_f32 v232, v212, v213
    v_cvt_pk_bf16_f32 v229, v218, v219
    v_cvt_pk_bf16_f32 v233, v220, v221
    v_lshlrev_b32 v192, 16, v92
    v_and_b32 v193, s65, v92
    v_lshlrev_b32 v194, 16, v96
    v_and_b32 v195, s65, v96
    v_lshlrev_b32 v198, 16, v93
    v_and_b32 v199, s65, v93
    v_lshlrev_b32 v200, 16, v97
    v_and_b32 v201, s65, v97
    v_add_f32 v210, v192, v194
    v_add_f32 v211, v193, v195
    v_sub_f32 v212, v194, v192
    v_sub_f32 v213, v195, v193
    v_lshlrev_b32 v204, 16, v94
    s_barrier
    ds_write_b128 v25, v[226:229] offset:12288
    v_and_b32 v205, s65, v94
    v_lshlrev_b32 v206, 16, v98
    v_and_b32 v207, s65, v98
    v_add_f32 v218, v198, v200
    v_add_f32 v219, v199, v201
    v_sub_f32 v220, v200, v198
    v_sub_f32 v221, v201, v199
    v_cvt_pk_bf16_f32 v234, v210, v211
    v_cvt_pk_bf16_f32 v238, v212, v213
    v_lshlrev_b32 v192, 16, v95
    v_and_b32 v193, s65, v95
    v_lshlrev_b32 v194, 16, v99
    v_and_b32 v195, s65, v99
    v_add_f32 v210, v204, v206
    v_add_f32 v211, v205, v207
    v_sub_f32 v212, v206, v204
    v_sub_f32 v213, v207, v205
    v_cvt_pk_bf16_f32 v235, v218, v219
    v_cvt_pk_bf16_f32 v239, v220, v221
    v_add_f32 v218, v192, v194
    s_barrier
    ds_write_b128 v25, v[230:233] offset:21504
    v_add_f32 v219, v193, v195
    v_sub_f32 v220, v194, v192
    v_sub_f32 v221, v195, v193
    v_cvt_pk_bf16_f32 v236, v210, v211
    v_cvt_pk_bf16_f32 v240, v212, v213
    v_cvt_pk_bf16_f32 v237, v218, v219
    v_cvt_pk_bf16_f32 v241, v220, v221
    s_barrier
    ds_write_b128 v25, v[234:237] offset:10240
    v_lshlrev_b32 v192, 16, v108
    v_and_b32 v193, s65, v108
    v_lshlrev_b32 v194, 16, v112
    v_and_b32 v195, s65, v112
    v_lshlrev_b32 v198, 16, v109
    v_and_b32 v199, s65, v109
    v_lshlrev_b32 v200, 16, v113
    v_and_b32 v201, s65, v113
    v_add_f32 v210, v192, v194
    v_add_f32 v211, v193, v195
    v_sub_f32 v212, v194, v192
    v_sub_f32 v213, v195, v193
    v_lshlrev_b32 v204, 16, v110
    v_and_b32 v205, s65, v110
    v_lshlrev_b32 v206, 16, v114
    v_and_b32 v207, s65, v114
    v_add_f32 v218, v198, v200
    v_add_f32 v219, v199, v201
    v_sub_f32 v220, v200, v198
    v_sub_f32 v221, v201, v199
    s_waitcnt lgkmcnt(4)
    s_barrier
    ds_write_b128 v25, v[238:241] offset:19456
    v_cvt_pk_bf16_f32 v226, v210, v211
    v_cvt_pk_bf16_f32 v230, v212, v213
    v_lshlrev_b32 v192, 16, v111
    v_and_b32 v193, s65, v111
    v_lshlrev_b32 v194, 16, v115
    v_and_b32 v195, s65, v115
    v_add_f32 v210, v204, v206
    v_add_f32 v211, v205, v207
    v_sub_f32 v212, v206, v204
    v_sub_f32 v213, v207, v205
    v_cvt_pk_bf16_f32 v227, v218, v219
    v_cvt_pk_bf16_f32 v231, v220, v221
    v_add_f32 v218, v192, v194
    v_add_f32 v219, v193, v195
    v_sub_f32 v220, v194, v192
    v_sub_f32 v221, v195, v193
    v_cvt_pk_bf16_f32 v228, v210, v211
    v_cvt_pk_bf16_f32 v232, v212, v213
    v_cvt_pk_bf16_f32 v229, v218, v219
    v_cvt_pk_bf16_f32 v233, v220, v221
    s_waitcnt lgkmcnt(1)
    s_barrier
    v_lshlrev_b32 v192, 16, v120
    v_and_b32 v193, s65, v120
    v_lshlrev_b32 v194, 16, v124
    v_and_b32 v195, s65, v124
    v_lshlrev_b32 v198, 16, v121
    v_and_b32 v199, s65, v121
    v_lshlrev_b32 v200, 16, v125
    v_and_b32 v201, s65, v125
    v_add_f32 v210, v192, v194
    v_add_f32 v211, v193, v195
    v_sub_f32 v212, v194, v192
    v_sub_f32 v213, v195, v193
    v_lshlrev_b32 v204, 16, v122
    v_and_b32 v205, s65, v122
    v_lshlrev_b32 v206, 16, v126
    v_and_b32 v207, s65, v126
    v_add_f32 v218, v198, v200
    v_add_f32 v219, v199, v201
    s_barrier
    ds_write_b128 v25, v[226:229] offset:26624
    v_sub_f32 v220, v200, v198
    v_sub_f32 v221, v201, v199
    v_cvt_pk_bf16_f32 v234, v210, v211
    v_cvt_pk_bf16_f32 v238, v212, v213
    v_lshlrev_b32 v192, 16, v123
    v_and_b32 v193, s65, v123
    v_lshlrev_b32 v194, 16, v127
    v_and_b32 v195, s65, v127
    v_add_f32 v210, v204, v206
    v_add_f32 v211, v205, v207
    v_sub_f32 v212, v206, v204
    v_sub_f32 v213, v207, v205
    v_cvt_pk_bf16_f32 v235, v218, v219
    v_cvt_pk_bf16_f32 v239, v220, v221
    v_add_f32 v218, v192, v194
    v_add_f32 v219, v193, v195
    v_sub_f32 v220, v194, v192
    v_sub_f32 v221, v195, v193
    v_cvt_pk_bf16_f32 v236, v210, v211
    v_cvt_pk_bf16_f32 v240, v212, v213
    s_barrier
    ds_write_b128 v25, v[230:233] offset:35840
    v_cvt_pk_bf16_f32 v237, v218, v219
    v_cvt_pk_bf16_f32 v241, v220, v221
    v_lshlrev_b32 v192, 16, v180
    v_and_b32 v193, s65, v180
    v_lshlrev_b32 v194, 16, v182
    v_and_b32 v195, s65, v182
    v_lshlrev_b32 v198, 16, v181
    v_and_b32 v199, s65, v181
    v_lshlrev_b32 v200, 16, v183
    v_and_b32 v201, s65, v183
    v_add_f32 v210, v192, v194
    v_add_f32 v211, v193, v195
    v_sub_f32 v212, v194, v192
    v_sub_f32 v213, v195, v193
    v_add_f32 v218, v198, v200
    v_add_f32 v219, v199, v201
    v_sub_f32 v220, v200, v198
    v_sub_f32 v221, v201, v199
    s_barrier
    ds_write_b128 v25, v[234:237] offset:24576
    v_cvt_pk_bf16_f32 v242, v210, v211
    v_cvt_pk_bf16_f32 v244, v212, v213
    v_cvt_pk_bf16_f32 v243, v218, v219
    v_cvt_pk_bf16_f32 v245, v220, v221
    v_lshlrev_b32 v192, 16, v104
    v_and_b32 v193, s65, v104
    v_lshlrev_b32 v194, 16, v108
    v_and_b32 v195, s65, v108
    v_lshlrev_b32 v198, 16, v105
    v_and_b32 v199, s65, v105
    v_lshlrev_b32 v200, 16, v109
    v_and_b32 v201, s65, v109
    v_add_f32 v210, v192, v194
    v_add_f32 v211, v193, v195
    v_sub_f32 v212, v194, v192
    v_sub_f32 v213, v195, v193
    v_lshlrev_b32 v204, 16, v106
    v_and_b32 v205, s65, v106
    v_lshlrev_b32 v206, 16, v110
    s_barrier
    ds_write2st64_b64 v27, v[242:243], v[244:245] offset0:48 offset1:66
    v_and_b32 v207, s65, v110
    v_add_f32 v218, v198, v200
    v_add_f32 v219, v199, v201
    v_sub_f32 v220, v200, v198
    v_sub_f32 v221, v201, v199
    v_cvt_pk_bf16_f32 v226, v210, v211
    v_cvt_pk_bf16_f32 v230, v212, v213
    v_lshlrev_b32 v192, 16, v107
    v_and_b32 v193, s65, v107
    v_lshlrev_b32 v194, 16, v111
    v_and_b32 v195, s65, v111
    v_add_f32 v210, v204, v206
    v_add_f32 v211, v205, v207
    v_sub_f32 v212, v206, v204
    v_sub_f32 v213, v207, v205
    v_cvt_pk_bf16_f32 v227, v218, v219
    v_cvt_pk_bf16_f32 v231, v220, v221
    v_add_f32 v218, v192, v194
    v_add_f32 v219, v193, v195
    v_sub_f32 v220, v194, v192
    s_waitcnt lgkmcnt(4)
    s_barrier
    ds_write_b128 v25, v[238:241] offset:33792
    v_sub_f32 v221, v195, v193
    v_cvt_pk_bf16_f32 v228, v210, v211
    v_cvt_pk_bf16_f32 v232, v212, v213
    v_cvt_pk_bf16_f32 v229, v218, v219
    v_cvt_pk_bf16_f32 v233, v220, v221
    v_lshlrev_b32 v192, 16, v116
    v_and_b32 v193, s65, v116
    v_lshlrev_b32 v194, 16, v120
    v_and_b32 v195, s65, v120
    v_lshlrev_b32 v198, 16, v117
    v_and_b32 v199, s65, v117
    v_lshlrev_b32 v200, 16, v121
    v_and_b32 v201, s65, v121
    v_add_f32 v210, v192, v194
    v_add_f32 v211, v193, v195
    v_sub_f32 v212, v194, v192
    v_sub_f32 v213, v195, v193
    v_lshlrev_b32 v204, 16, v118
    s_barrier
    ds_write_b128 v25, v[226:229] offset:31744
    v_and_b32 v205, s65, v118
    v_lshlrev_b32 v206, 16, v122
    v_and_b32 v207, s65, v122
    v_add_f32 v218, v198, v200
    v_add_f32 v219, v199, v201
    v_sub_f32 v220, v200, v198
    v_sub_f32 v221, v201, v199
    v_cvt_pk_bf16_f32 v234, v210, v211
    v_cvt_pk_bf16_f32 v238, v212, v213
    v_lshlrev_b32 v192, 16, v119
    v_and_b32 v193, s65, v119
    v_lshlrev_b32 v194, 16, v123
    v_and_b32 v195, s65, v123
    v_add_f32 v210, v204, v206
    v_add_f32 v211, v205, v207
    v_sub_f32 v212, v206, v204
    v_sub_f32 v213, v207, v205
    v_cvt_pk_bf16_f32 v235, v218, v219
    v_cvt_pk_bf16_f32 v239, v220, v221
    v_add_f32 v218, v192, v194
    s_barrier
    ds_write_b128 v25, v[230:233] offset:40960
    v_add_f32 v219, v193, v195
    v_sub_f32 v220, v194, v192
    v_sub_f32 v221, v195, v193
    v_cvt_pk_bf16_f32 v236, v210, v211
    v_cvt_pk_bf16_f32 v240, v212, v213
    v_cvt_pk_bf16_f32 v237, v218, v219
    v_cvt_pk_bf16_f32 v241, v220, v221
    s_barrier
    ds_write_b128 v25, v[234:237] offset:29696
    v_lshlrev_b32 v192, 16, v132
    v_and_b32 v193, s65, v132
    v_lshlrev_b32 v194, 16, v136
    v_and_b32 v195, s65, v136
    v_lshlrev_b32 v198, 16, v133
    v_and_b32 v199, s65, v133
    v_lshlrev_b32 v200, 16, v137
    v_and_b32 v201, s65, v137
    v_add_f32 v210, v192, v194
    v_add_f32 v211, v193, v195
    v_sub_f32 v212, v194, v192
    v_sub_f32 v213, v195, v193
    v_lshlrev_b32 v204, 16, v134
    v_and_b32 v205, s65, v134
    v_lshlrev_b32 v206, 16, v138
    v_and_b32 v207, s65, v138
    v_add_f32 v218, v198, v200
    v_add_f32 v219, v199, v201
    v_sub_f32 v220, v200, v198
    v_sub_f32 v221, v201, v199
    v_cvt_pk_bf16_f32 v226, v210, v211
    s_waitcnt lgkmcnt(4)
    s_barrier
    ds_write_b128 v25, v[238:241] offset:38912
    v_cvt_pk_bf16_f32 v230, v212, v213
    v_lshlrev_b32 v192, 16, v135
    v_and_b32 v193, s65, v135
    v_lshlrev_b32 v194, 16, v139
    v_and_b32 v195, s65, v139
    v_add_f32 v210, v204, v206
    v_add_f32 v211, v205, v207
    v_sub_f32 v212, v206, v204
    v_sub_f32 v213, v207, v205
    v_cvt_pk_bf16_f32 v227, v218, v219
    v_cvt_pk_bf16_f32 v231, v220, v221
    v_add_f32 v218, v192, v194
    v_add_f32 v219, v193, v195
    v_sub_f32 v220, v194, v192
    v_sub_f32 v221, v195, v193
    v_cvt_pk_bf16_f32 v228, v210, v211
    v_cvt_pk_bf16_f32 v232, v212, v213
    v_cvt_pk_bf16_f32 v229, v218, v219
    v_cvt_pk_bf16_f32 v233, v220, v221
    s_waitcnt lgkmcnt(1)
    s_barrier
    ds_write_b128 v26, v[226:229] offset:7168
    v_lshlrev_b32 v192, 16, v144
    v_and_b32 v193, s65, v144
    v_lshlrev_b32 v194, 16, v148
    v_and_b32 v195, s65, v148
    v_lshlrev_b32 v198, 16, v145
    v_and_b32 v199, s65, v145
    v_lshlrev_b32 v200, 16, v149
    v_and_b32 v201, s65, v149
    v_add_f32 v210, v192, v194
    v_add_f32 v211, v193, v195
    v_sub_f32 v212, v194, v192
    v_sub_f32 v213, v195, v193
    v_lshlrev_b32 v204, 16, v146
    v_and_b32 v205, s65, v146
    v_lshlrev_b32 v206, 16, v150
    v_and_b32 v207, s65, v150
    v_add_f32 v218, v198, v200
    v_add_f32 v219, v199, v201
    v_sub_f32 v220, v200, v198
    v_sub_f32 v221, v201, v199
    v_cvt_pk_bf16_f32 v234, v210, v211
    s_barrier
    ds_write_b128 v26, v[230:233] offset:16384
    v_cvt_pk_bf16_f32 v238, v212, v213
    v_lshlrev_b32 v192, 16, v147
    v_and_b32 v193, s65, v147
    v_lshlrev_b32 v194, 16, v151
    v_and_b32 v195, s65, v151
    v_add_f32 v210, v204, v206
    v_add_f32 v211, v205, v207
    v_sub_f32 v212, v206, v204
    v_sub_f32 v213, v207, v205
    v_cvt_pk_bf16_f32 v235, v218, v219
    v_cvt_pk_bf16_f32 v239, v220, v221
    v_add_f32 v218, v192, v194
    v_add_f32 v219, v193, v195
    v_sub_f32 v220, v194, v192
    v_sub_f32 v221, v195, v193
    v_cvt_pk_bf16_f32 v236, v210, v211
    v_cvt_pk_bf16_f32 v240, v212, v213
    v_cvt_pk_bf16_f32 v237, v218, v219
    v_cvt_pk_bf16_f32 v241, v220, v221
    s_barrier
    ds_write_b128 v26, v[234:237] offset:5120
    v_lshlrev_b32 v192, 16, v184
    v_and_b32 v193, s65, v184
    v_lshlrev_b32 v194, 16, v186
    v_and_b32 v195, s65, v186
    v_lshlrev_b32 v198, 16, v185
    v_and_b32 v199, s65, v185
    v_lshlrev_b32 v200, 16, v187
    v_and_b32 v201, s65, v187
    v_add_f32 v210, v192, v194
    v_add_f32 v211, v193, v195
    v_sub_f32 v212, v194, v192
    v_sub_f32 v213, v195, v193
    v_add_f32 v218, v198, v200
    v_add_f32 v219, v199, v201
    v_sub_f32 v220, v200, v198
    v_sub_f32 v221, v201, v199
    v_cvt_pk_bf16_f32 v242, v210, v211
    v_cvt_pk_bf16_f32 v244, v212, v213
    v_cvt_pk_bf16_f32 v243, v218, v219
    v_cvt_pk_bf16_f32 v245, v220, v221
    s_barrier
    ds_write2st64_b64 v28, v[242:243], v[244:245] offset0:10 offset1:28
    v_lshlrev_b32 v192, 16, v128
    v_and_b32 v193, s65, v128
    v_lshlrev_b32 v194, 16, v132
    v_and_b32 v195, s65, v132
    v_lshlrev_b32 v198, 16, v129
    v_and_b32 v199, s65, v129
    v_lshlrev_b32 v200, 16, v133
    v_and_b32 v201, s65, v133
    v_add_f32 v210, v192, v194
    v_add_f32 v211, v193, v195
    v_sub_f32 v212, v194, v192
    v_sub_f32 v213, v195, v193
    v_lshlrev_b32 v204, 16, v130
    v_and_b32 v205, s65, v130
    v_lshlrev_b32 v206, 16, v134
    v_and_b32 v207, s65, v134
    v_add_f32 v218, v198, v200
    v_add_f32 v219, v199, v201
    v_sub_f32 v220, v200, v198
    v_sub_f32 v221, v201, v199
    v_cvt_pk_bf16_f32 v226, v210, v211
    s_barrier
    ds_write_b128 v26, v[238:241] offset:14336
    v_cvt_pk_bf16_f32 v230, v212, v213
    v_lshlrev_b32 v192, 16, v131
    v_and_b32 v193, s65, v131
    v_lshlrev_b32 v194, 16, v135
    v_and_b32 v195, s65, v135
    v_add_f32 v210, v204, v206
    v_add_f32 v211, v205, v207
    v_sub_f32 v212, v206, v204
    v_sub_f32 v213, v207, v205
    v_cvt_pk_bf16_f32 v227, v218, v219
    v_cvt_pk_bf16_f32 v231, v220, v221
    v_add_f32 v218, v192, v194
    v_add_f32 v219, v193, v195
    v_sub_f32 v220, v194, v192
    v_sub_f32 v221, v195, v193
    v_cvt_pk_bf16_f32 v228, v210, v211
    v_cvt_pk_bf16_f32 v232, v212, v213
    v_cvt_pk_bf16_f32 v229, v218, v219
    v_cvt_pk_bf16_f32 v233, v220, v221
    s_waitcnt lgkmcnt(5)
    s_barrier
    ds_write_b128 v26, v[226:229] offset:12288
    v_lshlrev_b32 v192, 16, v140
    v_and_b32 v193, s65, v140
    v_lshlrev_b32 v194, 16, v144
    v_and_b32 v195, s65, v144
    v_lshlrev_b32 v198, 16, v141
    v_and_b32 v199, s65, v141
    v_lshlrev_b32 v200, 16, v145
    v_and_b32 v201, s65, v145
    v_add_f32 v210, v192, v194
    v_add_f32 v211, v193, v195
    v_sub_f32 v212, v194, v192
    v_sub_f32 v213, v195, v193
    v_lshlrev_b32 v204, 16, v142
    v_and_b32 v205, s65, v142
    v_lshlrev_b32 v206, 16, v146
    v_and_b32 v207, s65, v146
    v_add_f32 v218, v198, v200
    v_add_f32 v219, v199, v201
    v_sub_f32 v220, v200, v198
    v_sub_f32 v221, v201, v199
    v_cvt_pk_bf16_f32 v234, v210, v211
    s_barrier
    ds_write_b128 v26, v[230:233] offset:21504
    v_cvt_pk_bf16_f32 v238, v212, v213
    v_lshlrev_b32 v192, 16, v143
    v_and_b32 v193, s65, v143
    v_lshlrev_b32 v194, 16, v147
    v_and_b32 v195, s65, v147
    v_add_f32 v210, v204, v206
    v_add_f32 v211, v205, v207
    v_sub_f32 v212, v206, v204
    v_sub_f32 v213, v207, v205
    v_cvt_pk_bf16_f32 v235, v218, v219
    v_cvt_pk_bf16_f32 v239, v220, v221
    v_add_f32 v218, v192, v194
    v_add_f32 v219, v193, v195
    v_sub_f32 v220, v194, v192
    v_sub_f32 v221, v195, v193
    v_cvt_pk_bf16_f32 v236, v210, v211
    v_cvt_pk_bf16_f32 v240, v212, v213
    v_cvt_pk_bf16_f32 v237, v218, v219
    v_cvt_pk_bf16_f32 v241, v220, v221
    s_barrier
    ds_write_b128 v26, v[234:237] offset:10240
    s_barrier
    ds_write_b128 v26, v[238:241] offset:19456
    v_lshlrev_b32 v29, 4, v0
    s_lshl_b32 s44, s38, 10
    s_waitcnt lgkmcnt(1)
    s_barrier
    s_lshr_b32 s41, s38, 1
    s_and_b32 s42, s38, 1
    s_mul_i32 s43, s41, 4608
    v_lshlrev_b32 v166, 4, v0
    v_add_u32 v216, s43, v166
    s_add_u32 s43, s43, 4096
    v_lshlrev_b32 v166, 3, v0
    v_add_u32 v217, s43, v166
    s_mul_i32 s42, s42, 160
    v_lshrrev_b32 v166, 2, v0
    v_mul_u32_u24 v166, 288, v166
    v_and_b32 v167, 3, v0
    v_lshl_add_u32 v166, v167, 3, v166
    s_add_u32 s43, s42, 121856
    s_barrier
    s_add_u32 m0, s44, 121856
    s_add_u32 s49, s44, 0
    buffer_load_dwordx4 v29, s[32:35], s49 offen lds
    v_add_u32 v218, s43, v166
    v_and_b32 v166, 15, v0
    v_mul_u32_u24 v166, 304, v166
    v_lshrrev_b32 v167, 4, v0
    v_lshl_add_u32 v166, v167, 3, v166
    s_mul_i32 s43, s41, 4864
    s_add_u32 s43, s43, s42
    s_add_u32 m0, s44, 125952
    s_add_u32 s49, s44, 4096
    buffer_load_dwordx4 v29, s[32:35], s49 offen lds
    s_add_u32 s43, s43, 46080
    v_add_u32 v219, s43, v166
    s_lshl_b32 s41, s38, 6
    s_add_u32 s41, s41, 0
    v_add_u32 v166, s41, v0
    v_mul_u32_u24 v167, 3641, v166
    v_lshrrev_b32 v167, 16, v167
    s_add_u32 m0, s44, 130048
    s_add_u32 s49, s44, 8192
    buffer_load_dwordx4 v29, s[32:35], s49 offen lds
    s_barrier
    s_add_u32 m0, s44, 134144
    s_add_u32 s49, s44, 12288
    buffer_load_dwordx4 v29, s[32:35], s49 offen lds
    v_mul_u32_u24 v168, 18, v167
    v_sub_u32 v166, v166, v168
    v_lshlrev_b32 v166, 4, v166
    v_mul_u32_u24 v168, 304, v167
    v_add_u32 v168, v168, v166
    s_add_u32 m0, s44, 138240
    s_add_u32 s49, s44, 16384
    buffer_load_dwordx4 v29, s[32:35], s49 offen lds
    v_add_u32 v220, 46080, v168
    v_bfe_u32 v168, v167, 1, 3
    v_mul_u32_u24 v168, 20, v168
    v_lshrrev_b32 v169, 4, v167
    v_mul_u32_u24 v169, 10, v169
    s_add_u32 m0, s44, 142336
    s_add_u32 s49, s44, 20480
    buffer_load_dwordx4 v29, s[32:35], s49 offen lds
    v_add_u32 v168, v168, v169
    v_and_b32 v169, 1, v167
    v_add_u32 v168, v168, v169
    v_mul_u32_u24 v168, 288, v168
    s_add_u32 m0, s44, 146432
    s_add_u32 s49, s44, 24576
    buffer_load_dwordx4 v29, s[32:35], s49 offen lds
    s_waitcnt lgkmcnt(0)
    s_barrier
    s_add_u32 m0, s44, 150528
    s_add_u32 s49, s44, 28672
    buffer_load_dwordx4 v29, s[32:35], s49 offen lds
    v_add_u32 v223, v168, v166
    s_lshl_b32 s41, s38, 6
    s_add_u32 s41, s41, 256
    v_add_u32 v166, s41, v0
    v_mul_u32_u24 v167, 3641, v166
    s_add_u32 m0, s44, 154624
    s_add_u32 s49, s44, 32768
    buffer_load_dwordx4 v29, s[32:35], s49 offen lds
    v_lshrrev_b32 v167, 16, v167
    v_mul_u32_u24 v168, 18, v167
    v_sub_u32 v166, v166, v168
    v_lshlrev_b32 v166, 4, v166
    v_mul_u32_u24 v168, 304, v167
    s_add_u32 m0, s44, 158720
    s_add_u32 s49, s44, 36864
    buffer_load_dwordx4 v29, s[32:35], s49 offen lds
    v_add_u32 v168, v168, v166
    v_add_u32 v221, 46080, v168
    v_bfe_u32 v168, v167, 1, 3
    v_mul_u32_u24 v168, 20, v168
    s_add_u32 m0, s44, 162816
    s_add_u32 s49, s44, 40960
    s_cmp_eq_u32 s38, 0
    s_cbranch_scc0 L_sk2
    buffer_load_dwordx4 v29, s[32:35], s49 offen lds
L_sk2:
    s_barrier
    v_lshrrev_b32 v169, 4, v167
    v_mul_u32_u24 v169, 10, v169
    v_add_u32 v168, v168, v169
    v_and_b32 v169, 1, v167
    v_add_u32 v168, v168, v169
    v_mul_u32_u24 v168, 288, v168
    v_add_u32 v224, v168, v166
    s_mov_b32 s41, 512
    v_add_u32 v166, s41, v0
    v_mul_u32_u24 v167, 3641, v166
    v_lshrrev_b32 v167, 16, v167
    v_mul_u32_u24 v168, 18, v167
    v_sub_u32 v166, v166, v168
    s_barrier
    v_lshlrev_b32 v166, 4, v166
    v_mul_u32_u24 v168, 304, v167
    v_add_u32 v168, v168, v166
    v_add_u32 v222, 46080, v168
    v_bfe_u32 v168, v167, 1, 3
    v_mul_u32_u24 v168, 20, v168
    v_lshrrev_b32 v169, 4, v167
    v_mul_u32_u24 v169, 10, v169
    v_add_u32 v168, v168, v169
    v_and_b32 v169, 1, v167
    v_add_u32 v168, v168, v169
    v_mul_u32_u24 v168, 288, v168
    v_add_u32 v225, v168, v166
    s_waitcnt vmcnt(0)
    s_barrier
L_lepi:
    ds_read_b64_tr_b16 v[32:33], v218 offset:0
    ds_read_b64_tr_b16 v[34:35], v218 offset:4608
    ds_read_b64_tr_b16 v[36:37], v218 offset:9216
    ds_read_b64_tr_b16 v[38:39], v218 offset:13824
    ds_read_b64_tr_b16 v[40:41], v218 offset:18432
    ds_read_b64_tr_b16 v[42:43], v218 offset:23040
    ds_read_b64_tr_b16 v[44:45], v218 offset:27648
    ds_read_b64_tr_b16 v[46:47], v218 offset:32256
    ds_read_b64_tr_b16 v[48:49], v218 offset:36864
    ds_read_b64_tr_b16 v[50:51], v218 offset:32
    ds_read_b64_tr_b16 v[52:53], v218 offset:4640
    ds_read_b64_tr_b16 v[54:55], v218 offset:9248
    ds_read_b64_tr_b16 v[56:57], v218 offset:13856
    ds_read_b64_tr_b16 v[58:59], v218 offset:18464
    ds_read_b64_tr_b16 v[60:61], v218 offset:23072
    ds_read_b64_tr_b16 v[62:63], v218 offset:27680
    ds_read_b64_tr_b16 v[64:65], v218 offset:32288
    ds_read_b64_tr_b16 v[66:67], v218 offset:36896
    ds_read_b64_tr_b16 v[68:69], v218 offset:64
    ds_read_b64_tr_b16 v[70:71], v218 offset:4672
    ds_read_b64_tr_b16 v[72:73], v218 offset:9280
    ds_read_b64_tr_b16 v[74:75], v218 offset:13888
    ds_read_b64_tr_b16 v[76:77], v218 offset:18496
    ds_read_b64_tr_b16 v[78:79], v218 offset:23104
    ds_read_b64_tr_b16 v[80:81], v218 offset:27712
    ds_read_b64_tr_b16 v[82:83], v218 offset:32320
    ds_read_b64_tr_b16 v[84:85], v218 offset:36928
    ds_read_b64_tr_b16 v[86:87], v218 offset:96
    ds_read_b64_tr_b16 v[88:89], v218 offset:4704
    ds_read_b64_tr_b16 v[90:91], v218 offset:9312
    ds_read_b64_tr_b16 v[92:93], v218 offset:13920
    ds_read_b64_tr_b16 v[94:95], v218 offset:18528
    ds_read_b64_tr_b16 v[96:97], v218 offset:23136
    ds_read_b64_tr_b16 v[98:99], v218 offset:27744
    ds_read_b64_tr_b16 v[100:101], v218 offset:32352
    ds_read_b64_tr_b16 v[102:103], v218 offset:36960
    ds_read_b64_tr_b16 v[104:105], v218 offset:128
    ds_read_b64_tr_b16 v[106:107], v218 offset:4736
    ds_read_b64_tr_b16 v[108:109], v218 offset:9344
    ds_read_b64_tr_b16 v[110:111], v218 offset:13952
    ds_read_b64_tr_b16 v[112:113], v218 offset:18560
    ds_read_b64_tr_b16 v[114:115], v218 offset:23168
    ds_read_b64_tr_b16 v[116:117], v218 offset:27776
    ds_read_b64_tr_b16 v[118:119], v218 offset:32384
    ds_read_b64_tr_b16 v[120:121], v218 offset:36992
    s_and_b32 s48, s38, 1
    s_setprio 2
    s_waitcnt lgkmcnt(0)
    s_barrier
    ds_read_b64 v[160:161], v217 offset:0
    ds_read_b128 v[144:147], v216 offset:0
    ds_read_b128 v[148:151], v216 offset:1024
    ds_read_b128 v[152:155], v216 offset:2048
    ds_read_b128 v[156:159], v216 offset:3072
    s_waitcnt lgkmcnt(4)
    v_mfma_f32_16x16x16_bf16 v[124:127], v[48:49], v[160:161], 0
    v_mfma_f32_16x16x16_bf16 v[128:131], v[66:67], v[160:161], 0
    v_mfma_f32_16x16x16_bf16 v[132:135], v[84:85], v[160:161], 0
    v_mfma_f32_16x16x16_bf16 v[136:139], v[102:103], v[160:161], 0
    v_mfma_f32_16x16x16_bf16 v[140:143], v[120:121], v[160:161], 0
    s_waitcnt lgkmcnt(3)
    s_nop 0
    v_mfma_f32_16x16x32_bf16 v[124:127], v[32:35], v[144:147], v[124:127]
    v_mfma_f32_16x16x32_bf16 v[128:131], v[50:53], v[144:147], v[128:131]
    v_mfma_f32_16x16x32_bf16 v[132:135], v[68:71], v[144:147], v[132:135]
    v_mfma_f32_16x16x32_bf16 v[136:139], v[86:89], v[144:147], v[136:139]
    s_waitcnt lgkmcnt(2)
    v_mfma_f32_16x16x32_bf16 v[124:127], v[36:39], v[148:151], v[124:127]
    v_mfma_f32_16x16x32_bf16 v[128:131], v[54:57], v[148:151], v[128:131]
    v_mfma_f32_16x16x32_bf16 v[132:135], v[72:75], v[148:151], v[132:135]
    v_mfma_f32_16x16x32_bf16 v[136:139], v[90:93], v[148:151], v[136:139]
    s_waitcnt lgkmcnt(1)
    v_mfma_f32_16x16x32_bf16 v[124:127], v[40:43], v[152:155], v[124:127]
    v_mfma_f32_16x16x32_bf16 v[128:131], v[58:61], v[152:155], v[128:131]
    v_mfma_f32_16x16x32_bf16 v[132:135], v[76:79], v[152:155], v[132:135]
    v_mfma_f32_16x16x32_bf16 v[136:139], v[94:97], v[152:155], v[136:139]
    s_waitcnt lgkmcnt(0)
    v_mfma_f32_16x16x32_bf16 v[124:127], v[44:47], v[156:159], v[124:127]
    v_mfma_f32_16x16x32_bf16 v[128:131], v[62:65], v[156:159], v[128:131]
    v_mfma_f32_16x16x32_bf16 v[132:135], v[80:83], v[156:159], v[132:135]
    v_mfma_f32_16x16x32_bf16 v[136:139], v[98:101], v[156:159], v[136:139]
    s_cmp_eq_u32 s48, 0
    s_cbranch_scc0 L_sk3
    v_mfma_f32_16x16x32_bf16 v[140:143], v[104:107], v[144:147], v[140:143]
    v_mfma_f32_16x16x32_bf16 v[140:143], v[108:111], v[148:151], v[140:143]
    v_mfma_f32_16x16x32_bf16 v[140:143], v[112:115], v[152:155], v[140:143]
    v_mfma_f32_16x16x32_bf16 v[140:143], v[116:119], v[156:159], v[140:143]
L_sk3:
    s_waitcnt lgkmcnt(0)
    s_barrier
    ds_read_b64 v[160:161], v217 offset:9216
    ds_read_b128 v[144:147], v216 offset:9216
    ds_read_b128 v[148:151], v216 offset:10240
    ds_read_b128 v[152:155], v216 offset:11264
    ds_read_b128 v[156:159], v216 offset:12288
    s_cmp_eq_u32 s48, 0
    s_cbranch_scc0 L_sk4
    v_cvt_pk_bf16_f32 v172, v140, v141
    v_cvt_pk_bf16_f32 v173, v142, v143
    ds_write_b64 v219, v[172:173] offset:128
L_sk4:
    v_cvt_pk_bf16_f32 v164, v124, v125
    v_cvt_pk_bf16_f32 v165, v126, v127
    ds_write_b64 v219, v[164:165] offset:0
    v_cvt_pk_bf16_f32 v166, v128, v129
    v_cvt_pk_bf16_f32 v167, v130, v131
    ds_write_b64 v219, v[166:167] offset:32
    v_cvt_pk_bf16_f32 v168, v132, v133
    v_cvt_pk_bf16_f32 v169, v134, v135
    ds_write_b64 v219, v[168:169] offset:64
    v_cvt_pk_bf16_f32 v170, v136, v137
    v_cvt_pk_bf16_f32 v171, v138, v139
    ds_write_b64 v219, v[170:171] offset:96
    s_waitcnt lgkmcnt(8)
    v_mfma_f32_16x16x16_bf16 v[124:127], v[48:49], v[160:161], 0
    v_mfma_f32_16x16x16_bf16 v[128:131], v[66:67], v[160:161], 0
    v_mfma_f32_16x16x16_bf16 v[132:135], v[84:85], v[160:161], 0
    v_mfma_f32_16x16x16_bf16 v[136:139], v[102:103], v[160:161], 0
    v_mfma_f32_16x16x16_bf16 v[140:143], v[120:121], v[160:161], 0
    s_waitcnt lgkmcnt(7)
    s_nop 0
    v_mfma_f32_16x16x32_bf16 v[124:127], v[32:35], v[144:147], v[124:127]
    v_mfma_f32_16x16x32_bf16 v[128:131], v[50:53], v[144:147], v[128:131]
    v_mfma_f32_16x16x32_bf16 v[132:135], v[68:71], v[144:147], v[132:135]
    v_mfma_f32_16x16x32_bf16 v[136:139], v[86:89], v[144:147], v[136:139]
    s_waitcnt lgkmcnt(6)
    v_mfma_f32_16x16x32_bf16 v[124:127], v[36:39], v[148:151], v[124:127]
    v_mfma_f32_16x16x32_bf16 v[128:131], v[54:57], v[148:151], v[128:131]
    v_mfma_f32_16x16x32_bf16 v[132:135], v[72:75], v[148:151], v[132:135]
    v_mfma_f32_16x16x32_bf16 v[136:139], v[90:93], v[148:151], v[136:139]
    s_waitcnt lgkmcnt(5)
    v_mfma_f32_16x16x32_bf16 v[124:127], v[40:43], v[152:155], v[124:127]
    v_mfma_f32_16x16x32_bf16 v[128:131], v[58:61], v[152:155], v[128:131]
    v_mfma_f32_16x16x32_bf16 v[132:135], v[76:79], v[152:155], v[132:135]
    v_mfma_f32_16x16x32_bf16 v[136:139], v[94:97], v[152:155], v[136:139]
    s_waitcnt lgkmcnt(4)
    v_mfma_f32_16x16x32_bf16 v[124:127], v[44:47], v[156:159], v[124:127]
    v_mfma_f32_16x16x32_bf16 v[128:131], v[62:65], v[156:159], v[128:131]
    v_mfma_f32_16x16x32_bf16 v[132:135], v[80:83], v[156:159], v[132:135]
    v_mfma_f32_16x16x32_bf16 v[136:139], v[98:101], v[156:159], v[136:139]
    s_cmp_eq_u32 s48, 0
    s_cbranch_scc0 L_sk5
    v_mfma_f32_16x16x32_bf16 v[140:143], v[104:107], v[144:147], v[140:143]
    v_mfma_f32_16x16x32_bf16 v[140:143], v[108:111], v[148:151], v[140:143]
    v_mfma_f32_16x16x32_bf16 v[140:143], v[112:115], v[152:155], v[140:143]
    v_mfma_f32_16x16x32_bf16 v[140:143], v[116:119], v[156:159], v[140:143]
L_sk5:
    s_waitcnt lgkmcnt(0)
    s_barrier
    ds_read_b64 v[160:161], v217 offset:18432
    ds_read_b128 v[144:147], v216 offset:18432
    ds_read_b128 v[148:151], v216 offset:19456
    ds_read_b128 v[152:155], v216 offset:20480
    ds_read_b128 v[156:159], v216 offset:21504
    ds_read_b128 v[176:179], v220 offset:0
    ds_read_b128 v[180:183], v221 offset:0
    ds_read_b128 v[184:187], v222 offset:0
    s_cmp_eq_u32 s48, 0
    s_cbranch_scc0 L_sk6
    v_cvt_pk_bf16_f32 v172, v140, v141
    v_cvt_pk_bf16_f32 v173, v142, v143
    ds_write_b64 v219, v[172:173] offset:9856
L_sk6:
    v_cvt_pk_bf16_f32 v164, v124, v125
    v_cvt_pk_bf16_f32 v165, v126, v127
    ds_write_b64 v219, v[164:165] offset:9728
    v_cvt_pk_bf16_f32 v166, v128, v129
    v_cvt_pk_bf16_f32 v167, v130, v131
    ds_write_b64 v219, v[166:167] offset:9760
    v_cvt_pk_bf16_f32 v168, v132, v133
    v_cvt_pk_bf16_f32 v169, v134, v135
    ds_write_b64 v219, v[168:169] offset:9792
    v_cvt_pk_bf16_f32 v170, v136, v137
    v_cvt_pk_bf16_f32 v171, v138, v139
    ds_write_b64 v219, v[170:171] offset:9824
    s_waitcnt lgkmcnt(11)
    v_mfma_f32_16x16x16_bf16 v[124:127], v[48:49], v[160:161], 0
    v_mfma_f32_16x16x16_bf16 v[128:131], v[66:67], v[160:161], 0
    v_mfma_f32_16x16x16_bf16 v[132:135], v[84:85], v[160:161], 0
    v_mfma_f32_16x16x16_bf16 v[136:139], v[102:103], v[160:161], 0
    v_mfma_f32_16x16x16_bf16 v[140:143], v[120:121], v[160:161], 0
    s_waitcnt lgkmcnt(10)
    s_nop 0
    v_mfma_f32_16x16x32_bf16 v[124:127], v[32:35], v[144:147], v[124:127]
    v_mfma_f32_16x16x32_bf16 v[128:131], v[50:53], v[144:147], v[128:131]
    v_mfma_f32_16x16x32_bf16 v[132:135], v[68:71], v[144:147], v[132:135]
    v_mfma_f32_16x16x32_bf16 v[136:139], v[86:89], v[144:147], v[136:139]
    s_waitcnt lgkmcnt(4)
    buffer_store_dwordx4 v[176:179], v223, s[28:31], 0 offen offset:0 sc1 nt
    buffer_store_dwordx4 v[180:183], v224, s[28:31], 0 offen offset:0 sc1 nt
    s_cmp_eq_u32 s38, 0
    s_cbranch_scc0 L_sk7
    buffer_store_dwordx4 v[184:187], v225, s[28:31], 0 offen offset:0 sc1 nt
L_sk7:
    v_mfma_f32_16x16x32_bf16 v[124:127], v[36:39], v[148:151], v[124:127]
    v_mfma_f32_16x16x32_bf16 v[128:131], v[54:57], v[148:151], v[128:131]
    v_mfma_f32_16x16x32_bf16 v[132:135], v[72:75], v[148:151], v[132:135]
    v_mfma_f32_16x16x32_bf16 v[136:139], v[90:93], v[148:151], v[136:139]
    v_mfma_f32_16x16x32_bf16 v[124:127], v[40:43], v[152:155], v[124:127]
    v_mfma_f32_16x16x32_bf16 v[128:131], v[58:61], v[152:155], v[128:131]
    v_mfma_f32_16x16x32_bf16 v[132:135], v[76:79], v[152:155], v[132:135]
    v_mfma_f32_16x16x32_bf16 v[136:139], v[94:97], v[152:155], v[136:139]
    v_mfma_f32_16x16x32_bf16 v[124:127], v[44:47], v[156:159], v[124:127]
    v_mfma_f32_16x16x32_bf16 v[128:131], v[62:65], v[156:159], v[128:131]
    v_mfma_f32_16x16x32_bf16 v[132:135], v[80:83], v[156:159], v[132:135]
    v_mfma_f32_16x16x32_bf16 v[136:139], v[98:101], v[156:159], v[136:139]
    s_cmp_eq_u32 s48, 0
    s_cbranch_scc0 L_sk8
    v_mfma_f32_16x16x32_bf16 v[140:143], v[104:107], v[144:147], v[140:143]
    v_mfma_f32_16x16x32_bf16 v[140:143], v[108:111], v[148:151], v[140:143]
    v_mfma_f32_16x16x32_bf16 v[140:143], v[112:115], v[152:155], v[140:143]
    v_mfma_f32_16x16x32_bf16 v[140:143], v[116:119], v[156:159], v[140:143]
L_sk8:
    s_waitcnt lgkmcnt(0)
    s_barrier
    ds_read_b64 v[160:161], v217 offset:27648
    ds_read_b128 v[144:147], v216 offset:27648
    ds_read_b128 v[148:151], v216 offset:28672
    ds_read_b128 v[152:155], v216 offset:29696
    ds_read_b128 v[156:159], v216 offset:30720
    ds_read_b128 v[176:179], v220 offset:9728
    ds_read_b128 v[180:183], v221 offset:9728
    ds_read_b128 v[184:187], v222 offset:9728
    s_cmp_eq_u32 s48, 0
    s_cbranch_scc0 L_sk9
    v_cvt_pk_bf16_f32 v172, v140, v141
    v_cvt_pk_bf16_f32 v173, v142, v143
    ds_write_b64 v219, v[172:173] offset:19584
L_sk9:
    v_cvt_pk_bf16_f32 v164, v124, v125
    v_cvt_pk_bf16_f32 v165, v126, v127
    ds_write_b64 v219, v[164:165] offset:19456
    v_cvt_pk_bf16_f32 v166, v128, v129
    v_cvt_pk_bf16_f32 v167, v130, v131
    ds_write_b64 v219, v[166:167] offset:19488
    v_cvt_pk_bf16_f32 v168, v132, v133
    v_cvt_pk_bf16_f32 v169, v134, v135
    ds_write_b64 v219, v[168:169] offset:19520
    v_cvt_pk_bf16_f32 v170, v136, v137
    v_cvt_pk_bf16_f32 v171, v138, v139
    ds_write_b64 v219, v[170:171] offset:19552
    s_waitcnt lgkmcnt(11)
    v_mfma_f32_16x16x16_bf16 v[124:127], v[48:49], v[160:161], 0
    v_mfma_f32_16x16x16_bf16 v[128:131], v[66:67], v[160:161], 0
    v_mfma_f32_16x16x16_bf16 v[132:135], v[84:85], v[160:161], 0
    v_mfma_f32_16x16x16_bf16 v[136:139], v[102:103], v[160:161], 0
    v_mfma_f32_16x16x16_bf16 v[140:143], v[120:121], v[160:161], 0
    s_waitcnt lgkmcnt(10)
    s_nop 0
    v_mfma_f32_16x16x32_bf16 v[124:127], v[32:35], v[144:147], v[124:127]
    v_mfma_f32_16x16x32_bf16 v[128:131], v[50:53], v[144:147], v[128:131]
    v_mfma_f32_16x16x32_bf16 v[132:135], v[68:71], v[144:147], v[132:135]
    v_mfma_f32_16x16x32_bf16 v[136:139], v[86:89], v[144:147], v[136:139]
    s_waitcnt lgkmcnt(4)
    buffer_store_dwordx4 v[176:179], v223, s[28:31], 0 offen offset:576 sc1 nt
    buffer_store_dwordx4 v[180:183], v224, s[28:31], 0 offen offset:576 sc1 nt
    s_cmp_eq_u32 s38, 0
    s_cbranch_scc0 L_sk10
    buffer_store_dwordx4 v[184:187], v225, s[28:31], 0 offen offset:576 sc1 nt
L_sk10:
    v_mfma_f32_16x16x32_bf16 v[124:127], v[36:39], v[148:151], v[124:127]
    v_mfma_f32_16x16x32_bf16 v[128:131], v[54:57], v[148:151], v[128:131]
    v_mfma_f32_16x16x32_bf16 v[132:135], v[72:75], v[148:151], v[132:135]
    v_mfma_f32_16x16x32_bf16 v[136:139], v[90:93], v[148:151], v[136:139]
    v_mfma_f32_16x16x32_bf16 v[124:127], v[40:43], v[152:155], v[124:127]
    v_mfma_f32_16x16x32_bf16 v[128:131], v[58:61], v[152:155], v[128:131]
    v_mfma_f32_16x16x32_bf16 v[132:135], v[76:79], v[152:155], v[132:135]
    v_mfma_f32_16x16x32_bf16 v[136:139], v[94:97], v[152:155], v[136:139]
    v_mfma_f32_16x16x32_bf16 v[124:127], v[44:47], v[156:159], v[124:127]
    v_mfma_f32_16x16x32_bf16 v[128:131], v[62:65], v[156:159], v[128:131]
    v_mfma_f32_16x16x32_bf16 v[132:135], v[80:83], v[156:159], v[132:135]
    v_mfma_f32_16x16x32_bf16 v[136:139], v[98:101], v[156:159], v[136:139]
    s_cmp_eq_u32 s48, 0
    s_cbranch_scc0 L_sk11
    v_mfma_f32_16x16x32_bf16 v[140:143], v[104:107], v[144:147], v[140:143]
    v_mfma_f32_16x16x32_bf16 v[140:143], v[108:111], v[148:151], v[140:143]
    v_mfma_f32_16x16x32_bf16 v[140:143], v[112:115], v[152:155], v[140:143]
    v_mfma_f32_16x16x32_bf16 v[140:143], v[116:119], v[156:159], v[140:143]
L_sk11:
    s_waitcnt lgkmcnt(0)
    s_barrier
    ds_read_b64 v[160:161], v217 offset:36864
    ds_read_b128 v[144:147], v216 offset:36864
    ds_read_b128 v[148:151], v216 offset:37888
    ds_read_b128 v[152:155], v216 offset:38912
    ds_read_b128 v[156:159], v216 offset:39936
    ds_read_b128 v[176:179], v220 offset:19456
    ds_read_b128 v[180:183], v221 offset:19456
    ds_read_b128 v[184:187], v222 offset:19456
    s_cmp_eq_u32 s48, 0
    s_cbranch_scc0 L_sk12
    v_cvt_pk_bf16_f32 v172, v140, v141
    v_cvt_pk_bf16_f32 v173, v142, v143
    ds_write_b64 v219, v[172:173] offset:29312
L_sk12:
    v_cvt_pk_bf16_f32 v164, v124, v125
    v_cvt_pk_bf16_f32 v165, v126, v127
    ds_write_b64 v219, v[164:165] offset:29184
    v_cvt_pk_bf16_f32 v166, v128, v129
    v_cvt_pk_bf16_f32 v167, v130, v131
    ds_write_b64 v219, v[166:167] offset:29216
    v_cvt_pk_bf16_f32 v168, v132, v133
    v_cvt_pk_bf16_f32 v169, v134, v135
    ds_write_b64 v219, v[168:169] offset:29248
    v_cvt_pk_bf16_f32 v170, v136, v137
    v_cvt_pk_bf16_f32 v171, v138, v139
    ds_write_b64 v219, v[170:171] offset:29280
    s_waitcnt lgkmcnt(11)
    v_mfma_f32_16x16x16_bf16 v[124:127], v[48:49], v[160:161], 0
    v_mfma_f32_16x16x16_bf16 v[128:131], v[66:67], v[160:161], 0
    v_mfma_f32_16x16x16_bf16 v[132:135], v[84:85], v[160:161], 0
    v_mfma_f32_16x16x16_bf16 v[136:139], v[102:103], v[160:161], 0
    v_mfma_f32_16x16x16_bf16 v[140:143], v[120:121], v[160:161], 0
    s_waitcnt lgkmcnt(10)
    s_nop 0
    v_mfma_f32_16x16x32_bf16 v[124:127], v[32:35], v[144:147], v[124:127]
    v_mfma_f32_16x16x32_bf16 v[128:131], v[50:53], v[144:147], v[128:131]
    v_mfma_f32_16x16x32_bf16 v[132:135], v[68:71], v[144:147], v[132:135]
    v_mfma_f32_16x16x32_bf16 v[136:139], v[86:89], v[144:147], v[136:139]
    s_waitcnt lgkmcnt(4)
    buffer_store_dwordx4 v[176:179], v223, s[28:31], 0 offen offset:1152 sc1 nt
    buffer_store_dwordx4 v[180:183], v224, s[28:31], 0 offen offset:1152 sc1 nt
    s_cmp_eq_u32 s38, 0
    s_cbranch_scc0 L_sk13
    buffer_store_dwordx4 v[184:187], v225, s[28:31], 0 offen offset:1152 sc1 nt
L_sk13:
    v_mfma_f32_16x16x32_bf16 v[124:127], v[36:39], v[148:151], v[124:127]
    v_mfma_f32_16x16x32_bf16 v[128:131], v[54:57], v[148:151], v[128:131]
    v_mfma_f32_16x16x32_bf16 v[132:135], v[72:75], v[148:151], v[132:135]
    v_mfma_f32_16x16x32_bf16 v[136:139], v[90:93], v[148:151], v[136:139]
    s_waitcnt lgkmcnt(0)
    s_barrier
    ds_read_b128 v[176:179], v220 offset:29184
    ds_read_b128 v[180:183], v221 offset:29184
    ds_read_b128 v[184:187], v222 offset:29184
    v_mfma_f32_16x16x32_bf16 v[124:127], v[40:43], v[152:155], v[124:127]
    v_mfma_f32_16x16x32_bf16 v[128:131], v[58:61], v[152:155], v[128:131]
    v_mfma_f32_16x16x32_bf16 v[132:135], v[76:79], v[152:155], v[132:135]
    v_mfma_f32_16x16x32_bf16 v[136:139], v[94:97], v[152:155], v[136:139]
    v_mfma_f32_16x16x32_bf16 v[124:127], v[44:47], v[156:159], v[124:127]
    v_mfma_f32_16x16x32_bf16 v[128:131], v[62:65], v[156:159], v[128:131]
    v_mfma_f32_16x16x32_bf16 v[132:135], v[80:83], v[156:159], v[132:135]
    v_mfma_f32_16x16x32_bf16 v[136:139], v[98:101], v[156:159], v[136:139]
    s_cmp_eq_u32 s48, 0
    s_cbranch_scc0 L_sk14
    v_mfma_f32_16x16x32_bf16 v[140:143], v[104:107], v[144:147], v[140:143]
    v_mfma_f32_16x16x32_bf16 v[140:143], v[108:111], v[148:151], v[140:143]
    v_mfma_f32_16x16x32_bf16 v[140:143], v[112:115], v[152:155], v[140:143]
    v_mfma_f32_16x16x32_bf16 v[140:143], v[116:119], v[156:159], v[140:143]
L_sk14:
    s_waitcnt lgkmcnt(0)
    buffer_store_dwordx4 v[176:179], v223, s[28:31], 0 offen offset:1728 sc1 nt
    buffer_store_dwordx4 v[180:183], v224, s[28:31], 0 offen offset:1728 sc1 nt
    s_cmp_eq_u32 s38, 0
    s_cbranch_scc0 L_sk15
    buffer_store_dwordx4 v[184:187], v225, s[28:31], 0 offen offset:1728 sc1 nt
L_sk15:
    v_cvt_pk_bf16_f32 v164, v124, v125
    v_cvt_pk_bf16_f32 v165, v126, v127
    ds_write_b64 v219, v[164:165] offset:38912
    v_cvt_pk_bf16_f32 v166, v128, v129
    v_cvt_pk_bf16_f32 v167, v130, v131
    ds_write_b64 v219, v[166:167] offset:38944
    v_cvt_pk_bf16_f32 v168, v132, v133
    v_cvt_pk_bf16_f32 v169, v134, v135
    ds_write_b64 v219, v[168:169] offset:38976
    v_cvt_pk_bf16_f32 v170, v136, v137
    v_cvt_pk_bf16_f32 v171, v138, v139
    ds_write_b64 v219, v[170:171] offset:39008
    s_cmp_eq_u32 s48, 0
    s_cbranch_scc0 L_sk16
    v_cvt_pk_bf16_f32 v172, v140, v141
    v_cvt_pk_bf16_f32 v173, v142, v143
    ds_write_b64 v219, v[172:173] offset:39040
L_sk16:
    s_waitcnt lgkmcnt(0)
    s_barrier
    ds_read_b128 v[176:179], v220 offset:38912
    ds_read_b128 v[180:183], v221 offset:38912
    ds_read_b128 v[184:187], v222 offset:38912
    s_waitcnt lgkmcnt(0)
    buffer_store_dwordx4 v[176:179], v223, s[28:31], 0 offen offset:2304 sc1 nt
    buffer_store_dwordx4 v[180:183], v224, s[28:31], 0 offen offset:2304 sc1 nt
    s_cmp_eq_u32 s38, 0
    s_cbranch_scc0 L_sk17
    buffer_store_dwordx4 v[184:187], v225, s[28:31], 0 offen offset:2304 sc1 nt
L_sk17:
    s_endpgm
L_spin:
L_spin2:
    global_load_dword v22, v21, s[12:13] sc1
    s_waitcnt vmcnt(0)
    v_readfirstlane_b32 s41, v22
    s_nop 0
    s_cmp_lt_u32 s41, 56
    s_cbranch_scc1 L_spin2
    s_branch L_gok
.p2align 6
L_cw0:
    s_barrier
    ds_read_b64_tr_b16 v[20:21], v1 offset:0
    ds_read_b64_tr_b16 v[22:23], v1 offset:2304
    ds_read_b64_tr_b16 v[24:25], v2 offset:288
    ds_read_b64_tr_b16 v[26:27], v2 offset:2592
    ds_read_b128 v[44:47], v5 offset:1024
    ds_read_b128 v[48:51], v5 offset:2048
    ds_read_b128 v[52:55], v5 offset:3072
    ds_read_b128 v[56:59], v5 offset:4096
    ds_read_b128 v[60:63], v5 offset:5120
    s_waitcnt lgkmcnt(0)
    s_mov_b32 s40, 0
.p2align 3
L_c0_0:
    s_waitcnt lgkmcnt(0)
    v_mfma_f32_16x16x32_bf16 v[108:111], v[20:23], v[44:47], v[108:111]
    ds_read_b64_tr_b16 v[28:29], v1 offset:256
    v_mfma_f32_16x16x32_bf16 v[148:151], v[24:27], v[44:47], v[148:151]
    ds_read_b64_tr_b16 v[30:31], v1 offset:2560
    v_mfma_f32_16x16x32_bf16 v[100:103], v[20:23], v[48:51], v[100:103]
    ds_read_b64_tr_b16 v[32:33], v2 offset:544
    v_mfma_f32_16x16x32_bf16 v[140:143], v[24:27], v[48:51], v[140:143]
    ds_read_b64_tr_b16 v[34:35], v2 offset:2848
    v_mfma_f32_16x16x32_bf16 v[92:95], v[20:23], v[52:55], v[92:95]
    ds_read_b64_tr_b16 v[36:37], v2 offset:32
    v_mfma_f32_16x16x32_bf16 v[132:135], v[24:27], v[52:55], v[132:135]
    ds_read_b64_tr_b16 v[38:39], v2 offset:2336
    v_mfma_f32_16x16x32_bf16 v[84:87], v[20:23], v[56:59], v[84:87]
    ds_read_b64_tr_b16 v[40:41], v1 offset:320
    v_mfma_f32_16x16x32_bf16 v[124:127], v[24:27], v[56:59], v[124:127]
    ds_read_b64_tr_b16 v[42:43], v1 offset:2624
    v_mfma_f32_16x16x32_bf16 v[76:79], v[20:23], v[60:63], v[76:79]
    v_mfma_f32_16x16x32_bf16 v[116:119], v[24:27], v[60:63], v[116:119]
    s_waitcnt lgkmcnt(2)
    v_mfma_f32_16x16x32_bf16 v[236:239], v[28:31], v[60:63], v[236:239]
    v_mfma_f32_16x16x32_bf16 v[244:247], v[32:35], v[60:63], v[244:247]
    s_waitcnt lgkmcnt(0)
    v_mfma_f32_16x16x32_bf16 v[252:255], v[28:31], v[44:47], v[252:255]
    s_barrier
    v_mfma_f32_16x16x32_bf16 v[188:191], v[36:39], v[44:47], v[188:191]
    ds_read_b64_tr_b16 v[20:21], v1 offset:18432
    v_mfma_f32_16x16x32_bf16 v[228:231], v[40:43], v[44:47], v[228:231]
    ds_read_b64_tr_b16 v[22:23], v1 offset:20736
    v_mfma_f32_16x16x32_bf16 v[180:183], v[36:39], v[48:51], v[180:183]
    ds_read_b64_tr_b16 v[24:25], v2 offset:18720
    v_mfma_f32_16x16x32_bf16 v[220:223], v[40:43], v[48:51], v[220:223]
    ds_read_b64_tr_b16 v[26:27], v2 offset:21024
    v_mfma_f32_16x16x32_bf16 v[172:175], v[36:39], v[52:55], v[172:175]
    ds_read_b128 v[64:67], v5 offset:6144
    v_mfma_f32_16x16x32_bf16 v[212:215], v[40:43], v[52:55], v[212:215]
    v_mfma_f32_16x16x32_bf16 v[164:167], v[36:39], v[56:59], v[164:167]
    v_mfma_f32_16x16x32_bf16 v[204:207], v[40:43], v[56:59], v[204:207]
    v_mfma_f32_16x16x32_bf16 v[156:159], v[36:39], v[60:63], v[156:159]
    v_mfma_f32_16x16x32_bf16 v[196:199], v[40:43], v[60:63], v[196:199]
    s_waitcnt lgkmcnt(0)
    v_mfma_f32_16x16x32_bf16 v[108:111], v[20:23], v[48:51], v[108:111]
    ds_read_b64_tr_b16 v[28:29], v1 offset:18688
    v_mfma_f32_16x16x32_bf16 v[148:151], v[24:27], v[48:51], v[148:151]
    ds_read_b64_tr_b16 v[30:31], v1 offset:20992
    v_mfma_f32_16x16x32_bf16 v[100:103], v[20:23], v[52:55], v[100:103]
    ds_read_b64_tr_b16 v[32:33], v2 offset:18976
    v_mfma_f32_16x16x32_bf16 v[140:143], v[24:27], v[52:55], v[140:143]
    ds_read_b64_tr_b16 v[34:35], v2 offset:21280
    v_mfma_f32_16x16x32_bf16 v[92:95], v[20:23], v[56:59], v[92:95]
    ds_read_b64_tr_b16 v[36:37], v2 offset:18464
    v_mfma_f32_16x16x32_bf16 v[132:135], v[24:27], v[56:59], v[132:135]
    ds_read_b64_tr_b16 v[38:39], v2 offset:20768
    v_mfma_f32_16x16x32_bf16 v[84:87], v[20:23], v[60:63], v[84:87]
    ds_read_b64_tr_b16 v[40:41], v1 offset:18752
    v_mfma_f32_16x16x32_bf16 v[124:127], v[24:27], v[60:63], v[124:127]
    ds_read_b64_tr_b16 v[42:43], v1 offset:21056
    v_mfma_f32_16x16x32_bf16 v[76:79], v[20:23], v[64:67], v[76:79]
    v_mfma_f32_16x16x32_bf16 v[116:119], v[24:27], v[64:67], v[116:119]
    s_waitcnt lgkmcnt(2)
    v_mfma_f32_16x16x32_bf16 v[236:239], v[28:31], v[64:67], v[236:239]
    v_mfma_f32_16x16x32_bf16 v[244:247], v[32:35], v[64:67], v[244:247]
    s_waitcnt lgkmcnt(0)
    v_mfma_f32_16x16x32_bf16 v[252:255], v[28:31], v[48:51], v[252:255]
    s_barrier
    v_mfma_f32_16x16x32_bf16 v[188:191], v[36:39], v[48:51], v[188:191]
    ds_read_b64_tr_b16 v[20:21], v1 offset:36864
    v_mfma_f32_16x16x32_bf16 v[228:231], v[40:43], v[48:51], v[228:231]
    ds_read_b64_tr_b16 v[22:23], v1 offset:39168
    v_mfma_f32_16x16x32_bf16 v[180:183], v[36:39], v[52:55], v[180:183]
    ds_read_b64_tr_b16 v[24:25], v2 offset:37152
    v_mfma_f32_16x16x32_bf16 v[220:223], v[40:43], v[52:55], v[220:223]
    ds_read_b64_tr_b16 v[26:27], v2 offset:39456
    v_mfma_f32_16x16x32_bf16 v[172:175], v[36:39], v[56:59], v[172:175]
    ds_read_b128 v[68:71], v5 offset:7168
    v_mfma_f32_16x16x32_bf16 v[212:215], v[40:43], v[56:59], v[212:215]
    v_mfma_f32_16x16x32_bf16 v[164:167], v[36:39], v[60:63], v[164:167]
    v_mfma_f32_16x16x32_bf16 v[204:207], v[40:43], v[60:63], v[204:207]
    v_mfma_f32_16x16x32_bf16 v[156:159], v[36:39], v[64:67], v[156:159]
    v_mfma_f32_16x16x32_bf16 v[196:199], v[40:43], v[64:67], v[196:199]
    s_waitcnt lgkmcnt(0)
    v_mfma_f32_16x16x32_bf16 v[108:111], v[20:23], v[52:55], v[108:111]
    ds_read_b64_tr_b16 v[28:29], v1 offset:37120
    v_mfma_f32_16x16x32_bf16 v[148:151], v[24:27], v[52:55], v[148:151]
    ds_read_b64_tr_b16 v[30:31], v1 offset:39424
    v_mfma_f32_16x16x32_bf16 v[100:103], v[20:23], v[56:59], v[100:103]
    ds_read_b64_tr_b16 v[32:33], v2 offset:37408
    v_mfma_f32_16x16x32_bf16 v[140:143], v[24:27], v[56:59], v[140:143]
    ds_read_b64_tr_b16 v[34:35], v2 offset:39712
    v_mfma_f32_16x16x32_bf16 v[92:95], v[20:23], v[60:63], v[92:95]
    ds_read_b64_tr_b16 v[36:37], v2 offset:36896
    v_mfma_f32_16x16x32_bf16 v[132:135], v[24:27], v[60:63], v[132:135]
    ds_read_b64_tr_b16 v[38:39], v2 offset:39200
    v_mfma_f32_16x16x32_bf16 v[84:87], v[20:23], v[64:67], v[84:87]
    ds_read_b64_tr_b16 v[40:41], v1 offset:37184
    v_mfma_f32_16x16x32_bf16 v[124:127], v[24:27], v[64:67], v[124:127]
    ds_read_b64_tr_b16 v[42:43], v1 offset:39488
    v_mfma_f32_16x16x32_bf16 v[76:79], v[20:23], v[68:71], v[76:79]
    v_mfma_f32_16x16x32_bf16 v[116:119], v[24:27], v[68:71], v[116:119]
    s_waitcnt lgkmcnt(2)
    v_mfma_f32_16x16x32_bf16 v[236:239], v[28:31], v[68:71], v[236:239]
    v_mfma_f32_16x16x32_bf16 v[244:247], v[32:35], v[68:71], v[244:247]
    s_waitcnt lgkmcnt(0)
    v_mfma_f32_16x16x32_bf16 v[252:255], v[28:31], v[52:55], v[252:255]
    s_barrier
    v_mfma_f32_16x16x32_bf16 v[188:191], v[36:39], v[52:55], v[188:191]
    ds_read_b64_tr_b16 v[20:21], v3 offset:0
    v_mfma_f32_16x16x32_bf16 v[228:231], v[40:43], v[52:55], v[228:231]
    ds_read_b64_tr_b16 v[22:23], v3 offset:2304
    v_mfma_f32_16x16x32_bf16 v[180:183], v[36:39], v[56:59], v[180:183]
    ds_read_b64_tr_b16 v[24:25], v4 offset:288
    v_mfma_f32_16x16x32_bf16 v[220:223], v[40:43], v[56:59], v[220:223]
    ds_read_b64_tr_b16 v[26:27], v4 offset:2592
    v_mfma_f32_16x16x32_bf16 v[172:175], v[36:39], v[60:63], v[172:175]
    ds_read_b128 v[44:47], v5 offset:8192
    v_mfma_f32_16x16x32_bf16 v[212:215], v[40:43], v[60:63], v[212:215]
    v_mfma_f32_16x16x32_bf16 v[164:167], v[36:39], v[64:67], v[164:167]
    v_mfma_f32_16x16x32_bf16 v[204:207], v[40:43], v[64:67], v[204:207]
    v_mfma_f32_16x16x32_bf16 v[156:159], v[36:39], v[68:71], v[156:159]
    v_mfma_f32_16x16x32_bf16 v[196:199], v[40:43], v[68:71], v[196:199]
    s_waitcnt lgkmcnt(0)
    v_mfma_f32_16x16x32_bf16 v[108:111], v[20:23], v[56:59], v[108:111]
    ds_read_b64_tr_b16 v[28:29], v3 offset:256
    v_mfma_f32_16x16x32_bf16 v[148:151], v[24:27], v[56:59], v[148:151]
    ds_read_b64_tr_b16 v[30:31], v3 offset:2560
    v_mfma_f32_16x16x32_bf16 v[100:103], v[20:23], v[60:63], v[100:103]
    ds_read_b64_tr_b16 v[32:33], v4 offset:544
    v_mfma_f32_16x16x32_bf16 v[140:143], v[24:27], v[60:63], v[140:143]
    ds_read_b64_tr_b16 v[34:35], v4 offset:2848
    v_mfma_f32_16x16x32_bf16 v[92:95], v[20:23], v[64:67], v[92:95]
    ds_read_b64_tr_b16 v[36:37], v4 offset:32
    v_mfma_f32_16x16x32_bf16 v[132:135], v[24:27], v[64:67], v[132:135]
    ds_read_b64_tr_b16 v[38:39], v4 offset:2336
    v_mfma_f32_16x16x32_bf16 v[84:87], v[20:23], v[68:71], v[84:87]
    ds_read_b64_tr_b16 v[40:41], v3 offset:320
    v_mfma_f32_16x16x32_bf16 v[124:127], v[24:27], v[68:71], v[124:127]
    ds_read_b64_tr_b16 v[42:43], v3 offset:2624
    v_mfma_f32_16x16x32_bf16 v[76:79], v[20:23], v[44:47], v[76:79]
    v_mfma_f32_16x16x32_bf16 v[116:119], v[24:27], v[44:47], v[116:119]
    s_waitcnt lgkmcnt(2)
    v_mfma_f32_16x16x32_bf16 v[236:239], v[28:31], v[44:47], v[236:239]
    v_mfma_f32_16x16x32_bf16 v[244:247], v[32:35], v[44:47], v[244:247]
    s_waitcnt lgkmcnt(0)
    v_mfma_f32_16x16x32_bf16 v[252:255], v[28:31], v[56:59], v[252:255]
    s_barrier
    v_mfma_f32_16x16x32_bf16 v[188:191], v[36:39], v[56:59], v[188:191]
    ds_read_b64_tr_b16 v[20:21], v3 offset:18432
    v_mfma_f32_16x16x32_bf16 v[228:231], v[40:43], v[56:59], v[228:231]
    ds_read_b64_tr_b16 v[22:23], v3 offset:20736
    v_mfma_f32_16x16x32_bf16 v[180:183], v[36:39], v[60:63], v[180:183]
    ds_read_b64_tr_b16 v[24:25], v4 offset:18720
    v_mfma_f32_16x16x32_bf16 v[220:223], v[40:43], v[60:63], v[220:223]
    ds_read_b64_tr_b16 v[26:27], v4 offset:21024
    v_mfma_f32_16x16x32_bf16 v[172:175], v[36:39], v[64:67], v[172:175]
    ds_read_b128 v[48:51], v5 offset:9216
    v_mfma_f32_16x16x32_bf16 v[212:215], v[40:43], v[64:67], v[212:215]
    v_mfma_f32_16x16x32_bf16 v[164:167], v[36:39], v[68:71], v[164:167]
    v_mfma_f32_16x16x32_bf16 v[204:207], v[40:43], v[68:71], v[204:207]
    v_mfma_f32_16x16x32_bf16 v[156:159], v[36:39], v[44:47], v[156:159]
    v_mfma_f32_16x16x32_bf16 v[196:199], v[40:43], v[44:47], v[196:199]
    s_waitcnt lgkmcnt(0)
    v_mfma_f32_16x16x32_bf16 v[108:111], v[20:23], v[60:63], v[108:111]
    ds_read_b64_tr_b16 v[28:29], v3 offset:18688
    v_mfma_f32_16x16x32_bf16 v[148:151], v[24:27], v[60:63], v[148:151]
    ds_read_b64_tr_b16 v[30:31], v3 offset:20992
    v_mfma_f32_16x16x32_bf16 v[100:103], v[20:23], v[64:67], v[100:103]
    ds_read_b64_tr_b16 v[32:33], v4 offset:18976
    v_mfma_f32_16x16x32_bf16 v[140:143], v[24:27], v[64:67], v[140:143]
    ds_read_b64_tr_b16 v[34:35], v4 offset:21280
    v_mfma_f32_16x16x32_bf16 v[92:95], v[20:23], v[68:71], v[92:95]
    ds_read_b64_tr_b16 v[36:37], v4 offset:18464
    v_mfma_f32_16x16x32_bf16 v[132:135], v[24:27], v[68:71], v[132:135]
    ds_read_b64_tr_b16 v[38:39], v4 offset:20768
    v_mfma_f32_16x16x32_bf16 v[84:87], v[20:23], v[44:47], v[84:87]
    ds_read_b64_tr_b16 v[40:41], v3 offset:18752
    v_mfma_f32_16x16x32_bf16 v[124:127], v[24:27], v[44:47], v[124:127]
    ds_read_b64_tr_b16 v[42:43], v3 offset:21056
    v_mfma_f32_16x16x32_bf16 v[76:79], v[20:23], v[48:51], v[76:79]
    v_mfma_f32_16x16x32_bf16 v[116:119], v[24:27], v[48:51], v[116:119]
    s_waitcnt lgkmcnt(2)
    v_mfma_f32_16x16x32_bf16 v[236:239], v[28:31], v[48:51], v[236:239]
    v_mfma_f32_16x16x32_bf16 v[244:247], v[32:35], v[48:51], v[244:247]
    s_waitcnt lgkmcnt(0)
    v_mfma_f32_16x16x32_bf16 v[252:255], v[28:31], v[60:63], v[252:255]
    s_barrier
    v_mfma_f32_16x16x32_bf16 v[188:191], v[36:39], v[60:63], v[188:191]
    ds_read_b64_tr_b16 v[20:21], v1 offset:0
    v_mfma_f32_16x16x32_bf16 v[228:231], v[40:43], v[60:63], v[228:231]
    ds_read_b64_tr_b16 v[22:23], v1 offset:2304
    v_mfma_f32_16x16x32_bf16 v[180:183], v[36:39], v[64:67], v[180:183]
    ds_read_b64_tr_b16 v[24:25], v2 offset:288
    v_mfma_f32_16x16x32_bf16 v[220:223], v[40:43], v[64:67], v[220:223]
    ds_read_b64_tr_b16 v[26:27], v2 offset:2592
    v_mfma_f32_16x16x32_bf16 v[172:175], v[36:39], v[68:71], v[172:175]
    ds_read_b128 v[52:55], v5 offset:10240
    v_mfma_f32_16x16x32_bf16 v[212:215], v[40:43], v[68:71], v[212:215]
    v_mfma_f32_16x16x32_bf16 v[164:167], v[36:39], v[44:47], v[164:167]
    v_mfma_f32_16x16x32_bf16 v[204:207], v[40:43], v[44:47], v[204:207]
    v_mfma_f32_16x16x32_bf16 v[156:159], v[36:39], v[48:51], v[156:159]
    v_mfma_f32_16x16x32_bf16 v[196:199], v[40:43], v[48:51], v[196:199]
    s_waitcnt lgkmcnt(0)
    v_mfma_f32_16x16x32_bf16 v[104:107], v[20:23], v[64:67], v[104:107]
    ds_read_b64_tr_b16 v[28:29], v1 offset:256
    v_mfma_f32_16x16x32_bf16 v[144:147], v[24:27], v[64:67], v[144:147]
    ds_read_b64_tr_b16 v[30:31], v1 offset:2560
    v_mfma_f32_16x16x32_bf16 v[96:99], v[20:23], v[68:71], v[96:99]
    ds_read_b64_tr_b16 v[32:33], v2 offset:544
    v_mfma_f32_16x16x32_bf16 v[136:139], v[24:27], v[68:71], v[136:139]
    ds_read_b64_tr_b16 v[34:35], v2 offset:2848
    v_mfma_f32_16x16x32_bf16 v[88:91], v[20:23], v[44:47], v[88:91]
    ds_read_b64_tr_b16 v[36:37], v2 offset:32
    v_mfma_f32_16x16x32_bf16 v[128:131], v[24:27], v[44:47], v[128:131]
    ds_read_b64_tr_b16 v[38:39], v2 offset:2336
    v_mfma_f32_16x16x32_bf16 v[80:83], v[20:23], v[48:51], v[80:83]
    ds_read_b64_tr_b16 v[40:41], v1 offset:320
    v_mfma_f32_16x16x32_bf16 v[120:123], v[24:27], v[48:51], v[120:123]
    ds_read_b64_tr_b16 v[42:43], v1 offset:2624
    v_mfma_f32_16x16x32_bf16 v[72:75], v[20:23], v[52:55], v[72:75]
    v_mfma_f32_16x16x32_bf16 v[112:115], v[24:27], v[52:55], v[112:115]
    s_waitcnt lgkmcnt(2)
    v_mfma_f32_16x16x32_bf16 v[232:235], v[28:31], v[52:55], v[232:235]
    v_mfma_f32_16x16x32_bf16 v[240:243], v[32:35], v[52:55], v[240:243]
    s_waitcnt lgkmcnt(0)
    v_mfma_f32_16x16x32_bf16 v[248:251], v[28:31], v[64:67], v[248:251]
    s_barrier
    v_mfma_f32_16x16x32_bf16 v[184:187], v[36:39], v[64:67], v[184:187]
    ds_read_b64_tr_b16 v[20:21], v1 offset:18432
    v_mfma_f32_16x16x32_bf16 v[224:227], v[40:43], v[64:67], v[224:227]
    ds_read_b64_tr_b16 v[22:23], v1 offset:20736
    v_mfma_f32_16x16x32_bf16 v[176:179], v[36:39], v[68:71], v[176:179]
    ds_read_b64_tr_b16 v[24:25], v2 offset:18720
    v_mfma_f32_16x16x32_bf16 v[216:219], v[40:43], v[68:71], v[216:219]
    ds_read_b64_tr_b16 v[26:27], v2 offset:21024
    v_mfma_f32_16x16x32_bf16 v[168:171], v[36:39], v[44:47], v[168:171]
    ds_read_b128 v[56:59], v5 offset:11264
    v_mfma_f32_16x16x32_bf16 v[208:211], v[40:43], v[44:47], v[208:211]
    v_mfma_f32_16x16x32_bf16 v[160:163], v[36:39], v[48:51], v[160:163]
    v_mfma_f32_16x16x32_bf16 v[200:203], v[40:43], v[48:51], v[200:203]
    v_mfma_f32_16x16x32_bf16 v[152:155], v[36:39], v[52:55], v[152:155]
    v_mfma_f32_16x16x32_bf16 v[192:195], v[40:43], v[52:55], v[192:195]
    s_waitcnt lgkmcnt(0)
    v_mfma_f32_16x16x32_bf16 v[104:107], v[20:23], v[68:71], v[104:107]
    ds_read_b64_tr_b16 v[28:29], v1 offset:18688
    v_mfma_f32_16x16x32_bf16 v[144:147], v[24:27], v[68:71], v[144:147]
    ds_read_b64_tr_b16 v[30:31], v1 offset:20992
    v_mfma_f32_16x16x32_bf16 v[96:99], v[20:23], v[44:47], v[96:99]
    ds_read_b64_tr_b16 v[32:33], v2 offset:18976
    v_mfma_f32_16x16x32_bf16 v[136:139], v[24:27], v[44:47], v[136:139]
    ds_read_b64_tr_b16 v[34:35], v2 offset:21280
    v_mfma_f32_16x16x32_bf16 v[88:91], v[20:23], v[48:51], v[88:91]
    ds_read_b64_tr_b16 v[36:37], v2 offset:18464
    v_mfma_f32_16x16x32_bf16 v[128:131], v[24:27], v[48:51], v[128:131]
    ds_read_b64_tr_b16 v[38:39], v2 offset:20768
    v_mfma_f32_16x16x32_bf16 v[80:83], v[20:23], v[52:55], v[80:83]
    ds_read_b64_tr_b16 v[40:41], v1 offset:18752
    v_mfma_f32_16x16x32_bf16 v[120:123], v[24:27], v[52:55], v[120:123]
    ds_read_b64_tr_b16 v[42:43], v1 offset:21056
    v_mfma_f32_16x16x32_bf16 v[72:75], v[20:23], v[56:59], v[72:75]
    v_mfma_f32_16x16x32_bf16 v[112:115], v[24:27], v[56:59], v[112:115]
    s_waitcnt lgkmcnt(2)
    v_mfma_f32_16x16x32_bf16 v[232:235], v[28:31], v[56:59], v[232:235]
    v_mfma_f32_16x16x32_bf16 v[240:243], v[32:35], v[56:59], v[240:243]
    s_waitcnt lgkmcnt(0)
    v_mfma_f32_16x16x32_bf16 v[248:251], v[28:31], v[68:71], v[248:251]
    s_barrier
    v_mfma_f32_16x16x32_bf16 v[184:187], v[36:39], v[68:71], v[184:187]
    ds_read_b64_tr_b16 v[20:21], v1 offset:36864
    v_mfma_f32_16x16x32_bf16 v[224:227], v[40:43], v[68:71], v[224:227]
    ds_read_b64_tr_b16 v[22:23], v1 offset:39168
    v_mfma_f32_16x16x32_bf16 v[176:179], v[36:39], v[44:47], v[176:179]
    ds_read_b64_tr_b16 v[24:25], v2 offset:37152
    v_mfma_f32_16x16x32_bf16 v[216:219], v[40:43], v[44:47], v[216:219]
    ds_read_b64_tr_b16 v[26:27], v2 offset:39456
    v_mfma_f32_16x16x32_bf16 v[168:171], v[36:39], v[48:51], v[168:171]
    ds_read_b128 v[60:63], v5 offset:12288
    v_mfma_f32_16x16x32_bf16 v[208:211], v[40:43], v[48:51], v[208:211]
    v_mfma_f32_16x16x32_bf16 v[160:163], v[36:39], v[52:55], v[160:163]
    v_mfma_f32_16x16x32_bf16 v[200:203], v[40:43], v[52:55], v[200:203]
    v_mfma_f32_16x16x32_bf16 v[152:155], v[36:39], v[56:59], v[152:155]
    v_mfma_f32_16x16x32_bf16 v[192:195], v[40:43], v[56:59], v[192:195]
    s_waitcnt lgkmcnt(0)
    v_mfma_f32_16x16x32_bf16 v[104:107], v[20:23], v[44:47], v[104:107]
    ds_read_b64_tr_b16 v[28:29], v1 offset:37120
    v_mfma_f32_16x16x32_bf16 v[144:147], v[24:27], v[44:47], v[144:147]
    ds_read_b64_tr_b16 v[30:31], v1 offset:39424
    v_mfma_f32_16x16x32_bf16 v[96:99], v[20:23], v[48:51], v[96:99]
    ds_read_b64_tr_b16 v[32:33], v2 offset:37408
    v_mfma_f32_16x16x32_bf16 v[136:139], v[24:27], v[48:51], v[136:139]
    ds_read_b64_tr_b16 v[34:35], v2 offset:39712
    v_mfma_f32_16x16x32_bf16 v[88:91], v[20:23], v[52:55], v[88:91]
    ds_read_b64_tr_b16 v[36:37], v2 offset:36896
    v_mfma_f32_16x16x32_bf16 v[128:131], v[24:27], v[52:55], v[128:131]
    ds_read_b64_tr_b16 v[38:39], v2 offset:39200
    v_mfma_f32_16x16x32_bf16 v[80:83], v[20:23], v[56:59], v[80:83]
    ds_read_b64_tr_b16 v[40:41], v1 offset:37184
    v_mfma_f32_16x16x32_bf16 v[120:123], v[24:27], v[56:59], v[120:123]
    ds_read_b64_tr_b16 v[42:43], v1 offset:39488
    v_mfma_f32_16x16x32_bf16 v[72:75], v[20:23], v[60:63], v[72:75]
    v_mfma_f32_16x16x32_bf16 v[112:115], v[24:27], v[60:63], v[112:115]
    s_waitcnt lgkmcnt(2)
    v_mfma_f32_16x16x32_bf16 v[232:235], v[28:31], v[60:63], v[232:235]
    v_mfma_f32_16x16x32_bf16 v[240:243], v[32:35], v[60:63], v[240:243]
    s_waitcnt lgkmcnt(0)
    v_mfma_f32_16x16x32_bf16 v[248:251], v[28:31], v[44:47], v[248:251]
    s_barrier
    v_mfma_f32_16x16x32_bf16 v[184:187], v[36:39], v[44:47], v[184:187]
    ds_read_b64_tr_b16 v[20:21], v3 offset:0
    v_mfma_f32_16x16x32_bf16 v[224:227], v[40:43], v[44:47], v[224:227]
    ds_read_b64_tr_b16 v[22:23], v3 offset:2304
    v_mfma_f32_16x16x32_bf16 v[176:179], v[36:39], v[48:51], v[176:179]
    ds_read_b64_tr_b16 v[24:25], v4 offset:288
    v_mfma_f32_16x16x32_bf16 v[216:219], v[40:43], v[48:51], v[216:219]
    ds_read_b64_tr_b16 v[26:27], v4 offset:2592
    v_mfma_f32_16x16x32_bf16 v[168:171], v[36:39], v[52:55], v[168:171]
    ds_read_b128 v[64:67], v5 offset:13312
    v_mfma_f32_16x16x32_bf16 v[208:211], v[40:43], v[52:55], v[208:211]
    v_mfma_f32_16x16x32_bf16 v[160:163], v[36:39], v[56:59], v[160:163]
    v_mfma_f32_16x16x32_bf16 v[200:203], v[40:43], v[56:59], v[200:203]
    v_mfma_f32_16x16x32_bf16 v[152:155], v[36:39], v[60:63], v[152:155]
    v_mfma_f32_16x16x32_bf16 v[192:195], v[40:43], v[60:63], v[192:195]
    s_waitcnt lgkmcnt(0)
    v_mfma_f32_16x16x32_bf16 v[104:107], v[20:23], v[48:51], v[104:107]
    ds_read_b64_tr_b16 v[28:29], v3 offset:256
    v_mfma_f32_16x16x32_bf16 v[144:147], v[24:27], v[48:51], v[144:147]
    ds_read_b64_tr_b16 v[30:31], v3 offset:2560
    v_mfma_f32_16x16x32_bf16 v[96:99], v[20:23], v[52:55], v[96:99]
    ds_read_b64_tr_b16 v[32:33], v4 offset:544
    v_mfma_f32_16x16x32_bf16 v[136:139], v[24:27], v[52:55], v[136:139]
    ds_read_b64_tr_b16 v[34:35], v4 offset:2848
    v_mfma_f32_16x16x32_bf16 v[88:91], v[20:23], v[56:59], v[88:91]
    ds_read_b64_tr_b16 v[36:37], v4 offset:32
    v_mfma_f32_16x16x32_bf16 v[128:131], v[24:27], v[56:59], v[128:131]
    ds_read_b64_tr_b16 v[38:39], v4 offset:2336
    v_mfma_f32_16x16x32_bf16 v[80:83], v[20:23], v[60:63], v[80:83]
    ds_read_b64_tr_b16 v[40:41], v3 offset:320
    v_mfma_f32_16x16x32_bf16 v[120:123], v[24:27], v[60:63], v[120:123]
    ds_read_b64_tr_b16 v[42:43], v3 offset:2624
    v_mfma_f32_16x16x32_bf16 v[72:75], v[20:23], v[64:67], v[72:75]
    v_mfma_f32_16x16x32_bf16 v[112:115], v[24:27], v[64:67], v[112:115]
    s_waitcnt lgkmcnt(2)
    v_mfma_f32_16x16x32_bf16 v[232:235], v[28:31], v[64:67], v[232:235]
    v_mfma_f32_16x16x32_bf16 v[240:243], v[32:35], v[64:67], v[240:243]
    s_waitcnt lgkmcnt(0)
    v_mfma_f32_16x16x32_bf16 v[248:251], v[28:31], v[48:51], v[248:251]
    s_barrier
    v_mfma_f32_16x16x32_bf16 v[184:187], v[36:39], v[48:51], v[184:187]
    ds_read_b64_tr_b16 v[20:21], v3 offset:18432
    v_mfma_f32_16x16x32_bf16 v[224:227], v[40:43], v[48:51], v[224:227]
    ds_read_b64_tr_b16 v[22:23], v3 offset:20736
    v_mfma_f32_16x16x32_bf16 v[176:179], v[36:39], v[52:55], v[176:179]
    ds_read_b64_tr_b16 v[24:25], v4 offset:18720
    v_mfma_f32_16x16x32_bf16 v[216:219], v[40:43], v[52:55], v[216:219]
    ds_read_b64_tr_b16 v[26:27], v4 offset:21024
    v_mfma_f32_16x16x32_bf16 v[168:171], v[36:39], v[56:59], v[168:171]
    ds_read_b128 v[68:71], v5 offset:14336
    v_mfma_f32_16x16x32_bf16 v[208:211], v[40:43], v[56:59], v[208:211]
    v_mfma_f32_16x16x32_bf16 v[160:163], v[36:39], v[60:63], v[160:163]
    v_mfma_f32_16x16x32_bf16 v[200:203], v[40:43], v[60:63], v[200:203]
    v_mfma_f32_16x16x32_bf16 v[152:155], v[36:39], v[64:67], v[152:155]
    v_mfma_f32_16x16x32_bf16 v[192:195], v[40:43], v[64:67], v[192:195]
    s_waitcnt lgkmcnt(0)
    v_mfma_f32_16x16x32_bf16 v[104:107], v[20:23], v[52:55], v[104:107]
    ds_read_b64_tr_b16 v[28:29], v3 offset:18688
    v_mfma_f32_16x16x32_bf16 v[144:147], v[24:27], v[52:55], v[144:147]
    ds_read_b64_tr_b16 v[30:31], v3 offset:20992
    v_mfma_f32_16x16x32_bf16 v[96:99], v[20:23], v[56:59], v[96:99]
    ds_read_b64_tr_b16 v[32:33], v4 offset:18976
    v_mfma_f32_16x16x32_bf16 v[136:139], v[24:27], v[56:59], v[136:139]
    ds_read_b64_tr_b16 v[34:35], v4 offset:21280
    v_mfma_f32_16x16x32_bf16 v[88:91], v[20:23], v[60:63], v[88:91]
    ds_read_b64_tr_b16 v[36:37], v4 offset:18464
    v_mfma_f32_16x16x32_bf16 v[128:131], v[24:27], v[60:63], v[128:131]
    ds_read_b64_tr_b16 v[38:39], v4 offset:20768
    v_mfma_f32_16x16x32_bf16 v[80:83], v[20:23], v[64:67], v[80:83]
    ds_read_b64_tr_b16 v[40:41], v3 offset:18752
    v_mfma_f32_16x16x32_bf16 v[120:123], v[24:27], v[64:67], v[120:123]
    ds_read_b64_tr_b16 v[42:43], v3 offset:21056
    v_mfma_f32_16x16x32_bf16 v[72:75], v[20:23], v[68:71], v[72:75]
    v_mfma_f32_16x16x32_bf16 v[112:115], v[24:27], v[68:71], v[112:115]
    s_waitcnt lgkmcnt(2)
    v_mfma_f32_16x16x32_bf16 v[232:235], v[28:31], v[68:71], v[232:235]
    v_mfma_f32_16x16x32_bf16 v[240:243], v[32:35], v[68:71], v[240:243]
    s_waitcnt lgkmcnt(0)
    v_mfma_f32_16x16x32_bf16 v[248:251], v[28:31], v[52:55], v[248:251]
    s_barrier
    v_xor_b32 v5, 0xdc00, v5
    v_mfma_f32_16x16x32_bf16 v[184:187], v[36:39], v[52:55], v[184:187]
    ds_read_b64_tr_b16 v[20:21], v1 offset:0
    ds_read_b64_tr_b16 v[22:23], v1 offset:2304
    v_mfma_f32_16x16x32_bf16 v[224:227], v[40:43], v[52:55], v[224:227]
    ds_read_b128 v[44:47], v5 offset:1024
    ds_read_b64_tr_b16 v[24:25], v2 offset:288
    v_mfma_f32_16x16x32_bf16 v[176:179], v[36:39], v[56:59], v[176:179]
    ds_read_b64_tr_b16 v[26:27], v2 offset:2592
    ds_read_b128 v[48:51], v5 offset:2048
    v_mfma_f32_16x16x32_bf16 v[216:219], v[40:43], v[56:59], v[216:219]
    ds_read_b128 v[52:55], v5 offset:3072
    ds_read_b128 v[56:59], v5 offset:4096
    v_mfma_f32_16x16x32_bf16 v[168:171], v[36:39], v[60:63], v[168:171]
    v_mfma_f32_16x16x32_bf16 v[208:211], v[40:43], v[60:63], v[208:211]
    ds_read_b128 v[60:63], v5 offset:5120
    v_mfma_f32_16x16x32_bf16 v[160:163], v[36:39], v[64:67], v[160:163]
    s_add_u32 s40, s40, 1
    s_cmp_lt_u32 s40, 4
    v_mfma_f32_16x16x32_bf16 v[200:203], v[40:43], v[64:67], v[200:203]
    v_mfma_f32_16x16x32_bf16 v[152:155], v[36:39], v[68:71], v[152:155]
    v_mfma_f32_16x16x32_bf16 v[192:195], v[40:43], v[68:71], v[192:195]
    s_cbranch_scc1 L_c0_0
    s_waitcnt lgkmcnt(0)
    v_mfma_f32_16x16x32_bf16 v[108:111], v[20:23], v[44:47], v[108:111]
    ds_read_b64_tr_b16 v[28:29], v1 offset:256
    v_mfma_f32_16x16x32_bf16 v[148:151], v[24:27], v[44:47], v[148:151]
    ds_read_b64_tr_b16 v[30:31], v1 offset:2560
    v_mfma_f32_16x16x32_bf16 v[100:103], v[20:23], v[48:51], v[100:103]
    ds_read_b64_tr_b16 v[32:33], v2 offset:544
    v_mfma_f32_16x16x32_bf16 v[140:143], v[24:27], v[48:51], v[140:143]
    ds_read_b64_tr_b16 v[34:35], v2 offset:2848
    v_mfma_f32_16x16x32_bf16 v[92:95], v[20:23], v[52:55], v[92:95]
    ds_read_b64_tr_b16 v[36:37], v2 offset:32
    v_mfma_f32_16x16x32_bf16 v[132:135], v[24:27], v[52:55], v[132:135]
    ds_read_b64_tr_b16 v[38:39], v2 offset:2336
    v_mfma_f32_16x16x32_bf16 v[84:87], v[20:23], v[56:59], v[84:87]
    ds_read_b64_tr_b16 v[40:41], v1 offset:320
    v_mfma_f32_16x16x32_bf16 v[124:127], v[24:27], v[56:59], v[124:127]
    ds_read_b64_tr_b16 v[42:43], v1 offset:2624
    v_mfma_f32_16x16x32_bf16 v[76:79], v[20:23], v[60:63], v[76:79]
    v_mfma_f32_16x16x32_bf16 v[116:119], v[24:27], v[60:63], v[116:119]
    s_waitcnt lgkmcnt(2)
    v_mfma_f32_16x16x32_bf16 v[236:239], v[28:31], v[60:63], v[236:239]
    v_mfma_f32_16x16x32_bf16 v[244:247], v[32:35], v[60:63], v[244:247]
    s_waitcnt lgkmcnt(0)
    v_mfma_f32_16x16x32_bf16 v[252:255], v[28:31], v[44:47], v[252:255]
    s_barrier
    v_mfma_f32_16x16x32_bf16 v[188:191], v[36:39], v[44:47], v[188:191]
    ds_read_b64_tr_b16 v[20:21], v1 offset:18432
    v_mfma_f32_16x16x32_bf16 v[228:231], v[40:43], v[44:47], v[228:231]
    ds_read_b64_tr_b16 v[22:23], v1 offset:20736
    v_mfma_f32_16x16x32_bf16 v[180:183], v[36:39], v[48:51], v[180:183]
    ds_read_b64_tr_b16 v[24:25], v2 offset:18720
    v_mfma_f32_16x16x32_bf16 v[220:223], v[40:43], v[48:51], v[220:223]
    ds_read_b64_tr_b16 v[26:27], v2 offset:21024
    v_mfma_f32_16x16x32_bf16 v[172:175], v[36:39], v[52:55], v[172:175]
    ds_read_b128 v[64:67], v5 offset:6144
    v_mfma_f32_16x16x32_bf16 v[212:215], v[40:43], v[52:55], v[212:215]
    ds_read_b128 v[68:71], v5 offset:7168
    v_mfma_f32_16x16x32_bf16 v[164:167], v[36:39], v[56:59], v[164:167]
    v_mfma_f32_16x16x32_bf16 v[204:207], v[40:43], v[56:59], v[204:207]
    v_mfma_f32_16x16x32_bf16 v[156:159], v[36:39], v[60:63], v[156:159]
    v_mfma_f32_16x16x32_bf16 v[196:199], v[40:43], v[60:63], v[196:199]
    s_waitcnt lgkmcnt(0)
    v_mfma_f32_16x16x32_bf16 v[108:111], v[20:23], v[52:55], v[108:111]
    ds_read_b64_tr_b16 v[28:29], v1 offset:18688
    v_mfma_f32_16x16x32_bf16 v[148:151], v[24:27], v[52:55], v[148:151]
    ds_read_b64_tr_b16 v[30:31], v1 offset:20992
    v_mfma_f32_16x16x32_bf16 v[100:103], v[20:23], v[56:59], v[100:103]
    ds_read_b64_tr_b16 v[32:33], v2 offset:18976
    v_mfma_f32_16x16x32_bf16 v[140:143], v[24:27], v[56:59], v[140:143]
    ds_read_b64_tr_b16 v[34:35], v2 offset:21280
    v_mfma_f32_16x16x32_bf16 v[92:95], v[20:23], v[60:63], v[92:95]
    ds_read_b64_tr_b16 v[36:37], v2 offset:18464
    v_mfma_f32_16x16x32_bf16 v[132:135], v[24:27], v[60:63], v[132:135]
    ds_read_b64_tr_b16 v[38:39], v2 offset:20768
    v_mfma_f32_16x16x32_bf16 v[84:87], v[20:23], v[64:67], v[84:87]
    ds_read_b64_tr_b16 v[40:41], v1 offset:18752
    v_mfma_f32_16x16x32_bf16 v[124:127], v[24:27], v[64:67], v[124:127]
    ds_read_b64_tr_b16 v[42:43], v1 offset:21056
    v_mfma_f32_16x16x32_bf16 v[76:79], v[20:23], v[68:71], v[76:79]
    v_mfma_f32_16x16x32_bf16 v[116:119], v[24:27], v[68:71], v[116:119]
    s_waitcnt lgkmcnt(2)
    v_mfma_f32_16x16x32_bf16 v[236:239], v[28:31], v[68:71], v[236:239]
    v_mfma_f32_16x16x32_bf16 v[244:247], v[32:35], v[68:71], v[244:247]
    s_waitcnt lgkmcnt(0)
    v_mfma_f32_16x16x32_bf16 v[252:255], v[28:31], v[52:55], v[252:255]
    s_barrier
    v_mfma_f32_16x16x32_bf16 v[188:191], v[36:39], v[52:55], v[188:191]
    ds_read_b64_tr_b16 v[20:21], v18 offset:36864
    v_mfma_f32_16x16x32_bf16 v[228:231], v[40:43], v[52:55], v[228:231]
    ds_read_b64 v[44:45], v6 offset:24576
    v_mfma_f32_16x16x32_bf16 v[180:183], v[36:39], v[56:59], v[180:183]
    ds_read_b64_tr_b16 v[24:25], v19 offset:37152
    v_mfma_f32_16x16x32_bf16 v[220:223], v[40:43], v[56:59], v[220:223]
    ds_read_b64 v[48:49], v6 offset:25600
    v_mfma_f32_16x16x32_bf16 v[172:175], v[36:39], v[60:63], v[172:175]
    ds_read_b64 v[52:53], v6 offset:26624
    v_mfma_f32_16x16x32_bf16 v[212:215], v[40:43], v[60:63], v[212:215]
    ds_read_b64 v[56:57], v6 offset:27648
    v_mfma_f32_16x16x32_bf16 v[164:167], v[36:39], v[64:67], v[164:167]
    ds_read_b64 v[60:61], v6 offset:28672
    v_mfma_f32_16x16x32_bf16 v[204:207], v[40:43], v[64:67], v[204:207]
    v_mfma_f32_16x16x32_bf16 v[156:159], v[36:39], v[68:71], v[156:159]
    v_mfma_f32_16x16x32_bf16 v[196:199], v[40:43], v[68:71], v[196:199]
    s_waitcnt lgkmcnt(1)
    v_mfma_f32_16x16x16_bf16 v[108:111], v[20:21], v[44:45], v[108:111]
    ds_read_b64_tr_b16 v[28:29], v18 offset:37120
    v_mfma_f32_16x16x16_bf16 v[148:151], v[24:25], v[44:45], v[148:151]
    ds_read_b64_tr_b16 v[32:33], v19 offset:37408
    v_mfma_f32_16x16x16_bf16 v[100:103], v[20:21], v[48:49], v[100:103]
    ds_read_b64_tr_b16 v[36:37], v19 offset:36896
    v_mfma_f32_16x16x16_bf16 v[140:143], v[24:25], v[48:49], v[140:143]
    ds_read_b64_tr_b16 v[40:41], v18 offset:37184
    v_mfma_f32_16x16x16_bf16 v[92:95], v[20:21], v[52:53], v[92:95]
    v_mfma_f32_16x16x16_bf16 v[132:135], v[24:25], v[52:53], v[132:135]
    v_mfma_f32_16x16x16_bf16 v[84:87], v[20:21], v[56:57], v[84:87]
    v_mfma_f32_16x16x16_bf16 v[124:127], v[24:25], v[56:57], v[124:127]
    s_waitcnt lgkmcnt(0)
    v_mfma_f32_16x16x16_bf16 v[76:79], v[20:21], v[60:61], v[76:79]
    v_mfma_f32_16x16x16_bf16 v[116:119], v[24:25], v[60:61], v[116:119]
    v_mfma_f32_16x16x16_bf16 v[236:239], v[28:29], v[60:61], v[236:239]
    v_mfma_f32_16x16x16_bf16 v[244:247], v[32:33], v[60:61], v[244:247]
    v_mfma_f32_16x16x16_bf16 v[252:255], v[28:29], v[44:45], v[252:255]
    s_barrier
    v_mfma_f32_16x16x16_bf16 v[188:191], v[36:37], v[44:45], v[188:191]
    ds_read_b64_tr_b16 v[20:21], v3 offset:0
    ds_read_b64_tr_b16 v[22:23], v3 offset:2304
    v_mfma_f32_16x16x16_bf16 v[228:231], v[40:41], v[44:45], v[228:231]
    ds_read_b128 v[64:67], v5 offset:6144
    ds_read_b64_tr_b16 v[24:25], v4 offset:288
    v_mfma_f32_16x16x16_bf16 v[180:183], v[36:37], v[48:49], v[180:183]
    ds_read_b64_tr_b16 v[26:27], v4 offset:2592
    v_mfma_f32_16x16x16_bf16 v[220:223], v[40:41], v[48:49], v[220:223]
    ds_read_b128 v[68:71], v5 offset:7168
    v_mfma_f32_16x16x16_bf16 v[172:175], v[36:37], v[52:53], v[172:175]
    ds_read_b128 v[44:47], v5 offset:8192
    v_mfma_f32_16x16x16_bf16 v[212:215], v[40:41], v[52:53], v[212:215]
    ds_read_b128 v[48:51], v5 offset:9216
    v_mfma_f32_16x16x16_bf16 v[164:167], v[36:37], v[56:57], v[164:167]
    ds_read_b128 v[52:55], v5 offset:10240
    v_mfma_f32_16x16x16_bf16 v[204:207], v[40:41], v[56:57], v[204:207]
    v_mfma_f32_16x16x16_bf16 v[156:159], v[36:37], v[60:61], v[156:159]
    v_mfma_f32_16x16x16_bf16 v[196:199], v[40:41], v[60:61], v[196:199]
    s_waitcnt lgkmcnt(1)
    v_mfma_f32_16x16x32_bf16 v[104:107], v[20:23], v[64:67], v[104:107]
    ds_read_b64_tr_b16 v[28:29], v3 offset:256
    v_sub_f32 v184, v184, v188
    v_mfma_f32_16x16x32_bf16 v[144:147], v[24:27], v[64:67], v[144:147]
    ds_read_b64_tr_b16 v[30:31], v3 offset:2560
    v_sub_f32 v185, v185, v189
    v_mfma_f32_16x16x32_bf16 v[96:99], v[20:23], v[68:71], v[96:99]
    ds_read_b64_tr_b16 v[32:33], v4 offset:544
    v_sub_f32 v186, v186, v190
    v_mfma_f32_16x16x32_bf16 v[136:139], v[24:27], v[68:71], v[136:139]
    ds_read_b64_tr_b16 v[34:35], v4 offset:2848
    v_sub_f32 v187, v187, v191
    v_mfma_f32_16x16x32_bf16 v[88:91], v[20:23], v[44:47], v[88:91]
    ds_read_b64_tr_b16 v[36:37], v4 offset:32
    v_sub_f32 v224, v224, v228
    v_mfma_f32_16x16x32_bf16 v[128:131], v[24:27], v[44:47], v[128:131]
    ds_read_b64_tr_b16 v[38:39], v4 offset:2336
    v_sub_f32 v225, v225, v229
    v_mfma_f32_16x16x32_bf16 v[80:83], v[20:23], v[48:51], v[80:83]
    ds_read_b64_tr_b16 v[40:41], v3 offset:320
    v_sub_f32 v226, v226, v230
    v_mfma_f32_16x16x32_bf16 v[120:123], v[24:27], v[48:51], v[120:123]
    ds_read_b64_tr_b16 v[42:43], v3 offset:2624
    s_waitcnt lgkmcnt(4)
    v_mfma_f32_16x16x32_bf16 v[72:75], v[20:23], v[52:55], v[72:75]
    v_sub_f32 v227, v227, v231
    v_sub_f32 v176, v176, v180
    v_mfma_f32_16x16x32_bf16 v[112:115], v[24:27], v[52:55], v[112:115]
    v_sub_f32 v177, v177, v181
    v_sub_f32 v178, v178, v182
    v_mfma_f32_16x16x32_bf16 v[232:235], v[28:31], v[52:55], v[232:235]
    v_sub_f32 v179, v179, v183
    v_sub_f32 v216, v216, v220
    v_mfma_f32_16x16x32_bf16 v[240:243], v[32:35], v[52:55], v[240:243]
    v_sub_f32 v217, v217, v221
    s_waitcnt lgkmcnt(0)
    v_mfma_f32_16x16x32_bf16 v[248:251], v[28:31], v[64:67], v[248:251]
    v_sub_f32 v218, v218, v222
    s_barrier
    v_mfma_f32_16x16x32_bf16 v[184:187], v[36:39], v[64:67], v[184:187]
    ds_read_b64_tr_b16 v[20:21], v3 offset:18432
    v_sub_f32 v219, v219, v223
    v_mfma_f32_16x16x32_bf16 v[224:227], v[40:43], v[64:67], v[224:227]
    ds_read_b64_tr_b16 v[22:23], v3 offset:20736
    v_sub_f32 v168, v168, v172
    v_mfma_f32_16x16x32_bf16 v[176:179], v[36:39], v[68:71], v[176:179]
    ds_read_b64_tr_b16 v[24:25], v4 offset:18720
    v_sub_f32 v208, v208, v212
    v_mfma_f32_16x16x32_bf16 v[216:219], v[40:43], v[68:71], v[216:219]
    ds_read_b64_tr_b16 v[26:27], v4 offset:21024
    v_sub_f32 v160, v160, v164
    v_mfma_f32_16x16x32_bf16 v[168:171], v[36:39], v[44:47], v[168:171]
    ds_read_b128 v[56:59], v5 offset:11264
    v_sub_f32 v200, v200, v204
    v_mfma_f32_16x16x32_bf16 v[208:211], v[40:43], v[44:47], v[208:211]
    ds_read_b128 v[60:63], v5 offset:12288
    v_sub_f32 v192, v192, v196
    v_mfma_f32_16x16x32_bf16 v[160:163], v[36:39], v[48:51], v[160:163]
    v_sub_f32 v104, v104, v108
    v_sub_f32 v105, v105, v109
    v_mfma_f32_16x16x32_bf16 v[200:203], v[40:43], v[48:51], v[200:203]
    v_sub_f32 v169, v169, v173
    v_sub_f32 v170, v170, v174
    v_mfma_f32_16x16x32_bf16 v[152:155], v[36:39], v[52:55], v[152:155]
    v_sub_f32 v171, v171, v175
    v_sub_f32 v209, v209, v213
    v_mfma_f32_16x16x32_bf16 v[192:195], v[40:43], v[52:55], v[192:195]
    v_sub_f32 v210, v210, v214
    s_waitcnt lgkmcnt(0)
    v_mfma_f32_16x16x32_bf16 v[104:107], v[20:23], v[44:47], v[104:107]
    ds_read_b64_tr_b16 v[28:29], v3 offset:18688
    v_sub_f32 v211, v211, v215
    v_mfma_f32_16x16x32_bf16 v[144:147], v[24:27], v[44:47], v[144:147]
    ds_read_b64_tr_b16 v[30:31], v3 offset:20992
    v_sub_f32 v161, v161, v165
    v_mfma_f32_16x16x32_bf16 v[96:99], v[20:23], v[48:51], v[96:99]
    ds_read_b64_tr_b16 v[32:33], v4 offset:18976
    v_sub_f32 v162, v162, v166
    v_mfma_f32_16x16x32_bf16 v[136:139], v[24:27], v[48:51], v[136:139]
    ds_read_b64_tr_b16 v[34:35], v4 offset:21280
    v_sub_f32 v163, v163, v167
    v_mfma_f32_16x16x32_bf16 v[88:91], v[20:23], v[52:55], v[88:91]
    ds_read_b64_tr_b16 v[36:37], v4 offset:18464
    v_sub_f32 v201, v201, v205
    v_mfma_f32_16x16x32_bf16 v[128:131], v[24:27], v[52:55], v[128:131]
    ds_read_b64_tr_b16 v[38:39], v4 offset:20768
    v_sub_f32 v202, v202, v206
    v_mfma_f32_16x16x32_bf16 v[80:83], v[20:23], v[56:59], v[80:83]
    ds_read_b64_tr_b16 v[40:41], v3 offset:18752
    v_sub_f32 v203, v203, v207
    v_mfma_f32_16x16x32_bf16 v[120:123], v[24:27], v[56:59], v[120:123]
    ds_read_b64_tr_b16 v[42:43], v3 offset:21056
    v_sub_f32 v152, v152, v156
    v_mfma_f32_16x16x32_bf16 v[72:75], v[20:23], v[60:63], v[72:75]
    v_sub_f32 v153, v153, v157
    v_sub_f32 v154, v154, v158
    v_mfma_f32_16x16x32_bf16 v[112:115], v[24:27], v[60:63], v[112:115]
    v_sub_f32 v155, v155, v159
    s_waitcnt lgkmcnt(2)
    v_mfma_f32_16x16x32_bf16 v[232:235], v[28:31], v[60:63], v[232:235]
    v_sub_f32 v193, v193, v197
    v_sub_f32 v194, v194, v198
    v_mfma_f32_16x16x32_bf16 v[240:243], v[32:35], v[60:63], v[240:243]
    v_sub_f32 v195, v195, v199
    s_waitcnt lgkmcnt(0)
    v_mfma_f32_16x16x32_bf16 v[248:251], v[28:31], v[44:47], v[248:251]
    v_sub_f32 v106, v106, v110
    s_barrier
    v_mfma_f32_16x16x32_bf16 v[184:187], v[36:39], v[44:47], v[184:187]
    ds_read_b64_tr_b16 v[20:21], v18 offset:0
    v_sub_f32 v107, v107, v111
    v_mfma_f32_16x16x32_bf16 v[224:227], v[40:43], v[44:47], v[224:227]
    ds_read_b64 v[64:65], v6 offset:29696
    v_sub_f32 v144, v144, v148
    v_mfma_f32_16x16x32_bf16 v[176:179], v[36:39], v[48:51], v[176:179]
    ds_read_b64_tr_b16 v[24:25], v19 offset:288
    v_sub_f32 v145, v145, v149
    v_mfma_f32_16x16x32_bf16 v[216:219], v[40:43], v[48:51], v[216:219]
    ds_read_b64 v[68:69], v6 offset:30720
    v_sub_f32 v146, v146, v150
    v_mfma_f32_16x16x32_bf16 v[168:171], v[36:39], v[52:55], v[168:171]
    ds_read_b64 v[44:45], v6 offset:31744
    v_sub_f32 v147, v147, v151
    v_mfma_f32_16x16x32_bf16 v[208:211], v[40:43], v[52:55], v[208:211]
    ds_read_b64 v[48:49], v6 offset:32768
    v_sub_f32 v96, v96, v100
    v_mfma_f32_16x16x32_bf16 v[160:163], v[36:39], v[56:59], v[160:163]
    ds_read_b64 v[52:53], v6 offset:33792
    v_sub_f32 v97, v97, v101
    v_mfma_f32_16x16x32_bf16 v[200:203], v[40:43], v[56:59], v[200:203]
    v_sub_f32 v98, v98, v102
    v_sub_f32 v99, v99, v103
    v_mfma_f32_16x16x32_bf16 v[152:155], v[36:39], v[60:63], v[152:155]
    v_sub_f32 v136, v136, v140
    v_sub_f32 v137, v137, v141
    v_mfma_f32_16x16x32_bf16 v[192:195], v[40:43], v[60:63], v[192:195]
    v_sub_f32 v138, v138, v142
    s_waitcnt lgkmcnt(1)
    v_mfma_f32_16x16x16_bf16 v[104:107], v[20:21], v[64:65], v[104:107]
    ds_read_b64_tr_b16 v[28:29], v18 offset:256
    v_sub_f32 v139, v139, v143
    v_mfma_f32_16x16x16_bf16 v[144:147], v[24:25], v[64:65], v[144:147]
    ds_read_b64_tr_b16 v[32:33], v19 offset:544
    v_sub_f32 v88, v88, v92
    v_mfma_f32_16x16x16_bf16 v[96:99], v[20:21], v[68:69], v[96:99]
    ds_read_b64_tr_b16 v[36:37], v19 offset:32
    v_sub_f32 v128, v128, v132
    v_mfma_f32_16x16x16_bf16 v[136:139], v[24:25], v[68:69], v[136:139]
    ds_read_b64_tr_b16 v[40:41], v18 offset:320
    v_sub_f32 v120, v120, v124
    v_mfma_f32_16x16x16_bf16 v[88:91], v[20:21], v[44:45], v[88:91]
    v_sub_f32 v72, v72, v76
    v_sub_f32 v73, v73, v77
    v_mfma_f32_16x16x16_bf16 v[128:131], v[24:25], v[44:45], v[128:131]
    v_sub_f32 v74, v74, v78
    v_sub_f32 v75, v75, v79
    v_mfma_f32_16x16x16_bf16 v[80:83], v[20:21], v[48:49], v[80:83]
    v_sub_f32 v112, v112, v116
    v_sub_f32 v113, v113, v117
    v_mfma_f32_16x16x16_bf16 v[120:123], v[24:25], v[48:49], v[120:123]
    v_sub_f32 v89, v89, v93
    s_waitcnt lgkmcnt(0)
    v_mfma_f32_16x16x16_bf16 v[72:75], v[20:21], v[52:53], v[72:75]
    v_sub_f32 v90, v90, v94
    v_sub_f32 v91, v91, v95
    v_mfma_f32_16x16x16_bf16 v[112:115], v[24:25], v[52:53], v[112:115]
    v_sub_f32 v129, v129, v133
    v_sub_f32 v130, v130, v134
    v_mfma_f32_16x16x16_bf16 v[232:235], v[28:29], v[52:53], v[232:235]
    v_sub_f32 v131, v131, v135
    v_sub_f32 v80, v80, v84
    v_mfma_f32_16x16x16_bf16 v[240:243], v[32:33], v[52:53], v[240:243]
    v_sub_f32 v81, v81, v85
    v_sub_f32 v82, v82, v86
    v_mfma_f32_16x16x16_bf16 v[248:251], v[28:29], v[64:65], v[248:251]
    s_barrier
    v_xor_b32 v5, 0xdc00, v5
    v_mfma_f32_16x16x16_bf16 v[184:187], v[36:37], v[64:65], v[184:187]
    ds_read_b64_tr_b16 v[20:21], v1 offset:18432
    ds_read_b64_tr_b16 v[22:23], v1 offset:20736
    v_mfma_f32_16x16x16_bf16 v[224:227], v[40:41], v[64:65], v[224:227]
    ds_read_b64_tr_b16 v[24:25], v2 offset:18720
    ds_read_b64_tr_b16 v[26:27], v2 offset:21024
    v_mfma_f32_16x16x16_bf16 v[176:179], v[36:37], v[68:69], v[176:179]
    ds_read_b128 v[56:59], v5 offset:4096
    v_sub_f32 v83, v83, v87
    v_mfma_f32_16x16x16_bf16 v[216:219], v[40:41], v[68:69], v[216:219]
    ds_read_b128 v[60:63], v5 offset:5120
    v_sub_f32 v121, v121, v125
    v_mfma_f32_16x16x16_bf16 v[168:171], v[36:37], v[44:45], v[168:171]
    v_sub_f32 v122, v122, v126
    v_sub_f32 v123, v123, v127
    v_mfma_f32_16x16x16_bf16 v[208:211], v[40:41], v[44:45], v[208:211]
    ds_read_b128 v[44:47], v5 offset:1024
    v_sub_f32 v114, v114, v118
    v_mfma_f32_16x16x16_bf16 v[160:163], v[36:37], v[48:49], v[160:163]
    v_sub_f32 v115, v115, v119
    v_sub_f32 v232, v232, v236
    v_mfma_f32_16x16x16_bf16 v[200:203], v[40:41], v[48:49], v[200:203]
    ds_read_b128 v[48:51], v5 offset:2048
    v_sub_f32 v233, v233, v237
    v_mfma_f32_16x16x16_bf16 v[152:155], v[36:37], v[52:53], v[152:155]
    v_sub_f32 v234, v234, v238
    v_sub_f32 v235, v235, v239
    v_mfma_f32_16x16x16_bf16 v[192:195], v[40:41], v[52:53], v[192:195]
    ds_read_b128 v[52:55], v5 offset:3072
    s_nop 7
    v_sub_f32 v240, v240, v244
    v_sub_f32 v241, v241, v245
    v_sub_f32 v242, v242, v246
    v_sub_f32 v243, v243, v247
    v_sub_f32 v248, v248, v252
    v_sub_f32 v249, v249, v253
    v_sub_f32 v250, v250, v254
    v_sub_f32 v251, v251, v255
    v_pk_fma_f32 v[108:109], v[108:109], s[60:61], v[104:105]
    v_pk_fma_f32 v[110:111], v[110:111], s[60:61], v[106:107]
    v_pk_fma_f32 v[100:101], v[100:101], s[60:61], v[96:97]
    v_pk_fma_f32 v[102:103], v[102:103], s[60:61], v[98:99]
    v_pk_fma_f32 v[92:93], v[92:93], s[60:61], v[88:89]
    v_pk_fma_f32 v[94:95], v[94:95], s[60:61], v[90:91]
    v_pk_fma_f32 v[84:85], v[84:85], s[60:61], v[80:81]
    v_pk_fma_f32 v[86:87], v[86:87], s[60:61], v[82:83]
    v_pk_fma_f32 v[76:77], v[76:77], s[60:61], v[72:73]
    v_pk_fma_f32 v[78:79], v[78:79], s[60:61], v[74:75]
    v_pk_fma_f32 v[148:149], v[148:149], s[60:61], v[144:145]
    v_pk_fma_f32 v[150:151], v[150:151], s[60:61], v[146:147]
    v_pk_fma_f32 v[140:141], v[140:141], s[60:61], v[136:137]
    v_pk_fma_f32 v[142:143], v[142:143], s[60:61], v[138:139]
    v_pk_fma_f32 v[132:133], v[132:133], s[60:61], v[128:129]
    v_pk_fma_f32 v[134:135], v[134:135], s[60:61], v[130:131]
    v_pk_fma_f32 v[124:125], v[124:125], s[60:61], v[120:121]
    v_pk_fma_f32 v[126:127], v[126:127], s[60:61], v[122:123]
    v_pk_fma_f32 v[116:117], v[116:117], s[60:61], v[112:113]
    v_pk_fma_f32 v[118:119], v[118:119], s[60:61], v[114:115]
    v_pk_fma_f32 v[236:237], v[236:237], s[60:61], v[232:233]
    v_pk_fma_f32 v[238:239], v[238:239], s[60:61], v[234:235]
    v_pk_fma_f32 v[244:245], v[244:245], s[60:61], v[240:241]
    v_pk_fma_f32 v[246:247], v[246:247], s[60:61], v[242:243]
    v_pk_fma_f32 v[252:253], v[252:253], s[60:61], v[248:249]
    v_pk_fma_f32 v[254:255], v[254:255], s[60:61], v[250:251]
    v_pk_fma_f32 v[188:189], v[188:189], s[60:61], v[184:185]
    v_pk_fma_f32 v[190:191], v[190:191], s[60:61], v[186:187]
    v_pk_fma_f32 v[228:229], v[228:229], s[60:61], v[224:225]
    v_pk_fma_f32 v[230:231], v[230:231], s[60:61], v[226:227]
    v_pk_fma_f32 v[180:181], v[180:181], s[60:61], v[176:177]
    v_pk_fma_f32 v[182:183], v[182:183], s[60:61], v[178:179]
    v_pk_fma_f32 v[220:221], v[220:221], s[60:61], v[216:217]
    v_pk_fma_f32 v[222:223], v[222:223], s[60:61], v[218:219]
    v_pk_fma_f32 v[172:173], v[172:173], s[60:61], v[168:169]
    v_pk_fma_f32 v[174:175], v[174:175], s[60:61], v[170:171]
    v_pk_fma_f32 v[212:213], v[212:213], s[60:61], v[208:209]
    v_pk_fma_f32 v[214:215], v[214:215], s[60:61], v[210:211]
    v_pk_fma_f32 v[164:165], v[164:165], s[60:61], v[160:161]
    v_pk_fma_f32 v[166:167], v[166:167], s[60:61], v[162:163]
    v_pk_fma_f32 v[204:205], v[204:205], s[60:61], v[200:201]
    v_pk_fma_f32 v[206:207], v[206:207], s[60:61], v[202:203]
    v_pk_fma_f32 v[156:157], v[156:157], s[60:61], v[152:153]
    v_pk_fma_f32 v[158:159], v[158:159], s[60:61], v[154:155]
    v_pk_fma_f32 v[196:197], v[196:197], s[60:61], v[192:193]
    v_pk_fma_f32 v[198:199], v[198:199], s[60:61], v[194:195]
    s_waitcnt lgkmcnt(0)
    s_mov_b32 s40, 0
.p2align 3
L_c0_46:
    s_waitcnt lgkmcnt(1)
    v_mfma_f32_16x16x32_bf16 v[104:107], v[20:23], v[44:47], v[104:107]
    ds_read_b64_tr_b16 v[28:29], v1 offset:18688
    v_mfma_f32_16x16x32_bf16 v[144:147], v[24:27], v[44:47], v[144:147]
    ds_read_b64_tr_b16 v[30:31], v1 offset:20992
    v_mfma_f32_16x16x32_bf16 v[96:99], v[20:23], v[48:51], v[96:99]
    ds_read_b64_tr_b16 v[32:33], v2 offset:18976
    v_mfma_f32_16x16x32_bf16 v[136:139], v[24:27], v[48:51], v[136:139]
    ds_read_b64_tr_b16 v[34:35], v2 offset:21280
    v_mfma_f32_16x16x32_bf16 v[88:91], v[20:23], v[52:55], v[88:91]
    ds_read_b64_tr_b16 v[36:37], v2 offset:18464
    v_mfma_f32_16x16x32_bf16 v[128:131], v[24:27], v[52:55], v[128:131]
    ds_read_b64_tr_b16 v[38:39], v2 offset:20768
    v_mfma_f32_16x16x32_bf16 v[80:83], v[20:23], v[56:59], v[80:83]
    ds_read_b64_tr_b16 v[40:41], v1 offset:18752
    v_mfma_f32_16x16x32_bf16 v[120:123], v[24:27], v[56:59], v[120:123]
    ds_read_b64_tr_b16 v[42:43], v1 offset:21056
    s_waitcnt lgkmcnt(4)
    v_mfma_f32_16x16x32_bf16 v[72:75], v[20:23], v[60:63], v[72:75]
    v_mfma_f32_16x16x32_bf16 v[112:115], v[24:27], v[60:63], v[112:115]
    v_mfma_f32_16x16x32_bf16 v[232:235], v[28:31], v[60:63], v[232:235]
    v_mfma_f32_16x16x32_bf16 v[240:243], v[32:35], v[60:63], v[240:243]
    s_waitcnt lgkmcnt(0)
    v_mfma_f32_16x16x32_bf16 v[248:251], v[28:31], v[44:47], v[248:251]
    s_barrier
    v_mfma_f32_16x16x32_bf16 v[184:187], v[36:39], v[44:47], v[184:187]
    ds_read_b64_tr_b16 v[20:21], v1 offset:36864
    v_mfma_f32_16x16x32_bf16 v[224:227], v[40:43], v[44:47], v[224:227]
    ds_read_b64_tr_b16 v[22:23], v1 offset:39168
    v_mfma_f32_16x16x32_bf16 v[176:179], v[36:39], v[48:51], v[176:179]
    ds_read_b64_tr_b16 v[24:25], v2 offset:37152
    v_mfma_f32_16x16x32_bf16 v[216:219], v[40:43], v[48:51], v[216:219]
    ds_read_b64_tr_b16 v[26:27], v2 offset:39456
    v_mfma_f32_16x16x32_bf16 v[168:171], v[36:39], v[52:55], v[168:171]
    ds_read_b128 v[64:67], v5 offset:6144
    v_mfma_f32_16x16x32_bf16 v[208:211], v[40:43], v[52:55], v[208:211]
    v_mfma_f32_16x16x32_bf16 v[160:163], v[36:39], v[56:59], v[160:163]
    v_mfma_f32_16x16x32_bf16 v[200:203], v[40:43], v[56:59], v[200:203]
    v_mfma_f32_16x16x32_bf16 v[152:155], v[36:39], v[60:63], v[152:155]
    v_mfma_f32_16x16x32_bf16 v[192:195], v[40:43], v[60:63], v[192:195]
    s_waitcnt lgkmcnt(0)
    v_mfma_f32_16x16x32_bf16 v[104:107], v[20:23], v[48:51], v[104:107]
    ds_read_b64_tr_b16 v[28:29], v1 offset:37120
    v_mfma_f32_16x16x32_bf16 v[144:147], v[24:27], v[48:51], v[144:147]
    ds_read_b64_tr_b16 v[30:31], v1 offset:39424
    v_mfma_f32_16x16x32_bf16 v[96:99], v[20:23], v[52:55], v[96:99]
    ds_read_b64_tr_b16 v[32:33], v2 offset:37408
    v_mfma_f32_16x16x32_bf16 v[136:139], v[24:27], v[52:55], v[136:139]
    ds_read_b64_tr_b16 v[34:35], v2 offset:39712
    v_mfma_f32_16x16x32_bf16 v[88:91], v[20:23], v[56:59], v[88:91]
    ds_read_b64_tr_b16 v[36:37], v2 offset:36896
    v_mfma_f32_16x16x32_bf16 v[128:131], v[24:27], v[56:59], v[128:131]
    ds_read_b64_tr_b16 v[38:39], v2 offset:39200
    v_mfma_f32_16x16x32_bf16 v[80:83], v[20:23], v[60:63], v[80:83]
    ds_read_b64_tr_b16 v[40:41], v1 offset:37184
    v_mfma_f32_16x16x32_bf16 v[120:123], v[24:27], v[60:63], v[120:123]
    ds_read_b64_tr_b16 v[42:43], v1 offset:39488
    v_mfma_f32_16x16x32_bf16 v[72:75], v[20:23], v[64:67], v[72:75]
    v_mfma_f32_16x16x32_bf16 v[112:115], v[24:27], v[64:67], v[112:115]
    s_waitcnt lgkmcnt(2)
    v_mfma_f32_16x16x32_bf16 v[232:235], v[28:31], v[64:67], v[232:235]
    v_mfma_f32_16x16x32_bf16 v[240:243], v[32:35], v[64:67], v[240:243]
    s_waitcnt lgkmcnt(0)
    v_mfma_f32_16x16x32_bf16 v[248:251], v[28:31], v[48:51], v[248:251]
    s_barrier
    v_mfma_f32_16x16x32_bf16 v[184:187], v[36:39], v[48:51], v[184:187]
    ds_read_b64_tr_b16 v[20:21], v3 offset:0
    v_mfma_f32_16x16x32_bf16 v[224:227], v[40:43], v[48:51], v[224:227]
    ds_read_b64_tr_b16 v[22:23], v3 offset:2304
    v_mfma_f32_16x16x32_bf16 v[176:179], v[36:39], v[52:55], v[176:179]
    ds_read_b64_tr_b16 v[24:25], v4 offset:288
    v_mfma_f32_16x16x32_bf16 v[216:219], v[40:43], v[52:55], v[216:219]
    ds_read_b64_tr_b16 v[26:27], v4 offset:2592
    v_mfma_f32_16x16x32_bf16 v[168:171], v[36:39], v[56:59], v[168:171]
    ds_read_b128 v[44:47], v5 offset:7168
    v_mfma_f32_16x16x32_bf16 v[208:211], v[40:43], v[56:59], v[208:211]
    v_mfma_f32_16x16x32_bf16 v[160:163], v[36:39], v[60:63], v[160:163]
    v_mfma_f32_16x16x32_bf16 v[200:203], v[40:43], v[60:63], v[200:203]
    v_mfma_f32_16x16x32_bf16 v[152:155], v[36:39], v[64:67], v[152:155]
    v_mfma_f32_16x16x32_bf16 v[192:195], v[40:43], v[64:67], v[192:195]
    s_waitcnt lgkmcnt(0)
    v_mfma_f32_16x16x32_bf16 v[104:107], v[20:23], v[52:55], v[104:107]
    ds_read_b64_tr_b16 v[28:29], v3 offset:256
    v_mfma_f32_16x16x32_bf16 v[144:147], v[24:27], v[52:55], v[144:147]
    ds_read_b64_tr_b16 v[30:31], v3 offset:2560
    v_mfma_f32_16x16x32_bf16 v[96:99], v[20:23], v[56:59], v[96:99]
    ds_read_b64_tr_b16 v[32:33], v4 offset:544
    v_mfma_f32_16x16x32_bf16 v[136:139], v[24:27], v[56:59], v[136:139]
    ds_read_b64_tr_b16 v[34:35], v4 offset:2848
    v_mfma_f32_16x16x32_bf16 v[88:91], v[20:23], v[60:63], v[88:91]
    ds_read_b64_tr_b16 v[36:37], v4 offset:32
    v_mfma_f32_16x16x32_bf16 v[128:131], v[24:27], v[60:63], v[128:131]
    ds_read_b64_tr_b16 v[38:39], v4 offset:2336
    v_mfma_f32_16x16x32_bf16 v[80:83], v[20:23], v[64:67], v[80:83]
    ds_read_b64_tr_b16 v[40:41], v3 offset:320
    v_mfma_f32_16x16x32_bf16 v[120:123], v[24:27], v[64:67], v[120:123]
    ds_read_b64_tr_b16 v[42:43], v3 offset:2624
    v_mfma_f32_16x16x32_bf16 v[72:75], v[20:23], v[44:47], v[72:75]
    v_mfma_f32_16x16x32_bf16 v[112:115], v[24:27], v[44:47], v[112:115]
    s_waitcnt lgkmcnt(2)
    v_mfma_f32_16x16x32_bf16 v[232:235], v[28:31], v[44:47], v[232:235]
    v_mfma_f32_16x16x32_bf16 v[240:243], v[32:35], v[44:47], v[240:243]
    s_waitcnt lgkmcnt(0)
    v_mfma_f32_16x16x32_bf16 v[248:251], v[28:31], v[52:55], v[248:251]
    s_barrier
    v_mfma_f32_16x16x32_bf16 v[184:187], v[36:39], v[52:55], v[184:187]
    ds_read_b64_tr_b16 v[20:21], v3 offset:18432
    v_mfma_f32_16x16x32_bf16 v[224:227], v[40:43], v[52:55], v[224:227]
    ds_read_b64_tr_b16 v[22:23], v3 offset:20736
    v_mfma_f32_16x16x32_bf16 v[176:179], v[36:39], v[56:59], v[176:179]
    ds_read_b64_tr_b16 v[24:25], v4 offset:18720
    v_mfma_f32_16x16x32_bf16 v[216:219], v[40:43], v[56:59], v[216:219]
    ds_read_b64_tr_b16 v[26:27], v4 offset:21024
    v_mfma_f32_16x16x32_bf16 v[168:171], v[36:39], v[60:63], v[168:171]
    ds_read_b128 v[48:51], v5 offset:8192
    v_mfma_f32_16x16x32_bf16 v[208:211], v[40:43], v[60:63], v[208:211]
    v_mfma_f32_16x16x32_bf16 v[160:163], v[36:39], v[64:67], v[160:163]
    v_mfma_f32_16x16x32_bf16 v[200:203], v[40:43], v[64:67], v[200:203]
    v_mfma_f32_16x16x32_bf16 v[152:155], v[36:39], v[44:47], v[152:155]
    v_mfma_f32_16x16x32_bf16 v[192:195], v[40:43], v[44:47], v[192:195]
    s_waitcnt lgkmcnt(0)
    v_mfma_f32_16x16x32_bf16 v[104:107], v[20:23], v[56:59], v[104:107]
    ds_read_b64_tr_b16 v[28:29], v3 offset:18688
    v_mfma_f32_16x16x32_bf16 v[144:147], v[24:27], v[56:59], v[144:147]
    ds_read_b64_tr_b16 v[30:31], v3 offset:20992
    v_mfma_f32_16x16x32_bf16 v[96:99], v[20:23], v[60:63], v[96:99]
    ds_read_b64_tr_b16 v[32:33], v4 offset:18976
    v_mfma_f32_16x16x32_bf16 v[136:139], v[24:27], v[60:63], v[136:139]
    ds_read_b64_tr_b16 v[34:35], v4 offset:21280
    v_mfma_f32_16x16x32_bf16 v[88:91], v[20:23], v[64:67], v[88:91]
    ds_read_b64_tr_b16 v[36:37], v4 offset:18464
    v_mfma_f32_16x16x32_bf16 v[128:131], v[24:27], v[64:67], v[128:131]
    ds_read_b64_tr_b16 v[38:39], v4 offset:20768
    v_mfma_f32_16x16x32_bf16 v[80:83], v[20:23], v[44:47], v[80:83]
    ds_read_b64_tr_b16 v[40:41], v3 offset:18752
    v_mfma_f32_16x16x32_bf16 v[120:123], v[24:27], v[44:47], v[120:123]
    ds_read_b64_tr_b16 v[42:43], v3 offset:21056
    v_mfma_f32_16x16x32_bf16 v[72:75], v[20:23], v[48:51], v[72:75]
    v_mfma_f32_16x16x32_bf16 v[112:115], v[24:27], v[48:51], v[112:115]
    s_waitcnt lgkmcnt(2)
    v_mfma_f32_16x16x32_bf16 v[232:235], v[28:31], v[48:51], v[232:235]
    v_mfma_f32_16x16x32_bf16 v[240:243], v[32:35], v[48:51], v[240:243]
    s_waitcnt lgkmcnt(0)
    v_mfma_f32_16x16x32_bf16 v[248:251], v[28:31], v[56:59], v[248:251]
    s_barrier
    v_mfma_f32_16x16x32_bf16 v[184:187], v[36:39], v[56:59], v[184:187]
    ds_read_b64_tr_b16 v[20:21], v1 offset:0
    v_mfma_f32_16x16x32_bf16 v[224:227], v[40:43], v[56:59], v[224:227]
    ds_read_b64_tr_b16 v[22:23], v1 offset:2304
    v_mfma_f32_16x16x32_bf16 v[176:179], v[36:39], v[60:63], v[176:179]
    ds_read_b64_tr_b16 v[24:25], v2 offset:288
    v_mfma_f32_16x16x32_bf16 v[216:219], v[40:43], v[60:63], v[216:219]
    ds_read_b64_tr_b16 v[26:27], v2 offset:2592
    v_mfma_f32_16x16x32_bf16 v[168:171], v[36:39], v[64:67], v[168:171]
    ds_read_b128 v[52:55], v5 offset:9216
    v_mfma_f32_16x16x32_bf16 v[208:211], v[40:43], v[64:67], v[208:211]
    v_mfma_f32_16x16x32_bf16 v[160:163], v[36:39], v[44:47], v[160:163]
    v_mfma_f32_16x16x32_bf16 v[200:203], v[40:43], v[44:47], v[200:203]
    v_mfma_f32_16x16x32_bf16 v[152:155], v[36:39], v[48:51], v[152:155]
    v_mfma_f32_16x16x32_bf16 v[192:195], v[40:43], v[48:51], v[192:195]
    s_waitcnt lgkmcnt(0)
    v_mfma_f32_16x16x32_bf16 v[104:107], v[20:23], v[60:63], v[104:107]
    ds_read_b64_tr_b16 v[28:29], v1 offset:256
    v_mfma_f32_16x16x32_bf16 v[144:147], v[24:27], v[60:63], v[144:147]
    ds_read_b64_tr_b16 v[30:31], v1 offset:2560
    v_mfma_f32_16x16x32_bf16 v[96:99], v[20:23], v[64:67], v[96:99]
    ds_read_b64_tr_b16 v[32:33], v2 offset:544
    v_mfma_f32_16x16x32_bf16 v[136:139], v[24:27], v[64:67], v[136:139]
    ds_read_b64_tr_b16 v[34:35], v2 offset:2848
    v_mfma_f32_16x16x32_bf16 v[88:91], v[20:23], v[44:47], v[88:91]
    ds_read_b64_tr_b16 v[36:37], v2 offset:32
    v_mfma_f32_16x16x32_bf16 v[128:131], v[24:27], v[44:47], v[128:131]
    ds_read_b64_tr_b16 v[38:39], v2 offset:2336
    v_mfma_f32_16x16x32_bf16 v[80:83], v[20:23], v[48:51], v[80:83]
    ds_read_b64_tr_b16 v[40:41], v1 offset:320
    v_mfma_f32_16x16x32_bf16 v[120:123], v[24:27], v[48:51], v[120:123]
    ds_read_b64_tr_b16 v[42:43], v1 offset:2624
    v_mfma_f32_16x16x32_bf16 v[72:75], v[20:23], v[52:55], v[72:75]
    v_mfma_f32_16x16x32_bf16 v[112:115], v[24:27], v[52:55], v[112:115]
    s_waitcnt lgkmcnt(2)
    v_mfma_f32_16x16x32_bf16 v[232:235], v[28:31], v[52:55], v[232:235]
    v_mfma_f32_16x16x32_bf16 v[240:243], v[32:35], v[52:55], v[240:243]
    s_waitcnt lgkmcnt(0)
    v_mfma_f32_16x16x32_bf16 v[248:251], v[28:31], v[60:63], v[248:251]
    s_barrier
    v_mfma_f32_16x16x32_bf16 v[184:187], v[36:39], v[60:63], v[184:187]
    ds_read_b64_tr_b16 v[20:21], v1 offset:18432
    ds_read_b64_tr_b16 v[22:23], v1 offset:20736
    v_mfma_f32_16x16x32_bf16 v[224:227], v[40:43], v[60:63], v[224:227]
    ds_read_b128 v[56:59], v5 offset:10240
    ds_read_b64_tr_b16 v[24:25], v2 offset:18720
    v_mfma_f32_16x16x32_bf16 v[176:179], v[36:39], v[64:67], v[176:179]
    ds_read_b64_tr_b16 v[26:27], v2 offset:21024
    v_mfma_f32_16x16x32_bf16 v[216:219], v[40:43], v[64:67], v[216:219]
    ds_read_b128 v[60:63], v5 offset:11264
    v_mfma_f32_16x16x32_bf16 v[168:171], v[36:39], v[44:47], v[168:171]
    ds_read_b128 v[64:67], v5 offset:12288
    v_mfma_f32_16x16x32_bf16 v[208:211], v[40:43], v[44:47], v[208:211]
    ds_read_b128 v[44:47], v5 offset:13312
    v_mfma_f32_16x16x32_bf16 v[160:163], v[36:39], v[48:51], v[160:163]
    v_mfma_f32_16x16x32_bf16 v[200:203], v[40:43], v[48:51], v[200:203]
    ds_read_b128 v[48:51], v5 offset:14336
    v_mfma_f32_16x16x32_bf16 v[152:155], v[36:39], v[52:55], v[152:155]
    v_mfma_f32_16x16x32_bf16 v[192:195], v[40:43], v[52:55], v[192:195]
    s_waitcnt lgkmcnt(1)
    v_mfma_f32_16x16x32_bf16 v[108:111], v[20:23], v[56:59], v[108:111]
    ds_read_b64_tr_b16 v[28:29], v1 offset:18688
    v_mfma_f32_16x16x32_bf16 v[148:151], v[24:27], v[56:59], v[148:151]
    ds_read_b64_tr_b16 v[30:31], v1 offset:20992
    v_mfma_f32_16x16x32_bf16 v[100:103], v[20:23], v[60:63], v[100:103]
    ds_read_b64_tr_b16 v[32:33], v2 offset:18976
    v_mfma_f32_16x16x32_bf16 v[140:143], v[24:27], v[60:63], v[140:143]
    ds_read_b64_tr_b16 v[34:35], v2 offset:21280
    v_mfma_f32_16x16x32_bf16 v[92:95], v[20:23], v[64:67], v[92:95]
    ds_read_b64_tr_b16 v[36:37], v2 offset:18464
    v_mfma_f32_16x16x32_bf16 v[132:135], v[24:27], v[64:67], v[132:135]
    ds_read_b64_tr_b16 v[38:39], v2 offset:20768
    v_mfma_f32_16x16x32_bf16 v[84:87], v[20:23], v[44:47], v[84:87]
    ds_read_b64_tr_b16 v[40:41], v1 offset:18752
    v_mfma_f32_16x16x32_bf16 v[124:127], v[24:27], v[44:47], v[124:127]
    ds_read_b64_tr_b16 v[42:43], v1 offset:21056
    s_waitcnt lgkmcnt(4)
    v_mfma_f32_16x16x32_bf16 v[76:79], v[20:23], v[48:51], v[76:79]
    v_mfma_f32_16x16x32_bf16 v[116:119], v[24:27], v[48:51], v[116:119]
    v_mfma_f32_16x16x32_bf16 v[236:239], v[28:31], v[48:51], v[236:239]
    v_mfma_f32_16x16x32_bf16 v[244:247], v[32:35], v[48:51], v[244:247]
    s_waitcnt lgkmcnt(0)
    v_mfma_f32_16x16x32_bf16 v[252:255], v[28:31], v[56:59], v[252:255]
    s_barrier
    v_mfma_f32_16x16x32_bf16 v[188:191], v[36:39], v[56:59], v[188:191]
    ds_read_b64_tr_b16 v[20:21], v1 offset:36864
    v_mfma_f32_16x16x32_bf16 v[228:231], v[40:43], v[56:59], v[228:231]
    ds_read_b64_tr_b16 v[22:23], v1 offset:39168
    v_mfma_f32_16x16x32_bf16 v[180:183], v[36:39], v[60:63], v[180:183]
    ds_read_b64_tr_b16 v[24:25], v2 offset:37152
    v_mfma_f32_16x16x32_bf16 v[220:223], v[40:43], v[60:63], v[220:223]
    ds_read_b64_tr_b16 v[26:27], v2 offset:39456
    v_mfma_f32_16x16x32_bf16 v[172:175], v[36:39], v[64:67], v[172:175]
    ds_read_b128 v[52:55], v5 offset:15360
    v_mfma_f32_16x16x32_bf16 v[212:215], v[40:43], v[64:67], v[212:215]
    v_mfma_f32_16x16x32_bf16 v[164:167], v[36:39], v[44:47], v[164:167]
    v_mfma_f32_16x16x32_bf16 v[204:207], v[40:43], v[44:47], v[204:207]
    v_mfma_f32_16x16x32_bf16 v[156:159], v[36:39], v[48:51], v[156:159]
    v_mfma_f32_16x16x32_bf16 v[196:199], v[40:43], v[48:51], v[196:199]
    s_waitcnt lgkmcnt(0)
    v_mfma_f32_16x16x32_bf16 v[108:111], v[20:23], v[60:63], v[108:111]
    ds_read_b64_tr_b16 v[28:29], v1 offset:37120
    v_mfma_f32_16x16x32_bf16 v[148:151], v[24:27], v[60:63], v[148:151]
    ds_read_b64_tr_b16 v[30:31], v1 offset:39424
    v_mfma_f32_16x16x32_bf16 v[100:103], v[20:23], v[64:67], v[100:103]
    ds_read_b64_tr_b16 v[32:33], v2 offset:37408
    v_mfma_f32_16x16x32_bf16 v[140:143], v[24:27], v[64:67], v[140:143]
    ds_read_b64_tr_b16 v[34:35], v2 offset:39712
    v_mfma_f32_16x16x32_bf16 v[92:95], v[20:23], v[44:47], v[92:95]
    ds_read_b64_tr_b16 v[36:37], v2 offset:36896
    v_mfma_f32_16x16x32_bf16 v[132:135], v[24:27], v[44:47], v[132:135]
    ds_read_b64_tr_b16 v[38:39], v2 offset:39200
    v_mfma_f32_16x16x32_bf16 v[84:87], v[20:23], v[48:51], v[84:87]
    ds_read_b64_tr_b16 v[40:41], v1 offset:37184
    v_mfma_f32_16x16x32_bf16 v[124:127], v[24:27], v[48:51], v[124:127]
    ds_read_b64_tr_b16 v[42:43], v1 offset:39488
    v_mfma_f32_16x16x32_bf16 v[76:79], v[20:23], v[52:55], v[76:79]
    v_mfma_f32_16x16x32_bf16 v[116:119], v[24:27], v[52:55], v[116:119]
    s_waitcnt lgkmcnt(2)
    v_mfma_f32_16x16x32_bf16 v[236:239], v[28:31], v[52:55], v[236:239]
    v_mfma_f32_16x16x32_bf16 v[244:247], v[32:35], v[52:55], v[244:247]
    s_waitcnt lgkmcnt(0)
    v_mfma_f32_16x16x32_bf16 v[252:255], v[28:31], v[60:63], v[252:255]
    s_barrier
    v_mfma_f32_16x16x32_bf16 v[188:191], v[36:39], v[60:63], v[188:191]
    ds_read_b64_tr_b16 v[20:21], v3 offset:0
    v_mfma_f32_16x16x32_bf16 v[228:231], v[40:43], v[60:63], v[228:231]
    ds_read_b64_tr_b16 v[22:23], v3 offset:2304
    v_mfma_f32_16x16x32_bf16 v[180:183], v[36:39], v[64:67], v[180:183]
    ds_read_b64_tr_b16 v[24:25], v4 offset:288
    v_mfma_f32_16x16x32_bf16 v[220:223], v[40:43], v[64:67], v[220:223]
    ds_read_b64_tr_b16 v[26:27], v4 offset:2592
    v_mfma_f32_16x16x32_bf16 v[172:175], v[36:39], v[44:47], v[172:175]
    ds_read_b128 v[56:59], v5 offset:16384
    v_mfma_f32_16x16x32_bf16 v[212:215], v[40:43], v[44:47], v[212:215]
    v_mfma_f32_16x16x32_bf16 v[164:167], v[36:39], v[48:51], v[164:167]
    v_mfma_f32_16x16x32_bf16 v[204:207], v[40:43], v[48:51], v[204:207]
    v_mfma_f32_16x16x32_bf16 v[156:159], v[36:39], v[52:55], v[156:159]
    v_mfma_f32_16x16x32_bf16 v[196:199], v[40:43], v[52:55], v[196:199]
    s_waitcnt lgkmcnt(0)
    v_mfma_f32_16x16x32_bf16 v[108:111], v[20:23], v[64:67], v[108:111]
    ds_read_b64_tr_b16 v[28:29], v3 offset:256
    v_mfma_f32_16x16x32_bf16 v[148:151], v[24:27], v[64:67], v[148:151]
    ds_read_b64_tr_b16 v[30:31], v3 offset:2560
    v_mfma_f32_16x16x32_bf16 v[100:103], v[20:23], v[44:47], v[100:103]
    ds_read_b64_tr_b16 v[32:33], v4 offset:544
    v_mfma_f32_16x16x32_bf16 v[140:143], v[24:27], v[44:47], v[140:143]
    ds_read_b64_tr_b16 v[34:35], v4 offset:2848
    v_mfma_f32_16x16x32_bf16 v[92:95], v[20:23], v[48:51], v[92:95]
    ds_read_b64_tr_b16 v[36:37], v4 offset:32
    v_mfma_f32_16x16x32_bf16 v[132:135], v[24:27], v[48:51], v[132:135]
    ds_read_b64_tr_b16 v[38:39], v4 offset:2336
    v_mfma_f32_16x16x32_bf16 v[84:87], v[20:23], v[52:55], v[84:87]
    ds_read_b64_tr_b16 v[40:41], v3 offset:320
    v_mfma_f32_16x16x32_bf16 v[124:127], v[24:27], v[52:55], v[124:127]
    ds_read_b64_tr_b16 v[42:43], v3 offset:2624
    v_mfma_f32_16x16x32_bf16 v[76:79], v[20:23], v[56:59], v[76:79]
    v_mfma_f32_16x16x32_bf16 v[116:119], v[24:27], v[56:59], v[116:119]
    s_waitcnt lgkmcnt(2)
    v_mfma_f32_16x16x32_bf16 v[236:239], v[28:31], v[56:59], v[236:239]
    v_mfma_f32_16x16x32_bf16 v[244:247], v[32:35], v[56:59], v[244:247]
    s_waitcnt lgkmcnt(0)
    v_mfma_f32_16x16x32_bf16 v[252:255], v[28:31], v[64:67], v[252:255]
    s_barrier
    v_mfma_f32_16x16x32_bf16 v[188:191], v[36:39], v[64:67], v[188:191]
    ds_read_b64_tr_b16 v[20:21], v3 offset:18432
    v_mfma_f32_16x16x32_bf16 v[228:231], v[40:43], v[64:67], v[228:231]
    ds_read_b64_tr_b16 v[22:23], v3 offset:20736
    v_mfma_f32_16x16x32_bf16 v[180:183], v[36:39], v[44:47], v[180:183]
    ds_read_b64_tr_b16 v[24:25], v4 offset:18720
    v_mfma_f32_16x16x32_bf16 v[220:223], v[40:43], v[44:47], v[220:223]
    ds_read_b64_tr_b16 v[26:27], v4 offset:21024
    v_mfma_f32_16x16x32_bf16 v[172:175], v[36:39], v[48:51], v[172:175]
    ds_read_b128 v[60:63], v5 offset:17408
    v_mfma_f32_16x16x32_bf16 v[212:215], v[40:43], v[48:51], v[212:215]
    v_mfma_f32_16x16x32_bf16 v[164:167], v[36:39], v[52:55], v[164:167]
    v_mfma_f32_16x16x32_bf16 v[204:207], v[40:43], v[52:55], v[204:207]
    v_mfma_f32_16x16x32_bf16 v[156:159], v[36:39], v[56:59], v[156:159]
    v_mfma_f32_16x16x32_bf16 v[196:199], v[40:43], v[56:59], v[196:199]
    s_waitcnt lgkmcnt(0)
    v_mfma_f32_16x16x32_bf16 v[108:111], v[20:23], v[44:47], v[108:111]
    ds_read_b64_tr_b16 v[28:29], v3 offset:18688
    v_mfma_f32_16x16x32_bf16 v[148:151], v[24:27], v[44:47], v[148:151]
    ds_read_b64_tr_b16 v[30:31], v3 offset:20992
    v_mfma_f32_16x16x32_bf16 v[100:103], v[20:23], v[48:51], v[100:103]
    ds_read_b64_tr_b16 v[32:33], v4 offset:18976
    v_mfma_f32_16x16x32_bf16 v[140:143], v[24:27], v[48:51], v[140:143]
    ds_read_b64_tr_b16 v[34:35], v4 offset:21280
    v_mfma_f32_16x16x32_bf16 v[92:95], v[20:23], v[52:55], v[92:95]
    ds_read_b64_tr_b16 v[36:37], v4 offset:18464
    v_mfma_f32_16x16x32_bf16 v[132:135], v[24:27], v[52:55], v[132:135]
    ds_read_b64_tr_b16 v[38:39], v4 offset:20768
    v_mfma_f32_16x16x32_bf16 v[84:87], v[20:23], v[56:59], v[84:87]
    ds_read_b64_tr_b16 v[40:41], v3 offset:18752
    v_mfma_f32_16x16x32_bf16 v[124:127], v[24:27], v[56:59], v[124:127]
    ds_read_b64_tr_b16 v[42:43], v3 offset:21056
    v_mfma_f32_16x16x32_bf16 v[76:79], v[20:23], v[60:63], v[76:79]
    v_mfma_f32_16x16x32_bf16 v[116:119], v[24:27], v[60:63], v[116:119]
    s_waitcnt lgkmcnt(2)
    v_mfma_f32_16x16x32_bf16 v[236:239], v[28:31], v[60:63], v[236:239]
    v_mfma_f32_16x16x32_bf16 v[244:247], v[32:35], v[60:63], v[244:247]
    s_waitcnt lgkmcnt(0)
    v_mfma_f32_16x16x32_bf16 v[252:255], v[28:31], v[44:47], v[252:255]
    s_barrier
    v_mfma_f32_16x16x32_bf16 v[188:191], v[36:39], v[44:47], v[188:191]
    ds_read_b64_tr_b16 v[20:21], v1 offset:0
    v_mfma_f32_16x16x32_bf16 v[228:231], v[40:43], v[44:47], v[228:231]
    ds_read_b64_tr_b16 v[22:23], v1 offset:2304
    v_mfma_f32_16x16x32_bf16 v[180:183], v[36:39], v[48:51], v[180:183]
    ds_read_b64_tr_b16 v[24:25], v2 offset:288
    v_mfma_f32_16x16x32_bf16 v[220:223], v[40:43], v[48:51], v[220:223]
    ds_read_b64_tr_b16 v[26:27], v2 offset:2592
    v_mfma_f32_16x16x32_bf16 v[172:175], v[36:39], v[52:55], v[172:175]
    ds_read_b128 v[64:67], v5 offset:18432
    v_mfma_f32_16x16x32_bf16 v[212:215], v[40:43], v[52:55], v[212:215]
    v_mfma_f32_16x16x32_bf16 v[164:167], v[36:39], v[56:59], v[164:167]
    v_mfma_f32_16x16x32_bf16 v[204:207], v[40:43], v[56:59], v[204:207]
    v_mfma_f32_16x16x32_bf16 v[156:159], v[36:39], v[60:63], v[156:159]
    v_mfma_f32_16x16x32_bf16 v[196:199], v[40:43], v[60:63], v[196:199]
    s_waitcnt lgkmcnt(0)
    v_mfma_f32_16x16x32_bf16 v[108:111], v[20:23], v[48:51], v[108:111]
    ds_read_b64_tr_b16 v[28:29], v1 offset:256
    v_mfma_f32_16x16x32_bf16 v[148:151], v[24:27], v[48:51], v[148:151]
    ds_read_b64_tr_b16 v[30:31], v1 offset:2560
    v_mfma_f32_16x16x32_bf16 v[100:103], v[20:23], v[52:55], v[100:103]
    ds_read_b64_tr_b16 v[32:33], v2 offset:544
    v_mfma_f32_16x16x32_bf16 v[140:143], v[24:27], v[52:55], v[140:143]
    ds_read_b64_tr_b16 v[34:35], v2 offset:2848
    v_mfma_f32_16x16x32_bf16 v[92:95], v[20:23], v[56:59], v[92:95]
    ds_read_b64_tr_b16 v[36:37], v2 offset:32
    v_mfma_f32_16x16x32_bf16 v[132:135], v[24:27], v[56:59], v[132:135]
    ds_read_b64_tr_b16 v[38:39], v2 offset:2336
    v_mfma_f32_16x16x32_bf16 v[84:87], v[20:23], v[60:63], v[84:87]
    ds_read_b64_tr_b16 v[40:41], v1 offset:320
    v_mfma_f32_16x16x32_bf16 v[124:127], v[24:27], v[60:63], v[124:127]
    ds_read_b64_tr_b16 v[42:43], v1 offset:2624
    v_mfma_f32_16x16x32_bf16 v[76:79], v[20:23], v[64:67], v[76:79]
    v_mfma_f32_16x16x32_bf16 v[116:119], v[24:27], v[64:67], v[116:119]
    s_waitcnt lgkmcnt(2)
    v_mfma_f32_16x16x32_bf16 v[236:239], v[28:31], v[64:67], v[236:239]
    v_mfma_f32_16x16x32_bf16 v[244:247], v[32:35], v[64:67], v[244:247]
    s_waitcnt lgkmcnt(0)
    v_mfma_f32_16x16x32_bf16 v[252:255], v[28:31], v[48:51], v[252:255]
    s_barrier
    v_xor_b32 v5, 0xdc00, v5
    v_mfma_f32_16x16x32_bf16 v[188:191], v[36:39], v[48:51], v[188:191]
    ds_read_b64_tr_b16 v[20:21], v1 offset:18432
    ds_read_b64_tr_b16 v[22:23], v1 offset:20736
    v_mfma_f32_16x16x32_bf16 v[228:231], v[40:43], v[48:51], v[228:231]
    ds_read_b128 v[44:47], v5 offset:1024
    ds_read_b64_tr_b16 v[24:25], v2 offset:18720
    v_mfma_f32_16x16x32_bf16 v[180:183], v[36:39], v[52:55], v[180:183]
    ds_read_b64_tr_b16 v[26:27], v2 offset:21024
    ds_read_b128 v[48:51], v5 offset:2048
    v_mfma_f32_16x16x32_bf16 v[220:223], v[40:43], v[52:55], v[220:223]
    ds_read_b128 v[52:55], v5 offset:3072
    v_mfma_f32_16x16x32_bf16 v[172:175], v[36:39], v[56:59], v[172:175]
    v_mfma_f32_16x16x32_bf16 v[212:215], v[40:43], v[56:59], v[212:215]
    ds_read_b128 v[56:59], v5 offset:4096
    v_mfma_f32_16x16x32_bf16 v[164:167], v[36:39], v[60:63], v[164:167]
    s_add_u32 s40, s40, 1
    s_cmp_lt_u32 s40, 4
    v_mfma_f32_16x16x32_bf16 v[204:207], v[40:43], v[60:63], v[204:207]
    ds_read_b128 v[60:63], v5 offset:5120
    v_mfma_f32_16x16x32_bf16 v[156:159], v[36:39], v[64:67], v[156:159]
    v_mfma_f32_16x16x32_bf16 v[196:199], v[40:43], v[64:67], v[196:199]
    s_cbranch_scc1 L_c0_46
    s_waitcnt lgkmcnt(1)
    v_mfma_f32_16x16x32_bf16 v[104:107], v[20:23], v[44:47], v[104:107]
    ds_read_b64_tr_b16 v[28:29], v1 offset:18688
    v_mfma_f32_16x16x32_bf16 v[144:147], v[24:27], v[44:47], v[144:147]
    ds_read_b64_tr_b16 v[30:31], v1 offset:20992
    v_mfma_f32_16x16x32_bf16 v[96:99], v[20:23], v[48:51], v[96:99]
    ds_read_b64_tr_b16 v[32:33], v2 offset:18976
    v_mfma_f32_16x16x32_bf16 v[136:139], v[24:27], v[48:51], v[136:139]
    ds_read_b64_tr_b16 v[34:35], v2 offset:21280
    v_mfma_f32_16x16x32_bf16 v[88:91], v[20:23], v[52:55], v[88:91]
    ds_read_b64_tr_b16 v[36:37], v2 offset:18464
    v_mfma_f32_16x16x32_bf16 v[128:131], v[24:27], v[52:55], v[128:131]
    ds_read_b64_tr_b16 v[38:39], v2 offset:20768
    v_mfma_f32_16x16x32_bf16 v[80:83], v[20:23], v[56:59], v[80:83]
    ds_read_b64_tr_b16 v[40:41], v1 offset:18752
    v_mfma_f32_16x16x32_bf16 v[120:123], v[24:27], v[56:59], v[120:123]
    ds_read_b64_tr_b16 v[42:43], v1 offset:21056
    s_waitcnt lgkmcnt(4)
    v_mfma_f32_16x16x32_bf16 v[72:75], v[20:23], v[60:63], v[72:75]
    v_mfma_f32_16x16x32_bf16 v[112:115], v[24:27], v[60:63], v[112:115]
    v_mfma_f32_16x16x32_bf16 v[232:235], v[28:31], v[60:63], v[232:235]
    v_mfma_f32_16x16x32_bf16 v[240:243], v[32:35], v[60:63], v[240:243]
    s_waitcnt lgkmcnt(0)
    v_mfma_f32_16x16x32_bf16 v[248:251], v[28:31], v[44:47], v[248:251]
    s_barrier
    v_mfma_f32_16x16x32_bf16 v[184:187], v[36:39], v[44:47], v[184:187]
    ds_read_b64_tr_b16 v[20:21], v1 offset:36864
    v_mfma_f32_16x16x32_bf16 v[224:227], v[40:43], v[44:47], v[224:227]
    ds_read_b64_tr_b16 v[22:23], v1 offset:39168
    v_mfma_f32_16x16x32_bf16 v[176:179], v[36:39], v[48:51], v[176:179]
    ds_read_b64_tr_b16 v[24:25], v2 offset:37152
    v_mfma_f32_16x16x32_bf16 v[216:219], v[40:43], v[48:51], v[216:219]
    ds_read_b64_tr_b16 v[26:27], v2 offset:39456
    v_mfma_f32_16x16x32_bf16 v[168:171], v[36:39], v[52:55], v[168:171]
    ds_read_b128 v[64:67], v5 offset:6144
    v_mfma_f32_16x16x32_bf16 v[208:211], v[40:43], v[52:55], v[208:211]
    ds_read_b128 v[68:71], v5 offset:7168
    v_mfma_f32_16x16x32_bf16 v[160:163], v[36:39], v[56:59], v[160:163]
    v_mfma_f32_16x16x32_bf16 v[200:203], v[40:43], v[56:59], v[200:203]
    v_mfma_f32_16x16x32_bf16 v[152:155], v[36:39], v[60:63], v[152:155]
    v_mfma_f32_16x16x32_bf16 v[192:195], v[40:43], v[60:63], v[192:195]
    s_waitcnt lgkmcnt(0)
    v_mfma_f32_16x16x32_bf16 v[104:107], v[20:23], v[52:55], v[104:107]
    ds_read_b64_tr_b16 v[28:29], v1 offset:37120
    v_mfma_f32_16x16x32_bf16 v[144:147], v[24:27], v[52:55], v[144:147]
    ds_read_b64_tr_b16 v[30:31], v1 offset:39424
    v_mfma_f32_16x16x32_bf16 v[96:99], v[20:23], v[56:59], v[96:99]
    ds_read_b64_tr_b16 v[32:33], v2 offset:37408
    v_mfma_f32_16x16x32_bf16 v[136:139], v[24:27], v[56:59], v[136:139]
    ds_read_b64_tr_b16 v[34:35], v2 offset:39712
    v_mfma_f32_16x16x32_bf16 v[88:91], v[20:23], v[60:63], v[88:91]
    ds_read_b64_tr_b16 v[36:37], v2 offset:36896
    v_mfma_f32_16x16x32_bf16 v[128:131], v[24:27], v[60:63], v[128:131]
    ds_read_b64_tr_b16 v[38:39], v2 offset:39200
    v_mfma_f32_16x16x32_bf16 v[80:83], v[20:23], v[64:67], v[80:83]
    ds_read_b64_tr_b16 v[40:41], v1 offset:37184
    v_mfma_f32_16x16x32_bf16 v[120:123], v[24:27], v[64:67], v[120:123]
    ds_read_b64_tr_b16 v[42:43], v1 offset:39488
    v_mfma_f32_16x16x32_bf16 v[72:75], v[20:23], v[68:71], v[72:75]
    v_mfma_f32_16x16x32_bf16 v[112:115], v[24:27], v[68:71], v[112:115]
    s_waitcnt lgkmcnt(2)
    v_mfma_f32_16x16x32_bf16 v[232:235], v[28:31], v[68:71], v[232:235]
    v_mfma_f32_16x16x32_bf16 v[240:243], v[32:35], v[68:71], v[240:243]
    s_waitcnt lgkmcnt(0)
    v_mfma_f32_16x16x32_bf16 v[248:251], v[28:31], v[52:55], v[248:251]
    s_barrier
    v_mfma_f32_16x16x32_bf16 v[184:187], v[36:39], v[52:55], v[184:187]
    ds_read_b64_tr_b16 v[20:21], v18 offset:55296
    v_mfma_f32_16x16x32_bf16 v[224:227], v[40:43], v[52:55], v[224:227]
    ds_read_b64 v[44:45], v6 offset:5120
    v_mfma_f32_16x16x32_bf16 v[176:179], v[36:39], v[56:59], v[176:179]
    ds_read_b64_tr_b16 v[24:25], v19 offset:55584
    v_mfma_f32_16x16x32_bf16 v[216:219], v[40:43], v[56:59], v[216:219]
    ds_read_b64 v[48:49], v6 offset:6144
    v_mfma_f32_16x16x32_bf16 v[168:171], v[36:39], v[60:63], v[168:171]
    ds_read_b64 v[52:53], v6 offset:7168
    v_mfma_f32_16x16x32_bf16 v[208:211], v[40:43], v[60:63], v[208:211]
    ds_read_b64 v[56:57], v6 offset:8192
    v_mfma_f32_16x16x32_bf16 v[160:163], v[36:39], v[64:67], v[160:163]
    ds_read_b64 v[60:61], v6 offset:9216
    v_mfma_f32_16x16x32_bf16 v[200:203], v[40:43], v[64:67], v[200:203]
    v_mfma_f32_16x16x32_bf16 v[152:155], v[36:39], v[68:71], v[152:155]
    v_mfma_f32_16x16x32_bf16 v[192:195], v[40:43], v[68:71], v[192:195]
    s_waitcnt lgkmcnt(1)
    v_mfma_f32_16x16x16_bf16 v[104:107], v[20:21], v[44:45], v[104:107]
    ds_read_b64_tr_b16 v[28:29], v18 offset:55552
    v_mfma_f32_16x16x16_bf16 v[144:147], v[24:25], v[44:45], v[144:147]
    ds_read_b64_tr_b16 v[32:33], v19 offset:55840
    v_mfma_f32_16x16x16_bf16 v[96:99], v[20:21], v[48:49], v[96:99]
    ds_read_b64_tr_b16 v[36:37], v19 offset:55328
    v_mfma_f32_16x16x16_bf16 v[136:139], v[24:25], v[48:49], v[136:139]
    ds_read_b64_tr_b16 v[40:41], v18 offset:55616
    v_mfma_f32_16x16x16_bf16 v[88:91], v[20:21], v[52:53], v[88:91]
    v_mfma_f32_16x16x16_bf16 v[128:131], v[24:25], v[52:53], v[128:131]
    v_mfma_f32_16x16x16_bf16 v[80:83], v[20:21], v[56:57], v[80:83]
    v_mfma_f32_16x16x16_bf16 v[120:123], v[24:25], v[56:57], v[120:123]
    s_waitcnt lgkmcnt(0)
    v_mfma_f32_16x16x16_bf16 v[72:75], v[20:21], v[60:61], v[72:75]
    v_mfma_f32_16x16x16_bf16 v[112:115], v[24:25], v[60:61], v[112:115]
    v_mfma_f32_16x16x16_bf16 v[232:235], v[28:29], v[60:61], v[232:235]
    v_mfma_f32_16x16x16_bf16 v[240:243], v[32:33], v[60:61], v[240:243]
    v_mfma_f32_16x16x16_bf16 v[248:251], v[28:29], v[44:45], v[248:251]
    s_barrier
    v_mfma_f32_16x16x16_bf16 v[184:187], v[36:37], v[44:45], v[184:187]
    ds_read_b64_tr_b16 v[20:21], v3 offset:18432
    ds_read_b64_tr_b16 v[22:23], v3 offset:20736
    v_mfma_f32_16x16x16_bf16 v[224:227], v[40:41], v[44:45], v[224:227]
    ds_read_b128 v[64:67], v5 offset:10240
    ds_read_b64_tr_b16 v[24:25], v4 offset:18720
    v_mfma_f32_16x16x16_bf16 v[176:179], v[36:37], v[48:49], v[176:179]
    ds_read_b64_tr_b16 v[26:27], v4 offset:21024
    v_mfma_f32_16x16x16_bf16 v[216:219], v[40:41], v[48:49], v[216:219]
    ds_read_b128 v[68:71], v5 offset:11264
    v_mfma_f32_16x16x16_bf16 v[168:171], v[36:37], v[52:53], v[168:171]
    ds_read_b128 v[44:47], v5 offset:12288
    v_mfma_f32_16x16x16_bf16 v[208:211], v[40:41], v[52:53], v[208:211]
    ds_read_b128 v[48:51], v5 offset:13312
    v_mfma_f32_16x16x16_bf16 v[160:163], v[36:37], v[56:57], v[160:163]
    ds_read_b128 v[52:55], v5 offset:14336
    v_mfma_f32_16x16x16_bf16 v[200:203], v[40:41], v[56:57], v[200:203]
    v_mfma_f32_16x16x16_bf16 v[152:155], v[36:37], v[60:61], v[152:155]
    v_mfma_f32_16x16x16_bf16 v[192:195], v[40:41], v[60:61], v[192:195]
    s_waitcnt lgkmcnt(1)
    v_mfma_f32_16x16x32_bf16 v[108:111], v[20:23], v[64:67], v[108:111]
    ds_read_b64_tr_b16 v[28:29], v3 offset:18688
    v_fma_f32 v248, s54, v248, v7
    v_mfma_f32_16x16x32_bf16 v[148:151], v[24:27], v[64:67], v[148:151]
    ds_read_b64_tr_b16 v[30:31], v3 offset:20992
    v_fma_f32 v249, s54, v249, v7
    v_mfma_f32_16x16x32_bf16 v[100:103], v[20:23], v[68:71], v[100:103]
    ds_read_b64_tr_b16 v[32:33], v4 offset:18976
    v_fma_f32 v250, s54, v250, v7
    v_mfma_f32_16x16x32_bf16 v[140:143], v[24:27], v[68:71], v[140:143]
    ds_read_b64_tr_b16 v[34:35], v4 offset:21280
    v_fma_f32 v251, s54, v251, v7
    v_mfma_f32_16x16x32_bf16 v[92:95], v[20:23], v[44:47], v[92:95]
    ds_read_b64_tr_b16 v[36:37], v4 offset:18464
    v_fma_f32 v232, s50, v232, v7
    v_mfma_f32_16x16x32_bf16 v[132:135], v[24:27], v[44:47], v[132:135]
    ds_read_b64_tr_b16 v[38:39], v4 offset:20768
    v_fma_f32 v233, s50, v233, v7
    v_mfma_f32_16x16x32_bf16 v[84:87], v[20:23], v[48:51], v[84:87]
    ds_read_b64_tr_b16 v[40:41], v3 offset:18752
    v_fma_f32 v234, s50, v234, v7
    v_mfma_f32_16x16x32_bf16 v[124:127], v[24:27], v[48:51], v[124:127]
    ds_read_b64_tr_b16 v[42:43], v3 offset:21056
    s_waitcnt lgkmcnt(4)
    v_mfma_f32_16x16x32_bf16 v[76:79], v[20:23], v[52:55], v[76:79]
    v_fma_f32 v235, s50, v235, v7
    v_mul_f32 v240, s52, v240
    v_mfma_f32_16x16x32_bf16 v[116:119], v[24:27], v[52:55], v[116:119]
    v_mul_f32 v241, s52, v241
    v_mul_f32 v242, s52, v242
    v_mfma_f32_16x16x32_bf16 v[236:239], v[28:31], v[52:55], v[236:239]
    v_mul_f32 v243, s52, v243
    v_fma_f32 v72, s50, v72, v7
    v_mfma_f32_16x16x32_bf16 v[244:247], v[32:35], v[52:55], v[244:247]
    v_fma_f32 v73, s50, v73, v7
    s_waitcnt lgkmcnt(0)
    v_mfma_f32_16x16x32_bf16 v[252:255], v[28:31], v[64:67], v[252:255]
    v_fma_f32 v74, s50, v74, v7
    s_barrier
    v_mfma_f32_16x16x32_bf16 v[188:191], v[36:39], v[64:67], v[188:191]
    ds_read_b64_tr_b16 v[20:21], v1 offset:0
    v_fma_f32 v75, s50, v75, v7
    v_mfma_f32_16x16x32_bf16 v[228:231], v[40:43], v[64:67], v[228:231]
    ds_read_b64_tr_b16 v[22:23], v1 offset:2304
    v_mul_f32 v112, s52, v112
    v_mfma_f32_16x16x32_bf16 v[180:183], v[36:39], v[68:71], v[180:183]
    ds_read_b64_tr_b16 v[24:25], v2 offset:288
    v_mul_f32 v113, s52, v113
    v_mfma_f32_16x16x32_bf16 v[220:223], v[40:43], v[68:71], v[220:223]
    ds_read_b64_tr_b16 v[26:27], v2 offset:2592
    v_mul_f32 v114, s52, v114
    v_mfma_f32_16x16x32_bf16 v[172:175], v[36:39], v[44:47], v[172:175]
    ds_read_b128 v[56:59], v5 offset:15360
    v_mul_f32 v115, s52, v115
    v_mfma_f32_16x16x32_bf16 v[212:215], v[40:43], v[44:47], v[212:215]
    ds_read_b128 v[60:63], v5 offset:16384
    v_fma_f32 v80, s50, v80, v7
    v_mfma_f32_16x16x32_bf16 v[164:167], v[36:39], v[48:51], v[164:167]
    v_fma_f32 v81, s50, v81, v7
    v_fma_f32 v82, s50, v82, v7
    v_mfma_f32_16x16x32_bf16 v[204:207], v[40:43], v[48:51], v[204:207]
    v_fma_f32 v83, s50, v83, v7
    v_mul_f32 v120, s52, v120
    v_mfma_f32_16x16x32_bf16 v[156:159], v[36:39], v[52:55], v[156:159]
    v_mul_f32 v121, s52, v121
    v_mul_f32 v122, s52, v122
    v_mfma_f32_16x16x32_bf16 v[196:199], v[40:43], v[52:55], v[196:199]
    v_mul_f32 v123, s52, v123
    s_waitcnt lgkmcnt(0)
    v_mfma_f32_16x16x32_bf16 v[108:111], v[20:23], v[44:47], v[108:111]
    ds_read_b64_tr_b16 v[28:29], v1 offset:256
    v_fma_f32 v88, s50, v88, v7
    v_mfma_f32_16x16x32_bf16 v[148:151], v[24:27], v[44:47], v[148:151]
    ds_read_b64_tr_b16 v[30:31], v1 offset:2560
    v_fma_f32 v89, s50, v89, v7
    v_mfma_f32_16x16x32_bf16 v[100:103], v[20:23], v[48:51], v[100:103]
    ds_read_b64_tr_b16 v[32:33], v2 offset:544
    v_fma_f32 v90, s50, v90, v7
    v_mfma_f32_16x16x32_bf16 v[140:143], v[24:27], v[48:51], v[140:143]
    ds_read_b64_tr_b16 v[34:35], v2 offset:2848
    v_fma_f32 v91, s50, v91, v7
    v_mfma_f32_16x16x32_bf16 v[92:95], v[20:23], v[52:55], v[92:95]
    ds_read_b64_tr_b16 v[36:37], v2 offset:32
    v_mul_f32 v128, s52, v128
    v_mfma_f32_16x16x32_bf16 v[132:135], v[24:27], v[52:55], v[132:135]
    ds_read_b64_tr_b16 v[38:39], v2 offset:2336
    v_mul_f32 v129, s52, v129
    v_mfma_f32_16x16x32_bf16 v[84:87], v[20:23], v[56:59], v[84:87]
    ds_read_b64_tr_b16 v[40:41], v1 offset:320
    v_mul_f32 v130, s52, v130
    v_mfma_f32_16x16x32_bf16 v[124:127], v[24:27], v[56:59], v[124:127]
    ds_read_b64_tr_b16 v[42:43], v1 offset:2624
    v_mul_f32 v131, s52, v131
    v_mfma_f32_16x16x32_bf16 v[76:79], v[20:23], v[60:63], v[76:79]
    v_fma_f32 v96, s50, v96, v7
    v_fma_f32 v97, s50, v97, v7
    v_mfma_f32_16x16x32_bf16 v[116:119], v[24:27], v[60:63], v[116:119]
    v_fma_f32 v98, s50, v98, v7
    s_waitcnt lgkmcnt(2)
    v_mfma_f32_16x16x32_bf16 v[236:239], v[28:31], v[60:63], v[236:239]
    v_fma_f32 v99, s50, v99, v7
    v_mul_f32 v136, s52, v136
    v_mfma_f32_16x16x32_bf16 v[244:247], v[32:35], v[60:63], v[244:247]
    v_mul_f32 v137, s52, v137
    s_waitcnt lgkmcnt(0)
    v_mfma_f32_16x16x32_bf16 v[252:255], v[28:31], v[44:47], v[252:255]
    v_mul_f32 v138, s52, v138
    s_barrier
    v_mfma_f32_16x16x32_bf16 v[188:191], v[36:39], v[44:47], v[188:191]
    ds_read_b64_tr_b16 v[20:21], v18 offset:18432
    v_mul_f32 v139, s52, v139
    v_mfma_f32_16x16x32_bf16 v[228:231], v[40:43], v[44:47], v[228:231]
    ds_read_b64 v[64:65], v6 offset:14336
    v_fma_f32 v104, s50, v104, v7
    v_mfma_f32_16x16x32_bf16 v[180:183], v[36:39], v[48:51], v[180:183]
    ds_read_b64_tr_b16 v[24:25], v19 offset:18720
    v_fma_f32 v105, s50, v105, v7
    v_mfma_f32_16x16x32_bf16 v[220:223], v[40:43], v[48:51], v[220:223]
    ds_read_b64 v[68:69], v6 offset:15360
    v_fma_f32 v106, s50, v106, v7
    v_mfma_f32_16x16x32_bf16 v[172:175], v[36:39], v[52:55], v[172:175]
    ds_read_b64 v[44:45], v6 offset:16384
    v_fma_f32 v107, s50, v107, v7
    v_mfma_f32_16x16x32_bf16 v[212:215], v[40:43], v[52:55], v[212:215]
    ds_read_b64 v[48:49], v6 offset:17408
    v_mul_f32 v144, s52, v144
    v_mfma_f32_16x16x32_bf16 v[164:167], v[36:39], v[56:59], v[164:167]
    ds_read_b64 v[52:53], v6 offset:18432
    v_mul_f32 v145, s52, v145
    v_mfma_f32_16x16x32_bf16 v[204:207], v[40:43], v[56:59], v[204:207]
    v_mul_f32 v146, s52, v146
    v_mul_f32 v147, s52, v147
    v_mfma_f32_16x16x32_bf16 v[156:159], v[36:39], v[60:63], v[156:159]
    v_fma_f32 v152, s50, v152, v7
    v_fma_f32 v153, s50, v153, v7
    v_mfma_f32_16x16x32_bf16 v[196:199], v[40:43], v[60:63], v[196:199]
    v_fma_f32 v154, s50, v154, v7
    s_waitcnt lgkmcnt(1)
    v_mfma_f32_16x16x16_bf16 v[108:111], v[20:21], v[64:65], v[108:111]
    ds_read_b64_tr_b16 v[28:29], v18 offset:18688
    v_fma_f32 v155, s50, v155, v7
    v_mfma_f32_16x16x16_bf16 v[148:151], v[24:25], v[64:65], v[148:151]
    ds_read_b64_tr_b16 v[32:33], v19 offset:18976
    v_mul_f32 v192, s52, v192
    v_mfma_f32_16x16x16_bf16 v[100:103], v[20:21], v[68:69], v[100:103]
    ds_read_b64_tr_b16 v[36:37], v19 offset:18464
    v_mul_f32 v193, s52, v193
    v_mfma_f32_16x16x16_bf16 v[140:143], v[24:25], v[68:69], v[140:143]
    ds_read_b64_tr_b16 v[40:41], v18 offset:18752
    v_mul_f32 v194, s52, v194
    v_mfma_f32_16x16x16_bf16 v[92:95], v[20:21], v[44:45], v[92:95]
    v_mul_f32 v195, s52, v195
    v_fma_f32 v160, s50, v160, v7
    v_mfma_f32_16x16x16_bf16 v[132:135], v[24:25], v[44:45], v[132:135]
    v_fma_f32 v161, s50, v161, v7
    v_fma_f32 v162, s50, v162, v7
    v_mfma_f32_16x16x16_bf16 v[84:87], v[20:21], v[48:49], v[84:87]
    v_fma_f32 v163, s50, v163, v7
    v_mul_f32 v200, s52, v200
    v_mfma_f32_16x16x16_bf16 v[124:127], v[24:25], v[48:49], v[124:127]
    v_mul_f32 v201, s52, v201
    s_waitcnt lgkmcnt(0)
    v_mfma_f32_16x16x16_bf16 v[76:79], v[20:21], v[52:53], v[76:79]
    v_mul_f32 v202, s52, v202
    v_mul_f32 v203, s52, v203
    v_mfma_f32_16x16x16_bf16 v[116:119], v[24:25], v[52:53], v[116:119]
    v_fma_f32 v168, s50, v168, v7
    v_fma_f32 v169, s50, v169, v7
    v_mfma_f32_16x16x16_bf16 v[236:239], v[28:29], v[52:53], v[236:239]
    v_fma_f32 v170, s50, v170, v7
    v_fma_f32 v171, s50, v171, v7
    v_mfma_f32_16x16x16_bf16 v[244:247], v[32:33], v[52:53], v[244:247]
    v_mul_f32 v208, s52, v208
    v_mul_f32 v209, s52, v209
    v_mfma_f32_16x16x16_bf16 v[252:255], v[28:29], v[64:65], v[252:255]
    v_mul_f32 v210, s52, v210
    s_barrier
    v_mfma_f32_16x16x16_bf16 v[188:191], v[36:37], v[64:65], v[188:191]
    v_mul_f32 v211, s52, v211
    v_fma_f32 v176, s50, v176, v7
    v_mfma_f32_16x16x16_bf16 v[228:231], v[40:41], v[64:65], v[228:231]
    v_fma_f32 v177, s50, v177, v7
    v_fma_f32 v178, s50, v178, v7
    v_mfma_f32_16x16x16_bf16 v[180:183], v[36:37], v[68:69], v[180:183]
    v_fma_f32 v179, s50, v179, v7
    v_mul_f32 v216, s52, v216
    v_mfma_f32_16x16x16_bf16 v[220:223], v[40:41], v[68:69], v[220:223]
    v_mul_f32 v217, s52, v217
    v_mul_f32 v218, s52, v218
    v_mfma_f32_16x16x16_bf16 v[172:175], v[36:37], v[44:45], v[172:175]
    v_mul_f32 v219, s52, v219
    v_fma_f32 v184, s50, v184, v7
    v_mfma_f32_16x16x16_bf16 v[212:215], v[40:41], v[44:45], v[212:215]
    v_fma_f32 v185, s50, v185, v7
    v_fma_f32 v186, s50, v186, v7
    v_mfma_f32_16x16x16_bf16 v[164:167], v[36:37], v[48:49], v[164:167]
    v_fma_f32 v187, s50, v187, v7
    v_mul_f32 v224, s52, v224
    v_mfma_f32_16x16x16_bf16 v[204:207], v[40:41], v[48:49], v[204:207]
    v_mul_f32 v225, s52, v225
    v_mul_f32 v226, s52, v226
    v_mfma_f32_16x16x16_bf16 v[156:159], v[36:37], v[52:53], v[156:159]
    v_mul_f32 v227, s52, v227
    v_mfma_f32_16x16x16_bf16 v[196:199], v[40:41], v[52:53], v[196:199]
    s_branch L_cepi
.p2align 6
L_cw1:
    s_barrier
    ds_read_b64_tr_b16 v[20:21], v1 offset:64
    ds_read_b64_tr_b16 v[22:23], v1 offset:2368
    ds_read_b64_tr_b16 v[24:25], v2 offset:352
    ds_read_b64_tr_b16 v[26:27], v2 offset:2656
    ds_read_b128 v[44:47], v5 offset:1024
    ds_read_b128 v[48:51], v5 offset:2048
    ds_read_b128 v[52:55], v5 offset:3072
    ds_read_b128 v[56:59], v5 offset:4096
    ds_read_b128 v[60:63], v5 offset:5120
    s_waitcnt lgkmcnt(0)
    s_mov_b32 s40, 0
.p2align 3
L_c1_0:
    s_waitcnt lgkmcnt(0)
    v_mfma_f32_16x16x32_bf16 v[108:111], v[20:23], v[44:47], v[108:111]
    ds_read_b64_tr_b16 v[28:29], v1 offset:256
    v_mfma_f32_16x16x32_bf16 v[148:151], v[24:27], v[44:47], v[148:151]
    ds_read_b64_tr_b16 v[30:31], v1 offset:2560
    v_mfma_f32_16x16x32_bf16 v[100:103], v[20:23], v[48:51], v[100:103]
    ds_read_b64_tr_b16 v[32:33], v2 offset:544
    v_mfma_f32_16x16x32_bf16 v[140:143], v[24:27], v[48:51], v[140:143]
    ds_read_b64_tr_b16 v[34:35], v2 offset:2848
    v_mfma_f32_16x16x32_bf16 v[92:95], v[20:23], v[52:55], v[92:95]
    ds_read_b64_tr_b16 v[36:37], v2 offset:96
    v_mfma_f32_16x16x32_bf16 v[132:135], v[24:27], v[52:55], v[132:135]
    ds_read_b64_tr_b16 v[38:39], v2 offset:2400
    v_mfma_f32_16x16x32_bf16 v[84:87], v[20:23], v[56:59], v[84:87]
    ds_read_b64_tr_b16 v[40:41], v1 offset:384
    v_mfma_f32_16x16x32_bf16 v[124:127], v[24:27], v[56:59], v[124:127]
    ds_read_b64_tr_b16 v[42:43], v1 offset:2688
    v_mfma_f32_16x16x32_bf16 v[76:79], v[20:23], v[60:63], v[76:79]
    v_mfma_f32_16x16x32_bf16 v[116:119], v[24:27], v[60:63], v[116:119]
    s_waitcnt lgkmcnt(2)
    v_mfma_f32_16x16x32_bf16 v[236:239], v[28:31], v[56:59], v[236:239]
    v_mfma_f32_16x16x32_bf16 v[244:247], v[32:35], v[56:59], v[244:247]
    s_waitcnt lgkmcnt(0)
    v_mfma_f32_16x16x32_bf16 v[252:255], v[32:35], v[44:47], v[252:255]
    s_barrier
    v_mfma_f32_16x16x32_bf16 v[188:191], v[36:39], v[44:47], v[188:191]
    ds_read_b64_tr_b16 v[20:21], v1 offset:18496
    v_mfma_f32_16x16x32_bf16 v[228:231], v[40:43], v[44:47], v[228:231]
    ds_read_b64_tr_b16 v[22:23], v1 offset:20800
    v_mfma_f32_16x16x32_bf16 v[180:183], v[36:39], v[48:51], v[180:183]
    ds_read_b64_tr_b16 v[24:25], v2 offset:18784
    v_mfma_f32_16x16x32_bf16 v[220:223], v[40:43], v[48:51], v[220:223]
    ds_read_b64_tr_b16 v[26:27], v2 offset:21088
    v_mfma_f32_16x16x32_bf16 v[172:175], v[36:39], v[52:55], v[172:175]
    ds_read_b128 v[64:67], v5 offset:6144
    v_mfma_f32_16x16x32_bf16 v[212:215], v[40:43], v[52:55], v[212:215]
    v_mfma_f32_16x16x32_bf16 v[164:167], v[36:39], v[56:59], v[164:167]
    v_mfma_f32_16x16x32_bf16 v[204:207], v[40:43], v[56:59], v[204:207]
    v_mfma_f32_16x16x32_bf16 v[156:159], v[36:39], v[60:63], v[156:159]
    v_mfma_f32_16x16x32_bf16 v[196:199], v[40:43], v[60:63], v[196:199]
    s_waitcnt lgkmcnt(0)
    v_mfma_f32_16x16x32_bf16 v[108:111], v[20:23], v[48:51], v[108:111]
    ds_read_b64_tr_b16 v[28:29], v1 offset:18688
    v_mfma_f32_16x16x32_bf16 v[148:151], v[24:27], v[48:51], v[148:151]
    ds_read_b64_tr_b16 v[30:31], v1 offset:20992
    v_mfma_f32_16x16x32_bf16 v[100:103], v[20:23], v[52:55], v[100:103]
    ds_read_b64_tr_b16 v[32:33], v2 offset:18976
    v_mfma_f32_16x16x32_bf16 v[140:143], v[24:27], v[52:55], v[140:143]
    ds_read_b64_tr_b16 v[34:35], v2 offset:21280
    v_mfma_f32_16x16x32_bf16 v[92:95], v[20:23], v[56:59], v[92:95]
    ds_read_b64_tr_b16 v[36:37], v2 offset:18528
    v_mfma_f32_16x16x32_bf16 v[132:135], v[24:27], v[56:59], v[132:135]
    ds_read_b64_tr_b16 v[38:39], v2 offset:20832
    v_mfma_f32_16x16x32_bf16 v[84:87], v[20:23], v[60:63], v[84:87]
    ds_read_b64_tr_b16 v[40:41], v1 offset:18816
    v_mfma_f32_16x16x32_bf16 v[124:127], v[24:27], v[60:63], v[124:127]
    ds_read_b64_tr_b16 v[42:43], v1 offset:21120
    v_mfma_f32_16x16x32_bf16 v[76:79], v[20:23], v[64:67], v[76:79]
    v_mfma_f32_16x16x32_bf16 v[116:119], v[24:27], v[64:67], v[116:119]
    s_waitcnt lgkmcnt(2)
    v_mfma_f32_16x16x32_bf16 v[236:239], v[28:31], v[60:63], v[236:239]
    v_mfma_f32_16x16x32_bf16 v[244:247], v[32:35], v[60:63], v[244:247]
    s_waitcnt lgkmcnt(0)
    v_mfma_f32_16x16x32_bf16 v[252:255], v[32:35], v[48:51], v[252:255]
    s_barrier
    v_mfma_f32_16x16x32_bf16 v[188:191], v[36:39], v[48:51], v[188:191]
    ds_read_b64_tr_b16 v[20:21], v1 offset:36928
    v_mfma_f32_16x16x32_bf16 v[228:231], v[40:43], v[48:51], v[228:231]
    ds_read_b64_tr_b16 v[22:23], v1 offset:39232
    v_mfma_f32_16x16x32_bf16 v[180:183], v[36:39], v[52:55], v[180:183]
    ds_read_b64_tr_b16 v[24:25], v2 offset:37216
    v_mfma_f32_16x16x32_bf16 v[220:223], v[40:43], v[52:55], v[220:223]
    ds_read_b64_tr_b16 v[26:27], v2 offset:39520
    v_mfma_f32_16x16x32_bf16 v[172:175], v[36:39], v[56:59], v[172:175]
    ds_read_b128 v[68:71], v5 offset:7168
    v_mfma_f32_16x16x32_bf16 v[212:215], v[40:43], v[56:59], v[212:215]
    v_mfma_f32_16x16x32_bf16 v[164:167], v[36:39], v[60:63], v[164:167]
    v_mfma_f32_16x16x32_bf16 v[204:207], v[40:43], v[60:63], v[204:207]
    v_mfma_f32_16x16x32_bf16 v[156:159], v[36:39], v[64:67], v[156:159]
    v_mfma_f32_16x16x32_bf16 v[196:199], v[40:43], v[64:67], v[196:199]
    s_waitcnt lgkmcnt(0)
    v_mfma_f32_16x16x32_bf16 v[108:111], v[20:23], v[52:55], v[108:111]
    ds_read_b64_tr_b16 v[28:29], v1 offset:37120
    v_mfma_f32_16x16x32_bf16 v[148:151], v[24:27], v[52:55], v[148:151]
    ds_read_b64_tr_b16 v[30:31], v1 offset:39424
    v_mfma_f32_16x16x32_bf16 v[100:103], v[20:23], v[56:59], v[100:103]
    ds_read_b64_tr_b16 v[32:33], v2 offset:37408
    v_mfma_f32_16x16x32_bf16 v[140:143], v[24:27], v[56:59], v[140:143]
    ds_read_b64_tr_b16 v[34:35], v2 offset:39712
    v_mfma_f32_16x16x32_bf16 v[92:95], v[20:23], v[60:63], v[92:95]
    ds_read_b64_tr_b16 v[36:37], v2 offset:36960
    v_mfma_f32_16x16x32_bf16 v[132:135], v[24:27], v[60:63], v[132:135]
    ds_read_b64_tr_b16 v[38:39], v2 offset:39264
    v_mfma_f32_16x16x32_bf16 v[84:87], v[20:23], v[64:67], v[84:87]
    ds_read_b64_tr_b16 v[40:41], v1 offset:37248
    v_mfma_f32_16x16x32_bf16 v[124:127], v[24:27], v[64:67], v[124:127]
    ds_read_b64_tr_b16 v[42:43], v1 offset:39552
    v_mfma_f32_16x16x32_bf16 v[76:79], v[20:23], v[68:71], v[76:79]
    v_mfma_f32_16x16x32_bf16 v[116:119], v[24:27], v[68:71], v[116:119]
    s_waitcnt lgkmcnt(2)
    v_mfma_f32_16x16x32_bf16 v[236:239], v[28:31], v[64:67], v[236:239]
    v_mfma_f32_16x16x32_bf16 v[244:247], v[32:35], v[64:67], v[244:247]
    s_waitcnt lgkmcnt(0)
    v_mfma_f32_16x16x32_bf16 v[252:255], v[32:35], v[52:55], v[252:255]
    s_barrier
    v_mfma_f32_16x16x32_bf16 v[188:191], v[36:39], v[52:55], v[188:191]
    ds_read_b64_tr_b16 v[20:21], v3 offset:64
    v_mfma_f32_16x16x32_bf16 v[228:231], v[40:43], v[52:55], v[228:231]
    ds_read_b64_tr_b16 v[22:23], v3 offset:2368
    v_mfma_f32_16x16x32_bf16 v[180:183], v[36:39], v[56:59], v[180:183]
    ds_read_b64_tr_b16 v[24:25], v4 offset:352
    v_mfma_f32_16x16x32_bf16 v[220:223], v[40:43], v[56:59], v[220:223]
    ds_read_b64_tr_b16 v[26:27], v4 offset:2656
    v_mfma_f32_16x16x32_bf16 v[172:175], v[36:39], v[60:63], v[172:175]
    ds_read_b128 v[44:47], v5 offset:8192
    v_mfma_f32_16x16x32_bf16 v[212:215], v[40:43], v[60:63], v[212:215]
    v_mfma_f32_16x16x32_bf16 v[164:167], v[36:39], v[64:67], v[164:167]
    v_mfma_f32_16x16x32_bf16 v[204:207], v[40:43], v[64:67], v[204:207]
    v_mfma_f32_16x16x32_bf16 v[156:159], v[36:39], v[68:71], v[156:159]
    v_mfma_f32_16x16x32_bf16 v[196:199], v[40:43], v[68:71], v[196:199]
    s_waitcnt lgkmcnt(0)
    v_mfma_f32_16x16x32_bf16 v[108:111], v[20:23], v[56:59], v[108:111]
    ds_read_b64_tr_b16 v[28:29], v3 offset:256
    v_mfma_f32_16x16x32_bf16 v[148:151], v[24:27], v[56:59], v[148:151]
    ds_read_b64_tr_b16 v[30:31], v3 offset:2560
    v_mfma_f32_16x16x32_bf16 v[100:103], v[20:23], v[60:63], v[100:103]
    ds_read_b64_tr_b16 v[32:33], v4 offset:544
    v_mfma_f32_16x16x32_bf16 v[140:143], v[24:27], v[60:63], v[140:143]
    ds_read_b64_tr_b16 v[34:35], v4 offset:2848
    v_mfma_f32_16x16x32_bf16 v[92:95], v[20:23], v[64:67], v[92:95]
    ds_read_b64_tr_b16 v[36:37], v4 offset:96
    v_mfma_f32_16x16x32_bf16 v[132:135], v[24:27], v[64:67], v[132:135]
    ds_read_b64_tr_b16 v[38:39], v4 offset:2400
    v_mfma_f32_16x16x32_bf16 v[84:87], v[20:23], v[68:71], v[84:87]
    ds_read_b64_tr_b16 v[40:41], v3 offset:384
    v_mfma_f32_16x16x32_bf16 v[124:127], v[24:27], v[68:71], v[124:127]
    ds_read_b64_tr_b16 v[42:43], v3 offset:2688
    v_mfma_f32_16x16x32_bf16 v[76:79], v[20:23], v[44:47], v[76:79]
    v_mfma_f32_16x16x32_bf16 v[116:119], v[24:27], v[44:47], v[116:119]
    s_waitcnt lgkmcnt(2)
    v_mfma_f32_16x16x32_bf16 v[236:239], v[28:31], v[68:71], v[236:239]
    v_mfma_f32_16x16x32_bf16 v[244:247], v[32:35], v[68:71], v[244:247]
    s_waitcnt lgkmcnt(0)
    v_mfma_f32_16x16x32_bf16 v[252:255], v[32:35], v[56:59], v[252:255]
    s_barrier
    v_mfma_f32_16x16x32_bf16 v[188:191], v[36:39], v[56:59], v[188:191]
    ds_read_b64_tr_b16 v[20:21], v3 offset:18496
    v_mfma_f32_16x16x32_bf16 v[228:231], v[40:43], v[56:59], v[228:231]
    ds_read_b64_tr_b16 v[22:23], v3 offset:20800
    v_mfma_f32_16x16x32_bf16 v[180:183], v[36:39], v[60:63], v[180:183]
    ds_read_b64_tr_b16 v[24:25], v4 offset:18784
    v_mfma_f32_16x16x32_bf16 v[220:223], v[40:43], v[60:63], v[220:223]
    ds_read_b64_tr_b16 v[26:27], v4 offset:21088
    v_mfma_f32_16x16x32_bf16 v[172:175], v[36:39], v[64:67], v[172:175]
    ds_read_b128 v[48:51], v5 offset:9216
    v_mfma_f32_16x16x32_bf16 v[212:215], v[40:43], v[64:67], v[212:215]
    v_mfma_f32_16x16x32_bf16 v[164:167], v[36:39], v[68:71], v[164:167]
    v_mfma_f32_16x16x32_bf16 v[204:207], v[40:43], v[68:71], v[204:207]
    v_mfma_f32_16x16x32_bf16 v[156:159], v[36:39], v[44:47], v[156:159]
    v_mfma_f32_16x16x32_bf16 v[196:199], v[40:43], v[44:47], v[196:199]
    s_waitcnt lgkmcnt(0)
    v_mfma_f32_16x16x32_bf16 v[108:111], v[20:23], v[60:63], v[108:111]
    ds_read_b64_tr_b16 v[28:29], v3 offset:18688
    v_mfma_f32_16x16x32_bf16 v[148:151], v[24:27], v[60:63], v[148:151]
    ds_read_b64_tr_b16 v[30:31], v3 offset:20992
    v_mfma_f32_16x16x32_bf16 v[100:103], v[20:23], v[64:67], v[100:103]
    ds_read_b64_tr_b16 v[32:33], v4 offset:18976
    v_mfma_f32_16x16x32_bf16 v[140:143], v[24:27], v[64:67], v[140:143]
    ds_read_b64_tr_b16 v[34:35], v4 offset:21280
    v_mfma_f32_16x16x32_bf16 v[92:95], v[20:23], v[68:71], v[92:95]
    ds_read_b64_tr_b16 v[36:37], v4 offset:18528
    v_mfma_f32_16x16x32_bf16 v[132:135], v[24:27], v[68:71], v[132:135]
    ds_read_b64_tr_b16 v[38:39], v4 offset:20832
    v_mfma_f32_16x16x32_bf16 v[84:87], v[20:23], v[44:47], v[84:87]
    ds_read_b64_tr_b16 v[40:41], v3 offset:18816
    v_mfma_f32_16x16x32_bf16 v[124:127], v[24:27], v[44:47], v[124:127]
    ds_read_b64_tr_b16 v[42:43], v3 offset:21120
    v_mfma_f32_16x16x32_bf16 v[76:79], v[20:23], v[48:51], v[76:79]
    v_mfma_f32_16x16x32_bf16 v[116:119], v[24:27], v[48:51], v[116:119]
    s_waitcnt lgkmcnt(2)
    v_mfma_f32_16x16x32_bf16 v[236:239], v[28:31], v[44:47], v[236:239]
    v_mfma_f32_16x16x32_bf16 v[244:247], v[32:35], v[44:47], v[244:247]
    s_waitcnt lgkmcnt(0)
    v_mfma_f32_16x16x32_bf16 v[252:255], v[32:35], v[60:63], v[252:255]
    s_barrier
    v_mfma_f32_16x16x32_bf16 v[188:191], v[36:39], v[60:63], v[188:191]
    ds_read_b64_tr_b16 v[20:21], v1 offset:64
    v_mfma_f32_16x16x32_bf16 v[228:231], v[40:43], v[60:63], v[228:231]
    ds_read_b64_tr_b16 v[22:23], v1 offset:2368
    v_mfma_f32_16x16x32_bf16 v[180:183], v[36:39], v[64:67], v[180:183]
    ds_read_b64_tr_b16 v[24:25], v2 offset:352
    v_mfma_f32_16x16x32_bf16 v[220:223], v[40:43], v[64:67], v[220:223]
    ds_read_b64_tr_b16 v[26:27], v2 offset:2656
    v_mfma_f32_16x16x32_bf16 v[172:175], v[36:39], v[68:71], v[172:175]
    ds_read_b128 v[52:55], v5 offset:10240
    v_mfma_f32_16x16x32_bf16 v[212:215], v[40:43], v[68:71], v[212:215]
    v_mfma_f32_16x16x32_bf16 v[164:167], v[36:39], v[44:47], v[164:167]
    v_mfma_f32_16x16x32_bf16 v[204:207], v[40:43], v[44:47], v[204:207]
    v_mfma_f32_16x16x32_bf16 v[156:159], v[36:39], v[48:51], v[156:159]
    v_mfma_f32_16x16x32_bf16 v[196:199], v[40:43], v[48:51], v[196:199]
    s_waitcnt lgkmcnt(0)
    v_mfma_f32_16x16x32_bf16 v[104:107], v[20:23], v[64:67], v[104:107]
    ds_read_b64_tr_b16 v[28:29], v1 offset:256
    v_mfma_f32_16x16x32_bf16 v[144:147], v[24:27], v[64:67], v[144:147]
    ds_read_b64_tr_b16 v[30:31], v1 offset:2560
    v_mfma_f32_16x16x32_bf16 v[96:99], v[20:23], v[68:71], v[96:99]
    ds_read_b64_tr_b16 v[32:33], v2 offset:544
    v_mfma_f32_16x16x32_bf16 v[136:139], v[24:27], v[68:71], v[136:139]
    ds_read_b64_tr_b16 v[34:35], v2 offset:2848
    v_mfma_f32_16x16x32_bf16 v[88:91], v[20:23], v[44:47], v[88:91]
    ds_read_b64_tr_b16 v[36:37], v2 offset:96
    v_mfma_f32_16x16x32_bf16 v[128:131], v[24:27], v[44:47], v[128:131]
    ds_read_b64_tr_b16 v[38:39], v2 offset:2400
    v_mfma_f32_16x16x32_bf16 v[80:83], v[20:23], v[48:51], v[80:83]
    ds_read_b64_tr_b16 v[40:41], v1 offset:384
    v_mfma_f32_16x16x32_bf16 v[120:123], v[24:27], v[48:51], v[120:123]
    ds_read_b64_tr_b16 v[42:43], v1 offset:2688
    v_mfma_f32_16x16x32_bf16 v[72:75], v[20:23], v[52:55], v[72:75]
    v_mfma_f32_16x16x32_bf16 v[112:115], v[24:27], v[52:55], v[112:115]
    s_waitcnt lgkmcnt(2)
    v_mfma_f32_16x16x32_bf16 v[232:235], v[28:31], v[48:51], v[232:235]
    v_mfma_f32_16x16x32_bf16 v[240:243], v[32:35], v[48:51], v[240:243]
    s_waitcnt lgkmcnt(0)
    v_mfma_f32_16x16x32_bf16 v[248:251], v[32:35], v[64:67], v[248:251]
    s_barrier
    v_mfma_f32_16x16x32_bf16 v[184:187], v[36:39], v[64:67], v[184:187]
    ds_read_b64_tr_b16 v[20:21], v1 offset:18496
    v_mfma_f32_16x16x32_bf16 v[224:227], v[40:43], v[64:67], v[224:227]
    ds_read_b64_tr_b16 v[22:23], v1 offset:20800
    v_mfma_f32_16x16x32_bf16 v[176:179], v[36:39], v[68:71], v[176:179]
    ds_read_b64_tr_b16 v[24:25], v2 offset:18784
    v_mfma_f32_16x16x32_bf16 v[216:219], v[40:43], v[68:71], v[216:219]
    ds_read_b64_tr_b16 v[26:27], v2 offset:21088
    v_mfma_f32_16x16x32_bf16 v[168:171], v[36:39], v[44:47], v[168:171]
    ds_read_b128 v[56:59], v5 offset:11264
    v_mfma_f32_16x16x32_bf16 v[208:211], v[40:43], v[44:47], v[208:211]
    v_mfma_f32_16x16x32_bf16 v[160:163], v[36:39], v[48:51], v[160:163]
    v_mfma_f32_16x16x32_bf16 v[200:203], v[40:43], v[48:51], v[200:203]
    v_mfma_f32_16x16x32_bf16 v[152:155], v[36:39], v[52:55], v[152:155]
    v_mfma_f32_16x16x32_bf16 v[192:195], v[40:43], v[52:55], v[192:195]
    s_waitcnt lgkmcnt(0)
    v_mfma_f32_16x16x32_bf16 v[104:107], v[20:23], v[68:71], v[104:107]
    ds_read_b64_tr_b16 v[28:29], v1 offset:18688
    v_mfma_f32_16x16x32_bf16 v[144:147], v[24:27], v[68:71], v[144:147]
    ds_read_b64_tr_b16 v[30:31], v1 offset:20992
    v_mfma_f32_16x16x32_bf16 v[96:99], v[20:23], v[44:47], v[96:99]
    ds_read_b64_tr_b16 v[32:33], v2 offset:18976
    v_mfma_f32_16x16x32_bf16 v[136:139], v[24:27], v[44:47], v[136:139]
    ds_read_b64_tr_b16 v[34:35], v2 offset:21280
    v_mfma_f32_16x16x32_bf16 v[88:91], v[20:23], v[48:51], v[88:91]
    ds_read_b64_tr_b16 v[36:37], v2 offset:18528
    v_mfma_f32_16x16x32_bf16 v[128:131], v[24:27], v[48:51], v[128:131]
    ds_read_b64_tr_b16 v[38:39], v2 offset:20832
    v_mfma_f32_16x16x32_bf16 v[80:83], v[20:23], v[52:55], v[80:83]
    ds_read_b64_tr_b16 v[40:41], v1 offset:18816
    v_mfma_f32_16x16x32_bf16 v[120:123], v[24:27], v[52:55], v[120:123]
    ds_read_b64_tr_b16 v[42:43], v1 offset:21120
    v_mfma_f32_16x16x32_bf16 v[72:75], v[20:23], v[56:59], v[72:75]
    v_mfma_f32_16x16x32_bf16 v[112:115], v[24:27], v[56:59], v[112:115]
    s_waitcnt lgkmcnt(2)
    v_mfma_f32_16x16x32_bf16 v[232:235], v[28:31], v[52:55], v[232:235]
    v_mfma_f32_16x16x32_bf16 v[240:243], v[32:35], v[52:55], v[240:243]
    s_waitcnt lgkmcnt(0)
    v_mfma_f32_16x16x32_bf16 v[248:251], v[32:35], v[68:71], v[248:251]
    s_barrier
    v_mfma_f32_16x16x32_bf16 v[184:187], v[36:39], v[68:71], v[184:187]
    ds_read_b64_tr_b16 v[20:21], v1 offset:36928
    v_mfma_f32_16x16x32_bf16 v[224:227], v[40:43], v[68:71], v[224:227]
    ds_read_b64_tr_b16 v[22:23], v1 offset:39232
    v_mfma_f32_16x16x32_bf16 v[176:179], v[36:39], v[44:47], v[176:179]
    ds_read_b64_tr_b16 v[24:25], v2 offset:37216
    v_mfma_f32_16x16x32_bf16 v[216:219], v[40:43], v[44:47], v[216:219]
    ds_read_b64_tr_b16 v[26:27], v2 offset:39520
    v_mfma_f32_16x16x32_bf16 v[168:171], v[36:39], v[48:51], v[168:171]
    ds_read_b128 v[60:63], v5 offset:12288
    v_mfma_f32_16x16x32_bf16 v[208:211], v[40:43], v[48:51], v[208:211]
    v_mfma_f32_16x16x32_bf16 v[160:163], v[36:39], v[52:55], v[160:163]
    v_mfma_f32_16x16x32_bf16 v[200:203], v[40:43], v[52:55], v[200:203]
    v_mfma_f32_16x16x32_bf16 v[152:155], v[36:39], v[56:59], v[152:155]
    v_mfma_f32_16x16x32_bf16 v[192:195], v[40:43], v[56:59], v[192:195]
    s_waitcnt lgkmcnt(0)
    v_mfma_f32_16x16x32_bf16 v[104:107], v[20:23], v[44:47], v[104:107]
    ds_read_b64_tr_b16 v[28:29], v1 offset:37120
    v_mfma_f32_16x16x32_bf16 v[144:147], v[24:27], v[44:47], v[144:147]
    ds_read_b64_tr_b16 v[30:31], v1 offset:39424
    v_mfma_f32_16x16x32_bf16 v[96:99], v[20:23], v[48:51], v[96:99]
    ds_read_b64_tr_b16 v[32:33], v2 offset:37408
    v_mfma_f32_16x16x32_bf16 v[136:139], v[24:27], v[48:51], v[136:139]
    ds_read_b64_tr_b16 v[34:35], v2 offset:39712
    v_mfma_f32_16x16x32_bf16 v[88:91], v[20:23], v[52:55], v[88:91]
    ds_read_b64_tr_b16 v[36:37], v2 offset:36960
    v_mfma_f32_16x16x32_bf16 v[128:131], v[24:27], v[52:55], v[128:131]
    ds_read_b64_tr_b16 v[38:39], v2 offset:39264
    v_mfma_f32_16x16x32_bf16 v[80:83], v[20:23], v[56:59], v[80:83]
    ds_read_b64_tr_b16 v[40:41], v1 offset:37248
    v_mfma_f32_16x16x32_bf16 v[120:123], v[24:27], v[56:59], v[120:123]
    ds_read_b64_tr_b16 v[42:43], v1 offset:39552
    v_mfma_f32_16x16x32_bf16 v[72:75], v[20:23], v[60:63], v[72:75]
    v_mfma_f32_16x16x32_bf16 v[112:115], v[24:27], v[60:63], v[112:115]
    s_waitcnt lgkmcnt(2)
    v_mfma_f32_16x16x32_bf16 v[232:235], v[28:31], v[56:59], v[232:235]
    v_mfma_f32_16x16x32_bf16 v[240:243], v[32:35], v[56:59], v[240:243]
    s_waitcnt lgkmcnt(0)
    v_mfma_f32_16x16x32_bf16 v[248:251], v[32:35], v[44:47], v[248:251]
    s_barrier
    v_mfma_f32_16x16x32_bf16 v[184:187], v[36:39], v[44:47], v[184:187]
    ds_read_b64_tr_b16 v[20:21], v3 offset:64
    v_mfma_f32_16x16x32_bf16 v[224:227], v[40:43], v[44:47], v[224:227]
    ds_read_b64_tr_b16 v[22:23], v3 offset:2368
    v_mfma_f32_16x16x32_bf16 v[176:179], v[36:39], v[48:51], v[176:179]
    ds_read_b64_tr_b16 v[24:25], v4 offset:352
    v_mfma_f32_16x16x32_bf16 v[216:219], v[40:43], v[48:51], v[216:219]
    ds_read_b64_tr_b16 v[26:27], v4 offset:2656
    v_mfma_f32_16x16x32_bf16 v[168:171], v[36:39], v[52:55], v[168:171]
    ds_read_b128 v[64:67], v5 offset:13312
    v_mfma_f32_16x16x32_bf16 v[208:211], v[40:43], v[52:55], v[208:211]
    v_mfma_f32_16x16x32_bf16 v[160:163], v[36:39], v[56:59], v[160:163]
    v_mfma_f32_16x16x32_bf16 v[200:203], v[40:43], v[56:59], v[200:203]
    v_mfma_f32_16x16x32_bf16 v[152:155], v[36:39], v[60:63], v[152:155]
    v_mfma_f32_16x16x32_bf16 v[192:195], v[40:43], v[60:63], v[192:195]
    s_waitcnt lgkmcnt(0)
    v_mfma_f32_16x16x32_bf16 v[104:107], v[20:23], v[48:51], v[104:107]
    ds_read_b64_tr_b16 v[28:29], v3 offset:256
    v_mfma_f32_16x16x32_bf16 v[144:147], v[24:27], v[48:51], v[144:147]
    ds_read_b64_tr_b16 v[30:31], v3 offset:2560
    v_mfma_f32_16x16x32_bf16 v[96:99], v[20:23], v[52:55], v[96:99]
    ds_read_b64_tr_b16 v[32:33], v4 offset:544
    v_mfma_f32_16x16x32_bf16 v[136:139], v[24:27], v[52:55], v[136:139]
    ds_read_b64_tr_b16 v[34:35], v4 offset:2848
    v_mfma_f32_16x16x32_bf16 v[88:91], v[20:23], v[56:59], v[88:91]
    ds_read_b64_tr_b16 v[36:37], v4 offset:96
    v_mfma_f32_16x16x32_bf16 v[128:131], v[24:27], v[56:59], v[128:131]
    ds_read_b64_tr_b16 v[38:39], v4 offset:2400
    v_mfma_f32_16x16x32_bf16 v[80:83], v[20:23], v[60:63], v[80:83]
    ds_read_b64_tr_b16 v[40:41], v3 offset:384
    v_mfma_f32_16x16x32_bf16 v[120:123], v[24:27], v[60:63], v[120:123]
    ds_read_b64_tr_b16 v[42:43], v3 offset:2688
    v_mfma_f32_16x16x32_bf16 v[72:75], v[20:23], v[64:67], v[72:75]
    v_mfma_f32_16x16x32_bf16 v[112:115], v[24:27], v[64:67], v[112:115]
    s_waitcnt lgkmcnt(2)
    v_mfma_f32_16x16x32_bf16 v[232:235], v[28:31], v[60:63], v[232:235]
    v_mfma_f32_16x16x32_bf16 v[240:243], v[32:35], v[60:63], v[240:243]
    s_waitcnt lgkmcnt(0)
    v_mfma_f32_16x16x32_bf16 v[248:251], v[32:35], v[48:51], v[248:251]
    s_barrier
    v_mfma_f32_16x16x32_bf16 v[184:187], v[36:39], v[48:51], v[184:187]
    ds_read_b64_tr_b16 v[20:21], v3 offset:18496
    v_mfma_f32_16x16x32_bf16 v[224:227], v[40:43], v[48:51], v[224:227]
    ds_read_b64_tr_b16 v[22:23], v3 offset:20800
    v_mfma_f32_16x16x32_bf16 v[176:179], v[36:39], v[52:55], v[176:179]
    ds_read_b64_tr_b16 v[24:25], v4 offset:18784
    v_mfma_f32_16x16x32_bf16 v[216:219], v[40:43], v[52:55], v[216:219]
    ds_read_b64_tr_b16 v[26:27], v4 offset:21088
    v_mfma_f32_16x16x32_bf16 v[168:171], v[36:39], v[56:59], v[168:171]
    ds_read_b128 v[68:71], v5 offset:14336
    v_mfma_f32_16x16x32_bf16 v[208:211], v[40:43], v[56:59], v[208:211]
    v_mfma_f32_16x16x32_bf16 v[160:163], v[36:39], v[60:63], v[160:163]
    v_mfma_f32_16x16x32_bf16 v[200:203], v[40:43], v[60:63], v[200:203]
    v_mfma_f32_16x16x32_bf16 v[152:155], v[36:39], v[64:67], v[152:155]
    v_mfma_f32_16x16x32_bf16 v[192:195], v[40:43], v[64:67], v[192:195]
    s_waitcnt lgkmcnt(0)
    v_mfma_f32_16x16x32_bf16 v[104:107], v[20:23], v[52:55], v[104:107]
    ds_read_b64_tr_b16 v[28:29], v3 offset:18688
    v_mfma_f32_16x16x32_bf16 v[144:147], v[24:27], v[52:55], v[144:147]
    ds_read_b64_tr_b16 v[30:31], v3 offset:20992
    v_mfma_f32_16x16x32_bf16 v[96:99], v[20:23], v[56:59], v[96:99]
    ds_read_b64_tr_b16 v[32:33], v4 offset:18976
    v_mfma_f32_16x16x32_bf16 v[136:139], v[24:27], v[56:59], v[136:139]
    ds_read_b64_tr_b16 v[34:35], v4 offset:21280
    v_mfma_f32_16x16x32_bf16 v[88:91], v[20:23], v[60:63], v[88:91]
    ds_read_b64_tr_b16 v[36:37], v4 offset:18528
    v_mfma_f32_16x16x32_bf16 v[128:131], v[24:27], v[60:63], v[128:131]
    ds_read_b64_tr_b16 v[38:39], v4 offset:20832
    v_mfma_f32_16x16x32_bf16 v[80:83], v[20:23], v[64:67], v[80:83]
    ds_read_b64_tr_b16 v[40:41], v3 offset:18816
    v_mfma_f32_16x16x32_bf16 v[120:123], v[24:27], v[64:67], v[120:123]
    ds_read_b64_tr_b16 v[42:43], v3 offset:21120
    v_mfma_f32_16x16x32_bf16 v[72:75], v[20:23], v[68:71], v[72:75]
    v_mfma_f32_16x16x32_bf16 v[112:115], v[24:27], v[68:71], v[112:115]
    s_waitcnt lgkmcnt(2)
    v_mfma_f32_16x16x32_bf16 v[232:235], v[28:31], v[64:67], v[232:235]
    v_mfma_f32_16x16x32_bf16 v[240:243], v[32:35], v[64:67], v[240:243]
    s_waitcnt lgkmcnt(0)
    v_mfma_f32_16x16x32_bf16 v[248:251], v[32:35], v[52:55], v[248:251]
    s_barrier
    v_xor_b32 v5, 0xdc00, v5
    v_mfma_f32_16x16x32_bf16 v[184:187], v[36:39], v[52:55], v[184:187]
    ds_read_b64_tr_b16 v[20:21], v1 offset:64
    ds_read_b64_tr_b16 v[22:23], v1 offset:2368
    v_mfma_f32_16x16x32_bf16 v[224:227], v[40:43], v[52:55], v[224:227]
    ds_read_b128 v[44:47], v5 offset:1024
    ds_read_b64_tr_b16 v[24:25], v2 offset:352
    v_mfma_f32_16x16x32_bf16 v[176:179], v[36:39], v[56:59], v[176:179]
    ds_read_b64_tr_b16 v[26:27], v2 offset:2656
    ds_read_b128 v[48:51], v5 offset:2048
    v_mfma_f32_16x16x32_bf16 v[216:219], v[40:43], v[56:59], v[216:219]
    ds_read_b128 v[52:55], v5 offset:3072
    ds_read_b128 v[56:59], v5 offset:4096
    v_mfma_f32_16x16x32_bf16 v[168:171], v[36:39], v[60:63], v[168:171]
    v_mfma_f32_16x16x32_bf16 v[208:211], v[40:43], v[60:63], v[208:211]
    ds_read_b128 v[60:63], v5 offset:5120
    v_mfma_f32_16x16x32_bf16 v[160:163], v[36:39], v[64:67], v[160:163]
    s_add_u32 s40, s40, 1
    s_cmp_lt_u32 s40, 4
    v_mfma_f32_16x16x32_bf16 v[200:203], v[40:43], v[64:67], v[200:203]
    v_mfma_f32_16x16x32_bf16 v[152:155], v[36:39], v[68:71], v[152:155]
    v_mfma_f32_16x16x32_bf16 v[192:195], v[40:43], v[68:71], v[192:195]
    s_cbranch_scc1 L_c1_0
    s_waitcnt lgkmcnt(0)
    v_mfma_f32_16x16x32_bf16 v[108:111], v[20:23], v[44:47], v[108:111]
    ds_read_b64_tr_b16 v[28:29], v1 offset:256
    v_mfma_f32_16x16x32_bf16 v[148:151], v[24:27], v[44:47], v[148:151]
    ds_read_b64_tr_b16 v[30:31], v1 offset:2560
    v_mfma_f32_16x16x32_bf16 v[100:103], v[20:23], v[48:51], v[100:103]
    ds_read_b64_tr_b16 v[32:33], v2 offset:544
    v_mfma_f32_16x16x32_bf16 v[140:143], v[24:27], v[48:51], v[140:143]
    ds_read_b64_tr_b16 v[34:35], v2 offset:2848
    v_mfma_f32_16x16x32_bf16 v[92:95], v[20:23], v[52:55], v[92:95]
    ds_read_b64_tr_b16 v[36:37], v2 offset:96
    v_mfma_f32_16x16x32_bf16 v[132:135], v[24:27], v[52:55], v[132:135]
    ds_read_b64_tr_b16 v[38:39], v2 offset:2400
    v_mfma_f32_16x16x32_bf16 v[84:87], v[20:23], v[56:59], v[84:87]
    ds_read_b64_tr_b16 v[40:41], v1 offset:384
    v_mfma_f32_16x16x32_bf16 v[124:127], v[24:27], v[56:59], v[124:127]
    ds_read_b64_tr_b16 v[42:43], v1 offset:2688
    v_mfma_f32_16x16x32_bf16 v[76:79], v[20:23], v[60:63], v[76:79]
    v_mfma_f32_16x16x32_bf16 v[116:119], v[24:27], v[60:63], v[116:119]
    s_waitcnt lgkmcnt(2)
    v_mfma_f32_16x16x32_bf16 v[236:239], v[28:31], v[56:59], v[236:239]
    v_mfma_f32_16x16x32_bf16 v[244:247], v[32:35], v[56:59], v[244:247]
    s_waitcnt lgkmcnt(0)
    v_mfma_f32_16x16x32_bf16 v[252:255], v[32:35], v[44:47], v[252:255]
    s_barrier
    v_mfma_f32_16x16x32_bf16 v[188:191], v[36:39], v[44:47], v[188:191]
    ds_read_b64_tr_b16 v[20:21], v1 offset:18496
    v_mfma_f32_16x16x32_bf16 v[228:231], v[40:43], v[44:47], v[228:231]
    ds_read_b64_tr_b16 v[22:23], v1 offset:20800
    v_mfma_f32_16x16x32_bf16 v[180:183], v[36:39], v[48:51], v[180:183]
    ds_read_b64_tr_b16 v[24:25], v2 offset:18784
    v_mfma_f32_16x16x32_bf16 v[220:223], v[40:43], v[48:51], v[220:223]
    ds_read_b64_tr_b16 v[26:27], v2 offset:21088
    v_mfma_f32_16x16x32_bf16 v[172:175], v[36:39], v[52:55], v[172:175]
    ds_read_b128 v[64:67], v5 offset:6144
    v_mfma_f32_16x16x32_bf16 v[212:215], v[40:43], v[52:55], v[212:215]
    ds_read_b128 v[68:71], v5 offset:7168
    v_mfma_f32_16x16x32_bf16 v[164:167], v[36:39], v[56:59], v[164:167]
    v_mfma_f32_16x16x32_bf16 v[204:207], v[40:43], v[56:59], v[204:207]
    v_mfma_f32_16x16x32_bf16 v[156:159], v[36:39], v[60:63], v[156:159]
    v_mfma_f32_16x16x32_bf16 v[196:199], v[40:43], v[60:63], v[196:199]
    s_waitcnt lgkmcnt(0)
    v_mfma_f32_16x16x32_bf16 v[108:111], v[20:23], v[52:55], v[108:111]
    ds_read_b64_tr_b16 v[28:29], v1 offset:18688
    v_mfma_f32_16x16x32_bf16 v[148:151], v[24:27], v[52:55], v[148:151]
    ds_read_b64_tr_b16 v[30:31], v1 offset:20992
    v_mfma_f32_16x16x32_bf16 v[100:103], v[20:23], v[56:59], v[100:103]
    ds_read_b64_tr_b16 v[32:33], v2 offset:18976
    v_mfma_f32_16x16x32_bf16 v[140:143], v[24:27], v[56:59], v[140:143]
    ds_read_b64_tr_b16 v[34:35], v2 offset:21280
    v_mfma_f32_16x16x32_bf16 v[92:95], v[20:23], v[60:63], v[92:95]
    ds_read_b64_tr_b16 v[36:37], v2 offset:18528
    v_mfma_f32_16x16x32_bf16 v[132:135], v[24:27], v[60:63], v[132:135]
    ds_read_b64_tr_b16 v[38:39], v2 offset:20832
    v_mfma_f32_16x16x32_bf16 v[84:87], v[20:23], v[64:67], v[84:87]
    ds_read_b64_tr_b16 v[40:41], v1 offset:18816
    v_mfma_f32_16x16x32_bf16 v[124:127], v[24:27], v[64:67], v[124:127]
    ds_read_b64_tr_b16 v[42:43], v1 offset:21120
    v_mfma_f32_16x16x32_bf16 v[76:79], v[20:23], v[68:71], v[76:79]
    v_mfma_f32_16x16x32_bf16 v[116:119], v[24:27], v[68:71], v[116:119]
    s_waitcnt lgkmcnt(2)
    v_mfma_f32_16x16x32_bf16 v[236:239], v[28:31], v[64:67], v[236:239]
    v_mfma_f32_16x16x32_bf16 v[244:247], v[32:35], v[64:67], v[244:247]
    s_waitcnt lgkmcnt(0)
    v_mfma_f32_16x16x32_bf16 v[252:255], v[32:35], v[52:55], v[252:255]
    s_barrier
    v_mfma_f32_16x16x32_bf16 v[188:191], v[36:39], v[52:55], v[188:191]
    ds_read_b64_tr_b16 v[20:21], v18 offset:36928
    v_mfma_f32_16x16x32_bf16 v[228:231], v[40:43], v[52:55], v[228:231]
    ds_read_b64 v[44:45], v6 offset:24576
    v_mfma_f32_16x16x32_bf16 v[180:183], v[36:39], v[56:59], v[180:183]
    ds_read_b64_tr_b16 v[24:25], v19 offset:37216
    v_mfma_f32_16x16x32_bf16 v[220:223], v[40:43], v[56:59], v[220:223]
    ds_read_b64 v[48:49], v6 offset:25600
    v_mfma_f32_16x16x32_bf16 v[172:175], v[36:39], v[60:63], v[172:175]
    ds_read_b64 v[52:53], v6 offset:26624
    v_mfma_f32_16x16x32_bf16 v[212:215], v[40:43], v[60:63], v[212:215]
    ds_read_b64 v[56:57], v6 offset:27648
    v_mfma_f32_16x16x32_bf16 v[164:167], v[36:39], v[64:67], v[164:167]
    ds_read_b64 v[60:61], v6 offset:28672
    v_mfma_f32_16x16x32_bf16 v[204:207], v[40:43], v[64:67], v[204:207]
    v_mfma_f32_16x16x32_bf16 v[156:159], v[36:39], v[68:71], v[156:159]
    v_mfma_f32_16x16x32_bf16 v[196:199], v[40:43], v[68:71], v[196:199]
    s_waitcnt lgkmcnt(1)
    v_mfma_f32_16x16x16_bf16 v[108:111], v[20:21], v[44:45], v[108:111]
    ds_read_b64_tr_b16 v[28:29], v18 offset:37120
    v_mfma_f32_16x16x16_bf16 v[148:151], v[24:25], v[44:45], v[148:151]
    ds_read_b64_tr_b16 v[32:33], v19 offset:37408
    v_mfma_f32_16x16x16_bf16 v[100:103], v[20:21], v[48:49], v[100:103]
    ds_read_b64_tr_b16 v[36:37], v19 offset:36960
    v_mfma_f32_16x16x16_bf16 v[140:143], v[24:25], v[48:49], v[140:143]
    ds_read_b64_tr_b16 v[40:41], v18 offset:37248
    v_mfma_f32_16x16x16_bf16 v[92:95], v[20:21], v[52:53], v[92:95]
    v_mfma_f32_16x16x16_bf16 v[132:135], v[24:25], v[52:53], v[132:135]
    v_mfma_f32_16x16x16_bf16 v[84:87], v[20:21], v[56:57], v[84:87]
    v_mfma_f32_16x16x16_bf16 v[124:127], v[24:25], v[56:57], v[124:127]
    s_waitcnt lgkmcnt(0)
    v_mfma_f32_16x16x16_bf16 v[76:79], v[20:21], v[60:61], v[76:79]
    v_mfma_f32_16x16x16_bf16 v[116:119], v[24:25], v[60:61], v[116:119]
    v_mfma_f32_16x16x16_bf16 v[236:239], v[28:29], v[56:57], v[236:239]
    v_mfma_f32_16x16x16_bf16 v[244:247], v[32:33], v[56:57], v[244:247]
    v_mfma_f32_16x16x16_bf16 v[252:255], v[32:33], v[44:45], v[252:255]
    s_barrier
    v_mfma_f32_16x16x16_bf16 v[188:191], v[36:37], v[44:45], v[188:191]
    ds_read_b64_tr_b16 v[20:21], v3 offset:64
    ds_read_b64_tr_b16 v[22:23], v3 offset:2368
    v_mfma_f32_16x16x16_bf16 v[228:231], v[40:41], v[44:45], v[228:231]
    ds_read_b128 v[64:67], v5 offset:6144
    ds_read_b64_tr_b16 v[24:25], v4 offset:352
    v_mfma_f32_16x16x16_bf16 v[180:183], v[36:37], v[48:49], v[180:183]
    ds_read_b64_tr_b16 v[26:27], v4 offset:2656
    v_mfma_f32_16x16x16_bf16 v[220:223], v[40:41], v[48:49], v[220:223]
    ds_read_b128 v[68:71], v5 offset:7168
    v_mfma_f32_16x16x16_bf16 v[172:175], v[36:37], v[52:53], v[172:175]
    ds_read_b128 v[44:47], v5 offset:8192
    v_mfma_f32_16x16x16_bf16 v[212:215], v[40:41], v[52:53], v[212:215]
    ds_read_b128 v[48:51], v5 offset:9216
    v_mfma_f32_16x16x16_bf16 v[164:167], v[36:37], v[56:57], v[164:167]
    ds_read_b128 v[52:55], v5 offset:10240
    v_mfma_f32_16x16x16_bf16 v[204:207], v[40:41], v[56:57], v[204:207]
    v_mfma_f32_16x16x16_bf16 v[156:159], v[36:37], v[60:61], v[156:159]
    v_mfma_f32_16x16x16_bf16 v[196:199], v[40:41], v[60:61], v[196:199]
    s_waitcnt lgkmcnt(1)
    v_mfma_f32_16x16x32_bf16 v[104:107], v[20:23], v[64:67], v[104:107]
    ds_read_b64_tr_b16 v[28:29], v3 offset:256
    v_sub_f32 v184, v184, v188
    v_mfma_f32_16x16x32_bf16 v[144:147], v[24:27], v[64:67], v[144:147]
    ds_read_b64_tr_b16 v[30:31], v3 offset:2560
    v_sub_f32 v185, v185, v189
    v_mfma_f32_16x16x32_bf16 v[96:99], v[20:23], v[68:71], v[96:99]
    ds_read_b64_tr_b16 v[32:33], v4 offset:544
    v_sub_f32 v186, v186, v190
    v_mfma_f32_16x16x32_bf16 v[136:139], v[24:27], v[68:71], v[136:139]
    ds_read_b64_tr_b16 v[34:35], v4 offset:2848
    v_sub_f32 v187, v187, v191
    v_mfma_f32_16x16x32_bf16 v[88:91], v[20:23], v[44:47], v[88:91]
    ds_read_b64_tr_b16 v[36:37], v4 offset:96
    v_sub_f32 v224, v224, v228
    v_mfma_f32_16x16x32_bf16 v[128:131], v[24:27], v[44:47], v[128:131]
    ds_read_b64_tr_b16 v[38:39], v4 offset:2400
    v_sub_f32 v225, v225, v229
    v_mfma_f32_16x16x32_bf16 v[80:83], v[20:23], v[48:51], v[80:83]
    ds_read_b64_tr_b16 v[40:41], v3 offset:384
    v_sub_f32 v226, v226, v230
    v_mfma_f32_16x16x32_bf16 v[120:123], v[24:27], v[48:51], v[120:123]
    ds_read_b64_tr_b16 v[42:43], v3 offset:2688
    s_waitcnt lgkmcnt(4)
    v_mfma_f32_16x16x32_bf16 v[72:75], v[20:23], v[52:55], v[72:75]
    v_sub_f32 v227, v227, v231
    v_sub_f32 v176, v176, v180
    v_mfma_f32_16x16x32_bf16 v[112:115], v[24:27], v[52:55], v[112:115]
    v_sub_f32 v177, v177, v181
    v_sub_f32 v178, v178, v182
    v_mfma_f32_16x16x32_bf16 v[232:235], v[28:31], v[48:51], v[232:235]
    v_sub_f32 v179, v179, v183
    v_sub_f32 v216, v216, v220
    v_mfma_f32_16x16x32_bf16 v[240:243], v[32:35], v[48:51], v[240:243]
    v_sub_f32 v217, v217, v221
    s_waitcnt lgkmcnt(0)
    v_mfma_f32_16x16x32_bf16 v[248:251], v[32:35], v[64:67], v[248:251]
    v_sub_f32 v218, v218, v222
    s_barrier
    v_mfma_f32_16x16x32_bf16 v[184:187], v[36:39], v[64:67], v[184:187]
    ds_read_b64_tr_b16 v[20:21], v3 offset:18496
    v_sub_f32 v219, v219, v223
    v_mfma_f32_16x16x32_bf16 v[224:227], v[40:43], v[64:67], v[224:227]
    ds_read_b64_tr_b16 v[22:23], v3 offset:20800
    v_sub_f32 v168, v168, v172
    v_mfma_f32_16x16x32_bf16 v[176:179], v[36:39], v[68:71], v[176:179]
    ds_read_b64_tr_b16 v[24:25], v4 offset:18784
    v_sub_f32 v208, v208, v212
    v_mfma_f32_16x16x32_bf16 v[216:219], v[40:43], v[68:71], v[216:219]
    ds_read_b64_tr_b16 v[26:27], v4 offset:21088
    v_sub_f32 v160, v160, v164
    v_mfma_f32_16x16x32_bf16 v[168:171], v[36:39], v[44:47], v[168:171]
    ds_read_b128 v[56:59], v5 offset:11264
    v_sub_f32 v200, v200, v204
    v_mfma_f32_16x16x32_bf16 v[208:211], v[40:43], v[44:47], v[208:211]
    ds_read_b128 v[60:63], v5 offset:12288
    v_sub_f32 v192, v192, v196
    v_mfma_f32_16x16x32_bf16 v[160:163], v[36:39], v[48:51], v[160:163]
    v_sub_f32 v104, v104, v108
    v_sub_f32 v105, v105, v109
    v_mfma_f32_16x16x32_bf16 v[200:203], v[40:43], v[48:51], v[200:203]
    v_sub_f32 v169, v169, v173
    v_sub_f32 v170, v170, v174
    v_mfma_f32_16x16x32_bf16 v[152:155], v[36:39], v[52:55], v[152:155]
    v_sub_f32 v171, v171, v175
    v_sub_f32 v209, v209, v213
    v_mfma_f32_16x16x32_bf16 v[192:195], v[40:43], v[52:55], v[192:195]
    v_sub_f32 v210, v210, v214
    s_waitcnt lgkmcnt(0)
    v_mfma_f32_16x16x32_bf16 v[104:107], v[20:23], v[44:47], v[104:107]
    ds_read_b64_tr_b16 v[28:29], v3 offset:18688
    v_sub_f32 v211, v211, v215
    v_mfma_f32_16x16x32_bf16 v[144:147], v[24:27], v[44:47], v[144:147]
    ds_read_b64_tr_b16 v[30:31], v3 offset:20992
    v_sub_f32 v161, v161, v165
    v_mfma_f32_16x16x32_bf16 v[96:99], v[20:23], v[48:51], v[96:99]
    ds_read_b64_tr_b16 v[32:33], v4 offset:18976
    v_sub_f32 v162, v162, v166
    v_mfma_f32_16x16x32_bf16 v[136:139], v[24:27], v[48:51], v[136:139]
    ds_read_b64_tr_b16 v[34:35], v4 offset:21280
    v_sub_f32 v163, v163, v167
    v_mfma_f32_16x16x32_bf16 v[88:91], v[20:23], v[52:55], v[88:91]
    ds_read_b64_tr_b16 v[36:37], v4 offset:18528
    v_sub_f32 v201, v201, v205
    v_mfma_f32_16x16x32_bf16 v[128:131], v[24:27], v[52:55], v[128:131]
    ds_read_b64_tr_b16 v[38:39], v4 offset:20832
    v_sub_f32 v202, v202, v206
    v_mfma_f32_16x16x32_bf16 v[80:83], v[20:23], v[56:59], v[80:83]
    ds_read_b64_tr_b16 v[40:41], v3 offset:18816
    v_sub_f32 v203, v203, v207
    v_mfma_f32_16x16x32_bf16 v[120:123], v[24:27], v[56:59], v[120:123]
    ds_read_b64_tr_b16 v[42:43], v3 offset:21120
    v_sub_f32 v152, v152, v156
    v_mfma_f32_16x16x32_bf16 v[72:75], v[20:23], v[60:63], v[72:75]
    v_sub_f32 v153, v153, v157
    v_sub_f32 v154, v154, v158
    v_mfma_f32_16x16x32_bf16 v[112:115], v[24:27], v[60:63], v[112:115]
    v_sub_f32 v155, v155, v159
    s_waitcnt lgkmcnt(2)
    v_mfma_f32_16x16x32_bf16 v[232:235], v[28:31], v[56:59], v[232:235]
    v_sub_f32 v193, v193, v197
    v_sub_f32 v194, v194, v198
    v_mfma_f32_16x16x32_bf16 v[240:243], v[32:35], v[56:59], v[240:243]
    v_sub_f32 v195, v195, v199
    s_waitcnt lgkmcnt(0)
    v_mfma_f32_16x16x32_bf16 v[248:251], v[32:35], v[44:47], v[248:251]
    v_sub_f32 v106, v106, v110
    s_barrier
    v_mfma_f32_16x16x32_bf16 v[184:187], v[36:39], v[44:47], v[184:187]
    ds_read_b64_tr_b16 v[20:21], v18 offset:64
    v_sub_f32 v107, v107, v111
    v_mfma_f32_16x16x32_bf16 v[224:227], v[40:43], v[44:47], v[224:227]
    ds_read_b64 v[64:65], v6 offset:29696
    v_sub_f32 v144, v144, v148
    v_mfma_f32_16x16x32_bf16 v[176:179], v[36:39], v[48:51], v[176:179]
    ds_read_b64_tr_b16 v[24:25], v19 offset:352
    v_sub_f32 v145, v145, v149
    v_mfma_f32_16x16x32_bf16 v[216:219], v[40:43], v[48:51], v[216:219]
    ds_read_b64 v[68:69], v6 offset:30720
    v_sub_f32 v146, v146, v150
    v_mfma_f32_16x16x32_bf16 v[168:171], v[36:39], v[52:55], v[168:171]
    ds_read_b64 v[44:45], v6 offset:31744
    v_sub_f32 v147, v147, v151
    v_mfma_f32_16x16x32_bf16 v[208:211], v[40:43], v[52:55], v[208:211]
    ds_read_b64 v[48:49], v6 offset:32768
    v_sub_f32 v96, v96, v100
    v_mfma_f32_16x16x32_bf16 v[160:163], v[36:39], v[56:59], v[160:163]
    ds_read_b64 v[52:53], v6 offset:33792
    v_sub_f32 v97, v97, v101
    v_mfma_f32_16x16x32_bf16 v[200:203], v[40:43], v[56:59], v[200:203]
    v_sub_f32 v98, v98, v102
    v_sub_f32 v99, v99, v103
    v_mfma_f32_16x16x32_bf16 v[152:155], v[36:39], v[60:63], v[152:155]
    v_sub_f32 v136, v136, v140
    v_sub_f32 v137, v137, v141
    v_mfma_f32_16x16x32_bf16 v[192:195], v[40:43], v[60:63], v[192:195]
    v_sub_f32 v138, v138, v142
    s_waitcnt lgkmcnt(1)
    v_mfma_f32_16x16x16_bf16 v[104:107], v[20:21], v[64:65], v[104:107]
    ds_read_b64_tr_b16 v[28:29], v18 offset:256
    v_sub_f32 v139, v139, v143
    v_mfma_f32_16x16x16_bf16 v[144:147], v[24:25], v[64:65], v[144:147]
    ds_read_b64_tr_b16 v[32:33], v19 offset:544
    v_sub_f32 v88, v88, v92
    v_mfma_f32_16x16x16_bf16 v[96:99], v[20:21], v[68:69], v[96:99]
    ds_read_b64_tr_b16 v[36:37], v19 offset:96
    v_sub_f32 v128, v128, v132
    v_mfma_f32_16x16x16_bf16 v[136:139], v[24:25], v[68:69], v[136:139]
    ds_read_b64_tr_b16 v[40:41], v18 offset:384
    v_sub_f32 v120, v120, v124
    v_mfma_f32_16x16x16_bf16 v[88:91], v[20:21], v[44:45], v[88:91]
    v_sub_f32 v72, v72, v76
    v_sub_f32 v73, v73, v77
    v_mfma_f32_16x16x16_bf16 v[128:131], v[24:25], v[44:45], v[128:131]
    v_sub_f32 v74, v74, v78
    v_sub_f32 v75, v75, v79
    v_mfma_f32_16x16x16_bf16 v[80:83], v[20:21], v[48:49], v[80:83]
    v_sub_f32 v112, v112, v116
    v_sub_f32 v113, v113, v117
    v_mfma_f32_16x16x16_bf16 v[120:123], v[24:25], v[48:49], v[120:123]
    v_sub_f32 v89, v89, v93
    s_waitcnt lgkmcnt(0)
    v_mfma_f32_16x16x16_bf16 v[72:75], v[20:21], v[52:53], v[72:75]
    v_sub_f32 v90, v90, v94
    v_sub_f32 v91, v91, v95
    v_mfma_f32_16x16x16_bf16 v[112:115], v[24:25], v[52:53], v[112:115]
    v_sub_f32 v129, v129, v133
    v_sub_f32 v130, v130, v134
    v_mfma_f32_16x16x16_bf16 v[232:235], v[28:29], v[48:49], v[232:235]
    v_sub_f32 v131, v131, v135
    v_sub_f32 v80, v80, v84
    v_mfma_f32_16x16x16_bf16 v[240:243], v[32:33], v[48:49], v[240:243]
    v_sub_f32 v81, v81, v85
    v_sub_f32 v82, v82, v86
    v_mfma_f32_16x16x16_bf16 v[248:251], v[32:33], v[64:65], v[248:251]
    s_barrier
    v_xor_b32 v5, 0xdc00, v5
    v_mfma_f32_16x16x16_bf16 v[184:187], v[36:37], v[64:65], v[184:187]
    ds_read_b64_tr_b16 v[20:21], v1 offset:18496
    ds_read_b64_tr_b16 v[22:23], v1 offset:20800
    v_mfma_f32_16x16x16_bf16 v[224:227], v[40:41], v[64:65], v[224:227]
    ds_read_b64_tr_b16 v[24:25], v2 offset:18784
    ds_read_b64_tr_b16 v[26:27], v2 offset:21088
    v_mfma_f32_16x16x16_bf16 v[176:179], v[36:37], v[68:69], v[176:179]
    ds_read_b128 v[56:59], v5 offset:4096
    v_sub_f32 v83, v83, v87
    v_mfma_f32_16x16x16_bf16 v[216:219], v[40:41], v[68:69], v[216:219]
    ds_read_b128 v[60:63], v5 offset:5120
    v_sub_f32 v121, v121, v125
    v_mfma_f32_16x16x16_bf16 v[168:171], v[36:37], v[44:45], v[168:171]
    v_sub_f32 v122, v122, v126
    v_sub_f32 v123, v123, v127
    v_mfma_f32_16x16x16_bf16 v[208:211], v[40:41], v[44:45], v[208:211]
    ds_read_b128 v[44:47], v5 offset:1024
    v_sub_f32 v114, v114, v118
    v_mfma_f32_16x16x16_bf16 v[160:163], v[36:37], v[48:49], v[160:163]
    v_sub_f32 v115, v115, v119
    v_sub_f32 v232, v232, v236
    v_mfma_f32_16x16x16_bf16 v[200:203], v[40:41], v[48:49], v[200:203]
    ds_read_b128 v[48:51], v5 offset:2048
    v_sub_f32 v233, v233, v237
    v_mfma_f32_16x16x16_bf16 v[152:155], v[36:37], v[52:53], v[152:155]
    v_sub_f32 v234, v234, v238
    v_sub_f32 v235, v235, v239
    v_mfma_f32_16x16x16_bf16 v[192:195], v[40:41], v[52:53], v[192:195]
    ds_read_b128 v[52:55], v5 offset:3072
    s_nop 7
    v_sub_f32 v240, v240, v244
    v_sub_f32 v241, v241, v245
    v_sub_f32 v242, v242, v246
    v_sub_f32 v243, v243, v247
    v_sub_f32 v248, v248, v252
    v_sub_f32 v249, v249, v253
    v_sub_f32 v250, v250, v254
    v_sub_f32 v251, v251, v255
    v_pk_fma_f32 v[108:109], v[108:109], s[60:61], v[104:105]
    v_pk_fma_f32 v[110:111], v[110:111], s[60:61], v[106:107]
    v_pk_fma_f32 v[100:101], v[100:101], s[60:61], v[96:97]
    v_pk_fma_f32 v[102:103], v[102:103], s[60:61], v[98:99]
    v_pk_fma_f32 v[92:93], v[92:93], s[60:61], v[88:89]
    v_pk_fma_f32 v[94:95], v[94:95], s[60:61], v[90:91]
    v_pk_fma_f32 v[84:85], v[84:85], s[60:61], v[80:81]
    v_pk_fma_f32 v[86:87], v[86:87], s[60:61], v[82:83]
    v_pk_fma_f32 v[76:77], v[76:77], s[60:61], v[72:73]
    v_pk_fma_f32 v[78:79], v[78:79], s[60:61], v[74:75]
    v_pk_fma_f32 v[148:149], v[148:149], s[60:61], v[144:145]
    v_pk_fma_f32 v[150:151], v[150:151], s[60:61], v[146:147]
    v_pk_fma_f32 v[140:141], v[140:141], s[60:61], v[136:137]
    v_pk_fma_f32 v[142:143], v[142:143], s[60:61], v[138:139]
    v_pk_fma_f32 v[132:133], v[132:133], s[60:61], v[128:129]
    v_pk_fma_f32 v[134:135], v[134:135], s[60:61], v[130:131]
    v_pk_fma_f32 v[124:125], v[124:125], s[60:61], v[120:121]
    v_pk_fma_f32 v[126:127], v[126:127], s[60:61], v[122:123]
    v_pk_fma_f32 v[116:117], v[116:117], s[60:61], v[112:113]
    v_pk_fma_f32 v[118:119], v[118:119], s[60:61], v[114:115]
    v_pk_fma_f32 v[236:237], v[236:237], s[60:61], v[232:233]
    v_pk_fma_f32 v[238:239], v[238:239], s[60:61], v[234:235]
    v_pk_fma_f32 v[244:245], v[244:245], s[60:61], v[240:241]
    v_pk_fma_f32 v[246:247], v[246:247], s[60:61], v[242:243]
    v_pk_fma_f32 v[252:253], v[252:253], s[60:61], v[248:249]
    v_pk_fma_f32 v[254:255], v[254:255], s[60:61], v[250:251]
    v_pk_fma_f32 v[188:189], v[188:189], s[60:61], v[184:185]
    v_pk_fma_f32 v[190:191], v[190:191], s[60:61], v[186:187]
    v_pk_fma_f32 v[228:229], v[228:229], s[60:61], v[224:225]
    v_pk_fma_f32 v[230:231], v[230:231], s[60:61], v[226:227]
    v_pk_fma_f32 v[180:181], v[180:181], s[60:61], v[176:177]
    v_pk_fma_f32 v[182:183], v[182:183], s[60:61], v[178:179]
    v_pk_fma_f32 v[220:221], v[220:221], s[60:61], v[216:217]
    v_pk_fma_f32 v[222:223], v[222:223], s[60:61], v[218:219]
    v_pk_fma_f32 v[172:173], v[172:173], s[60:61], v[168:169]
    v_pk_fma_f32 v[174:175], v[174:175], s[60:61], v[170:171]
    v_pk_fma_f32 v[212:213], v[212:213], s[60:61], v[208:209]
    v_pk_fma_f32 v[214:215], v[214:215], s[60:61], v[210:211]
    v_pk_fma_f32 v[164:165], v[164:165], s[60:61], v[160:161]
    v_pk_fma_f32 v[166:167], v[166:167], s[60:61], v[162:163]
    v_pk_fma_f32 v[204:205], v[204:205], s[60:61], v[200:201]
    v_pk_fma_f32 v[206:207], v[206:207], s[60:61], v[202:203]
    v_pk_fma_f32 v[156:157], v[156:157], s[60:61], v[152:153]
    v_pk_fma_f32 v[158:159], v[158:159], s[60:61], v[154:155]
    v_pk_fma_f32 v[196:197], v[196:197], s[60:61], v[192:193]
    v_pk_fma_f32 v[198:199], v[198:199], s[60:61], v[194:195]
    s_waitcnt lgkmcnt(0)
    s_mov_b32 s40, 0
.p2align 3
L_c1_46:
    s_waitcnt lgkmcnt(1)
    v_mfma_f32_16x16x32_bf16 v[104:107], v[20:23], v[44:47], v[104:107]
    ds_read_b64_tr_b16 v[28:29], v1 offset:18688
    v_mfma_f32_16x16x32_bf16 v[144:147], v[24:27], v[44:47], v[144:147]
    ds_read_b64_tr_b16 v[30:31], v1 offset:20992
    v_mfma_f32_16x16x32_bf16 v[96:99], v[20:23], v[48:51], v[96:99]
    ds_read_b64_tr_b16 v[32:33], v2 offset:18976
    v_mfma_f32_16x16x32_bf16 v[136:139], v[24:27], v[48:51], v[136:139]
    ds_read_b64_tr_b16 v[34:35], v2 offset:21280
    v_mfma_f32_16x16x32_bf16 v[88:91], v[20:23], v[52:55], v[88:91]
    ds_read_b64_tr_b16 v[36:37], v2 offset:18528
    v_mfma_f32_16x16x32_bf16 v[128:131], v[24:27], v[52:55], v[128:131]
    ds_read_b64_tr_b16 v[38:39], v2 offset:20832
    v_mfma_f32_16x16x32_bf16 v[80:83], v[20:23], v[56:59], v[80:83]
    ds_read_b64_tr_b16 v[40:41], v1 offset:18816
    v_mfma_f32_16x16x32_bf16 v[120:123], v[24:27], v[56:59], v[120:123]
    ds_read_b64_tr_b16 v[42:43], v1 offset:21120
    s_waitcnt lgkmcnt(4)
    v_mfma_f32_16x16x32_bf16 v[72:75], v[20:23], v[60:63], v[72:75]
    v_mfma_f32_16x16x32_bf16 v[112:115], v[24:27], v[60:63], v[112:115]
    v_mfma_f32_16x16x32_bf16 v[232:235], v[28:31], v[56:59], v[232:235]
    v_mfma_f32_16x16x32_bf16 v[240:243], v[32:35], v[56:59], v[240:243]
    s_waitcnt lgkmcnt(0)
    v_mfma_f32_16x16x32_bf16 v[248:251], v[32:35], v[44:47], v[248:251]
    s_barrier
    v_mfma_f32_16x16x32_bf16 v[184:187], v[36:39], v[44:47], v[184:187]
    ds_read_b64_tr_b16 v[20:21], v1 offset:36928
    v_mfma_f32_16x16x32_bf16 v[224:227], v[40:43], v[44:47], v[224:227]
    ds_read_b64_tr_b16 v[22:23], v1 offset:39232
    v_mfma_f32_16x16x32_bf16 v[176:179], v[36:39], v[48:51], v[176:179]
    ds_read_b64_tr_b16 v[24:25], v2 offset:37216
    v_mfma_f32_16x16x32_bf16 v[216:219], v[40:43], v[48:51], v[216:219]
    ds_read_b64_tr_b16 v[26:27], v2 offset:39520
    v_mfma_f32_16x16x32_bf16 v[168:171], v[36:39], v[52:55], v[168:171]
    ds_read_b128 v[64:67], v5 offset:6144
    v_mfma_f32_16x16x32_bf16 v[208:211], v[40:43], v[52:55], v[208:211]
    v_mfma_f32_16x16x32_bf16 v[160:163], v[36:39], v[56:59], v[160:163]
    v_mfma_f32_16x16x32_bf16 v[200:203], v[40:43], v[56:59], v[200:203]
    v_mfma_f32_16x16x32_bf16 v[152:155], v[36:39], v[60:63], v[152:155]
    v_mfma_f32_16x16x32_bf16 v[192:195], v[40:43], v[60:63], v[192:195]
    s_waitcnt lgkmcnt(0)
    v_mfma_f32_16x16x32_bf16 v[104:107], v[20:23], v[48:51], v[104:107]
    ds_read_b64_tr_b16 v[28:29], v1 offset:37120
    v_mfma_f32_16x16x32_bf16 v[144:147], v[24:27], v[48:51], v[144:147]
    ds_read_b64_tr_b16 v[30:31], v1 offset:39424
    v_mfma_f32_16x16x32_bf16 v[96:99], v[20:23], v[52:55], v[96:99]
    ds_read_b64_tr_b16 v[32:33], v2 offset:37408
    v_mfma_f32_16x16x32_bf16 v[136:139], v[24:27], v[52:55], v[136:139]
    ds_read_b64_tr_b16 v[34:35], v2 offset:39712
    v_mfma_f32_16x16x32_bf16 v[88:91], v[20:23], v[56:59], v[88:91]
    ds_read_b64_tr_b16 v[36:37], v2 offset:36960
    v_mfma_f32_16x16x32_bf16 v[128:131], v[24:27], v[56:59], v[128:131]
    ds_read_b64_tr_b16 v[38:39], v2 offset:39264
    v_mfma_f32_16x16x32_bf16 v[80:83], v[20:23], v[60:63], v[80:83]
    ds_read_b64_tr_b16 v[40:41], v1 offset:37248
    v_mfma_f32_16x16x32_bf16 v[120:123], v[24:27], v[60:63], v[120:123]
    ds_read_b64_tr_b16 v[42:43], v1 offset:39552
    v_mfma_f32_16x16x32_bf16 v[72:75], v[20:23], v[64:67], v[72:75]
    v_mfma_f32_16x16x32_bf16 v[112:115], v[24:27], v[64:67], v[112:115]
    s_waitcnt lgkmcnt(2)
    v_mfma_f32_16x16x32_bf16 v[232:235], v[28:31], v[60:63], v[232:235]
    v_mfma_f32_16x16x32_bf16 v[240:243], v[32:35], v[60:63], v[240:243]
    s_waitcnt lgkmcnt(0)
    v_mfma_f32_16x16x32_bf16 v[248:251], v[32:35], v[48:51], v[248:251]
    s_barrier
    v_mfma_f32_16x16x32_bf16 v[184:187], v[36:39], v[48:51], v[184:187]
    ds_read_b64_tr_b16 v[20:21], v3 offset:64
    v_mfma_f32_16x16x32_bf16 v[224:227], v[40:43], v[48:51], v[224:227]
    ds_read_b64_tr_b16 v[22:23], v3 offset:2368
    v_mfma_f32_16x16x32_bf16 v[176:179], v[36:39], v[52:55], v[176:179]
    ds_read_b64_tr_b16 v[24:25], v4 offset:352
    v_mfma_f32_16x16x32_bf16 v[216:219], v[40:43], v[52:55], v[216:219]
    ds_read_b64_tr_b16 v[26:27], v4 offset:2656
    v_mfma_f32_16x16x32_bf16 v[168:171], v[36:39], v[56:59], v[168:171]
    ds_read_b128 v[44:47], v5 offset:7168
    v_mfma_f32_16x16x32_bf16 v[208:211], v[40:43], v[56:59], v[208:211]
    v_mfma_f32_16x16x32_bf16 v[160:163], v[36:39], v[60:63], v[160:163]
    v_mfma_f32_16x16x32_bf16 v[200:203], v[40:43], v[60:63], v[200:203]
    v_mfma_f32_16x16x32_bf16 v[152:155], v[36:39], v[64:67], v[152:155]
    v_mfma_f32_16x16x32_bf16 v[192:195], v[40:43], v[64:67], v[192:195]
    s_waitcnt lgkmcnt(0)
    v_mfma_f32_16x16x32_bf16 v[104:107], v[20:23], v[52:55], v[104:107]
    ds_read_b64_tr_b16 v[28:29], v3 offset:256
    v_mfma_f32_16x16x32_bf16 v[144:147], v[24:27], v[52:55], v[144:147]
    ds_read_b64_tr_b16 v[30:31], v3 offset:2560
    v_mfma_f32_16x16x32_bf16 v[96:99], v[20:23], v[56:59], v[96:99]
    ds_read_b64_tr_b16 v[32:33], v4 offset:544
    v_mfma_f32_16x16x32_bf16 v[136:139], v[24:27], v[56:59], v[136:139]
    ds_read_b64_tr_b16 v[34:35], v4 offset:2848
    v_mfma_f32_16x16x32_bf16 v[88:91], v[20:23], v[60:63], v[88:91]
    ds_read_b64_tr_b16 v[36:37], v4 offset:96
    v_mfma_f32_16x16x32_bf16 v[128:131], v[24:27], v[60:63], v[128:131]
    ds_read_b64_tr_b16 v[38:39], v4 offset:2400
    v_mfma_f32_16x16x32_bf16 v[80:83], v[20:23], v[64:67], v[80:83]
    ds_read_b64_tr_b16 v[40:41], v3 offset:384
    v_mfma_f32_16x16x32_bf16 v[120:123], v[24:27], v[64:67], v[120:123]
    ds_read_b64_tr_b16 v[42:43], v3 offset:2688
    v_mfma_f32_16x16x32_bf16 v[72:75], v[20:23], v[44:47], v[72:75]
    v_mfma_f32_16x16x32_bf16 v[112:115], v[24:27], v[44:47], v[112:115]
    s_waitcnt lgkmcnt(2)
    v_mfma_f32_16x16x32_bf16 v[232:235], v[28:31], v[64:67], v[232:235]
    v_mfma_f32_16x16x32_bf16 v[240:243], v[32:35], v[64:67], v[240:243]
    s_waitcnt lgkmcnt(0)
    v_mfma_f32_16x16x32_bf16 v[248:251], v[32:35], v[52:55], v[248:251]
    s_barrier
    v_mfma_f32_16x16x32_bf16 v[184:187], v[36:39], v[52:55], v[184:187]
    ds_read_b64_tr_b16 v[20:21], v3 offset:18496
    v_mfma_f32_16x16x32_bf16 v[224:227], v[40:43], v[52:55], v[224:227]
    ds_read_b64_tr_b16 v[22:23], v3 offset:20800
    v_mfma_f32_16x16x32_bf16 v[176:179], v[36:39], v[56:59], v[176:179]
    ds_read_b64_tr_b16 v[24:25], v4 offset:18784
    v_mfma_f32_16x16x32_bf16 v[216:219], v[40:43], v[56:59], v[216:219]
    ds_read_b64_tr_b16 v[26:27], v4 offset:21088
    v_mfma_f32_16x16x32_bf16 v[168:171], v[36:39], v[60:63], v[168:171]
    ds_read_b128 v[48:51], v5 offset:8192
    v_mfma_f32_16x16x32_bf16 v[208:211], v[40:43], v[60:63], v[208:211]
    v_mfma_f32_16x16x32_bf16 v[160:163], v[36:39], v[64:67], v[160:163]
    v_mfma_f32_16x16x32_bf16 v[200:203], v[40:43], v[64:67], v[200:203]
    v_mfma_f32_16x16x32_bf16 v[152:155], v[36:39], v[44:47], v[152:155]
    v_mfma_f32_16x16x32_bf16 v[192:195], v[40:43], v[44:47], v[192:195]
    s_waitcnt lgkmcnt(0)
    v_mfma_f32_16x16x32_bf16 v[104:107], v[20:23], v[56:59], v[104:107]
    ds_read_b64_tr_b16 v[28:29], v3 offset:18688
    v_mfma_f32_16x16x32_bf16 v[144:147], v[24:27], v[56:59], v[144:147]
    ds_read_b64_tr_b16 v[30:31], v3 offset:20992
    v_mfma_f32_16x16x32_bf16 v[96:99], v[20:23], v[60:63], v[96:99]
    ds_read_b64_tr_b16 v[32:33], v4 offset:18976
    v_mfma_f32_16x16x32_bf16 v[136:139], v[24:27], v[60:63], v[136:139]
    ds_read_b64_tr_b16 v[34:35], v4 offset:21280
    v_mfma_f32_16x16x32_bf16 v[88:91], v[20:23], v[64:67], v[88:91]
    ds_read_b64_tr_b16 v[36:37], v4 offset:18528
    v_mfma_f32_16x16x32_bf16 v[128:131], v[24:27], v[64:67], v[128:131]
    ds_read_b64_tr_b16 v[38:39], v4 offset:20832
    v_mfma_f32_16x16x32_bf16 v[80:83], v[20:23], v[44:47], v[80:83]
    ds_read_b64_tr_b16 v[40:41], v3 offset:18816
    v_mfma_f32_16x16x32_bf16 v[120:123], v[24:27], v[44:47], v[120:123]
    ds_read_b64_tr_b16 v[42:43], v3 offset:21120
    v_mfma_f32_16x16x32_bf16 v[72:75], v[20:23], v[48:51], v[72:75]
    v_mfma_f32_16x16x32_bf16 v[112:115], v[24:27], v[48:51], v[112:115]
    s_waitcnt lgkmcnt(2)
    v_mfma_f32_16x16x32_bf16 v[232:235], v[28:31], v[44:47], v[232:235]
    v_mfma_f32_16x16x32_bf16 v[240:243], v[32:35], v[44:47], v[240:243]
    s_waitcnt lgkmcnt(0)
    v_mfma_f32_16x16x32_bf16 v[248:251], v[32:35], v[56:59], v[248:251]
    s_barrier
    v_mfma_f32_16x16x32_bf16 v[184:187], v[36:39], v[56:59], v[184:187]
    ds_read_b64_tr_b16 v[20:21], v1 offset:64
    v_mfma_f32_16x16x32_bf16 v[224:227], v[40:43], v[56:59], v[224:227]
    ds_read_b64_tr_b16 v[22:23], v1 offset:2368
    v_mfma_f32_16x16x32_bf16 v[176:179], v[36:39], v[60:63], v[176:179]
    ds_read_b64_tr_b16 v[24:25], v2 offset:352
    v_mfma_f32_16x16x32_bf16 v[216:219], v[40:43], v[60:63], v[216:219]
    ds_read_b64_tr_b16 v[26:27], v2 offset:2656
    v_mfma_f32_16x16x32_bf16 v[168:171], v[36:39], v[64:67], v[168:171]
    ds_read_b128 v[52:55], v5 offset:9216
    v_mfma_f32_16x16x32_bf16 v[208:211], v[40:43], v[64:67], v[208:211]
    v_mfma_f32_16x16x32_bf16 v[160:163], v[36:39], v[44:47], v[160:163]
    v_mfma_f32_16x16x32_bf16 v[200:203], v[40:43], v[44:47], v[200:203]
    v_mfma_f32_16x16x32_bf16 v[152:155], v[36:39], v[48:51], v[152:155]
    v_mfma_f32_16x16x32_bf16 v[192:195], v[40:43], v[48:51], v[192:195]
    s_waitcnt lgkmcnt(0)
    v_mfma_f32_16x16x32_bf16 v[104:107], v[20:23], v[60:63], v[104:107]
    ds_read_b64_tr_b16 v[28:29], v1 offset:256
    v_mfma_f32_16x16x32_bf16 v[144:147], v[24:27], v[60:63], v[144:147]
    ds_read_b64_tr_b16 v[30:31], v1 offset:2560
    v_mfma_f32_16x16x32_bf16 v[96:99], v[20:23], v[64:67], v[96:99]
    ds_read_b64_tr_b16 v[32:33], v2 offset:544
    v_mfma_f32_16x16x32_bf16 v[136:139], v[24:27], v[64:67], v[136:139]
    ds_read_b64_tr_b16 v[34:35], v2 offset:2848
    v_mfma_f32_16x16x32_bf16 v[88:91], v[20:23], v[44:47], v[88:91]
    ds_read_b64_tr_b16 v[36:37], v2 offset:96
    v_mfma_f32_16x16x32_bf16 v[128:131], v[24:27], v[44:47], v[128:131]
    ds_read_b64_tr_b16 v[38:39], v2 offset:2400
    v_mfma_f32_16x16x32_bf16 v[80:83], v[20:23], v[48:51], v[80:83]
    ds_read_b64_tr_b16 v[40:41], v1 offset:384
    v_mfma_f32_16x16x32_bf16 v[120:123], v[24:27], v[48:51], v[120:123]
    ds_read_b64_tr_b16 v[42:43], v1 offset:2688
    v_mfma_f32_16x16x32_bf16 v[72:75], v[20:23], v[52:55], v[72:75]
    v_mfma_f32_16x16x32_bf16 v[112:115], v[24:27], v[52:55], v[112:115]
    s_waitcnt lgkmcnt(2)
    v_mfma_f32_16x16x32_bf16 v[232:235], v[28:31], v[48:51], v[232:235]
    v_mfma_f32_16x16x32_bf16 v[240:243], v[32:35], v[48:51], v[240:243]
    s_waitcnt lgkmcnt(0)
    v_mfma_f32_16x16x32_bf16 v[248:251], v[32:35], v[60:63], v[248:251]
    s_barrier
    v_mfma_f32_16x16x32_bf16 v[184:187], v[36:39], v[60:63], v[184:187]
    ds_read_b64_tr_b16 v[20:21], v1 offset:18496
    ds_read_b64_tr_b16 v[22:23], v1 offset:20800
    v_mfma_f32_16x16x32_bf16 v[224:227], v[40:43], v[60:63], v[224:227]
    ds_read_b128 v[56:59], v5 offset:10240
    ds_read_b64_tr_b16 v[24:25], v2 offset:18784
    v_mfma_f32_16x16x32_bf16 v[176:179], v[36:39], v[64:67], v[176:179]
    ds_read_b64_tr_b16 v[26:27], v2 offset:21088
    v_mfma_f32_16x16x32_bf16 v[216:219], v[40:43], v[64:67], v[216:219]
    ds_read_b128 v[60:63], v5 offset:11264
    v_mfma_f32_16x16x32_bf16 v[168:171], v[36:39], v[44:47], v[168:171]
    ds_read_b128 v[64:67], v5 offset:12288
    v_mfma_f32_16x16x32_bf16 v[208:211], v[40:43], v[44:47], v[208:211]
    ds_read_b128 v[44:47], v5 offset:13312
    v_mfma_f32_16x16x32_bf16 v[160:163], v[36:39], v[48:51], v[160:163]
    v_mfma_f32_16x16x32_bf16 v[200:203], v[40:43], v[48:51], v[200:203]
    ds_read_b128 v[48:51], v5 offset:14336
    v_mfma_f32_16x16x32_bf16 v[152:155], v[36:39], v[52:55], v[152:155]
    v_mfma_f32_16x16x32_bf16 v[192:195], v[40:43], v[52:55], v[192:195]
    s_waitcnt lgkmcnt(1)
    v_mfma_f32_16x16x32_bf16 v[108:111], v[20:23], v[56:59], v[108:111]
    ds_read_b64_tr_b16 v[28:29], v1 offset:18688
    v_mfma_f32_16x16x32_bf16 v[148:151], v[24:27], v[56:59], v[148:151]
    ds_read_b64_tr_b16 v[30:31], v1 offset:20992
    v_mfma_f32_16x16x32_bf16 v[100:103], v[20:23], v[60:63], v[100:103]
    ds_read_b64_tr_b16 v[32:33], v2 offset:18976
    v_mfma_f32_16x16x32_bf16 v[140:143], v[24:27], v[60:63], v[140:143]
    ds_read_b64_tr_b16 v[34:35], v2 offset:21280
    v_mfma_f32_16x16x32_bf16 v[92:95], v[20:23], v[64:67], v[92:95]
    ds_read_b64_tr_b16 v[36:37], v2 offset:18528
    v_mfma_f32_16x16x32_bf16 v[132:135], v[24:27], v[64:67], v[132:135]
    ds_read_b64_tr_b16 v[38:39], v2 offset:20832
    v_mfma_f32_16x16x32_bf16 v[84:87], v[20:23], v[44:47], v[84:87]
    ds_read_b64_tr_b16 v[40:41], v1 offset:18816
    v_mfma_f32_16x16x32_bf16 v[124:127], v[24:27], v[44:47], v[124:127]
    ds_read_b64_tr_b16 v[42:43], v1 offset:21120
    s_waitcnt lgkmcnt(4)
    v_mfma_f32_16x16x32_bf16 v[76:79], v[20:23], v[48:51], v[76:79]
    v_mfma_f32_16x16x32_bf16 v[116:119], v[24:27], v[48:51], v[116:119]
    v_mfma_f32_16x16x32_bf16 v[236:239], v[28:31], v[44:47], v[236:239]
    v_mfma_f32_16x16x32_bf16 v[244:247], v[32:35], v[44:47], v[244:247]
    s_waitcnt lgkmcnt(0)
    v_mfma_f32_16x16x32_bf16 v[252:255], v[32:35], v[56:59], v[252:255]
    s_barrier
    v_mfma_f32_16x16x32_bf16 v[188:191], v[36:39], v[56:59], v[188:191]
    ds_read_b64_tr_b16 v[20:21], v1 offset:36928
    v_mfma_f32_16x16x32_bf16 v[228:231], v[40:43], v[56:59], v[228:231]
    ds_read_b64_tr_b16 v[22:23], v1 offset:39232
    v_mfma_f32_16x16x32_bf16 v[180:183], v[36:39], v[60:63], v[180:183]
    ds_read_b64_tr_b16 v[24:25], v2 offset:37216
    v_mfma_f32_16x16x32_bf16 v[220:223], v[40:43], v[60:63], v[220:223]
    ds_read_b64_tr_b16 v[26:27], v2 offset:39520
    v_mfma_f32_16x16x32_bf16 v[172:175], v[36:39], v[64:67], v[172:175]
    ds_read_b128 v[52:55], v5 offset:15360
    v_mfma_f32_16x16x32_bf16 v[212:215], v[40:43], v[64:67], v[212:215]
    v_mfma_f32_16x16x32_bf16 v[164:167], v[36:39], v[44:47], v[164:167]
    v_mfma_f32_16x16x32_bf16 v[204:207], v[40:43], v[44:47], v[204:207]
    v_mfma_f32_16x16x32_bf16 v[156:159], v[36:39], v[48:51], v[156:159]
    v_mfma_f32_16x16x32_bf16 v[196:199], v[40:43], v[48:51], v[196:199]
    s_waitcnt lgkmcnt(0)
    v_mfma_f32_16x16x32_bf16 v[108:111], v[20:23], v[60:63], v[108:111]
    ds_read_b64_tr_b16 v[28:29], v1 offset:37120
    v_mfma_f32_16x16x32_bf16 v[148:151], v[24:27], v[60:63], v[148:151]
    ds_read_b64_tr_b16 v[30:31], v1 offset:39424
    v_mfma_f32_16x16x32_bf16 v[100:103], v[20:23], v[64:67], v[100:103]
    ds_read_b64_tr_b16 v[32:33], v2 offset:37408
    v_mfma_f32_16x16x32_bf16 v[140:143], v[24:27], v[64:67], v[140:143]
    ds_read_b64_tr_b16 v[34:35], v2 offset:39712
    v_mfma_f32_16x16x32_bf16 v[92:95], v[20:23], v[44:47], v[92:95]
    ds_read_b64_tr_b16 v[36:37], v2 offset:36960
    v_mfma_f32_16x16x32_bf16 v[132:135], v[24:27], v[44:47], v[132:135]
    ds_read_b64_tr_b16 v[38:39], v2 offset:39264
    v_mfma_f32_16x16x32_bf16 v[84:87], v[20:23], v[48:51], v[84:87]
    ds_read_b64_tr_b16 v[40:41], v1 offset:37248
    v_mfma_f32_16x16x32_bf16 v[124:127], v[24:27], v[48:51], v[124:127]
    ds_read_b64_tr_b16 v[42:43], v1 offset:39552
    v_mfma_f32_16x16x32_bf16 v[76:79], v[20:23], v[52:55], v[76:79]
    v_mfma_f32_16x16x32_bf16 v[116:119], v[24:27], v[52:55], v[116:119]
    s_waitcnt lgkmcnt(2)
    v_mfma_f32_16x16x32_bf16 v[236:239], v[28:31], v[48:51], v[236:239]
    v_mfma_f32_16x16x32_bf16 v[244:247], v[32:35], v[48:51], v[244:247]
    s_waitcnt lgkmcnt(0)
    v_mfma_f32_16x16x32_bf16 v[252:255], v[32:35], v[60:63], v[252:255]
    s_barrier
    v_mfma_f32_16x16x32_bf16 v[188:191], v[36:39], v[60:63], v[188:191]
    ds_read_b64_tr_b16 v[20:21], v3 offset:64
    v_mfma_f32_16x16x32_bf16 v[228:231], v[40:43], v[60:63], v[228:231]
    ds_read_b64_tr_b16 v[22:23], v3 offset:2368
    v_mfma_f32_16x16x32_bf16 v[180:183], v[36:39], v[64:67], v[180:183]
    ds_read_b64_tr_b16 v[24:25], v4 offset:352
    v_mfma_f32_16x16x32_bf16 v[220:223], v[40:43], v[64:67], v[220:223]
    ds_read_b64_tr_b16 v[26:27], v4 offset:2656
    v_mfma_f32_16x16x32_bf16 v[172:175], v[36:39], v[44:47], v[172:175]
    ds_read_b128 v[56:59], v5 offset:16384
    v_mfma_f32_16x16x32_bf16 v[212:215], v[40:43], v[44:47], v[212:215]
    v_mfma_f32_16x16x32_bf16 v[164:167], v[36:39], v[48:51], v[164:167]
    v_mfma_f32_16x16x32_bf16 v[204:207], v[40:43], v[48:51], v[204:207]
    v_mfma_f32_16x16x32_bf16 v[156:159], v[36:39], v[52:55], v[156:159]
    v_mfma_f32_16x16x32_bf16 v[196:199], v[40:43], v[52:55], v[196:199]
    s_waitcnt lgkmcnt(0)
    v_mfma_f32_16x16x32_bf16 v[108:111], v[20:23], v[64:67], v[108:111]
    ds_read_b64_tr_b16 v[28:29], v3 offset:256
    v_mfma_f32_16x16x32_bf16 v[148:151], v[24:27], v[64:67], v[148:151]
    ds_read_b64_tr_b16 v[30:31], v3 offset:2560
    v_mfma_f32_16x16x32_bf16 v[100:103], v[20:23], v[44:47], v[100:103]
    ds_read_b64_tr_b16 v[32:33], v4 offset:544
    v_mfma_f32_16x16x32_bf16 v[140:143], v[24:27], v[44:47], v[140:143]
    ds_read_b64_tr_b16 v[34:35], v4 offset:2848
    v_mfma_f32_16x16x32_bf16 v[92:95], v[20:23], v[48:51], v[92:95]
    ds_read_b64_tr_b16 v[36:37], v4 offset:96
    v_mfma_f32_16x16x32_bf16 v[132:135], v[24:27], v[48:51], v[132:135]
    ds_read_b64_tr_b16 v[38:39], v4 offset:2400
    v_mfma_f32_16x16x32_bf16 v[84:87], v[20:23], v[52:55], v[84:87]
    ds_read_b64_tr_b16 v[40:41], v3 offset:384
    v_mfma_f32_16x16x32_bf16 v[124:127], v[24:27], v[52:55], v[124:127]
    ds_read_b64_tr_b16 v[42:43], v3 offset:2688
    v_mfma_f32_16x16x32_bf16 v[76:79], v[20:23], v[56:59], v[76:79]
    v_mfma_f32_16x16x32_bf16 v[116:119], v[24:27], v[56:59], v[116:119]
    s_waitcnt lgkmcnt(2)
    v_mfma_f32_16x16x32_bf16 v[236:239], v[28:31], v[52:55], v[236:239]
    v_mfma_f32_16x16x32_bf16 v[244:247], v[32:35], v[52:55], v[244:247]
    s_waitcnt lgkmcnt(0)
    v_mfma_f32_16x16x32_bf16 v[252:255], v[32:35], v[64:67], v[252:255]
    s_barrier
    v_mfma_f32_16x16x32_bf16 v[188:191], v[36:39], v[64:67], v[188:191]
    ds_read_b64_tr_b16 v[20:21], v3 offset:18496
    v_mfma_f32_16x16x32_bf16 v[228:231], v[40:43], v[64:67], v[228:231]
    ds_read_b64_tr_b16 v[22:23], v3 offset:20800
    v_mfma_f32_16x16x32_bf16 v[180:183], v[36:39], v[44:47], v[180:183]
    ds_read_b64_tr_b16 v[24:25], v4 offset:18784
    v_mfma_f32_16x16x32_bf16 v[220:223], v[40:43], v[44:47], v[220:223]
    ds_read_b64_tr_b16 v[26:27], v4 offset:21088
    v_mfma_f32_16x16x32_bf16 v[172:175], v[36:39], v[48:51], v[172:175]
    ds_read_b128 v[60:63], v5 offset:17408
    v_mfma_f32_16x16x32_bf16 v[212:215], v[40:43], v[48:51], v[212:215]
    v_mfma_f32_16x16x32_bf16 v[164:167], v[36:39], v[52:55], v[164:167]
    v_mfma_f32_16x16x32_bf16 v[204:207], v[40:43], v[52:55], v[204:207]
    v_mfma_f32_16x16x32_bf16 v[156:159], v[36:39], v[56:59], v[156:159]
    v_mfma_f32_16x16x32_bf16 v[196:199], v[40:43], v[56:59], v[196:199]
    s_waitcnt lgkmcnt(0)
    v_mfma_f32_16x16x32_bf16 v[108:111], v[20:23], v[44:47], v[108:111]
    ds_read_b64_tr_b16 v[28:29], v3 offset:18688
    v_mfma_f32_16x16x32_bf16 v[148:151], v[24:27], v[44:47], v[148:151]
    ds_read_b64_tr_b16 v[30:31], v3 offset:20992
    v_mfma_f32_16x16x32_bf16 v[100:103], v[20:23], v[48:51], v[100:103]
    ds_read_b64_tr_b16 v[32:33], v4 offset:18976
    v_mfma_f32_16x16x32_bf16 v[140:143], v[24:27], v[48:51], v[140:143]
    ds_read_b64_tr_b16 v[34:35], v4 offset:21280
    v_mfma_f32_16x16x32_bf16 v[92:95], v[20:23], v[52:55], v[92:95]
    ds_read_b64_tr_b16 v[36:37], v4 offset:18528
    v_mfma_f32_16x16x32_bf16 v[132:135], v[24:27], v[52:55], v[132:135]
    ds_read_b64_tr_b16 v[38:39], v4 offset:20832
    v_mfma_f32_16x16x32_bf16 v[84:87], v[20:23], v[56:59], v[84:87]
    ds_read_b64_tr_b16 v[40:41], v3 offset:18816
    v_mfma_f32_16x16x32_bf16 v[124:127], v[24:27], v[56:59], v[124:127]
    ds_read_b64_tr_b16 v[42:43], v3 offset:21120
    v_mfma_f32_16x16x32_bf16 v[76:79], v[20:23], v[60:63], v[76:79]
    v_mfma_f32_16x16x32_bf16 v[116:119], v[24:27], v[60:63], v[116:119]
    s_waitcnt lgkmcnt(2)
    v_mfma_f32_16x16x32_bf16 v[236:239], v[28:31], v[56:59], v[236:239]
    v_mfma_f32_16x16x32_bf16 v[244:247], v[32:35], v[56:59], v[244:247]
    s_waitcnt lgkmcnt(0)
    v_mfma_f32_16x16x32_bf16 v[252:255], v[32:35], v[44:47], v[252:255]
    s_barrier
    v_mfma_f32_16x16x32_bf16 v[188:191], v[36:39], v[44:47], v[188:191]
    ds_read_b64_tr_b16 v[20:21], v1 offset:64
    v_mfma_f32_16x16x32_bf16 v[228:231], v[40:43], v[44:47], v[228:231]
    ds_read_b64_tr_b16 v[22:23], v1 offset:2368
    v_mfma_f32_16x16x32_bf16 v[180:183], v[36:39], v[48:51], v[180:183]
    ds_read_b64_tr_b16 v[24:25], v2 offset:352
    v_mfma_f32_16x16x32_bf16 v[220:223], v[40:43], v[48:51], v[220:223]
    ds_read_b64_tr_b16 v[26:27], v2 offset:2656
    v_mfma_f32_16x16x32_bf16 v[172:175], v[36:39], v[52:55], v[172:175]
    ds_read_b128 v[64:67], v5 offset:18432
    v_mfma_f32_16x16x32_bf16 v[212:215], v[40:43], v[52:55], v[212:215]
    v_mfma_f32_16x16x32_bf16 v[164:167], v[36:39], v[56:59], v[164:167]
    v_mfma_f32_16x16x32_bf16 v[204:207], v[40:43], v[56:59], v[204:207]
    v_mfma_f32_16x16x32_bf16 v[156:159], v[36:39], v[60:63], v[156:159]
    v_mfma_f32_16x16x32_bf16 v[196:199], v[40:43], v[60:63], v[196:199]
    s_waitcnt lgkmcnt(0)
    v_mfma_f32_16x16x32_bf16 v[108:111], v[20:23], v[48:51], v[108:111]
    ds_read_b64_tr_b16 v[28:29], v1 offset:256
    v_mfma_f32_16x16x32_bf16 v[148:151], v[24:27], v[48:51], v[148:151]
    ds_read_b64_tr_b16 v[30:31], v1 offset:2560
    v_mfma_f32_16x16x32_bf16 v[100:103], v[20:23], v[52:55], v[100:103]
    ds_read_b64_tr_b16 v[32:33], v2 offset:544
    v_mfma_f32_16x16x32_bf16 v[140:143], v[24:27], v[52:55], v[140:143]
    ds_read_b64_tr_b16 v[34:35], v2 offset:2848
    v_mfma_f32_16x16x32_bf16 v[92:95], v[20:23], v[56:59], v[92:95]
    ds_read_b64_tr_b16 v[36:37], v2 offset:96
    v_mfma_f32_16x16x32_bf16 v[132:135], v[24:27], v[56:59], v[132:135]
    ds_read_b64_tr_b16 v[38:39], v2 offset:2400
    v_mfma_f32_16x16x32_bf16 v[84:87], v[20:23], v[60:63], v[84:87]
    ds_read_b64_tr_b16 v[40:41], v1 offset:384
    v_mfma_f32_16x16x32_bf16 v[124:127], v[24:27], v[60:63], v[124:127]
    ds_read_b64_tr_b16 v[42:43], v1 offset:2688
    v_mfma_f32_16x16x32_bf16 v[76:79], v[20:23], v[64:67], v[76:79]
    v_mfma_f32_16x16x32_bf16 v[116:119], v[24:27], v[64:67], v[116:119]
    s_waitcnt lgkmcnt(2)
    v_mfma_f32_16x16x32_bf16 v[236:239], v[28:31], v[60:63], v[236:239]
    v_mfma_f32_16x16x32_bf16 v[244:247], v[32:35], v[60:63], v[244:247]
    s_waitcnt lgkmcnt(0)
    v_mfma_f32_16x16x32_bf16 v[252:255], v[32:35], v[48:51], v[252:255]
    s_barrier
    v_xor_b32 v5, 0xdc00, v5
    v_mfma_f32_16x16x32_bf16 v[188:191], v[36:39], v[48:51], v[188:191]
    ds_read_b64_tr_b16 v[20:21], v1 offset:18496
    ds_read_b64_tr_b16 v[22:23], v1 offset:20800
    v_mfma_f32_16x16x32_bf16 v[228:231], v[40:43], v[48:51], v[228:231]
    ds_read_b128 v[44:47], v5 offset:1024
    ds_read_b64_tr_b16 v[24:25], v2 offset:18784
    v_mfma_f32_16x16x32_bf16 v[180:183], v[36:39], v[52:55], v[180:183]
    ds_read_b64_tr_b16 v[26:27], v2 offset:21088
    ds_read_b128 v[48:51], v5 offset:2048
    v_mfma_f32_16x16x32_bf16 v[220:223], v[40:43], v[52:55], v[220:223]
    ds_read_b128 v[52:55], v5 offset:3072
    v_mfma_f32_16x16x32_bf16 v[172:175], v[36:39], v[56:59], v[172:175]
    v_mfma_f32_16x16x32_bf16 v[212:215], v[40:43], v[56:59], v[212:215]
    ds_read_b128 v[56:59], v5 offset:4096
    v_mfma_f32_16x16x32_bf16 v[164:167], v[36:39], v[60:63], v[164:167]
    s_add_u32 s40, s40, 1
    s_cmp_lt_u32 s40, 4
    v_mfma_f32_16x16x32_bf16 v[204:207], v[40:43], v[60:63], v[204:207]
    ds_read_b128 v[60:63], v5 offset:5120
    v_mfma_f32_16x16x32_bf16 v[156:159], v[36:39], v[64:67], v[156:159]
    v_mfma_f32_16x16x32_bf16 v[196:199], v[40:43], v[64:67], v[196:199]
    s_cbranch_scc1 L_c1_46
    s_waitcnt lgkmcnt(1)
    v_mfma_f32_16x16x32_bf16 v[104:107], v[20:23], v[44:47], v[104:107]
    ds_read_b64_tr_b16 v[28:29], v1 offset:18688
    v_mfma_f32_16x16x32_bf16 v[144:147], v[24:27], v[44:47], v[144:147]
    ds_read_b64_tr_b16 v[30:31], v1 offset:20992
    v_mfma_f32_16x16x32_bf16 v[96:99], v[20:23], v[48:51], v[96:99]
    ds_read_b64_tr_b16 v[32:33], v2 offset:18976
    v_mfma_f32_16x16x32_bf16 v[136:139], v[24:27], v[48:51], v[136:139]
    ds_read_b64_tr_b16 v[34:35], v2 offset:21280
    v_mfma_f32_16x16x32_bf16 v[88:91], v[20:23], v[52:55], v[88:91]
    ds_read_b64_tr_b16 v[36:37], v2 offset:18528
    v_mfma_f32_16x16x32_bf16 v[128:131], v[24:27], v[52:55], v[128:131]
    ds_read_b64_tr_b16 v[38:39], v2 offset:20832
    v_mfma_f32_16x16x32_bf16 v[80:83], v[20:23], v[56:59], v[80:83]
    ds_read_b64_tr_b16 v[40:41], v1 offset:18816
    v_mfma_f32_16x16x32_bf16 v[120:123], v[24:27], v[56:59], v[120:123]
    ds_read_b64_tr_b16 v[42:43], v1 offset:21120
    s_waitcnt lgkmcnt(4)
    v_mfma_f32_16x16x32_bf16 v[72:75], v[20:23], v[60:63], v[72:75]
    v_mfma_f32_16x16x32_bf16 v[112:115], v[24:27], v[60:63], v[112:115]
    v_mfma_f32_16x16x32_bf16 v[232:235], v[28:31], v[56:59], v[232:235]
    v_mfma_f32_16x16x32_bf16 v[240:243], v[32:35], v[56:59], v[240:243]
    s_waitcnt lgkmcnt(0)
    v_mfma_f32_16x16x32_bf16 v[248:251], v[32:35], v[44:47], v[248:251]
    s_barrier
    v_mfma_f32_16x16x32_bf16 v[184:187], v[36:39], v[44:47], v[184:187]
    ds_read_b64_tr_b16 v[20:21], v1 offset:36928
    v_mfma_f32_16x16x32_bf16 v[224:227], v[40:43], v[44:47], v[224:227]
    ds_read_b64_tr_b16 v[22:23], v1 offset:39232
    v_mfma_f32_16x16x32_bf16 v[176:179], v[36:39], v[48:51], v[176:179]
    ds_read_b64_tr_b16 v[24:25], v2 offset:37216
    v_mfma_f32_16x16x32_bf16 v[216:219], v[40:43], v[48:51], v[216:219]
    ds_read_b64_tr_b16 v[26:27], v2 offset:39520
    v_mfma_f32_16x16x32_bf16 v[168:171], v[36:39], v[52:55], v[168:171]
    ds_read_b128 v[64:67], v5 offset:6144
    v_mfma_f32_16x16x32_bf16 v[208:211], v[40:43], v[52:55], v[208:211]
    ds_read_b128 v[68:71], v5 offset:7168
    v_mfma_f32_16x16x32_bf16 v[160:163], v[36:39], v[56:59], v[160:163]
    v_mfma_f32_16x16x32_bf16 v[200:203], v[40:43], v[56:59], v[200:203]
    v_mfma_f32_16x16x32_bf16 v[152:155], v[36:39], v[60:63], v[152:155]
    v_mfma_f32_16x16x32_bf16 v[192:195], v[40:43], v[60:63], v[192:195]
    s_waitcnt lgkmcnt(0)
    v_mfma_f32_16x16x32_bf16 v[104:107], v[20:23], v[52:55], v[104:107]
    ds_read_b64_tr_b16 v[28:29], v1 offset:37120
    v_mfma_f32_16x16x32_bf16 v[144:147], v[24:27], v[52:55], v[144:147]
    ds_read_b64_tr_b16 v[30:31], v1 offset:39424
    v_mfma_f32_16x16x32_bf16 v[96:99], v[20:23], v[56:59], v[96:99]
    ds_read_b64_tr_b16 v[32:33], v2 offset:37408
    v_mfma_f32_16x16x32_bf16 v[136:139], v[24:27], v[56:59], v[136:139]
    ds_read_b64_tr_b16 v[34:35], v2 offset:39712
    v_mfma_f32_16x16x32_bf16 v[88:91], v[20:23], v[60:63], v[88:91]
    ds_read_b64_tr_b16 v[36:37], v2 offset:36960
    v_mfma_f32_16x16x32_bf16 v[128:131], v[24:27], v[60:63], v[128:131]
    ds_read_b64_tr_b16 v[38:39], v2 offset:39264
    v_mfma_f32_16x16x32_bf16 v[80:83], v[20:23], v[64:67], v[80:83]
    ds_read_b64_tr_b16 v[40:41], v1 offset:37248
    v_mfma_f32_16x16x32_bf16 v[120:123], v[24:27], v[64:67], v[120:123]
    ds_read_b64_tr_b16 v[42:43], v1 offset:39552
    v_mfma_f32_16x16x32_bf16 v[72:75], v[20:23], v[68:71], v[72:75]
    v_mfma_f32_16x16x32_bf16 v[112:115], v[24:27], v[68:71], v[112:115]
    s_waitcnt lgkmcnt(2)
    v_mfma_f32_16x16x32_bf16 v[232:235], v[28:31], v[64:67], v[232:235]
    v_mfma_f32_16x16x32_bf16 v[240:243], v[32:35], v[64:67], v[240:243]
    s_waitcnt lgkmcnt(0)
    v_mfma_f32_16x16x32_bf16 v[248:251], v[32:35], v[52:55], v[248:251]
    s_barrier
    v_mfma_f32_16x16x32_bf16 v[184:187], v[36:39], v[52:55], v[184:187]
    ds_read_b64_tr_b16 v[20:21], v18 offset:55360
    v_mfma_f32_16x16x32_bf16 v[224:227], v[40:43], v[52:55], v[224:227]
    ds_read_b64 v[44:45], v6 offset:5120
    v_mfma_f32_16x16x32_bf16 v[176:179], v[36:39], v[56:59], v[176:179]
    ds_read_b64_tr_b16 v[24:25], v19 offset:55648
    v_mfma_f32_16x16x32_bf16 v[216:219], v[40:43], v[56:59], v[216:219]
    ds_read_b64 v[48:49], v6 offset:6144
    v_mfma_f32_16x16x32_bf16 v[168:171], v[36:39], v[60:63], v[168:171]
    ds_read_b64 v[52:53], v6 offset:7168
    v_mfma_f32_16x16x32_bf16 v[208:211], v[40:43], v[60:63], v[208:211]
    ds_read_b64 v[56:57], v6 offset:8192
    v_mfma_f32_16x16x32_bf16 v[160:163], v[36:39], v[64:67], v[160:163]
    ds_read_b64 v[60:61], v6 offset:9216
    v_mfma_f32_16x16x32_bf16 v[200:203], v[40:43], v[64:67], v[200:203]
    v_mfma_f32_16x16x32_bf16 v[152:155], v[36:39], v[68:71], v[152:155]
    v_mfma_f32_16x16x32_bf16 v[192:195], v[40:43], v[68:71], v[192:195]
    s_waitcnt lgkmcnt(1)
    v_mfma_f32_16x16x16_bf16 v[104:107], v[20:21], v[44:45], v[104:107]
    ds_read_b64_tr_b16 v[28:29], v18 offset:55552
    v_mfma_f32_16x16x16_bf16 v[144:147], v[24:25], v[44:45], v[144:147]
    ds_read_b64_tr_b16 v[32:33], v19 offset:55840
    v_mfma_f32_16x16x16_bf16 v[96:99], v[20:21], v[48:49], v[96:99]
    ds_read_b64_tr_b16 v[36:37], v19 offset:55392
    v_mfma_f32_16x16x16_bf16 v[136:139], v[24:25], v[48:49], v[136:139]
    ds_read_b64_tr_b16 v[40:41], v18 offset:55680
    v_mfma_f32_16x16x16_bf16 v[88:91], v[20:21], v[52:53], v[88:91]
    v_mfma_f32_16x16x16_bf16 v[128:131], v[24:25], v[52:53], v[128:131]
    v_mfma_f32_16x16x16_bf16 v[80:83], v[20:21], v[56:57], v[80:83]
    v_mfma_f32_16x16x16_bf16 v[120:123], v[24:25], v[56:57], v[120:123]
    s_waitcnt lgkmcnt(0)
    v_mfma_f32_16x16x16_bf16 v[72:75], v[20:21], v[60:61], v[72:75]
    v_mfma_f32_16x16x16_bf16 v[112:115], v[24:25], v[60:61], v[112:115]
    v_mfma_f32_16x16x16_bf16 v[232:235], v[28:29], v[56:57], v[232:235]
    v_mfma_f32_16x16x16_bf16 v[240:243], v[32:33], v[56:57], v[240:243]
    v_mfma_f32_16x16x16_bf16 v[248:251], v[32:33], v[44:45], v[248:251]
    s_barrier
    v_mfma_f32_16x16x16_bf16 v[184:187], v[36:37], v[44:45], v[184:187]
    ds_read_b64_tr_b16 v[20:21], v3 offset:18496
    ds_read_b64_tr_b16 v[22:23], v3 offset:20800
    v_mfma_f32_16x16x16_bf16 v[224:227], v[40:41], v[44:45], v[224:227]
    ds_read_b128 v[64:67], v5 offset:10240
    ds_read_b64_tr_b16 v[24:25], v4 offset:18784
    v_mfma_f32_16x16x16_bf16 v[176:179], v[36:37], v[48:49], v[176:179]
    ds_read_b64_tr_b16 v[26:27], v4 offset:21088
    v_mfma_f32_16x16x16_bf16 v[216:219], v[40:41], v[48:49], v[216:219]
    ds_read_b128 v[68:71], v5 offset:11264
    v_mfma_f32_16x16x16_bf16 v[168:171], v[36:37], v[52:53], v[168:171]
    ds_read_b128 v[44:47], v5 offset:12288
    v_mfma_f32_16x16x16_bf16 v[208:211], v[40:41], v[52:53], v[208:211]
    ds_read_b128 v[48:51], v5 offset:13312
    v_mfma_f32_16x16x16_bf16 v[160:163], v[36:37], v[56:57], v[160:163]
    ds_read_b128 v[52:55], v5 offset:14336
    v_mfma_f32_16x16x16_bf16 v[200:203], v[40:41], v[56:57], v[200:203]
    v_mfma_f32_16x16x16_bf16 v[152:155], v[36:37], v[60:61], v[152:155]
    v_mfma_f32_16x16x16_bf16 v[192:195], v[40:41], v[60:61], v[192:195]
    s_waitcnt lgkmcnt(1)
    v_mfma_f32_16x16x32_bf16 v[108:111], v[20:23], v[64:67], v[108:111]
    ds_read_b64_tr_b16 v[28:29], v3 offset:18688
    v_mul_f32 v248, s54, v248
    v_mfma_f32_16x16x32_bf16 v[148:151], v[24:27], v[64:67], v[148:151]
    ds_read_b64_tr_b16 v[30:31], v3 offset:20992
    v_mul_f32 v249, s54, v249
    v_mfma_f32_16x16x32_bf16 v[100:103], v[20:23], v[68:71], v[100:103]
    ds_read_b64_tr_b16 v[32:33], v4 offset:18976
    v_mul_f32 v250, s54, v250
    v_mfma_f32_16x16x32_bf16 v[140:143], v[24:27], v[68:71], v[140:143]
    ds_read_b64_tr_b16 v[34:35], v4 offset:21280
    v_mul_f32 v251, s54, v251
    v_mfma_f32_16x16x32_bf16 v[92:95], v[20:23], v[44:47], v[92:95]
    ds_read_b64_tr_b16 v[36:37], v4 offset:18528
    v_fma_f32 v232, s50, v232, v7
    v_mfma_f32_16x16x32_bf16 v[132:135], v[24:27], v[44:47], v[132:135]
    ds_read_b64_tr_b16 v[38:39], v4 offset:20832
    v_fma_f32 v233, s50, v233, v7
    v_mfma_f32_16x16x32_bf16 v[84:87], v[20:23], v[48:51], v[84:87]
    ds_read_b64_tr_b16 v[40:41], v3 offset:18816
    v_fma_f32 v234, s50, v234, v7
    v_mfma_f32_16x16x32_bf16 v[124:127], v[24:27], v[48:51], v[124:127]
    ds_read_b64_tr_b16 v[42:43], v3 offset:21120
    s_waitcnt lgkmcnt(4)
    v_mfma_f32_16x16x32_bf16 v[76:79], v[20:23], v[52:55], v[76:79]
    v_fma_f32 v235, s50, v235, v7
    v_mul_f32 v240, s52, v240
    v_mfma_f32_16x16x32_bf16 v[116:119], v[24:27], v[52:55], v[116:119]
    v_mul_f32 v241, s52, v241
    v_mul_f32 v242, s52, v242
    v_mfma_f32_16x16x32_bf16 v[236:239], v[28:31], v[48:51], v[236:239]
    v_mul_f32 v243, s52, v243
    v_fma_f32 v72, s50, v72, v7
    v_mfma_f32_16x16x32_bf16 v[244:247], v[32:35], v[48:51], v[244:247]
    v_fma_f32 v73, s50, v73, v7
    s_waitcnt lgkmcnt(0)
    v_mfma_f32_16x16x32_bf16 v[252:255], v[32:35], v[64:67], v[252:255]
    v_fma_f32 v74, s50, v74, v7
    s_barrier
    v_mfma_f32_16x16x32_bf16 v[188:191], v[36:39], v[64:67], v[188:191]
    ds_read_b64_tr_b16 v[20:21], v1 offset:64
    v_fma_f32 v75, s50, v75, v7
    v_mfma_f32_16x16x32_bf16 v[228:231], v[40:43], v[64:67], v[228:231]
    ds_read_b64_tr_b16 v[22:23], v1 offset:2368
    v_mul_f32 v112, s52, v112
    v_mfma_f32_16x16x32_bf16 v[180:183], v[36:39], v[68:71], v[180:183]
    ds_read_b64_tr_b16 v[24:25], v2 offset:352
    v_mul_f32 v113, s52, v113
    v_mfma_f32_16x16x32_bf16 v[220:223], v[40:43], v[68:71], v[220:223]
    ds_read_b64_tr_b16 v[26:27], v2 offset:2656
    v_mul_f32 v114, s52, v114
    v_mfma_f32_16x16x32_bf16 v[172:175], v[36:39], v[44:47], v[172:175]
    ds_read_b128 v[56:59], v5 offset:15360
    v_mul_f32 v115, s52, v115
    v_mfma_f32_16x16x32_bf16 v[212:215], v[40:43], v[44:47], v[212:215]
    ds_read_b128 v[60:63], v5 offset:16384
    v_fma_f32 v80, s50, v80, v7
    v_mfma_f32_16x16x32_bf16 v[164:167], v[36:39], v[48:51], v[164:167]
    v_fma_f32 v81, s50, v81, v7
    v_fma_f32 v82, s50, v82, v7
    v_mfma_f32_16x16x32_bf16 v[204:207], v[40:43], v[48:51], v[204:207]
    v_fma_f32 v83, s50, v83, v7
    v_mul_f32 v120, s52, v120
    v_mfma_f32_16x16x32_bf16 v[156:159], v[36:39], v[52:55], v[156:159]
    v_mul_f32 v121, s52, v121
    v_mul_f32 v122, s52, v122
    v_mfma_f32_16x16x32_bf16 v[196:199], v[40:43], v[52:55], v[196:199]
    v_mul_f32 v123, s52, v123
    s_waitcnt lgkmcnt(0)
    v_mfma_f32_16x16x32_bf16 v[108:111], v[20:23], v[44:47], v[108:111]
    ds_read_b64_tr_b16 v[28:29], v1 offset:256
    v_fma_f32 v88, s50, v88, v7
    v_mfma_f32_16x16x32_bf16 v[148:151], v[24:27], v[44:47], v[148:151]
    ds_read_b64_tr_b16 v[30:31], v1 offset:2560
    v_fma_f32 v89, s50, v89, v7
    v_mfma_f32_16x16x32_bf16 v[100:103], v[20:23], v[48:51], v[100:103]
    ds_read_b64_tr_b16 v[32:33], v2 offset:544
    v_fma_f32 v90, s50, v90, v7
    v_mfma_f32_16x16x32_bf16 v[140:143], v[24:27], v[48:51], v[140:143]
    ds_read_b64_tr_b16 v[34:35], v2 offset:2848
    v_fma_f32 v91, s50, v91, v7
    v_mfma_f32_16x16x32_bf16 v[92:95], v[20:23], v[52:55], v[92:95]
    ds_read_b64_tr_b16 v[36:37], v2 offset:96
    v_mul_f32 v128, s52, v128
    v_mfma_f32_16x16x32_bf16 v[132:135], v[24:27], v[52:55], v[132:135]
    ds_read_b64_tr_b16 v[38:39], v2 offset:2400
    v_mul_f32 v129, s52, v129
    v_mfma_f32_16x16x32_bf16 v[84:87], v[20:23], v[56:59], v[84:87]
    ds_read_b64_tr_b16 v[40:41], v1 offset:384
    v_mul_f32 v130, s52, v130
    v_mfma_f32_16x16x32_bf16 v[124:127], v[24:27], v[56:59], v[124:127]
    ds_read_b64_tr_b16 v[42:43], v1 offset:2688
    v_mul_f32 v131, s52, v131
    v_mfma_f32_16x16x32_bf16 v[76:79], v[20:23], v[60:63], v[76:79]
    v_fma_f32 v96, s50, v96, v7
    v_fma_f32 v97, s50, v97, v7
    v_mfma_f32_16x16x32_bf16 v[116:119], v[24:27], v[60:63], v[116:119]
    v_fma_f32 v98, s50, v98, v7
    s_waitcnt lgkmcnt(2)
    v_mfma_f32_16x16x32_bf16 v[236:239], v[28:31], v[56:59], v[236:239]
    v_fma_f32 v99, s50, v99, v7
    v_mul_f32 v136, s52, v136
    v_mfma_f32_16x16x32_bf16 v[244:247], v[32:35], v[56:59], v[244:247]
    v_mul_f32 v137, s52, v137
    s_waitcnt lgkmcnt(0)
    v_mfma_f32_16x16x32_bf16 v[252:255], v[32:35], v[44:47], v[252:255]
    v_mul_f32 v138, s52, v138
    s_barrier
    v_mfma_f32_16x16x32_bf16 v[188:191], v[36:39], v[44:47], v[188:191]
    ds_read_b64_tr_b16 v[20:21], v18 offset:18496
    v_mul_f32 v139, s52, v139
    v_mfma_f32_16x16x32_bf16 v[228:231], v[40:43], v[44:47], v[228:231]
    ds_read_b64 v[64:65], v6 offset:14336
    v_fma_f32 v104, s50, v104, v7
    v_mfma_f32_16x16x32_bf16 v[180:183], v[36:39], v[48:51], v[180:183]
    ds_read_b64_tr_b16 v[24:25], v19 offset:18784
    v_fma_f32 v105, s50, v105, v7
    v_mfma_f32_16x16x32_bf16 v[220:223], v[40:43], v[48:51], v[220:223]
    ds_read_b64 v[68:69], v6 offset:15360
    v_fma_f32 v106, s50, v106, v7
    v_mfma_f32_16x16x32_bf16 v[172:175], v[36:39], v[52:55], v[172:175]
    ds_read_b64 v[44:45], v6 offset:16384
    v_fma_f32 v107, s50, v107, v7
    v_mfma_f32_16x16x32_bf16 v[212:215], v[40:43], v[52:55], v[212:215]
    ds_read_b64 v[48:49], v6 offset:17408
    v_mul_f32 v144, s52, v144
    v_mfma_f32_16x16x32_bf16 v[164:167], v[36:39], v[56:59], v[164:167]
    ds_read_b64 v[52:53], v6 offset:18432
    v_mul_f32 v145, s52, v145
    v_mfma_f32_16x16x32_bf16 v[204:207], v[40:43], v[56:59], v[204:207]
    v_mul_f32 v146, s52, v146
    v_mul_f32 v147, s52, v147
    v_mfma_f32_16x16x32_bf16 v[156:159], v[36:39], v[60:63], v[156:159]
    v_fma_f32 v152, s50, v152, v7
    v_fma_f32 v153, s50, v153, v7
    v_mfma_f32_16x16x32_bf16 v[196:199], v[40:43], v[60:63], v[196:199]
    v_fma_f32 v154, s50, v154, v7
    s_waitcnt lgkmcnt(1)
    v_mfma_f32_16x16x16_bf16 v[108:111], v[20:21], v[64:65], v[108:111]
    ds_read_b64_tr_b16 v[28:29], v18 offset:18688
    v_fma_f32 v155, s50, v155, v7
    v_mfma_f32_16x16x16_bf16 v[148:151], v[24:25], v[64:65], v[148:151]
    ds_read_b64_tr_b16 v[32:33], v19 offset:18976
    v_mul_f32 v192, s52, v192
    v_mfma_f32_16x16x16_bf16 v[100:103], v[20:21], v[68:69], v[100:103]
    ds_read_b64_tr_b16 v[36:37], v19 offset:18528
    v_mul_f32 v193, s52, v193
    v_mfma_f32_16x16x16_bf16 v[140:143], v[24:25], v[68:69], v[140:143]
    ds_read_b64_tr_b16 v[40:41], v18 offset:18816
    v_mul_f32 v194, s52, v194
    v_mfma_f32_16x16x16_bf16 v[92:95], v[20:21], v[44:45], v[92:95]
    v_mul_f32 v195, s52, v195
    v_fma_f32 v160, s50, v160, v7
    v_mfma_f32_16x16x16_bf16 v[132:135], v[24:25], v[44:45], v[132:135]
    v_fma_f32 v161, s50, v161, v7
    v_fma_f32 v162, s50, v162, v7
    v_mfma_f32_16x16x16_bf16 v[84:87], v[20:21], v[48:49], v[84:87]
    v_fma_f32 v163, s50, v163, v7
    v_mul_f32 v200, s52, v200
    v_mfma_f32_16x16x16_bf16 v[124:127], v[24:25], v[48:49], v[124:127]
    v_mul_f32 v201, s52, v201
    s_waitcnt lgkmcnt(0)
    v_mfma_f32_16x16x16_bf16 v[76:79], v[20:21], v[52:53], v[76:79]
    v_mul_f32 v202, s52, v202
    v_mul_f32 v203, s52, v203
    v_mfma_f32_16x16x16_bf16 v[116:119], v[24:25], v[52:53], v[116:119]
    v_fma_f32 v168, s50, v168, v7
    v_fma_f32 v169, s50, v169, v7
    v_mfma_f32_16x16x16_bf16 v[236:239], v[28:29], v[48:49], v[236:239]
    v_fma_f32 v170, s50, v170, v7
    v_fma_f32 v171, s50, v171, v7
    v_mfma_f32_16x16x16_bf16 v[244:247], v[32:33], v[48:49], v[244:247]
    v_mul_f32 v208, s52, v208
    v_mul_f32 v209, s52, v209
    v_mfma_f32_16x16x16_bf16 v[252:255], v[32:33], v[64:65], v[252:255]
    v_mul_f32 v210, s52, v210
    s_barrier
    v_mfma_f32_16x16x16_bf16 v[188:191], v[36:37], v[64:65], v[188:191]
    v_mul_f32 v211, s52, v211
    v_fma_f32 v176, s50, v176, v7
    v_mfma_f32_16x16x16_bf16 v[228:231], v[40:41], v[64:65], v[228:231]
    v_fma_f32 v177, s50, v177, v7
    v_fma_f32 v178, s50, v178, v7
    v_mfma_f32_16x16x16_bf16 v[180:183], v[36:37], v[68:69], v[180:183]
    v_fma_f32 v179, s50, v179, v7
    v_mul_f32 v216, s52, v216
    v_mfma_f32_16x16x16_bf16 v[220:223], v[40:41], v[68:69], v[220:223]
    v_mul_f32 v217, s52, v217
    v_mul_f32 v218, s52, v218
    v_mfma_f32_16x16x16_bf16 v[172:175], v[36:37], v[44:45], v[172:175]
    v_mul_f32 v219, s52, v219
    v_fma_f32 v184, s50, v184, v7
    v_mfma_f32_16x16x16_bf16 v[212:215], v[40:41], v[44:45], v[212:215]
    v_fma_f32 v185, s50, v185, v7
    v_fma_f32 v186, s50, v186, v7
    v_mfma_f32_16x16x16_bf16 v[164:167], v[36:37], v[48:49], v[164:167]
    v_fma_f32 v187, s50, v187, v7
    v_mul_f32 v224, s52, v224
    v_mfma_f32_16x16x16_bf16 v[204:207], v[40:41], v[48:49], v[204:207]
    v_mul_f32 v225, s52, v225
    v_mul_f32 v226, s52, v226
    v_mfma_f32_16x16x16_bf16 v[156:159], v[36:37], v[52:53], v[156:159]
    v_mul_f32 v227, s52, v227
    v_mfma_f32_16x16x16_bf16 v[196:199], v[40:41], v[52:53], v[196:199]
    s_branch L_cepi
.p2align 6
L_cw2:
    s_barrier
    ds_read_b64_tr_b16 v[20:21], v1 offset:128
    ds_read_b64_tr_b16 v[22:23], v1 offset:2432
    ds_read_b64_tr_b16 v[24:25], v2 offset:416
    ds_read_b64_tr_b16 v[26:27], v2 offset:2720
    ds_read_b128 v[44:47], v5 offset:1024
    ds_read_b128 v[48:51], v5 offset:2048
    ds_read_b128 v[52:55], v5 offset:3072
    ds_read_b128 v[56:59], v5 offset:4096
    ds_read_b128 v[60:63], v5 offset:5120
    s_waitcnt lgkmcnt(0)
    s_mov_b32 s40, 0
.p2align 3
L_c2_0:
    s_waitcnt lgkmcnt(0)
    v_mfma_f32_16x16x32_bf16 v[108:111], v[20:23], v[44:47], v[108:111]
    ds_read_b64_tr_b16 v[28:29], v1 offset:256
    v_mfma_f32_16x16x32_bf16 v[148:151], v[24:27], v[44:47], v[148:151]
    ds_read_b64_tr_b16 v[30:31], v1 offset:2560
    v_mfma_f32_16x16x32_bf16 v[100:103], v[20:23], v[48:51], v[100:103]
    ds_read_b64_tr_b16 v[32:33], v2 offset:544
    v_mfma_f32_16x16x32_bf16 v[140:143], v[24:27], v[48:51], v[140:143]
    ds_read_b64_tr_b16 v[34:35], v2 offset:2848
    v_mfma_f32_16x16x32_bf16 v[92:95], v[20:23], v[52:55], v[92:95]
    ds_read_b64_tr_b16 v[36:37], v2 offset:160
    v_mfma_f32_16x16x32_bf16 v[132:135], v[24:27], v[52:55], v[132:135]
    ds_read_b64_tr_b16 v[38:39], v2 offset:2464
    v_mfma_f32_16x16x32_bf16 v[84:87], v[20:23], v[56:59], v[84:87]
    ds_read_b64_tr_b16 v[40:41], v1 offset:448
    v_mfma_f32_16x16x32_bf16 v[124:127], v[24:27], v[56:59], v[124:127]
    ds_read_b64_tr_b16 v[42:43], v1 offset:2752
    v_mfma_f32_16x16x32_bf16 v[76:79], v[20:23], v[60:63], v[76:79]
    v_mfma_f32_16x16x32_bf16 v[116:119], v[24:27], v[60:63], v[116:119]
    s_waitcnt lgkmcnt(2)
    v_mfma_f32_16x16x32_bf16 v[236:239], v[28:31], v[52:55], v[236:239]
    s_waitcnt lgkmcnt(0)
    v_mfma_f32_16x16x32_bf16 v[244:247], v[32:35], v[52:55], v[244:247]
    s_barrier
    v_mfma_f32_16x16x32_bf16 v[188:191], v[36:39], v[44:47], v[188:191]
    ds_read_b64_tr_b16 v[20:21], v1 offset:18560
    v_mfma_f32_16x16x32_bf16 v[228:231], v[40:43], v[44:47], v[228:231]
    ds_read_b64_tr_b16 v[22:23], v1 offset:20864
    v_mfma_f32_16x16x32_bf16 v[180:183], v[36:39], v[48:51], v[180:183]
    ds_read_b64_tr_b16 v[24:25], v2 offset:18848
    v_mfma_f32_16x16x32_bf16 v[220:223], v[40:43], v[48:51], v[220:223]
    ds_read_b64_tr_b16 v[26:27], v2 offset:21152
    v_mfma_f32_16x16x32_bf16 v[172:175], v[36:39], v[52:55], v[172:175]
    ds_read_b128 v[64:67], v5 offset:6144
    v_mfma_f32_16x16x32_bf16 v[212:215], v[40:43], v[52:55], v[212:215]
    v_mfma_f32_16x16x32_bf16 v[164:167], v[36:39], v[56:59], v[164:167]
    v_mfma_f32_16x16x32_bf16 v[204:207], v[40:43], v[56:59], v[204:207]
    v_mfma_f32_16x16x32_bf16 v[156:159], v[36:39], v[60:63], v[156:159]
    v_mfma_f32_16x16x32_bf16 v[196:199], v[40:43], v[60:63], v[196:199]
    s_waitcnt lgkmcnt(0)
    v_mfma_f32_16x16x32_bf16 v[108:111], v[20:23], v[48:51], v[108:111]
    ds_read_b64_tr_b16 v[28:29], v1 offset:18688
    v_mfma_f32_16x16x32_bf16 v[148:151], v[24:27], v[48:51], v[148:151]
    ds_read_b64_tr_b16 v[30:31], v1 offset:20992
    v_mfma_f32_16x16x32_bf16 v[100:103], v[20:23], v[52:55], v[100:103]
    ds_read_b64_tr_b16 v[32:33], v2 offset:18976
    v_mfma_f32_16x16x32_bf16 v[140:143], v[24:27], v[52:55], v[140:143]
    ds_read_b64_tr_b16 v[34:35], v2 offset:21280
    v_mfma_f32_16x16x32_bf16 v[92:95], v[20:23], v[56:59], v[92:95]
    ds_read_b64_tr_b16 v[36:37], v2 offset:18592
    v_mfma_f32_16x16x32_bf16 v[132:135], v[24:27], v[56:59], v[132:135]
    ds_read_b64_tr_b16 v[38:39], v2 offset:20896
    v_mfma_f32_16x16x32_bf16 v[84:87], v[20:23], v[60:63], v[84:87]
    ds_read_b64_tr_b16 v[40:41], v1 offset:18880
    v_mfma_f32_16x16x32_bf16 v[124:127], v[24:27], v[60:63], v[124:127]
    ds_read_b64_tr_b16 v[42:43], v1 offset:21184
    v_mfma_f32_16x16x32_bf16 v[76:79], v[20:23], v[64:67], v[76:79]
    v_mfma_f32_16x16x32_bf16 v[116:119], v[24:27], v[64:67], v[116:119]
    s_waitcnt lgkmcnt(2)
    v_mfma_f32_16x16x32_bf16 v[236:239], v[28:31], v[56:59], v[236:239]
    s_waitcnt lgkmcnt(0)
    v_mfma_f32_16x16x32_bf16 v[244:247], v[32:35], v[56:59], v[244:247]
    s_barrier
    v_mfma_f32_16x16x32_bf16 v[188:191], v[36:39], v[48:51], v[188:191]
    ds_read_b64_tr_b16 v[20:21], v1 offset:36992
    v_mfma_f32_16x16x32_bf16 v[228:231], v[40:43], v[48:51], v[228:231]
    ds_read_b64_tr_b16 v[22:23], v1 offset:39296
    v_mfma_f32_16x16x32_bf16 v[180:183], v[36:39], v[52:55], v[180:183]
    ds_read_b64_tr_b16 v[24:25], v2 offset:37280
    v_mfma_f32_16x16x32_bf16 v[220:223], v[40:43], v[52:55], v[220:223]
    ds_read_b64_tr_b16 v[26:27], v2 offset:39584
    v_mfma_f32_16x16x32_bf16 v[172:175], v[36:39], v[56:59], v[172:175]
    ds_read_b128 v[68:71], v5 offset:7168
    v_mfma_f32_16x16x32_bf16 v[212:215], v[40:43], v[56:59], v[212:215]
    v_mfma_f32_16x16x32_bf16 v[164:167], v[36:39], v[60:63], v[164:167]
    v_mfma_f32_16x16x32_bf16 v[204:207], v[40:43], v[60:63], v[204:207]
    v_mfma_f32_16x16x32_bf16 v[156:159], v[36:39], v[64:67], v[156:159]
    v_mfma_f32_16x16x32_bf16 v[196:199], v[40:43], v[64:67], v[196:199]
    s_waitcnt lgkmcnt(0)
    v_mfma_f32_16x16x32_bf16 v[108:111], v[20:23], v[52:55], v[108:111]
    ds_read_b64_tr_b16 v[28:29], v1 offset:37120
    v_mfma_f32_16x16x32_bf16 v[148:151], v[24:27], v[52:55], v[148:151]
    ds_read_b64_tr_b16 v[30:31], v1 offset:39424
    v_mfma_f32_16x16x32_bf16 v[100:103], v[20:23], v[56:59], v[100:103]
    ds_read_b64_tr_b16 v[32:33], v2 offset:37408
    v_mfma_f32_16x16x32_bf16 v[140:143], v[24:27], v[56:59], v[140:143]
    ds_read_b64_tr_b16 v[34:35], v2 offset:39712
    v_mfma_f32_16x16x32_bf16 v[92:95], v[20:23], v[60:63], v[92:95]
    ds_read_b64_tr_b16 v[36:37], v2 offset:37024
    v_mfma_f32_16x16x32_bf16 v[132:135], v[24:27], v[60:63], v[132:135]
    ds_read_b64_tr_b16 v[38:39], v2 offset:39328
    v_mfma_f32_16x16x32_bf16 v[84:87], v[20:23], v[64:67], v[84:87]
    ds_read_b64_tr_b16 v[40:41], v1 offset:37312
    v_mfma_f32_16x16x32_bf16 v[124:127], v[24:27], v[64:67], v[124:127]
    ds_read_b64_tr_b16 v[42:43], v1 offset:39616
    v_mfma_f32_16x16x32_bf16 v[76:79], v[20:23], v[68:71], v[76:79]
    v_mfma_f32_16x16x32_bf16 v[116:119], v[24:27], v[68:71], v[116:119]
    s_waitcnt lgkmcnt(2)
    v_mfma_f32_16x16x32_bf16 v[236:239], v[28:31], v[60:63], v[236:239]
    s_waitcnt lgkmcnt(0)
    v_mfma_f32_16x16x32_bf16 v[244:247], v[32:35], v[60:63], v[244:247]
    s_barrier
    v_mfma_f32_16x16x32_bf16 v[188:191], v[36:39], v[52:55], v[188:191]
    ds_read_b64_tr_b16 v[20:21], v3 offset:128
    v_mfma_f32_16x16x32_bf16 v[228:231], v[40:43], v[52:55], v[228:231]
    ds_read_b64_tr_b16 v[22:23], v3 offset:2432
    v_mfma_f32_16x16x32_bf16 v[180:183], v[36:39], v[56:59], v[180:183]
    ds_read_b64_tr_b16 v[24:25], v4 offset:416
    v_mfma_f32_16x16x32_bf16 v[220:223], v[40:43], v[56:59], v[220:223]
    ds_read_b64_tr_b16 v[26:27], v4 offset:2720
    v_mfma_f32_16x16x32_bf16 v[172:175], v[36:39], v[60:63], v[172:175]
    ds_read_b128 v[44:47], v5 offset:8192
    v_mfma_f32_16x16x32_bf16 v[212:215], v[40:43], v[60:63], v[212:215]
    v_mfma_f32_16x16x32_bf16 v[164:167], v[36:39], v[64:67], v[164:167]
    v_mfma_f32_16x16x32_bf16 v[204:207], v[40:43], v[64:67], v[204:207]
    v_mfma_f32_16x16x32_bf16 v[156:159], v[36:39], v[68:71], v[156:159]
    v_mfma_f32_16x16x32_bf16 v[196:199], v[40:43], v[68:71], v[196:199]
    s_waitcnt lgkmcnt(0)
    v_mfma_f32_16x16x32_bf16 v[108:111], v[20:23], v[56:59], v[108:111]
    ds_read_b64_tr_b16 v[28:29], v3 offset:256
    v_mfma_f32_16x16x32_bf16 v[148:151], v[24:27], v[56:59], v[148:151]
    ds_read_b64_tr_b16 v[30:31], v3 offset:2560
    v_mfma_f32_16x16x32_bf16 v[100:103], v[20:23], v[60:63], v[100:103]
    ds_read_b64_tr_b16 v[32:33], v4 offset:544
    v_mfma_f32_16x16x32_bf16 v[140:143], v[24:27], v[60:63], v[140:143]
    ds_read_b64_tr_b16 v[34:35], v4 offset:2848
    v_mfma_f32_16x16x32_bf16 v[92:95], v[20:23], v[64:67], v[92:95]
    ds_read_b64_tr_b16 v[36:37], v4 offset:160
    v_mfma_f32_16x16x32_bf16 v[132:135], v[24:27], v[64:67], v[132:135]
    ds_read_b64_tr_b16 v[38:39], v4 offset:2464
    v_mfma_f32_16x16x32_bf16 v[84:87], v[20:23], v[68:71], v[84:87]
    ds_read_b64_tr_b16 v[40:41], v3 offset:448
    v_mfma_f32_16x16x32_bf16 v[124:127], v[24:27], v[68:71], v[124:127]
    ds_read_b64_tr_b16 v[42:43], v3 offset:2752
    v_mfma_f32_16x16x32_bf16 v[76:79], v[20:23], v[44:47], v[76:79]
    v_mfma_f32_16x16x32_bf16 v[116:119], v[24:27], v[44:47], v[116:119]
    s_waitcnt lgkmcnt(2)
    v_mfma_f32_16x16x32_bf16 v[236:239], v[28:31], v[64:67], v[236:239]
    s_waitcnt lgkmcnt(0)
    v_mfma_f32_16x16x32_bf16 v[244:247], v[32:35], v[64:67], v[244:247]
    s_barrier
    v_mfma_f32_16x16x32_bf16 v[188:191], v[36:39], v[56:59], v[188:191]
    ds_read_b64_tr_b16 v[20:21], v3 offset:18560
    v_mfma_f32_16x16x32_bf16 v[228:231], v[40:43], v[56:59], v[228:231]
    ds_read_b64_tr_b16 v[22:23], v3 offset:20864
    v_mfma_f32_16x16x32_bf16 v[180:183], v[36:39], v[60:63], v[180:183]
    ds_read_b64_tr_b16 v[24:25], v4 offset:18848
    v_mfma_f32_16x16x32_bf16 v[220:223], v[40:43], v[60:63], v[220:223]
    ds_read_b64_tr_b16 v[26:27], v4 offset:21152
    v_mfma_f32_16x16x32_bf16 v[172:175], v[36:39], v[64:67], v[172:175]
    ds_read_b128 v[48:51], v5 offset:9216
    v_mfma_f32_16x16x32_bf16 v[212:215], v[40:43], v[64:67], v[212:215]
    v_mfma_f32_16x16x32_bf16 v[164:167], v[36:39], v[68:71], v[164:167]
    v_mfma_f32_16x16x32_bf16 v[204:207], v[40:43], v[68:71], v[204:207]
    v_mfma_f32_16x16x32_bf16 v[156:159], v[36:39], v[44:47], v[156:159]
    v_mfma_f32_16x16x32_bf16 v[196:199], v[40:43], v[44:47], v[196:199]
    s_waitcnt lgkmcnt(0)
    v_mfma_f32_16x16x32_bf16 v[108:111], v[20:23], v[60:63], v[108:111]
    ds_read_b64_tr_b16 v[28:29], v3 offset:18688
    v_mfma_f32_16x16x32_bf16 v[148:151], v[24:27], v[60:63], v[148:151]
    ds_read_b64_tr_b16 v[30:31], v3 offset:20992
    v_mfma_f32_16x16x32_bf16 v[100:103], v[20:23], v[64:67], v[100:103]
    ds_read_b64_tr_b16 v[32:33], v4 offset:18976
    v_mfma_f32_16x16x32_bf16 v[140:143], v[24:27], v[64:67], v[140:143]
    ds_read_b64_tr_b16 v[34:35], v4 offset:21280
    v_mfma_f32_16x16x32_bf16 v[92:95], v[20:23], v[68:71], v[92:95]
    ds_read_b64_tr_b16 v[36:37], v4 offset:18592
    v_mfma_f32_16x16x32_bf16 v[132:135], v[24:27], v[68:71], v[132:135]
    ds_read_b64_tr_b16 v[38:39], v4 offset:20896
    v_mfma_f32_16x16x32_bf16 v[84:87], v[20:23], v[44:47], v[84:87]
    ds_read_b64_tr_b16 v[40:41], v3 offset:18880
    v_mfma_f32_16x16x32_bf16 v[124:127], v[24:27], v[44:47], v[124:127]
    ds_read_b64_tr_b16 v[42:43], v3 offset:21184
    v_mfma_f32_16x16x32_bf16 v[76:79], v[20:23], v[48:51], v[76:79]
    v_mfma_f32_16x16x32_bf16 v[116:119], v[24:27], v[48:51], v[116:119]
    s_waitcnt lgkmcnt(2)
    v_mfma_f32_16x16x32_bf16 v[236:239], v[28:31], v[68:71], v[236:239]
    s_waitcnt lgkmcnt(0)
    v_mfma_f32_16x16x32_bf16 v[244:247], v[32:35], v[68:71], v[244:247]
    s_barrier
    v_mfma_f32_16x16x32_bf16 v[188:191], v[36:39], v[60:63], v[188:191]
    ds_read_b64_tr_b16 v[20:21], v1 offset:128
    v_mfma_f32_16x16x32_bf16 v[228:231], v[40:43], v[60:63], v[228:231]
    ds_read_b64_tr_b16 v[22:23], v1 offset:2432
    v_mfma_f32_16x16x32_bf16 v[180:183], v[36:39], v[64:67], v[180:183]
    ds_read_b64_tr_b16 v[24:25], v2 offset:416
    v_mfma_f32_16x16x32_bf16 v[220:223], v[40:43], v[64:67], v[220:223]
    ds_read_b64_tr_b16 v[26:27], v2 offset:2720
    v_mfma_f32_16x16x32_bf16 v[172:175], v[36:39], v[68:71], v[172:175]
    ds_read_b128 v[52:55], v5 offset:10240
    v_mfma_f32_16x16x32_bf16 v[212:215], v[40:43], v[68:71], v[212:215]
    v_mfma_f32_16x16x32_bf16 v[164:167], v[36:39], v[44:47], v[164:167]
    v_mfma_f32_16x16x32_bf16 v[204:207], v[40:43], v[44:47], v[204:207]
    v_mfma_f32_16x16x32_bf16 v[156:159], v[36:39], v[48:51], v[156:159]
    v_mfma_f32_16x16x32_bf16 v[196:199], v[40:43], v[48:51], v[196:199]
    s_waitcnt lgkmcnt(0)
    v_mfma_f32_16x16x32_bf16 v[104:107], v[20:23], v[64:67], v[104:107]
    ds_read_b64_tr_b16 v[28:29], v1 offset:256
    v_mfma_f32_16x16x32_bf16 v[144:147], v[24:27], v[64:67], v[144:147]
    ds_read_b64_tr_b16 v[30:31], v1 offset:2560
    v_mfma_f32_16x16x32_bf16 v[96:99], v[20:23], v[68:71], v[96:99]
    ds_read_b64_tr_b16 v[32:33], v2 offset:544
    v_mfma_f32_16x16x32_bf16 v[136:139], v[24:27], v[68:71], v[136:139]
    ds_read_b64_tr_b16 v[34:35], v2 offset:2848
    v_mfma_f32_16x16x32_bf16 v[88:91], v[20:23], v[44:47], v[88:91]
    ds_read_b64_tr_b16 v[36:37], v2 offset:160
    v_mfma_f32_16x16x32_bf16 v[128:131], v[24:27], v[44:47], v[128:131]
    ds_read_b64_tr_b16 v[38:39], v2 offset:2464
    v_mfma_f32_16x16x32_bf16 v[80:83], v[20:23], v[48:51], v[80:83]
    ds_read_b64_tr_b16 v[40:41], v1 offset:448
    v_mfma_f32_16x16x32_bf16 v[120:123], v[24:27], v[48:51], v[120:123]
    ds_read_b64_tr_b16 v[42:43], v1 offset:2752
    v_mfma_f32_16x16x32_bf16 v[72:75], v[20:23], v[52:55], v[72:75]
    v_mfma_f32_16x16x32_bf16 v[112:115], v[24:27], v[52:55], v[112:115]
    s_waitcnt lgkmcnt(2)
    v_mfma_f32_16x16x32_bf16 v[232:235], v[28:31], v[44:47], v[232:235]
    s_waitcnt lgkmcnt(0)
    v_mfma_f32_16x16x32_bf16 v[240:243], v[32:35], v[44:47], v[240:243]
    s_barrier
    v_mfma_f32_16x16x32_bf16 v[184:187], v[36:39], v[64:67], v[184:187]
    ds_read_b64_tr_b16 v[20:21], v1 offset:18560
    v_mfma_f32_16x16x32_bf16 v[224:227], v[40:43], v[64:67], v[224:227]
    ds_read_b64_tr_b16 v[22:23], v1 offset:20864
    v_mfma_f32_16x16x32_bf16 v[176:179], v[36:39], v[68:71], v[176:179]
    ds_read_b64_tr_b16 v[24:25], v2 offset:18848
    v_mfma_f32_16x16x32_bf16 v[216:219], v[40:43], v[68:71], v[216:219]
    ds_read_b64_tr_b16 v[26:27], v2 offset:21152
    v_mfma_f32_16x16x32_bf16 v[168:171], v[36:39], v[44:47], v[168:171]
    ds_read_b128 v[56:59], v5 offset:11264
    v_mfma_f32_16x16x32_bf16 v[208:211], v[40:43], v[44:47], v[208:211]
    v_mfma_f32_16x16x32_bf16 v[160:163], v[36:39], v[48:51], v[160:163]
    v_mfma_f32_16x16x32_bf16 v[200:203], v[40:43], v[48:51], v[200:203]
    v_mfma_f32_16x16x32_bf16 v[152:155], v[36:39], v[52:55], v[152:155]
    v_mfma_f32_16x16x32_bf16 v[192:195], v[40:43], v[52:55], v[192:195]
    s_waitcnt lgkmcnt(0)
    v_mfma_f32_16x16x32_bf16 v[104:107], v[20:23], v[68:71], v[104:107]
    ds_read_b64_tr_b16 v[28:29], v1 offset:18688
    v_mfma_f32_16x16x32_bf16 v[144:147], v[24:27], v[68:71], v[144:147]
    ds_read_b64_tr_b16 v[30:31], v1 offset:20992
    v_mfma_f32_16x16x32_bf16 v[96:99], v[20:23], v[44:47], v[96:99]
    ds_read_b64_tr_b16 v[32:33], v2 offset:18976
    v_mfma_f32_16x16x32_bf16 v[136:139], v[24:27], v[44:47], v[136:139]
    ds_read_b64_tr_b16 v[34:35], v2 offset:21280
    v_mfma_f32_16x16x32_bf16 v[88:91], v[20:23], v[48:51], v[88:91]
    ds_read_b64_tr_b16 v[36:37], v2 offset:18592
    v_mfma_f32_16x16x32_bf16 v[128:131], v[24:27], v[48:51], v[128:131]
    ds_read_b64_tr_b16 v[38:39], v2 offset:20896
    v_mfma_f32_16x16x32_bf16 v[80:83], v[20:23], v[52:55], v[80:83]
    ds_read_b64_tr_b16 v[40:41], v1 offset:18880
    v_mfma_f32_16x16x32_bf16 v[120:123], v[24:27], v[52:55], v[120:123]
    ds_read_b64_tr_b16 v[42:43], v1 offset:21184
    v_mfma_f32_16x16x32_bf16 v[72:75], v[20:23], v[56:59], v[72:75]
    v_mfma_f32_16x16x32_bf16 v[112:115], v[24:27], v[56:59], v[112:115]
    s_waitcnt lgkmcnt(2)
    v_mfma_f32_16x16x32_bf16 v[232:235], v[28:31], v[48:51], v[232:235]
    s_waitcnt lgkmcnt(0)
    v_mfma_f32_16x16x32_bf16 v[240:243], v[32:35], v[48:51], v[240:243]
    s_barrier
    v_mfma_f32_16x16x32_bf16 v[184:187], v[36:39], v[68:71], v[184:187]
    ds_read_b64_tr_b16 v[20:21], v1 offset:36992
    v_mfma_f32_16x16x32_bf16 v[224:227], v[40:43], v[68:71], v[224:227]
    ds_read_b64_tr_b16 v[22:23], v1 offset:39296
    v_mfma_f32_16x16x32_bf16 v[176:179], v[36:39], v[44:47], v[176:179]
    ds_read_b64_tr_b16 v[24:25], v2 offset:37280
    v_mfma_f32_16x16x32_bf16 v[216:219], v[40:43], v[44:47], v[216:219]
    ds_read_b64_tr_b16 v[26:27], v2 offset:39584
    v_mfma_f32_16x16x32_bf16 v[168:171], v[36:39], v[48:51], v[168:171]
    ds_read_b128 v[60:63], v5 offset:12288
    v_mfma_f32_16x16x32_bf16 v[208:211], v[40:43], v[48:51], v[208:211]
    v_mfma_f32_16x16x32_bf16 v[160:163], v[36:39], v[52:55], v[160:163]
    v_mfma_f32_16x16x32_bf16 v[200:203], v[40:43], v[52:55], v[200:203]
    v_mfma_f32_16x16x32_bf16 v[152:155], v[36:39], v[56:59], v[152:155]
    v_mfma_f32_16x16x32_bf16 v[192:195], v[40:43], v[56:59], v[192:195]
    s_waitcnt lgkmcnt(0)
    v_mfma_f32_16x16x32_bf16 v[104:107], v[20:23], v[44:47], v[104:107]
    ds_read_b64_tr_b16 v[28:29], v1 offset:37120
    v_mfma_f32_16x16x32_bf16 v[144:147], v[24:27], v[44:47], v[144:147]
    ds_read_b64_tr_b16 v[30:31], v1 offset:39424
    v_mfma_f32_16x16x32_bf16 v[96:99], v[20:23], v[48:51], v[96:99]
    ds_read_b64_tr_b16 v[32:33], v2 offset:37408
    v_mfma_f32_16x16x32_bf16 v[136:139], v[24:27], v[48:51], v[136:139]
    ds_read_b64_tr_b16 v[34:35], v2 offset:39712
    v_mfma_f32_16x16x32_bf16 v[88:91], v[20:23], v[52:55], v[88:91]
    ds_read_b64_tr_b16 v[36:37], v2 offset:37024
    v_mfma_f32_16x16x32_bf16 v[128:131], v[24:27], v[52:55], v[128:131]
    ds_read_b64_tr_b16 v[38:39], v2 offset:39328
    v_mfma_f32_16x16x32_bf16 v[80:83], v[20:23], v[56:59], v[80:83]
    ds_read_b64_tr_b16 v[40:41], v1 offset:37312
    v_mfma_f32_16x16x32_bf16 v[120:123], v[24:27], v[56:59], v[120:123]
    ds_read_b64_tr_b16 v[42:43], v1 offset:39616
    v_mfma_f32_16x16x32_bf16 v[72:75], v[20:23], v[60:63], v[72:75]
    v_mfma_f32_16x16x32_bf16 v[112:115], v[24:27], v[60:63], v[112:115]
    s_waitcnt lgkmcnt(2)
    v_mfma_f32_16x16x32_bf16 v[232:235], v[28:31], v[52:55], v[232:235]
    s_waitcnt lgkmcnt(0)
    v_mfma_f32_16x16x32_bf16 v[240:243], v[32:35], v[52:55], v[240:243]
    s_barrier
    v_mfma_f32_16x16x32_bf16 v[184:187], v[36:39], v[44:47], v[184:187]
    ds_read_b64_tr_b16 v[20:21], v3 offset:128
    v_mfma_f32_16x16x32_bf16 v[224:227], v[40:43], v[44:47], v[224:227]
    ds_read_b64_tr_b16 v[22:23], v3 offset:2432
    v_mfma_f32_16x16x32_bf16 v[176:179], v[36:39], v[48:51], v[176:179]
    ds_read_b64_tr_b16 v[24:25], v4 offset:416
    v_mfma_f32_16x16x32_bf16 v[216:219], v[40:43], v[48:51], v[216:219]
    ds_read_b64_tr_b16 v[26:27], v4 offset:2720
    v_mfma_f32_16x16x32_bf16 v[168:171], v[36:39], v[52:55], v[168:171]
    ds_read_b128 v[64:67], v5 offset:13312
    v_mfma_f32_16x16x32_bf16 v[208:211], v[40:43], v[52:55], v[208:211]
    v_mfma_f32_16x16x32_bf16 v[160:163], v[36:39], v[56:59], v[160:163]
    v_mfma_f32_16x16x32_bf16 v[200:203], v[40:43], v[56:59], v[200:203]
    v_mfma_f32_16x16x32_bf16 v[152:155], v[36:39], v[60:63], v[152:155]
    v_mfma_f32_16x16x32_bf16 v[192:195], v[40:43], v[60:63], v[192:195]
    s_waitcnt lgkmcnt(0)
    v_mfma_f32_16x16x32_bf16 v[104:107], v[20:23], v[48:51], v[104:107]
    ds_read_b64_tr_b16 v[28:29], v3 offset:256
    v_mfma_f32_16x16x32_bf16 v[144:147], v[24:27], v[48:51], v[144:147]
    ds_read_b64_tr_b16 v[30:31], v3 offset:2560
    v_mfma_f32_16x16x32_bf16 v[96:99], v[20:23], v[52:55], v[96:99]
    ds_read_b64_tr_b16 v[32:33], v4 offset:544
    v_mfma_f32_16x16x32_bf16 v[136:139], v[24:27], v[52:55], v[136:139]
    ds_read_b64_tr_b16 v[34:35], v4 offset:2848
    v_mfma_f32_16x16x32_bf16 v[88:91], v[20:23], v[56:59], v[88:91]
    ds_read_b64_tr_b16 v[36:37], v4 offset:160
    v_mfma_f32_16x16x32_bf16 v[128:131], v[24:27], v[56:59], v[128:131]
    ds_read_b64_tr_b16 v[38:39], v4 offset:2464
    v_mfma_f32_16x16x32_bf16 v[80:83], v[20:23], v[60:63], v[80:83]
    ds_read_b64_tr_b16 v[40:41], v3 offset:448
    v_mfma_f32_16x16x32_bf16 v[120:123], v[24:27], v[60:63], v[120:123]
    ds_read_b64_tr_b16 v[42:43], v3 offset:2752
    v_mfma_f32_16x16x32_bf16 v[72:75], v[20:23], v[64:67], v[72:75]
    v_mfma_f32_16x16x32_bf16 v[112:115], v[24:27], v[64:67], v[112:115]
    s_waitcnt lgkmcnt(2)
    v_mfma_f32_16x16x32_bf16 v[232:235], v[28:31], v[56:59], v[232:235]
    s_waitcnt lgkmcnt(0)
    v_mfma_f32_16x16x32_bf16 v[240:243], v[32:35], v[56:59], v[240:243]
    s_barrier
    v_mfma_f32_16x16x32_bf16 v[184:187], v[36:39], v[48:51], v[184:187]
    ds_read_b64_tr_b16 v[20:21], v3 offset:18560
    v_mfma_f32_16x16x32_bf16 v[224:227], v[40:43], v[48:51], v[224:227]
    ds_read_b64_tr_b16 v[22:23], v3 offset:20864
    v_mfma_f32_16x16x32_bf16 v[176:179], v[36:39], v[52:55], v[176:179]
    ds_read_b64_tr_b16 v[24:25], v4 offset:18848
    v_mfma_f32_16x16x32_bf16 v[216:219], v[40:43], v[52:55], v[216:219]
    ds_read_b64_tr_b16 v[26:27], v4 offset:21152
    v_mfma_f32_16x16x32_bf16 v[168:171], v[36:39], v[56:59], v[168:171]
    ds_read_b128 v[68:71], v5 offset:14336
    v_mfma_f32_16x16x32_bf16 v[208:211], v[40:43], v[56:59], v[208:211]
    v_mfma_f32_16x16x32_bf16 v[160:163], v[36:39], v[60:63], v[160:163]
    v_mfma_f32_16x16x32_bf16 v[200:203], v[40:43], v[60:63], v[200:203]
    v_mfma_f32_16x16x32_bf16 v[152:155], v[36:39], v[64:67], v[152:155]
    v_mfma_f32_16x16x32_bf16 v[192:195], v[40:43], v[64:67], v[192:195]
    s_waitcnt lgkmcnt(0)
    v_mfma_f32_16x16x32_bf16 v[104:107], v[20:23], v[52:55], v[104:107]
    ds_read_b64_tr_b16 v[28:29], v3 offset:18688
    v_mfma_f32_16x16x32_bf16 v[144:147], v[24:27], v[52:55], v[144:147]
    ds_read_b64_tr_b16 v[30:31], v3 offset:20992
    v_mfma_f32_16x16x32_bf16 v[96:99], v[20:23], v[56:59], v[96:99]
    ds_read_b64_tr_b16 v[32:33], v4 offset:18976
    v_mfma_f32_16x16x32_bf16 v[136:139], v[24:27], v[56:59], v[136:139]
    ds_read_b64_tr_b16 v[34:35], v4 offset:21280
    v_mfma_f32_16x16x32_bf16 v[88:91], v[20:23], v[60:63], v[88:91]
    ds_read_b64_tr_b16 v[36:37], v4 offset:18592
    v_mfma_f32_16x16x32_bf16 v[128:131], v[24:27], v[60:63], v[128:131]
    ds_read_b64_tr_b16 v[38:39], v4 offset:20896
    v_mfma_f32_16x16x32_bf16 v[80:83], v[20:23], v[64:67], v[80:83]
    ds_read_b64_tr_b16 v[40:41], v3 offset:18880
    v_mfma_f32_16x16x32_bf16 v[120:123], v[24:27], v[64:67], v[120:123]
    ds_read_b64_tr_b16 v[42:43], v3 offset:21184
    v_mfma_f32_16x16x32_bf16 v[72:75], v[20:23], v[68:71], v[72:75]
    v_mfma_f32_16x16x32_bf16 v[112:115], v[24:27], v[68:71], v[112:115]
    s_waitcnt lgkmcnt(2)
    v_mfma_f32_16x16x32_bf16 v[232:235], v[28:31], v[60:63], v[232:235]
    s_waitcnt lgkmcnt(0)
    v_mfma_f32_16x16x32_bf16 v[240:243], v[32:35], v[60:63], v[240:243]
    s_barrier
    v_xor_b32 v5, 0xdc00, v5
    v_mfma_f32_16x16x32_bf16 v[184:187], v[36:39], v[52:55], v[184:187]
    ds_read_b64_tr_b16 v[20:21], v1 offset:128
    ds_read_b64_tr_b16 v[22:23], v1 offset:2432
    v_mfma_f32_16x16x32_bf16 v[224:227], v[40:43], v[52:55], v[224:227]
    ds_read_b128 v[44:47], v5 offset:1024
    ds_read_b64_tr_b16 v[24:25], v2 offset:416
    v_mfma_f32_16x16x32_bf16 v[176:179], v[36:39], v[56:59], v[176:179]
    ds_read_b64_tr_b16 v[26:27], v2 offset:2720
    ds_read_b128 v[48:51], v5 offset:2048
    v_mfma_f32_16x16x32_bf16 v[216:219], v[40:43], v[56:59], v[216:219]
    ds_read_b128 v[52:55], v5 offset:3072
    ds_read_b128 v[56:59], v5 offset:4096
    v_mfma_f32_16x16x32_bf16 v[168:171], v[36:39], v[60:63], v[168:171]
    v_mfma_f32_16x16x32_bf16 v[208:211], v[40:43], v[60:63], v[208:211]
    ds_read_b128 v[60:63], v5 offset:5120
    v_mfma_f32_16x16x32_bf16 v[160:163], v[36:39], v[64:67], v[160:163]
    s_add_u32 s40, s40, 1
    s_cmp_lt_u32 s40, 4
    v_mfma_f32_16x16x32_bf16 v[200:203], v[40:43], v[64:67], v[200:203]
    v_mfma_f32_16x16x32_bf16 v[152:155], v[36:39], v[68:71], v[152:155]
    v_mfma_f32_16x16x32_bf16 v[192:195], v[40:43], v[68:71], v[192:195]
    s_cbranch_scc1 L_c2_0
    s_waitcnt lgkmcnt(0)
    v_mfma_f32_16x16x32_bf16 v[108:111], v[20:23], v[44:47], v[108:111]
    ds_read_b64_tr_b16 v[28:29], v1 offset:256
    v_mfma_f32_16x16x32_bf16 v[148:151], v[24:27], v[44:47], v[148:151]
    ds_read_b64_tr_b16 v[30:31], v1 offset:2560
    v_mfma_f32_16x16x32_bf16 v[100:103], v[20:23], v[48:51], v[100:103]
    ds_read_b64_tr_b16 v[32:33], v2 offset:544
    v_mfma_f32_16x16x32_bf16 v[140:143], v[24:27], v[48:51], v[140:143]
    ds_read_b64_tr_b16 v[34:35], v2 offset:2848
    v_mfma_f32_16x16x32_bf16 v[92:95], v[20:23], v[52:55], v[92:95]
    ds_read_b64_tr_b16 v[36:37], v2 offset:160
    v_mfma_f32_16x16x32_bf16 v[132:135], v[24:27], v[52:55], v[132:135]
    ds_read_b64_tr_b16 v[38:39], v2 offset:2464
    v_mfma_f32_16x16x32_bf16 v[84:87], v[20:23], v[56:59], v[84:87]
    ds_read_b64_tr_b16 v[40:41], v1 offset:448
    v_mfma_f32_16x16x32_bf16 v[124:127], v[24:27], v[56:59], v[124:127]
    ds_read_b64_tr_b16 v[42:43], v1 offset:2752
    v_mfma_f32_16x16x32_bf16 v[76:79], v[20:23], v[60:63], v[76:79]
    v_mfma_f32_16x16x32_bf16 v[116:119], v[24:27], v[60:63], v[116:119]
    s_waitcnt lgkmcnt(2)
    v_mfma_f32_16x16x32_bf16 v[236:239], v[28:31], v[52:55], v[236:239]
    s_waitcnt lgkmcnt(0)
    v_mfma_f32_16x16x32_bf16 v[244:247], v[32:35], v[52:55], v[244:247]
    s_barrier
    v_mfma_f32_16x16x32_bf16 v[188:191], v[36:39], v[44:47], v[188:191]
    ds_read_b64_tr_b16 v[20:21], v1 offset:18560
    v_mfma_f32_16x16x32_bf16 v[228:231], v[40:43], v[44:47], v[228:231]
    ds_read_b64_tr_b16 v[22:23], v1 offset:20864
    v_mfma_f32_16x16x32_bf16 v[180:183], v[36:39], v[48:51], v[180:183]
    ds_read_b64_tr_b16 v[24:25], v2 offset:18848
    v_mfma_f32_16x16x32_bf16 v[220:223], v[40:43], v[48:51], v[220:223]
    ds_read_b64_tr_b16 v[26:27], v2 offset:21152
    v_mfma_f32_16x16x32_bf16 v[172:175], v[36:39], v[52:55], v[172:175]
    ds_read_b128 v[64:67], v5 offset:6144
    v_mfma_f32_16x16x32_bf16 v[212:215], v[40:43], v[52:55], v[212:215]
    ds_read_b128 v[68:71], v5 offset:7168
    v_mfma_f32_16x16x32_bf16 v[164:167], v[36:39], v[56:59], v[164:167]
    v_mfma_f32_16x16x32_bf16 v[204:207], v[40:43], v[56:59], v[204:207]
    v_mfma_f32_16x16x32_bf16 v[156:159], v[36:39], v[60:63], v[156:159]
    v_mfma_f32_16x16x32_bf16 v[196:199], v[40:43], v[60:63], v[196:199]
    s_waitcnt lgkmcnt(0)
    v_mfma_f32_16x16x32_bf16 v[108:111], v[20:23], v[52:55], v[108:111]
    ds_read_b64_tr_b16 v[28:29], v1 offset:18688
    v_mfma_f32_16x16x32_bf16 v[148:151], v[24:27], v[52:55], v[148:151]
    ds_read_b64_tr_b16 v[30:31], v1 offset:20992
    v_mfma_f32_16x16x32_bf16 v[100:103], v[20:23], v[56:59], v[100:103]
    ds_read_b64_tr_b16 v[32:33], v2 offset:18976
    v_mfma_f32_16x16x32_bf16 v[140:143], v[24:27], v[56:59], v[140:143]
    ds_read_b64_tr_b16 v[34:35], v2 offset:21280
    v_mfma_f32_16x16x32_bf16 v[92:95], v[20:23], v[60:63], v[92:95]
    ds_read_b64_tr_b16 v[36:37], v2 offset:18592
    v_mfma_f32_16x16x32_bf16 v[132:135], v[24:27], v[60:63], v[132:135]
    ds_read_b64_tr_b16 v[38:39], v2 offset:20896
    v_mfma_f32_16x16x32_bf16 v[84:87], v[20:23], v[64:67], v[84:87]
    ds_read_b64_tr_b16 v[40:41], v1 offset:18880
    v_mfma_f32_16x16x32_bf16 v[124:127], v[24:27], v[64:67], v[124:127]
    ds_read_b64_tr_b16 v[42:43], v1 offset:21184
    v_mfma_f32_16x16x32_bf16 v[76:79], v[20:23], v[68:71], v[76:79]
    v_mfma_f32_16x16x32_bf16 v[116:119], v[24:27], v[68:71], v[116:119]
    s_waitcnt lgkmcnt(2)
    v_mfma_f32_16x16x32_bf16 v[236:239], v[28:31], v[60:63], v[236:239]
    s_waitcnt lgkmcnt(0)
    v_mfma_f32_16x16x32_bf16 v[244:247], v[32:35], v[60:63], v[244:247]
    s_barrier
    v_mfma_f32_16x16x32_bf16 v[188:191], v[36:39], v[52:55], v[188:191]
    ds_read_b64_tr_b16 v[20:21], v18 offset:36992
    v_mfma_f32_16x16x32_bf16 v[228:231], v[40:43], v[52:55], v[228:231]
    ds_read_b64 v[44:45], v6 offset:24576
    v_mfma_f32_16x16x32_bf16 v[180:183], v[36:39], v[56:59], v[180:183]
    ds_read_b64_tr_b16 v[24:25], v19 offset:37280
    v_mfma_f32_16x16x32_bf16 v[220:223], v[40:43], v[56:59], v[220:223]
    ds_read_b64 v[48:49], v6 offset:25600
    v_mfma_f32_16x16x32_bf16 v[172:175], v[36:39], v[60:63], v[172:175]
    ds_read_b64 v[52:53], v6 offset:26624
    v_mfma_f32_16x16x32_bf16 v[212:215], v[40:43], v[60:63], v[212:215]
    ds_read_b64 v[56:57], v6 offset:27648
    v_mfma_f32_16x16x32_bf16 v[164:167], v[36:39], v[64:67], v[164:167]
    ds_read_b64 v[60:61], v6 offset:28672
    v_mfma_f32_16x16x32_bf16 v[204:207], v[40:43], v[64:67], v[204:207]
    v_mfma_f32_16x16x32_bf16 v[156:159], v[36:39], v[68:71], v[156:159]
    v_mfma_f32_16x16x32_bf16 v[196:199], v[40:43], v[68:71], v[196:199]
    s_waitcnt lgkmcnt(1)
    v_mfma_f32_16x16x16_bf16 v[108:111], v[20:21], v[44:45], v[108:111]
    ds_read_b64_tr_b16 v[28:29], v18 offset:37120
    v_mfma_f32_16x16x16_bf16 v[148:151], v[24:25], v[44:45], v[148:151]
    ds_read_b64_tr_b16 v[32:33], v19 offset:37408
    v_mfma_f32_16x16x16_bf16 v[100:103], v[20:21], v[48:49], v[100:103]
    ds_read_b64_tr_b16 v[36:37], v19 offset:37024
    v_mfma_f32_16x16x16_bf16 v[140:143], v[24:25], v[48:49], v[140:143]
    ds_read_b64_tr_b16 v[40:41], v18 offset:37312
    v_mfma_f32_16x16x16_bf16 v[92:95], v[20:21], v[52:53], v[92:95]
    v_mfma_f32_16x16x16_bf16 v[132:135], v[24:25], v[52:53], v[132:135]
    v_mfma_f32_16x16x16_bf16 v[84:87], v[20:21], v[56:57], v[84:87]
    v_mfma_f32_16x16x16_bf16 v[124:127], v[24:25], v[56:57], v[124:127]
    s_waitcnt lgkmcnt(0)
    v_mfma_f32_16x16x16_bf16 v[76:79], v[20:21], v[60:61], v[76:79]
    v_mfma_f32_16x16x16_bf16 v[116:119], v[24:25], v[60:61], v[116:119]
    v_mfma_f32_16x16x16_bf16 v[236:239], v[28:29], v[52:53], v[236:239]
    v_mfma_f32_16x16x16_bf16 v[244:247], v[32:33], v[52:53], v[244:247]
    s_barrier
    v_mfma_f32_16x16x16_bf16 v[188:191], v[36:37], v[44:45], v[188:191]
    ds_read_b64_tr_b16 v[20:21], v3 offset:128
    ds_read_b64_tr_b16 v[22:23], v3 offset:2432
    v_mfma_f32_16x16x16_bf16 v[228:231], v[40:41], v[44:45], v[228:231]
    ds_read_b128 v[64:67], v5 offset:6144
    ds_read_b64_tr_b16 v[24:25], v4 offset:416
    v_mfma_f32_16x16x16_bf16 v[180:183], v[36:37], v[48:49], v[180:183]
    ds_read_b64_tr_b16 v[26:27], v4 offset:2720
    v_mfma_f32_16x16x16_bf16 v[220:223], v[40:41], v[48:49], v[220:223]
    ds_read_b128 v[68:71], v5 offset:7168
    v_mfma_f32_16x16x16_bf16 v[172:175], v[36:37], v[52:53], v[172:175]
    ds_read_b128 v[44:47], v5 offset:8192
    v_mfma_f32_16x16x16_bf16 v[212:215], v[40:41], v[52:53], v[212:215]
    ds_read_b128 v[48:51], v5 offset:9216
    v_mfma_f32_16x16x16_bf16 v[164:167], v[36:37], v[56:57], v[164:167]
    ds_read_b128 v[52:55], v5 offset:10240
    v_mfma_f32_16x16x16_bf16 v[204:207], v[40:41], v[56:57], v[204:207]
    v_mfma_f32_16x16x16_bf16 v[156:159], v[36:37], v[60:61], v[156:159]
    v_mfma_f32_16x16x16_bf16 v[196:199], v[40:41], v[60:61], v[196:199]
    s_waitcnt lgkmcnt(1)
    v_mfma_f32_16x16x32_bf16 v[104:107], v[20:23], v[64:67], v[104:107]
    ds_read_b64_tr_b16 v[28:29], v3 offset:256
    v_sub_f32 v184, v184, v188
    v_mfma_f32_16x16x32_bf16 v[144:147], v[24:27], v[64:67], v[144:147]
    ds_read_b64_tr_b16 v[30:31], v3 offset:2560
    v_sub_f32 v185, v185, v189
    v_mfma_f32_16x16x32_bf16 v[96:99], v[20:23], v[68:71], v[96:99]
    ds_read_b64_tr_b16 v[32:33], v4 offset:544
    v_sub_f32 v186, v186, v190
    v_mfma_f32_16x16x32_bf16 v[136:139], v[24:27], v[68:71], v[136:139]
    ds_read_b64_tr_b16 v[34:35], v4 offset:2848
    v_sub_f32 v187, v187, v191
    v_mfma_f32_16x16x32_bf16 v[88:91], v[20:23], v[44:47], v[88:91]
    ds_read_b64_tr_b16 v[36:37], v4 offset:160
    v_sub_f32 v224, v224, v228
    v_mfma_f32_16x16x32_bf16 v[128:131], v[24:27], v[44:47], v[128:131]
    ds_read_b64_tr_b16 v[38:39], v4 offset:2464
    v_sub_f32 v225, v225, v229
    v_mfma_f32_16x16x32_bf16 v[80:83], v[20:23], v[48:51], v[80:83]
    ds_read_b64_tr_b16 v[40:41], v3 offset:448
    v_sub_f32 v226, v226, v230
    v_mfma_f32_16x16x32_bf16 v[120:123], v[24:27], v[48:51], v[120:123]
    ds_read_b64_tr_b16 v[42:43], v3 offset:2752
    s_waitcnt lgkmcnt(4)
    v_mfma_f32_16x16x32_bf16 v[72:75], v[20:23], v[52:55], v[72:75]
    v_sub_f32 v227, v227, v231
    v_sub_f32 v176, v176, v180
    v_mfma_f32_16x16x32_bf16 v[112:115], v[24:27], v[52:55], v[112:115]
    v_sub_f32 v177, v177, v181
    v_sub_f32 v178, v178, v182
    v_mfma_f32_16x16x32_bf16 v[232:235], v[28:31], v[44:47], v[232:235]
    v_sub_f32 v179, v179, v183
    s_waitcnt lgkmcnt(0)
    v_mfma_f32_16x16x32_bf16 v[240:243], v[32:35], v[44:47], v[240:243]
    v_sub_f32 v216, v216, v220
    s_barrier
    v_mfma_f32_16x16x32_bf16 v[184:187], v[36:39], v[64:67], v[184:187]
    ds_read_b64_tr_b16 v[20:21], v3 offset:18560
    v_sub_f32 v217, v217, v221
    v_mfma_f32_16x16x32_bf16 v[224:227], v[40:43], v[64:67], v[224:227]
    ds_read_b64_tr_b16 v[22:23], v3 offset:20864
    v_sub_f32 v168, v168, v172
    v_mfma_f32_16x16x32_bf16 v[176:179], v[36:39], v[68:71], v[176:179]
    ds_read_b64_tr_b16 v[24:25], v4 offset:18848
    v_sub_f32 v208, v208, v212
    v_mfma_f32_16x16x32_bf16 v[216:219], v[40:43], v[68:71], v[216:219]
    ds_read_b64_tr_b16 v[26:27], v4 offset:21152
    v_sub_f32 v160, v160, v164
    v_mfma_f32_16x16x32_bf16 v[168:171], v[36:39], v[44:47], v[168:171]
    ds_read_b128 v[56:59], v5 offset:11264
    v_sub_f32 v200, v200, v204
    v_mfma_f32_16x16x32_bf16 v[208:211], v[40:43], v[44:47], v[208:211]
    ds_read_b128 v[60:63], v5 offset:12288
    v_sub_f32 v192, v192, v196
    v_mfma_f32_16x16x32_bf16 v[160:163], v[36:39], v[48:51], v[160:163]
    v_sub_f32 v218, v218, v222
    v_sub_f32 v219, v219, v223
    v_mfma_f32_16x16x32_bf16 v[200:203], v[40:43], v[48:51], v[200:203]
    v_sub_f32 v169, v169, v173
    v_sub_f32 v170, v170, v174
    v_mfma_f32_16x16x32_bf16 v[152:155], v[36:39], v[52:55], v[152:155]
    v_sub_f32 v171, v171, v175
    v_sub_f32 v209, v209, v213
    v_mfma_f32_16x16x32_bf16 v[192:195], v[40:43], v[52:55], v[192:195]
    v_sub_f32 v210, v210, v214
    s_waitcnt lgkmcnt(0)
    v_mfma_f32_16x16x32_bf16 v[104:107], v[20:23], v[44:47], v[104:107]
    ds_read_b64_tr_b16 v[28:29], v3 offset:18688
    v_sub_f32 v211, v211, v215
    v_mfma_f32_16x16x32_bf16 v[144:147], v[24:27], v[44:47], v[144:147]
    ds_read_b64_tr_b16 v[30:31], v3 offset:20992
    v_sub_f32 v161, v161, v165
    v_mfma_f32_16x16x32_bf16 v[96:99], v[20:23], v[48:51], v[96:99]
    ds_read_b64_tr_b16 v[32:33], v4 offset:18976
    v_sub_f32 v162, v162, v166
    v_mfma_f32_16x16x32_bf16 v[136:139], v[24:27], v[48:51], v[136:139]
    ds_read_b64_tr_b16 v[34:35], v4 offset:21280
    v_sub_f32 v163, v163, v167
    v_mfma_f32_16x16x32_bf16 v[88:91], v[20:23], v[52:55], v[88:91]
    ds_read_b64_tr_b16 v[36:37], v4 offset:18592
    v_sub_f32 v201, v201, v205
    v_mfma_f32_16x16x32_bf16 v[128:131], v[24:27], v[52:55], v[128:131]
    ds_read_b64_tr_b16 v[38:39], v4 offset:20896
    v_sub_f32 v202, v202, v206
    v_mfma_f32_16x16x32_bf16 v[80:83], v[20:23], v[56:59], v[80:83]
    ds_read_b64_tr_b16 v[40:41], v3 offset:18880
    v_sub_f32 v203, v203, v207
    v_mfma_f32_16x16x32_bf16 v[120:123], v[24:27], v[56:59], v[120:123]
    ds_read_b64_tr_b16 v[42:43], v3 offset:21184
    v_sub_f32 v152, v152, v156
    v_mfma_f32_16x16x32_bf16 v[72:75], v[20:23], v[60:63], v[72:75]
    v_sub_f32 v153, v153, v157
    v_sub_f32 v154, v154, v158
    v_mfma_f32_16x16x32_bf16 v[112:115], v[24:27], v[60:63], v[112:115]
    v_sub_f32 v155, v155, v159
    s_waitcnt lgkmcnt(2)
    v_mfma_f32_16x16x32_bf16 v[232:235], v[28:31], v[52:55], v[232:235]
    v_sub_f32 v193, v193, v197
    s_waitcnt lgkmcnt(0)
    v_mfma_f32_16x16x32_bf16 v[240:243], v[32:35], v[52:55], v[240:243]
    v_sub_f32 v194, v194, v198
    s_barrier
    v_mfma_f32_16x16x32_bf16 v[184:187], v[36:39], v[44:47], v[184:187]
    ds_read_b64_tr_b16 v[20:21], v18 offset:128
    v_sub_f32 v195, v195, v199
    v_mfma_f32_16x16x32_bf16 v[224:227], v[40:43], v[44:47], v[224:227]
    ds_read_b64 v[64:65], v6 offset:29696
    v_sub_f32 v104, v104, v108
    v_mfma_f32_16x16x32_bf16 v[176:179], v[36:39], v[48:51], v[176:179]
    ds_read_b64_tr_b16 v[24:25], v19 offset:416
    v_sub_f32 v105, v105, v109
    v_mfma_f32_16x16x32_bf16 v[216:219], v[40:43], v[48:51], v[216:219]
    ds_read_b64 v[68:69], v6 offset:30720
    v_sub_f32 v106, v106, v110
    v_mfma_f32_16x16x32_bf16 v[168:171], v[36:39], v[52:55], v[168:171]
    ds_read_b64 v[44:45], v6 offset:31744
    v_sub_f32 v107, v107, v111
    v_mfma_f32_16x16x32_bf16 v[208:211], v[40:43], v[52:55], v[208:211]
    ds_read_b64 v[48:49], v6 offset:32768
    v_sub_f32 v144, v144, v148
    v_mfma_f32_16x16x32_bf16 v[160:163], v[36:39], v[56:59], v[160:163]
    ds_read_b64 v[52:53], v6 offset:33792
    v_sub_f32 v145, v145, v149
    v_mfma_f32_16x16x32_bf16 v[200:203], v[40:43], v[56:59], v[200:203]
    v_sub_f32 v146, v146, v150
    v_sub_f32 v147, v147, v151
    v_mfma_f32_16x16x32_bf16 v[152:155], v[36:39], v[60:63], v[152:155]
    v_sub_f32 v96, v96, v100
    v_sub_f32 v97, v97, v101
    v_mfma_f32_16x16x32_bf16 v[192:195], v[40:43], v[60:63], v[192:195]
    v_sub_f32 v98, v98, v102
    s_waitcnt lgkmcnt(1)
    v_mfma_f32_16x16x16_bf16 v[104:107], v[20:21], v[64:65], v[104:107]
    ds_read_b64_tr_b16 v[28:29], v18 offset:256
    v_sub_f32 v136, v136, v140
    v_mfma_f32_16x16x16_bf16 v[144:147], v[24:25], v[64:65], v[144:147]
    ds_read_b64_tr_b16 v[32:33], v19 offset:544
    v_sub_f32 v88, v88, v92
    v_mfma_f32_16x16x16_bf16 v[96:99], v[20:21], v[68:69], v[96:99]
    ds_read_b64_tr_b16 v[36:37], v19 offset:160
    v_sub_f32 v128, v128, v132
    v_mfma_f32_16x16x16_bf16 v[136:139], v[24:25], v[68:69], v[136:139]
    ds_read_b64_tr_b16 v[40:41], v18 offset:448
    v_sub_f32 v120, v120, v124
    v_mfma_f32_16x16x16_bf16 v[88:91], v[20:21], v[44:45], v[88:91]
    v_sub_f32 v72, v72, v76
    v_sub_f32 v73, v73, v77
    v_mfma_f32_16x16x16_bf16 v[128:131], v[24:25], v[44:45], v[128:131]
    v_sub_f32 v99, v99, v103
    v_sub_f32 v74, v74, v78
    v_mfma_f32_16x16x16_bf16 v[80:83], v[20:21], v[48:49], v[80:83]
    v_sub_f32 v137, v137, v141
    v_sub_f32 v138, v138, v142
    v_mfma_f32_16x16x16_bf16 v[120:123], v[24:25], v[48:49], v[120:123]
    v_sub_f32 v139, v139, v143
    s_waitcnt lgkmcnt(0)
    v_mfma_f32_16x16x16_bf16 v[72:75], v[20:21], v[52:53], v[72:75]
    v_sub_f32 v89, v89, v93
    v_sub_f32 v90, v90, v94
    v_mfma_f32_16x16x16_bf16 v[112:115], v[24:25], v[52:53], v[112:115]
    v_sub_f32 v91, v91, v95
    v_sub_f32 v129, v129, v133
    v_mfma_f32_16x16x16_bf16 v[232:235], v[28:29], v[44:45], v[232:235]
    v_sub_f32 v130, v130, v134
    v_sub_f32 v131, v131, v135
    v_mfma_f32_16x16x16_bf16 v[240:243], v[32:33], v[44:45], v[240:243]
    s_barrier
    v_xor_b32 v5, 0xdc00, v5
    v_mfma_f32_16x16x16_bf16 v[184:187], v[36:37], v[64:65], v[184:187]
    ds_read_b64_tr_b16 v[20:21], v1 offset:18560
    ds_read_b64_tr_b16 v[22:23], v1 offset:20864
    v_mfma_f32_16x16x16_bf16 v[224:227], v[40:41], v[64:65], v[224:227]
    ds_read_b64_tr_b16 v[24:25], v2 offset:18848
    ds_read_b64_tr_b16 v[26:27], v2 offset:21152
    v_mfma_f32_16x16x16_bf16 v[176:179], v[36:37], v[68:69], v[176:179]
    ds_read_b128 v[56:59], v5 offset:4096
    v_sub_f32 v80, v80, v84
    v_mfma_f32_16x16x16_bf16 v[216:219], v[40:41], v[68:69], v[216:219]
    ds_read_b128 v[60:63], v5 offset:5120
    v_sub_f32 v81, v81, v85
    v_mfma_f32_16x16x16_bf16 v[168:171], v[36:37], v[44:45], v[168:171]
    v_sub_f32 v82, v82, v86
    v_sub_f32 v83, v83, v87
    v_mfma_f32_16x16x16_bf16 v[208:211], v[40:41], v[44:45], v[208:211]
    ds_read_b128 v[44:47], v5 offset:1024
    v_sub_f32 v121, v121, v125
    v_mfma_f32_16x16x16_bf16 v[160:163], v[36:37], v[48:49], v[160:163]
    v_sub_f32 v122, v122, v126
    v_sub_f32 v123, v123, v127
    v_mfma_f32_16x16x16_bf16 v[200:203], v[40:41], v[48:49], v[200:203]
    ds_read_b128 v[48:51], v5 offset:2048
    v_sub_f32 v75, v75, v79
    v_mfma_f32_16x16x16_bf16 v[152:155], v[36:37], v[52:53], v[152:155]
    v_sub_f32 v112, v112, v116
    v_sub_f32 v113, v113, v117
    v_mfma_f32_16x16x16_bf16 v[192:195], v[40:41], v[52:53], v[192:195]
    ds_read_b128 v[52:55], v5 offset:3072
    s_nop 7
    v_sub_f32 v114, v114, v118
    v_sub_f32 v115, v115, v119
    v_sub_f32 v232, v232, v236
    v_sub_f32 v233, v233, v237
    v_sub_f32 v234, v234, v238
    v_sub_f32 v235, v235, v239
    v_sub_f32 v240, v240, v244
    v_sub_f32 v241, v241, v245
    v_sub_f32 v242, v242, v246
    v_sub_f32 v243, v243, v247
    v_pk_fma_f32 v[108:109], v[108:109], s[60:61], v[104:105]
    v_pk_fma_f32 v[110:111], v[110:111], s[60:61], v[106:107]
    v_pk_fma_f32 v[100:101], v[100:101], s[60:61], v[96:97]
    v_pk_fma_f32 v[102:103], v[102:103], s[60:61], v[98:99]
    v_pk_fma_f32 v[92:93], v[92:93], s[60:61], v[88:89]
    v_pk_fma_f32 v[94:95], v[94:95], s[60:61], v[90:91]
    v_pk_fma_f32 v[84:85], v[84:85], s[60:61], v[80:81]
    v_pk_fma_f32 v[86:87], v[86:87], s[60:61], v[82:83]
    v_pk_fma_f32 v[76:77], v[76:77], s[60:61], v[72:73]
    v_pk_fma_f32 v[78:79], v[78:79], s[60:61], v[74:75]
    v_pk_fma_f32 v[148:149], v[148:149], s[60:61], v[144:145]
    v_pk_fma_f32 v[150:151], v[150:151], s[60:61], v[146:147]
    v_pk_fma_f32 v[140:141], v[140:141], s[60:61], v[136:137]
    v_pk_fma_f32 v[142:143], v[142:143], s[60:61], v[138:139]
    v_pk_fma_f32 v[132:133], v[132:133], s[60:61], v[128:129]
    v_pk_fma_f32 v[134:135], v[134:135], s[60:61], v[130:131]
    v_pk_fma_f32 v[124:125], v[124:125], s[60:61], v[120:121]
    v_pk_fma_f32 v[126:127], v[126:127], s[60:61], v[122:123]
    v_pk_fma_f32 v[116:117], v[116:117], s[60:61], v[112:113]
    v_pk_fma_f32 v[118:119], v[118:119], s[60:61], v[114:115]
    v_pk_fma_f32 v[236:237], v[236:237], s[60:61], v[232:233]
    v_pk_fma_f32 v[238:239], v[238:239], s[60:61], v[234:235]
    v_pk_fma_f32 v[244:245], v[244:245], s[60:61], v[240:241]
    v_pk_fma_f32 v[246:247], v[246:247], s[60:61], v[242:243]
    v_pk_fma_f32 v[188:189], v[188:189], s[60:61], v[184:185]
    v_pk_fma_f32 v[190:191], v[190:191], s[60:61], v[186:187]
    v_pk_fma_f32 v[228:229], v[228:229], s[60:61], v[224:225]
    v_pk_fma_f32 v[230:231], v[230:231], s[60:61], v[226:227]
    v_pk_fma_f32 v[180:181], v[180:181], s[60:61], v[176:177]
    v_pk_fma_f32 v[182:183], v[182:183], s[60:61], v[178:179]
    v_pk_fma_f32 v[220:221], v[220:221], s[60:61], v[216:217]
    v_pk_fma_f32 v[222:223], v[222:223], s[60:61], v[218:219]
    v_pk_fma_f32 v[172:173], v[172:173], s[60:61], v[168:169]
    v_pk_fma_f32 v[174:175], v[174:175], s[60:61], v[170:171]
    v_pk_fma_f32 v[212:213], v[212:213], s[60:61], v[208:209]
    v_pk_fma_f32 v[214:215], v[214:215], s[60:61], v[210:211]
    v_pk_fma_f32 v[164:165], v[164:165], s[60:61], v[160:161]
    v_pk_fma_f32 v[166:167], v[166:167], s[60:61], v[162:163]
    v_pk_fma_f32 v[204:205], v[204:205], s[60:61], v[200:201]
    v_pk_fma_f32 v[206:207], v[206:207], s[60:61], v[202:203]
    v_pk_fma_f32 v[156:157], v[156:157], s[60:61], v[152:153]
    v_pk_fma_f32 v[158:159], v[158:159], s[60:61], v[154:155]
    v_pk_fma_f32 v[196:197], v[196:197], s[60:61], v[192:193]
    v_pk_fma_f32 v[198:199], v[198:199], s[60:61], v[194:195]
    s_waitcnt lgkmcnt(0)
    s_mov_b32 s40, 0
.p2align 3
L_c2_46:
    s_waitcnt lgkmcnt(1)
    v_mfma_f32_16x16x32_bf16 v[104:107], v[20:23], v[44:47], v[104:107]
    ds_read_b64_tr_b16 v[28:29], v1 offset:18688
    v_mfma_f32_16x16x32_bf16 v[144:147], v[24:27], v[44:47], v[144:147]
    ds_read_b64_tr_b16 v[30:31], v1 offset:20992
    v_mfma_f32_16x16x32_bf16 v[96:99], v[20:23], v[48:51], v[96:99]
    ds_read_b64_tr_b16 v[32:33], v2 offset:18976
    v_mfma_f32_16x16x32_bf16 v[136:139], v[24:27], v[48:51], v[136:139]
    ds_read_b64_tr_b16 v[34:35], v2 offset:21280
    v_mfma_f32_16x16x32_bf16 v[88:91], v[20:23], v[52:55], v[88:91]
    ds_read_b64_tr_b16 v[36:37], v2 offset:18592
    v_mfma_f32_16x16x32_bf16 v[128:131], v[24:27], v[52:55], v[128:131]
    ds_read_b64_tr_b16 v[38:39], v2 offset:20896
    v_mfma_f32_16x16x32_bf16 v[80:83], v[20:23], v[56:59], v[80:83]
    ds_read_b64_tr_b16 v[40:41], v1 offset:18880
    v_mfma_f32_16x16x32_bf16 v[120:123], v[24:27], v[56:59], v[120:123]
    ds_read_b64_tr_b16 v[42:43], v1 offset:21184
    s_waitcnt lgkmcnt(4)
    v_mfma_f32_16x16x32_bf16 v[72:75], v[20:23], v[60:63], v[72:75]
    v_mfma_f32_16x16x32_bf16 v[112:115], v[24:27], v[60:63], v[112:115]
    v_mfma_f32_16x16x32_bf16 v[232:235], v[28:31], v[52:55], v[232:235]
    s_waitcnt lgkmcnt(0)
    v_mfma_f32_16x16x32_bf16 v[240:243], v[32:35], v[52:55], v[240:243]
    s_barrier
    v_mfma_f32_16x16x32_bf16 v[184:187], v[36:39], v[44:47], v[184:187]
    ds_read_b64_tr_b16 v[20:21], v1 offset:36992
    v_mfma_f32_16x16x32_bf16 v[224:227], v[40:43], v[44:47], v[224:227]
    ds_read_b64_tr_b16 v[22:23], v1 offset:39296
    v_mfma_f32_16x16x32_bf16 v[176:179], v[36:39], v[48:51], v[176:179]
    ds_read_b64_tr_b16 v[24:25], v2 offset:37280
    v_mfma_f32_16x16x32_bf16 v[216:219], v[40:43], v[48:51], v[216:219]
    ds_read_b64_tr_b16 v[26:27], v2 offset:39584
    v_mfma_f32_16x16x32_bf16 v[168:171], v[36:39], v[52:55], v[168:171]
    ds_read_b128 v[64:67], v5 offset:6144
    v_mfma_f32_16x16x32_bf16 v[208:211], v[40:43], v[52:55], v[208:211]
    v_mfma_f32_16x16x32_bf16 v[160:163], v[36:39], v[56:59], v[160:163]
    v_mfma_f32_16x16x32_bf16 v[200:203], v[40:43], v[56:59], v[200:203]
    v_mfma_f32_16x16x32_bf16 v[152:155], v[36:39], v[60:63], v[152:155]
    v_mfma_f32_16x16x32_bf16 v[192:195], v[40:43], v[60:63], v[192:195]
    s_waitcnt lgkmcnt(0)
    v_mfma_f32_16x16x32_bf16 v[104:107], v[20:23], v[48:51], v[104:107]
    ds_read_b64_tr_b16 v[28:29], v1 offset:37120
    v_mfma_f32_16x16x32_bf16 v[144:147], v[24:27], v[48:51], v[144:147]
    ds_read_b64_tr_b16 v[30:31], v1 offset:39424
    v_mfma_f32_16x16x32_bf16 v[96:99], v[20:23], v[52:55], v[96:99]
    ds_read_b64_tr_b16 v[32:33], v2 offset:37408
    v_mfma_f32_16x16x32_bf16 v[136:139], v[24:27], v[52:55], v[136:139]
    ds_read_b64_tr_b16 v[34:35], v2 offset:39712
    v_mfma_f32_16x16x32_bf16 v[88:91], v[20:23], v[56:59], v[88:91]
    ds_read_b64_tr_b16 v[36:37], v2 offset:37024
    v_mfma_f32_16x16x32_bf16 v[128:131], v[24:27], v[56:59], v[128:131]
    ds_read_b64_tr_b16 v[38:39], v2 offset:39328
    v_mfma_f32_16x16x32_bf16 v[80:83], v[20:23], v[60:63], v[80:83]
    ds_read_b64_tr_b16 v[40:41], v1 offset:37312
    v_mfma_f32_16x16x32_bf16 v[120:123], v[24:27], v[60:63], v[120:123]
    ds_read_b64_tr_b16 v[42:43], v1 offset:39616
    v_mfma_f32_16x16x32_bf16 v[72:75], v[20:23], v[64:67], v[72:75]
    v_mfma_f32_16x16x32_bf16 v[112:115], v[24:27], v[64:67], v[112:115]
    s_waitcnt lgkmcnt(2)
    v_mfma_f32_16x16x32_bf16 v[232:235], v[28:31], v[56:59], v[232:235]
    s_waitcnt lgkmcnt(0)
    v_mfma_f32_16x16x32_bf16 v[240:243], v[32:35], v[56:59], v[240:243]
    s_barrier
    v_mfma_f32_16x16x32_bf16 v[184:187], v[36:39], v[48:51], v[184:187]
    ds_read_b64_tr_b16 v[20:21], v3 offset:128
    v_mfma_f32_16x16x32_bf16 v[224:227], v[40:43], v[48:51], v[224:227]
    ds_read_b64_tr_b16 v[22:23], v3 offset:2432
    v_mfma_f32_16x16x32_bf16 v[176:179], v[36:39], v[52:55], v[176:179]
    ds_read_b64_tr_b16 v[24:25], v4 offset:416
    v_mfma_f32_16x16x32_bf16 v[216:219], v[40:43], v[52:55], v[216:219]
    ds_read_b64_tr_b16 v[26:27], v4 offset:2720
    v_mfma_f32_16x16x32_bf16 v[168:171], v[36:39], v[56:59], v[168:171]
    ds_read_b128 v[44:47], v5 offset:7168
    v_mfma_f32_16x16x32_bf16 v[208:211], v[40:43], v[56:59], v[208:211]
    v_mfma_f32_16x16x32_bf16 v[160:163], v[36:39], v[60:63], v[160:163]
    v_mfma_f32_16x16x32_bf16 v[200:203], v[40:43], v[60:63], v[200:203]
    v_mfma_f32_16x16x32_bf16 v[152:155], v[36:39], v[64:67], v[152:155]
    v_mfma_f32_16x16x32_bf16 v[192:195], v[40:43], v[64:67], v[192:195]
    s_waitcnt lgkmcnt(0)
    v_mfma_f32_16x16x32_bf16 v[104:107], v[20:23], v[52:55], v[104:107]
    ds_read_b64_tr_b16 v[28:29], v3 offset:256
    v_mfma_f32_16x16x32_bf16 v[144:147], v[24:27], v[52:55], v[144:147]
    ds_read_b64_tr_b16 v[30:31], v3 offset:2560
    v_mfma_f32_16x16x32_bf16 v[96:99], v[20:23], v[56:59], v[96:99]
    ds_read_b64_tr_b16 v[32:33], v4 offset:544
    v_mfma_f32_16x16x32_bf16 v[136:139], v[24:27], v[56:59], v[136:139]
    ds_read_b64_tr_b16 v[34:35], v4 offset:2848
    v_mfma_f32_16x16x32_bf16 v[88:91], v[20:23], v[60:63], v[88:91]
    ds_read_b64_tr_b16 v[36:37], v4 offset:160
    v_mfma_f32_16x16x32_bf16 v[128:131], v[24:27], v[60:63], v[128:131]
    ds_read_b64_tr_b16 v[38:39], v4 offset:2464
    v_mfma_f32_16x16x32_bf16 v[80:83], v[20:23], v[64:67], v[80:83]
    ds_read_b64_tr_b16 v[40:41], v3 offset:448
    v_mfma_f32_16x16x32_bf16 v[120:123], v[24:27], v[64:67], v[120:123]
    ds_read_b64_tr_b16 v[42:43], v3 offset:2752
    v_mfma_f32_16x16x32_bf16 v[72:75], v[20:23], v[44:47], v[72:75]
    v_mfma_f32_16x16x32_bf16 v[112:115], v[24:27], v[44:47], v[112:115]
    s_waitcnt lgkmcnt(2)
    v_mfma_f32_16x16x32_bf16 v[232:235], v[28:31], v[60:63], v[232:235]
    s_waitcnt lgkmcnt(0)
    v_mfma_f32_16x16x32_bf16 v[240:243], v[32:35], v[60:63], v[240:243]
    s_barrier
    v_mfma_f32_16x16x32_bf16 v[184:187], v[36:39], v[52:55], v[184:187]
    ds_read_b64_tr_b16 v[20:21], v3 offset:18560
    v_mfma_f32_16x16x32_bf16 v[224:227], v[40:43], v[52:55], v[224:227]
    ds_read_b64_tr_b16 v[22:23], v3 offset:20864
    v_mfma_f32_16x16x32_bf16 v[176:179], v[36:39], v[56:59], v[176:179]
    ds_read_b64_tr_b16 v[24:25], v4 offset:18848
    v_mfma_f32_16x16x32_bf16 v[216:219], v[40:43], v[56:59], v[216:219]
    ds_read_b64_tr_b16 v[26:27], v4 offset:21152
    v_mfma_f32_16x16x32_bf16 v[168:171], v[36:39], v[60:63], v[168:171]
    ds_read_b128 v[48:51], v5 offset:8192
    v_mfma_f32_16x16x32_bf16 v[208:211], v[40:43], v[60:63], v[208:211]
    v_mfma_f32_16x16x32_bf16 v[160:163], v[36:39], v[64:67], v[160:163]
    v_mfma_f32_16x16x32_bf16 v[200:203], v[40:43], v[64:67], v[200:203]
    v_mfma_f32_16x16x32_bf16 v[152:155], v[36:39], v[44:47], v[152:155]
    v_mfma_f32_16x16x32_bf16 v[192:195], v[40:43], v[44:47], v[192:195]
    s_waitcnt lgkmcnt(0)
    v_mfma_f32_16x16x32_bf16 v[104:107], v[20:23], v[56:59], v[104:107]
    ds_read_b64_tr_b16 v[28:29], v3 offset:18688
    v_mfma_f32_16x16x32_bf16 v[144:147], v[24:27], v[56:59], v[144:147]
    ds_read_b64_tr_b16 v[30:31], v3 offset:20992
    v_mfma_f32_16x16x32_bf16 v[96:99], v[20:23], v[60:63], v[96:99]
    ds_read_b64_tr_b16 v[32:33], v4 offset:18976
    v_mfma_f32_16x16x32_bf16 v[136:139], v[24:27], v[60:63], v[136:139]
    ds_read_b64_tr_b16 v[34:35], v4 offset:21280
    v_mfma_f32_16x16x32_bf16 v[88:91], v[20:23], v[64:67], v[88:91]
    ds_read_b64_tr_b16 v[36:37], v4 offset:18592
    v_mfma_f32_16x16x32_bf16 v[128:131], v[24:27], v[64:67], v[128:131]
    ds_read_b64_tr_b16 v[38:39], v4 offset:20896
    v_mfma_f32_16x16x32_bf16 v[80:83], v[20:23], v[44:47], v[80:83]
    ds_read_b64_tr_b16 v[40:41], v3 offset:18880
    v_mfma_f32_16x16x32_bf16 v[120:123], v[24:27], v[44:47], v[120:123]
    ds_read_b64_tr_b16 v[42:43], v3 offset:21184
    v_mfma_f32_16x16x32_bf16 v[72:75], v[20:23], v[48:51], v[72:75]
    v_mfma_f32_16x16x32_bf16 v[112:115], v[24:27], v[48:51], v[112:115]
    s_waitcnt lgkmcnt(2)
    v_mfma_f32_16x16x32_bf16 v[232:235], v[28:31], v[64:67], v[232:235]
    s_waitcnt lgkmcnt(0)
    v_mfma_f32_16x16x32_bf16 v[240:243], v[32:35], v[64:67], v[240:243]
    s_barrier
    v_mfma_f32_16x16x32_bf16 v[184:187], v[36:39], v[56:59], v[184:187]
    ds_read_b64_tr_b16 v[20:21], v1 offset:128
    v_mfma_f32_16x16x32_bf16 v[224:227], v[40:43], v[56:59], v[224:227]
    ds_read_b64_tr_b16 v[22:23], v1 offset:2432
    v_mfma_f32_16x16x32_bf16 v[176:179], v[36:39], v[60:63], v[176:179]
    ds_read_b64_tr_b16 v[24:25], v2 offset:416
    v_mfma_f32_16x16x32_bf16 v[216:219], v[40:43], v[60:63], v[216:219]
    ds_read_b64_tr_b16 v[26:27], v2 offset:2720
    v_mfma_f32_16x16x32_bf16 v[168:171], v[36:39], v[64:67], v[168:171]
    ds_read_b128 v[52:55], v5 offset:9216
    v_mfma_f32_16x16x32_bf16 v[208:211], v[40:43], v[64:67], v[208:211]
    v_mfma_f32_16x16x32_bf16 v[160:163], v[36:39], v[44:47], v[160:163]
    v_mfma_f32_16x16x32_bf16 v[200:203], v[40:43], v[44:47], v[200:203]
    v_mfma_f32_16x16x32_bf16 v[152:155], v[36:39], v[48:51], v[152:155]
    v_mfma_f32_16x16x32_bf16 v[192:195], v[40:43], v[48:51], v[192:195]
    s_waitcnt lgkmcnt(0)
    v_mfma_f32_16x16x32_bf16 v[104:107], v[20:23], v[60:63], v[104:107]
    ds_read_b64_tr_b16 v[28:29], v1 offset:256
    v_mfma_f32_16x16x32_bf16 v[144:147], v[24:27], v[60:63], v[144:147]
    ds_read_b64_tr_b16 v[30:31], v1 offset:2560
    v_mfma_f32_16x16x32_bf16 v[96:99], v[20:23], v[64:67], v[96:99]
    ds_read_b64_tr_b16 v[32:33], v2 offset:544
    v_mfma_f32_16x16x32_bf16 v[136:139], v[24:27], v[64:67], v[136:139]
    ds_read_b64_tr_b16 v[34:35], v2 offset:2848
    v_mfma_f32_16x16x32_bf16 v[88:91], v[20:23], v[44:47], v[88:91]
    ds_read_b64_tr_b16 v[36:37], v2 offset:160
    v_mfma_f32_16x16x32_bf16 v[128:131], v[24:27], v[44:47], v[128:131]
    ds_read_b64_tr_b16 v[38:39], v2 offset:2464
    v_mfma_f32_16x16x32_bf16 v[80:83], v[20:23], v[48:51], v[80:83]
    ds_read_b64_tr_b16 v[40:41], v1 offset:448
    v_mfma_f32_16x16x32_bf16 v[120:123], v[24:27], v[48:51], v[120:123]
    ds_read_b64_tr_b16 v[42:43], v1 offset:2752
    v_mfma_f32_16x16x32_bf16 v[72:75], v[20:23], v[52:55], v[72:75]
    v_mfma_f32_16x16x32_bf16 v[112:115], v[24:27], v[52:55], v[112:115]
    s_waitcnt lgkmcnt(2)
    v_mfma_f32_16x16x32_bf16 v[232:235], v[28:31], v[44:47], v[232:235]
    s_waitcnt lgkmcnt(0)
    v_mfma_f32_16x16x32_bf16 v[240:243], v[32:35], v[44:47], v[240:243]
    s_barrier
    v_mfma_f32_16x16x32_bf16 v[184:187], v[36:39], v[60:63], v[184:187]
    ds_read_b64_tr_b16 v[20:21], v1 offset:18560
    ds_read_b64_tr_b16 v[22:23], v1 offset:20864
    v_mfma_f32_16x16x32_bf16 v[224:227], v[40:43], v[60:63], v[224:227]
    ds_read_b128 v[56:59], v5 offset:10240
    ds_read_b64_tr_b16 v[24:25], v2 offset:18848
    v_mfma_f32_16x16x32_bf16 v[176:179], v[36:39], v[64:67], v[176:179]
    ds_read_b64_tr_b16 v[26:27], v2 offset:21152
    v_mfma_f32_16x16x32_bf16 v[216:219], v[40:43], v[64:67], v[216:219]
    ds_read_b128 v[60:63], v5 offset:11264
    v_mfma_f32_16x16x32_bf16 v[168:171], v[36:39], v[44:47], v[168:171]
    ds_read_b128 v[64:67], v5 offset:12288
    v_mfma_f32_16x16x32_bf16 v[208:211], v[40:43], v[44:47], v[208:211]
    ds_read_b128 v[44:47], v5 offset:13312
    v_mfma_f32_16x16x32_bf16 v[160:163], v[36:39], v[48:51], v[160:163]
    v_mfma_f32_16x16x32_bf16 v[200:203], v[40:43], v[48:51], v[200:203]
    ds_read_b128 v[48:51], v5 offset:14336
    v_mfma_f32_16x16x32_bf16 v[152:155], v[36:39], v[52:55], v[152:155]
    v_mfma_f32_16x16x32_bf16 v[192:195], v[40:43], v[52:55], v[192:195]
    s_waitcnt lgkmcnt(1)
    v_mfma_f32_16x16x32_bf16 v[108:111], v[20:23], v[56:59], v[108:111]
    ds_read_b64_tr_b16 v[28:29], v1 offset:18688
    v_mfma_f32_16x16x32_bf16 v[148:151], v[24:27], v[56:59], v[148:151]
    ds_read_b64_tr_b16 v[30:31], v1 offset:20992
    v_mfma_f32_16x16x32_bf16 v[100:103], v[20:23], v[60:63], v[100:103]
    ds_read_b64_tr_b16 v[32:33], v2 offset:18976
    v_mfma_f32_16x16x32_bf16 v[140:143], v[24:27], v[60:63], v[140:143]
    ds_read_b64_tr_b16 v[34:35], v2 offset:21280
    v_mfma_f32_16x16x32_bf16 v[92:95], v[20:23], v[64:67], v[92:95]
    ds_read_b64_tr_b16 v[36:37], v2 offset:18592
    v_mfma_f32_16x16x32_bf16 v[132:135], v[24:27], v[64:67], v[132:135]
    ds_read_b64_tr_b16 v[38:39], v2 offset:20896
    v_mfma_f32_16x16x32_bf16 v[84:87], v[20:23], v[44:47], v[84:87]
    ds_read_b64_tr_b16 v[40:41], v1 offset:18880
    v_mfma_f32_16x16x32_bf16 v[124:127], v[24:27], v[44:47], v[124:127]
    ds_read_b64_tr_b16 v[42:43], v1 offset:21184
    s_waitcnt lgkmcnt(4)
    v_mfma_f32_16x16x32_bf16 v[76:79], v[20:23], v[48:51], v[76:79]
    v_mfma_f32_16x16x32_bf16 v[116:119], v[24:27], v[48:51], v[116:119]
    v_mfma_f32_16x16x32_bf16 v[236:239], v[28:31], v[64:67], v[236:239]
    s_waitcnt lgkmcnt(0)
    v_mfma_f32_16x16x32_bf16 v[244:247], v[32:35], v[64:67], v[244:247]
    s_barrier
    v_mfma_f32_16x16x32_bf16 v[188:191], v[36:39], v[56:59], v[188:191]
    ds_read_b64_tr_b16 v[20:21], v1 offset:36992
    v_mfma_f32_16x16x32_bf16 v[228:231], v[40:43], v[56:59], v[228:231]
    ds_read_b64_tr_b16 v[22:23], v1 offset:39296
    v_mfma_f32_16x16x32_bf16 v[180:183], v[36:39], v[60:63], v[180:183]
    ds_read_b64_tr_b16 v[24:25], v2 offset:37280
    v_mfma_f32_16x16x32_bf16 v[220:223], v[40:43], v[60:63], v[220:223]
    ds_read_b64_tr_b16 v[26:27], v2 offset:39584
    v_mfma_f32_16x16x32_bf16 v[172:175], v[36:39], v[64:67], v[172:175]
    ds_read_b128 v[52:55], v5 offset:15360
    v_mfma_f32_16x16x32_bf16 v[212:215], v[40:43], v[64:67], v[212:215]
    v_mfma_f32_16x16x32_bf16 v[164:167], v[36:39], v[44:47], v[164:167]
    v_mfma_f32_16x16x32_bf16 v[204:207], v[40:43], v[44:47], v[204:207]
    v_mfma_f32_16x16x32_bf16 v[156:159], v[36:39], v[48:51], v[156:159]
    v_mfma_f32_16x16x32_bf16 v[196:199], v[40:43], v[48:51], v[196:199]
    s_waitcnt lgkmcnt(0)
    v_mfma_f32_16x16x32_bf16 v[108:111], v[20:23], v[60:63], v[108:111]
    ds_read_b64_tr_b16 v[28:29], v1 offset:37120
    v_mfma_f32_16x16x32_bf16 v[148:151], v[24:27], v[60:63], v[148:151]
    ds_read_b64_tr_b16 v[30:31], v1 offset:39424
    v_mfma_f32_16x16x32_bf16 v[100:103], v[20:23], v[64:67], v[100:103]
    ds_read_b64_tr_b16 v[32:33], v2 offset:37408
    v_mfma_f32_16x16x32_bf16 v[140:143], v[24:27], v[64:67], v[140:143]
    ds_read_b64_tr_b16 v[34:35], v2 offset:39712
    v_mfma_f32_16x16x32_bf16 v[92:95], v[20:23], v[44:47], v[92:95]
    ds_read_b64_tr_b16 v[36:37], v2 offset:37024
    v_mfma_f32_16x16x32_bf16 v[132:135], v[24:27], v[44:47], v[132:135]
    ds_read_b64_tr_b16 v[38:39], v2 offset:39328
    v_mfma_f32_16x16x32_bf16 v[84:87], v[20:23], v[48:51], v[84:87]
    ds_read_b64_tr_b16 v[40:41], v1 offset:37312
    v_mfma_f32_16x16x32_bf16 v[124:127], v[24:27], v[48:51], v[124:127]
    ds_read_b64_tr_b16 v[42:43], v1 offset:39616
    v_mfma_f32_16x16x32_bf16 v[76:79], v[20:23], v[52:55], v[76:79]
    v_mfma_f32_16x16x32_bf16 v[116:119], v[24:27], v[52:55], v[116:119]
    s_waitcnt lgkmcnt(2)
    v_mfma_f32_16x16x32_bf16 v[236:239], v[28:31], v[44:47], v[236:239]
    s_waitcnt lgkmcnt(0)
    v_mfma_f32_16x16x32_bf16 v[244:247], v[32:35], v[44:47], v[244:247]
    s_barrier
    v_mfma_f32_16x16x32_bf16 v[188:191], v[36:39], v[60:63], v[188:191]
    ds_read_b64_tr_b16 v[20:21], v3 offset:128
    v_mfma_f32_16x16x32_bf16 v[228:231], v[40:43], v[60:63], v[228:231]
    ds_read_b64_tr_b16 v[22:23], v3 offset:2432
    v_mfma_f32_16x16x32_bf16 v[180:183], v[36:39], v[64:67], v[180:183]
    ds_read_b64_tr_b16 v[24:25], v4 offset:416
    v_mfma_f32_16x16x32_bf16 v[220:223], v[40:43], v[64:67], v[220:223]
    ds_read_b64_tr_b16 v[26:27], v4 offset:2720
    v_mfma_f32_16x16x32_bf16 v[172:175], v[36:39], v[44:47], v[172:175]
    ds_read_b128 v[56:59], v5 offset:16384
    v_mfma_f32_16x16x32_bf16 v[212:215], v[40:43], v[44:47], v[212:215]
    v_mfma_f32_16x16x32_bf16 v[164:167], v[36:39], v[48:51], v[164:167]
    v_mfma_f32_16x16x32_bf16 v[204:207], v[40:43], v[48:51], v[204:207]
    v_mfma_f32_16x16x32_bf16 v[156:159], v[36:39], v[52:55], v[156:159]
    v_mfma_f32_16x16x32_bf16 v[196:199], v[40:43], v[52:55], v[196:199]
    s_waitcnt lgkmcnt(0)
    v_mfma_f32_16x16x32_bf16 v[108:111], v[20:23], v[64:67], v[108:111]
    ds_read_b64_tr_b16 v[28:29], v3 offset:256
    v_mfma_f32_16x16x32_bf16 v[148:151], v[24:27], v[64:67], v[148:151]
    ds_read_b64_tr_b16 v[30:31], v3 offset:2560
    v_mfma_f32_16x16x32_bf16 v[100:103], v[20:23], v[44:47], v[100:103]
    ds_read_b64_tr_b16 v[32:33], v4 offset:544
    v_mfma_f32_16x16x32_bf16 v[140:143], v[24:27], v[44:47], v[140:143]
    ds_read_b64_tr_b16 v[34:35], v4 offset:2848
    v_mfma_f32_16x16x32_bf16 v[92:95], v[20:23], v[48:51], v[92:95]
    ds_read_b64_tr_b16 v[36:37], v4 offset:160
    v_mfma_f32_16x16x32_bf16 v[132:135], v[24:27], v[48:51], v[132:135]
    ds_read_b64_tr_b16 v[38:39], v4 offset:2464
    v_mfma_f32_16x16x32_bf16 v[84:87], v[20:23], v[52:55], v[84:87]
    ds_read_b64_tr_b16 v[40:41], v3 offset:448
    v_mfma_f32_16x16x32_bf16 v[124:127], v[24:27], v[52:55], v[124:127]
    ds_read_b64_tr_b16 v[42:43], v3 offset:2752
    v_mfma_f32_16x16x32_bf16 v[76:79], v[20:23], v[56:59], v[76:79]
    v_mfma_f32_16x16x32_bf16 v[116:119], v[24:27], v[56:59], v[116:119]
    s_waitcnt lgkmcnt(2)
    v_mfma_f32_16x16x32_bf16 v[236:239], v[28:31], v[48:51], v[236:239]
    s_waitcnt lgkmcnt(0)
    v_mfma_f32_16x16x32_bf16 v[244:247], v[32:35], v[48:51], v[244:247]
    s_barrier
    v_mfma_f32_16x16x32_bf16 v[188:191], v[36:39], v[64:67], v[188:191]
    ds_read_b64_tr_b16 v[20:21], v3 offset:18560
    v_mfma_f32_16x16x32_bf16 v[228:231], v[40:43], v[64:67], v[228:231]
    ds_read_b64_tr_b16 v[22:23], v3 offset:20864
    v_mfma_f32_16x16x32_bf16 v[180:183], v[36:39], v[44:47], v[180:183]
    ds_read_b64_tr_b16 v[24:25], v4 offset:18848
    v_mfma_f32_16x16x32_bf16 v[220:223], v[40:43], v[44:47], v[220:223]
    ds_read_b64_tr_b16 v[26:27], v4 offset:21152
    v_mfma_f32_16x16x32_bf16 v[172:175], v[36:39], v[48:51], v[172:175]
    ds_read_b128 v[60:63], v5 offset:17408
    v_mfma_f32_16x16x32_bf16 v[212:215], v[40:43], v[48:51], v[212:215]
    v_mfma_f32_16x16x32_bf16 v[164:167], v[36:39], v[52:55], v[164:167]
    v_mfma_f32_16x16x32_bf16 v[204:207], v[40:43], v[52:55], v[204:207]
    v_mfma_f32_16x16x32_bf16 v[156:159], v[36:39], v[56:59], v[156:159]
    v_mfma_f32_16x16x32_bf16 v[196:199], v[40:43], v[56:59], v[196:199]
    s_waitcnt lgkmcnt(0)
    v_mfma_f32_16x16x32_bf16 v[108:111], v[20:23], v[44:47], v[108:111]
    ds_read_b64_tr_b16 v[28:29], v3 offset:18688
    v_mfma_f32_16x16x32_bf16 v[148:151], v[24:27], v[44:47], v[148:151]
    ds_read_b64_tr_b16 v[30:31], v3 offset:20992
    v_mfma_f32_16x16x32_bf16 v[100:103], v[20:23], v[48:51], v[100:103]
    ds_read_b64_tr_b16 v[32:33], v4 offset:18976
    v_mfma_f32_16x16x32_bf16 v[140:143], v[24:27], v[48:51], v[140:143]
    ds_read_b64_tr_b16 v[34:35], v4 offset:21280
    v_mfma_f32_16x16x32_bf16 v[92:95], v[20:23], v[52:55], v[92:95]
    ds_read_b64_tr_b16 v[36:37], v4 offset:18592
    v_mfma_f32_16x16x32_bf16 v[132:135], v[24:27], v[52:55], v[132:135]
    ds_read_b64_tr_b16 v[38:39], v4 offset:20896
    v_mfma_f32_16x16x32_bf16 v[84:87], v[20:23], v[56:59], v[84:87]
    ds_read_b64_tr_b16 v[40:41], v3 offset:18880
    v_mfma_f32_16x16x32_bf16 v[124:127], v[24:27], v[56:59], v[124:127]
    ds_read_b64_tr_b16 v[42:43], v3 offset:21184
    v_mfma_f32_16x16x32_bf16 v[76:79], v[20:23], v[60:63], v[76:79]
    v_mfma_f32_16x16x32_bf16 v[116:119], v[24:27], v[60:63], v[116:119]
    s_waitcnt lgkmcnt(2)
    v_mfma_f32_16x16x32_bf16 v[236:239], v[28:31], v[52:55], v[236:239]
    s_waitcnt lgkmcnt(0)
    v_mfma_f32_16x16x32_bf16 v[244:247], v[32:35], v[52:55], v[244:247]
    s_barrier
    v_mfma_f32_16x16x32_bf16 v[188:191], v[36:39], v[44:47], v[188:191]
    ds_read_b64_tr_b16 v[20:21], v1 offset:128
    v_mfma_f32_16x16x32_bf16 v[228:231], v[40:43], v[44:47], v[228:231]
    ds_read_b64_tr_b16 v[22:23], v1 offset:2432
    v_mfma_f32_16x16x32_bf16 v[180:183], v[36:39], v[48:51], v[180:183]
    ds_read_b64_tr_b16 v[24:25], v2 offset:416
    v_mfma_f32_16x16x32_bf16 v[220:223], v[40:43], v[48:51], v[220:223]
    ds_read_b64_tr_b16 v[26:27], v2 offset:2720
    v_mfma_f32_16x16x32_bf16 v[172:175], v[36:39], v[52:55], v[172:175]
    ds_read_b128 v[64:67], v5 offset:18432
    v_mfma_f32_16x16x32_bf16 v[212:215], v[40:43], v[52:55], v[212:215]
    v_mfma_f32_16x16x32_bf16 v[164:167], v[36:39], v[56:59], v[164:167]
    v_mfma_f32_16x16x32_bf16 v[204:207], v[40:43], v[56:59], v[204:207]
    v_mfma_f32_16x16x32_bf16 v[156:159], v[36:39], v[60:63], v[156:159]
    v_mfma_f32_16x16x32_bf16 v[196:199], v[40:43], v[60:63], v[196:199]
    s_waitcnt lgkmcnt(0)
    v_mfma_f32_16x16x32_bf16 v[108:111], v[20:23], v[48:51], v[108:111]
    ds_read_b64_tr_b16 v[28:29], v1 offset:256
    v_mfma_f32_16x16x32_bf16 v[148:151], v[24:27], v[48:51], v[148:151]
    ds_read_b64_tr_b16 v[30:31], v1 offset:2560
    v_mfma_f32_16x16x32_bf16 v[100:103], v[20:23], v[52:55], v[100:103]
    ds_read_b64_tr_b16 v[32:33], v2 offset:544
    v_mfma_f32_16x16x32_bf16 v[140:143], v[24:27], v[52:55], v[140:143]
    ds_read_b64_tr_b16 v[34:35], v2 offset:2848
    v_mfma_f32_16x16x32_bf16 v[92:95], v[20:23], v[56:59], v[92:95]
    ds_read_b64_tr_b16 v[36:37], v2 offset:160
    v_mfma_f32_16x16x32_bf16 v[132:135], v[24:27], v[56:59], v[132:135]
    ds_read_b64_tr_b16 v[38:39], v2 offset:2464
    v_mfma_f32_16x16x32_bf16 v[84:87], v[20:23], v[60:63], v[84:87]
    ds_read_b64_tr_b16 v[40:41], v1 offset:448
    v_mfma_f32_16x16x32_bf16 v[124:127], v[24:27], v[60:63], v[124:127]
    ds_read_b64_tr_b16 v[42:43], v1 offset:2752
    v_mfma_f32_16x16x32_bf16 v[76:79], v[20:23], v[64:67], v[76:79]
    v_mfma_f32_16x16x32_bf16 v[116:119], v[24:27], v[64:67], v[116:119]
    s_waitcnt lgkmcnt(2)
    v_mfma_f32_16x16x32_bf16 v[236:239], v[28:31], v[56:59], v[236:239]
    s_waitcnt lgkmcnt(0)
    v_mfma_f32_16x16x32_bf16 v[244:247], v[32:35], v[56:59], v[244:247]
    s_barrier
    v_xor_b32 v5, 0xdc00, v5
    v_mfma_f32_16x16x32_bf16 v[188:191], v[36:39], v[48:51], v[188:191]
    ds_read_b64_tr_b16 v[20:21], v1 offset:18560
    ds_read_b64_tr_b16 v[22:23], v1 offset:20864
    v_mfma_f32_16x16x32_bf16 v[228:231], v[40:43], v[48:51], v[228:231]
    ds_read_b128 v[44:47], v5 offset:1024
    ds_read_b64_tr_b16 v[24:25], v2 offset:18848
    v_mfma_f32_16x16x32_bf16 v[180:183], v[36:39], v[52:55], v[180:183]
    ds_read_b64_tr_b16 v[26:27], v2 offset:21152
    ds_read_b128 v[48:51], v5 offset:2048
    v_mfma_f32_16x16x32_bf16 v[220:223], v[40:43], v[52:55], v[220:223]
    ds_read_b128 v[52:55], v5 offset:3072
    v_mfma_f32_16x16x32_bf16 v[172:175], v[36:39], v[56:59], v[172:175]
    v_mfma_f32_16x16x32_bf16 v[212:215], v[40:43], v[56:59], v[212:215]
    ds_read_b128 v[56:59], v5 offset:4096
    v_mfma_f32_16x16x32_bf16 v[164:167], v[36:39], v[60:63], v[164:167]
    s_add_u32 s40, s40, 1
    s_cmp_lt_u32 s40, 4
    v_mfma_f32_16x16x32_bf16 v[204:207], v[40:43], v[60:63], v[204:207]
    ds_read_b128 v[60:63], v5 offset:5120
    v_mfma_f32_16x16x32_bf16 v[156:159], v[36:39], v[64:67], v[156:159]
    v_mfma_f32_16x16x32_bf16 v[196:199], v[40:43], v[64:67], v[196:199]
    s_cbranch_scc1 L_c2_46
    s_waitcnt lgkmcnt(1)
    v_mfma_f32_16x16x32_bf16 v[104:107], v[20:23], v[44:47], v[104:107]
    ds_read_b64_tr_b16 v[28:29], v1 offset:18688
    v_mfma_f32_16x16x32_bf16 v[144:147], v[24:27], v[44:47], v[144:147]
    ds_read_b64_tr_b16 v[30:31], v1 offset:20992
    v_mfma_f32_16x16x32_bf16 v[96:99], v[20:23], v[48:51], v[96:99]
    ds_read_b64_tr_b16 v[32:33], v2 offset:18976
    v_mfma_f32_16x16x32_bf16 v[136:139], v[24:27], v[48:51], v[136:139]
    ds_read_b64_tr_b16 v[34:35], v2 offset:21280
    v_mfma_f32_16x16x32_bf16 v[88:91], v[20:23], v[52:55], v[88:91]
    ds_read_b64_tr_b16 v[36:37], v2 offset:18592
    v_mfma_f32_16x16x32_bf16 v[128:131], v[24:27], v[52:55], v[128:131]
    ds_read_b64_tr_b16 v[38:39], v2 offset:20896
    v_mfma_f32_16x16x32_bf16 v[80:83], v[20:23], v[56:59], v[80:83]
    ds_read_b64_tr_b16 v[40:41], v1 offset:18880
    v_mfma_f32_16x16x32_bf16 v[120:123], v[24:27], v[56:59], v[120:123]
    ds_read_b64_tr_b16 v[42:43], v1 offset:21184
    s_waitcnt lgkmcnt(4)
    v_mfma_f32_16x16x32_bf16 v[72:75], v[20:23], v[60:63], v[72:75]
    v_mfma_f32_16x16x32_bf16 v[112:115], v[24:27], v[60:63], v[112:115]
    v_mfma_f32_16x16x32_bf16 v[232:235], v[28:31], v[52:55], v[232:235]
    s_waitcnt lgkmcnt(0)
    v_mfma_f32_16x16x32_bf16 v[240:243], v[32:35], v[52:55], v[240:243]
    s_barrier
    v_mfma_f32_16x16x32_bf16 v[184:187], v[36:39], v[44:47], v[184:187]
    ds_read_b64_tr_b16 v[20:21], v1 offset:36992
    v_mfma_f32_16x16x32_bf16 v[224:227], v[40:43], v[44:47], v[224:227]
    ds_read_b64_tr_b16 v[22:23], v1 offset:39296
    v_mfma_f32_16x16x32_bf16 v[176:179], v[36:39], v[48:51], v[176:179]
    ds_read_b64_tr_b16 v[24:25], v2 offset:37280
    v_mfma_f32_16x16x32_bf16 v[216:219], v[40:43], v[48:51], v[216:219]
    ds_read_b64_tr_b16 v[26:27], v2 offset:39584
    v_mfma_f32_16x16x32_bf16 v[168:171], v[36:39], v[52:55], v[168:171]
    ds_read_b128 v[64:67], v5 offset:6144
    v_mfma_f32_16x16x32_bf16 v[208:211], v[40:43], v[52:55], v[208:211]
    ds_read_b128 v[68:71], v5 offset:7168
    v_mfma_f32_16x16x32_bf16 v[160:163], v[36:39], v[56:59], v[160:163]
    v_mfma_f32_16x16x32_bf16 v[200:203], v[40:43], v[56:59], v[200:203]
    v_mfma_f32_16x16x32_bf16 v[152:155], v[36:39], v[60:63], v[152:155]
    v_mfma_f32_16x16x32_bf16 v[192:195], v[40:43], v[60:63], v[192:195]
    s_waitcnt lgkmcnt(0)
    v_mfma_f32_16x16x32_bf16 v[104:107], v[20:23], v[52:55], v[104:107]
    ds_read_b64_tr_b16 v[28:29], v1 offset:37120
    v_mfma_f32_16x16x32_bf16 v[144:147], v[24:27], v[52:55], v[144:147]
    ds_read_b64_tr_b16 v[30:31], v1 offset:39424
    v_mfma_f32_16x16x32_bf16 v[96:99], v[20:23], v[56:59], v[96:99]
    ds_read_b64_tr_b16 v[32:33], v2 offset:37408
    v_mfma_f32_16x16x32_bf16 v[136:139], v[24:27], v[56:59], v[136:139]
    ds_read_b64_tr_b16 v[34:35], v2 offset:39712
    v_mfma_f32_16x16x32_bf16 v[88:91], v[20:23], v[60:63], v[88:91]
    ds_read_b64_tr_b16 v[36:37], v2 offset:37024
    v_mfma_f32_16x16x32_bf16 v[128:131], v[24:27], v[60:63], v[128:131]
    ds_read_b64_tr_b16 v[38:39], v2 offset:39328
    v_mfma_f32_16x16x32_bf16 v[80:83], v[20:23], v[64:67], v[80:83]
    ds_read_b64_tr_b16 v[40:41], v1 offset:37312
    v_mfma_f32_16x16x32_bf16 v[120:123], v[24:27], v[64:67], v[120:123]
    ds_read_b64_tr_b16 v[42:43], v1 offset:39616
    v_mfma_f32_16x16x32_bf16 v[72:75], v[20:23], v[68:71], v[72:75]
    v_mfma_f32_16x16x32_bf16 v[112:115], v[24:27], v[68:71], v[112:115]
    s_waitcnt lgkmcnt(2)
    v_mfma_f32_16x16x32_bf16 v[232:235], v[28:31], v[60:63], v[232:235]
    s_waitcnt lgkmcnt(0)
    v_mfma_f32_16x16x32_bf16 v[240:243], v[32:35], v[60:63], v[240:243]
    s_barrier
    v_mfma_f32_16x16x32_bf16 v[184:187], v[36:39], v[52:55], v[184:187]
    ds_read_b64_tr_b16 v[20:21], v18 offset:55424
    v_mfma_f32_16x16x32_bf16 v[224:227], v[40:43], v[52:55], v[224:227]
    ds_read_b64 v[44:45], v6 offset:5120
    v_mfma_f32_16x16x32_bf16 v[176:179], v[36:39], v[56:59], v[176:179]
    ds_read_b64_tr_b16 v[24:25], v19 offset:55712
    v_mfma_f32_16x16x32_bf16 v[216:219], v[40:43], v[56:59], v[216:219]
    ds_read_b64 v[48:49], v6 offset:6144
    v_mfma_f32_16x16x32_bf16 v[168:171], v[36:39], v[60:63], v[168:171]
    ds_read_b64 v[52:53], v6 offset:7168
    v_mfma_f32_16x16x32_bf16 v[208:211], v[40:43], v[60:63], v[208:211]
    ds_read_b64 v[56:57], v6 offset:8192
    v_mfma_f32_16x16x32_bf16 v[160:163], v[36:39], v[64:67], v[160:163]
    ds_read_b64 v[60:61], v6 offset:9216
    v_mfma_f32_16x16x32_bf16 v[200:203], v[40:43], v[64:67], v[200:203]
    v_mfma_f32_16x16x32_bf16 v[152:155], v[36:39], v[68:71], v[152:155]
    v_mfma_f32_16x16x32_bf16 v[192:195], v[40:43], v[68:71], v[192:195]
    s_waitcnt lgkmcnt(1)
    v_mfma_f32_16x16x16_bf16 v[104:107], v[20:21], v[44:45], v[104:107]
    ds_read_b64_tr_b16 v[28:29], v18 offset:55552
    v_mfma_f32_16x16x16_bf16 v[144:147], v[24:25], v[44:45], v[144:147]
    ds_read_b64_tr_b16 v[32:33], v19 offset:55840
    v_mfma_f32_16x16x16_bf16 v[96:99], v[20:21], v[48:49], v[96:99]
    ds_read_b64_tr_b16 v[36:37], v19 offset:55456
    v_mfma_f32_16x16x16_bf16 v[136:139], v[24:25], v[48:49], v[136:139]
    ds_read_b64_tr_b16 v[40:41], v18 offset:55744
    v_mfma_f32_16x16x16_bf16 v[88:91], v[20:21], v[52:53], v[88:91]
    v_mfma_f32_16x16x16_bf16 v[128:131], v[24:25], v[52:53], v[128:131]
    v_mfma_f32_16x16x16_bf16 v[80:83], v[20:21], v[56:57], v[80:83]
    v_mfma_f32_16x16x16_bf16 v[120:123], v[24:25], v[56:57], v[120:123]
    s_waitcnt lgkmcnt(0)
    v_mfma_f32_16x16x16_bf16 v[72:75], v[20:21], v[60:61], v[72:75]
    v_mfma_f32_16x16x16_bf16 v[112:115], v[24:25], v[60:61], v[112:115]
    v_mfma_f32_16x16x16_bf16 v[232:235], v[28:29], v[52:53], v[232:235]
    v_mfma_f32_16x16x16_bf16 v[240:243], v[32:33], v[52:53], v[240:243]
    s_barrier
    v_mfma_f32_16x16x16_bf16 v[184:187], v[36:37], v[44:45], v[184:187]
    ds_read_b64_tr_b16 v[20:21], v3 offset:18560
    ds_read_b64_tr_b16 v[22:23], v3 offset:20864
    v_mfma_f32_16x16x16_bf16 v[224:227], v[40:41], v[44:45], v[224:227]
    ds_read_b128 v[64:67], v5 offset:10240
    ds_read_b64_tr_b16 v[24:25], v4 offset:18848
    v_mfma_f32_16x16x16_bf16 v[176:179], v[36:37], v[48:49], v[176:179]
    ds_read_b64_tr_b16 v[26:27], v4 offset:21152
    v_mfma_f32_16x16x16_bf16 v[216:219], v[40:41], v[48:49], v[216:219]
    ds_read_b128 v[68:71], v5 offset:11264
    v_mfma_f32_16x16x16_bf16 v[168:171], v[36:37], v[52:53], v[168:171]
    ds_read_b128 v[44:47], v5 offset:12288
    v_mfma_f32_16x16x16_bf16 v[208:211], v[40:41], v[52:53], v[208:211]
    ds_read_b128 v[48:51], v5 offset:13312
    v_mfma_f32_16x16x16_bf16 v[160:163], v[36:37], v[56:57], v[160:163]
    ds_read_b128 v[52:55], v5 offset:14336
    v_mfma_f32_16x16x16_bf16 v[200:203], v[40:41], v[56:57], v[200:203]
    v_mfma_f32_16x16x16_bf16 v[152:155], v[36:37], v[60:61], v[152:155]
    v_mfma_f32_16x16x16_bf16 v[192:195], v[40:41], v[60:61], v[192:195]
    s_waitcnt lgkmcnt(1)
    v_mfma_f32_16x16x32_bf16 v[108:111], v[20:23], v[64:67], v[108:111]
    ds_read_b64_tr_b16 v[28:29], v3 offset:18688
    v_fma_f32 v232, s50, v232, v7
    v_mfma_f32_16x16x32_bf16 v[148:151], v[24:27], v[64:67], v[148:151]
    ds_read_b64_tr_b16 v[30:31], v3 offset:20992
    v_fma_f32 v233, s50, v233, v7
    v_mfma_f32_16x16x32_bf16 v[100:103], v[20:23], v[68:71], v[100:103]
    ds_read_b64_tr_b16 v[32:33], v4 offset:18976
    v_fma_f32 v234, s50, v234, v7
    v_mfma_f32_16x16x32_bf16 v[140:143], v[24:27], v[68:71], v[140:143]
    ds_read_b64_tr_b16 v[34:35], v4 offset:21280
    v_fma_f32 v235, s50, v235, v7
    v_mfma_f32_16x16x32_bf16 v[92:95], v[20:23], v[44:47], v[92:95]
    ds_read_b64_tr_b16 v[36:37], v4 offset:18592
    v_mul_f32 v240, s52, v240
    v_mfma_f32_16x16x32_bf16 v[132:135], v[24:27], v[44:47], v[132:135]
    ds_read_b64_tr_b16 v[38:39], v4 offset:20896
    v_mul_f32 v241, s52, v241
    v_mfma_f32_16x16x32_bf16 v[84:87], v[20:23], v[48:51], v[84:87]
    ds_read_b64_tr_b16 v[40:41], v3 offset:18880
    v_mul_f32 v242, s52, v242
    v_mfma_f32_16x16x32_bf16 v[124:127], v[24:27], v[48:51], v[124:127]
    ds_read_b64_tr_b16 v[42:43], v3 offset:21184
    s_waitcnt lgkmcnt(4)
    v_mfma_f32_16x16x32_bf16 v[76:79], v[20:23], v[52:55], v[76:79]
    v_mul_f32 v243, s52, v243
    v_fma_f32 v72, s50, v72, v7
    v_mfma_f32_16x16x32_bf16 v[116:119], v[24:27], v[52:55], v[116:119]
    v_fma_f32 v73, s50, v73, v7
    v_fma_f32 v74, s50, v74, v7
    v_mfma_f32_16x16x32_bf16 v[236:239], v[28:31], v[44:47], v[236:239]
    v_fma_f32 v75, s50, v75, v7
    s_waitcnt lgkmcnt(0)
    v_mfma_f32_16x16x32_bf16 v[244:247], v[32:35], v[44:47], v[244:247]
    v_mul_f32 v112, s52, v112
    s_barrier
    v_mfma_f32_16x16x32_bf16 v[188:191], v[36:39], v[64:67], v[188:191]
    ds_read_b64_tr_b16 v[20:21], v1 offset:128
    v_mul_f32 v113, s52, v113
    v_mfma_f32_16x16x32_bf16 v[228:231], v[40:43], v[64:67], v[228:231]
    ds_read_b64_tr_b16 v[22:23], v1 offset:2432
    v_mul_f32 v114, s52, v114
    v_mfma_f32_16x16x32_bf16 v[180:183], v[36:39], v[68:71], v[180:183]
    ds_read_b64_tr_b16 v[24:25], v2 offset:416
    v_mul_f32 v115, s52, v115
    v_mfma_f32_16x16x32_bf16 v[220:223], v[40:43], v[68:71], v[220:223]
    ds_read_b64_tr_b16 v[26:27], v2 offset:2720
    v_fma_f32 v80, s50, v80, v7
    v_mfma_f32_16x16x32_bf16 v[172:175], v[36:39], v[44:47], v[172:175]
    ds_read_b128 v[56:59], v5 offset:15360
    v_fma_f32 v81, s50, v81, v7
    v_mfma_f32_16x16x32_bf16 v[212:215], v[40:43], v[44:47], v[212:215]
    ds_read_b128 v[60:63], v5 offset:16384
    v_fma_f32 v82, s50, v82, v7
    v_mfma_f32_16x16x32_bf16 v[164:167], v[36:39], v[48:51], v[164:167]
    v_fma_f32 v83, s50, v83, v7
    v_mul_f32 v120, s52, v120
    v_mfma_f32_16x16x32_bf16 v[204:207], v[40:43], v[48:51], v[204:207]
    v_mul_f32 v121, s52, v121
    v_mul_f32 v122, s52, v122
    v_mfma_f32_16x16x32_bf16 v[156:159], v[36:39], v[52:55], v[156:159]
    v_mul_f32 v123, s52, v123
    v_fma_f32 v88, s50, v88, v7
    v_mfma_f32_16x16x32_bf16 v[196:199], v[40:43], v[52:55], v[196:199]
    v_fma_f32 v89, s50, v89, v7
    s_waitcnt lgkmcnt(0)
    v_mfma_f32_16x16x32_bf16 v[108:111], v[20:23], v[44:47], v[108:111]
    ds_read_b64_tr_b16 v[28:29], v1 offset:256
    v_fma_f32 v90, s50, v90, v7
    v_mfma_f32_16x16x32_bf16 v[148:151], v[24:27], v[44:47], v[148:151]
    ds_read_b64_tr_b16 v[30:31], v1 offset:2560
    v_fma_f32 v91, s50, v91, v7
    v_mfma_f32_16x16x32_bf16 v[100:103], v[20:23], v[48:51], v[100:103]
    ds_read_b64_tr_b16 v[32:33], v2 offset:544
    v_mul_f32 v128, s52, v128
    v_mfma_f32_16x16x32_bf16 v[140:143], v[24:27], v[48:51], v[140:143]
    ds_read_b64_tr_b16 v[34:35], v2 offset:2848
    v_mul_f32 v129, s52, v129
    v_mfma_f32_16x16x32_bf16 v[92:95], v[20:23], v[52:55], v[92:95]
    ds_read_b64_tr_b16 v[36:37], v2 offset:160
    v_mul_f32 v130, s52, v130
    v_mfma_f32_16x16x32_bf16 v[132:135], v[24:27], v[52:55], v[132:135]
    ds_read_b64_tr_b16 v[38:39], v2 offset:2464
    v_mul_f32 v131, s52, v131
    v_mfma_f32_16x16x32_bf16 v[84:87], v[20:23], v[56:59], v[84:87]
    ds_read_b64_tr_b16 v[40:41], v1 offset:448
    v_fma_f32 v96, s50, v96, v7
    v_mfma_f32_16x16x32_bf16 v[124:127], v[24:27], v[56:59], v[124:127]
    ds_read_b64_tr_b16 v[42:43], v1 offset:2752
    v_fma_f32 v97, s50, v97, v7
    v_mfma_f32_16x16x32_bf16 v[76:79], v[20:23], v[60:63], v[76:79]
    v_fma_f32 v98, s50, v98, v7
    v_fma_f32 v99, s50, v99, v7
    v_mfma_f32_16x16x32_bf16 v[116:119], v[24:27], v[60:63], v[116:119]
    v_mul_f32 v136, s52, v136
    s_waitcnt lgkmcnt(2)
    v_mfma_f32_16x16x32_bf16 v[236:239], v[28:31], v[52:55], v[236:239]
    v_mul_f32 v137, s52, v137
    s_waitcnt lgkmcnt(0)
    v_mfma_f32_16x16x32_bf16 v[244:247], v[32:35], v[52:55], v[244:247]
    v_mul_f32 v138, s52, v138
    s_barrier
    v_mfma_f32_16x16x32_bf16 v[188:191], v[36:39], v[44:47], v[188:191]
    ds_read_b64_tr_b16 v[20:21], v18 offset:18560
    v_mul_f32 v139, s52, v139
    v_mfma_f32_16x16x32_bf16 v[228:231], v[40:43], v[44:47], v[228:231]
    ds_read_b64 v[64:65], v6 offset:14336
    v_fma_f32 v104, s50, v104, v7
    v_mfma_f32_16x16x32_bf16 v[180:183], v[36:39], v[48:51], v[180:183]
    ds_read_b64_tr_b16 v[24:25], v19 offset:18848
    v_fma_f32 v105, s50, v105, v7
    v_mfma_f32_16x16x32_bf16 v[220:223], v[40:43], v[48:51], v[220:223]
    ds_read_b64 v[68:69], v6 offset:15360
    v_fma_f32 v106, s50, v106, v7
    v_mfma_f32_16x16x32_bf16 v[172:175], v[36:39], v[52:55], v[172:175]
    ds_read_b64 v[44:45], v6 offset:16384
    v_fma_f32 v107, s50, v107, v7
    v_mfma_f32_16x16x32_bf16 v[212:215], v[40:43], v[52:55], v[212:215]
    ds_read_b64 v[48:49], v6 offset:17408
    v_mul_f32 v144, s52, v144
    v_mfma_f32_16x16x32_bf16 v[164:167], v[36:39], v[56:59], v[164:167]
    ds_read_b64 v[52:53], v6 offset:18432
    v_mul_f32 v145, s52, v145
    v_mfma_f32_16x16x32_bf16 v[204:207], v[40:43], v[56:59], v[204:207]
    v_mul_f32 v146, s52, v146
    v_mul_f32 v147, s52, v147
    v_mfma_f32_16x16x32_bf16 v[156:159], v[36:39], v[60:63], v[156:159]
    v_fma_f32 v152, s50, v152, v7
    v_fma_f32 v153, s50, v153, v7
    v_mfma_f32_16x16x32_bf16 v[196:199], v[40:43], v[60:63], v[196:199]
    v_fma_f32 v154, s50, v154, v7
    s_waitcnt lgkmcnt(1)
    v_mfma_f32_16x16x16_bf16 v[108:111], v[20:21], v[64:65], v[108:111]
    ds_read_b64_tr_b16 v[28:29], v18 offset:18688
    v_fma_f32 v155, s50, v155, v7
    v_mfma_f32_16x16x16_bf16 v[148:151], v[24:25], v[64:65], v[148:151]
    ds_read_b64_tr_b16 v[32:33], v19 offset:18976
    v_mul_f32 v192, s52, v192
    v_mfma_f32_16x16x16_bf16 v[100:103], v[20:21], v[68:69], v[100:103]
    ds_read_b64_tr_b16 v[36:37], v19 offset:18592
    v_mul_f32 v193, s52, v193
    v_mfma_f32_16x16x16_bf16 v[140:143], v[24:25], v[68:69], v[140:143]
    ds_read_b64_tr_b16 v[40:41], v18 offset:18880
    v_mul_f32 v194, s52, v194
    v_mfma_f32_16x16x16_bf16 v[92:95], v[20:21], v[44:45], v[92:95]
    v_mul_f32 v195, s52, v195
    v_fma_f32 v160, s50, v160, v7
    v_mfma_f32_16x16x16_bf16 v[132:135], v[24:25], v[44:45], v[132:135]
    v_fma_f32 v161, s50, v161, v7
    v_fma_f32 v162, s50, v162, v7
    v_mfma_f32_16x16x16_bf16 v[84:87], v[20:21], v[48:49], v[84:87]
    v_fma_f32 v163, s50, v163, v7
    v_mul_f32 v200, s52, v200
    v_mfma_f32_16x16x16_bf16 v[124:127], v[24:25], v[48:49], v[124:127]
    v_mul_f32 v201, s52, v201
    s_waitcnt lgkmcnt(0)
    v_mfma_f32_16x16x16_bf16 v[76:79], v[20:21], v[52:53], v[76:79]
    v_mul_f32 v202, s52, v202
    v_mul_f32 v203, s52, v203
    v_mfma_f32_16x16x16_bf16 v[116:119], v[24:25], v[52:53], v[116:119]
    v_fma_f32 v168, s50, v168, v7
    v_fma_f32 v169, s50, v169, v7
    v_mfma_f32_16x16x16_bf16 v[236:239], v[28:29], v[44:45], v[236:239]
    v_fma_f32 v170, s50, v170, v7
    v_fma_f32 v171, s50, v171, v7
    v_mfma_f32_16x16x16_bf16 v[244:247], v[32:33], v[44:45], v[244:247]
    v_mul_f32 v208, s52, v208
    s_barrier
    v_mfma_f32_16x16x16_bf16 v[188:191], v[36:37], v[64:65], v[188:191]
    v_mul_f32 v209, s52, v209
    v_mul_f32 v210, s52, v210
    v_mfma_f32_16x16x16_bf16 v[228:231], v[40:41], v[64:65], v[228:231]
    v_mul_f32 v211, s52, v211
    v_fma_f32 v176, s50, v176, v7
    v_mfma_f32_16x16x16_bf16 v[180:183], v[36:37], v[68:69], v[180:183]
    v_fma_f32 v177, s50, v177, v7
    v_fma_f32 v178, s50, v178, v7
    v_mfma_f32_16x16x16_bf16 v[220:223], v[40:41], v[68:69], v[220:223]
    v_fma_f32 v179, s50, v179, v7
    v_mul_f32 v216, s52, v216
    v_mfma_f32_16x16x16_bf16 v[172:175], v[36:37], v[44:45], v[172:175]
    v_mul_f32 v217, s52, v217
    v_mul_f32 v218, s52, v218
    v_mfma_f32_16x16x16_bf16 v[212:215], v[40:41], v[44:45], v[212:215]
    v_mul_f32 v219, s52, v219
    v_fma_f32 v184, s50, v184, v7
    v_mfma_f32_16x16x16_bf16 v[164:167], v[36:37], v[48:49], v[164:167]
    v_fma_f32 v185, s50, v185, v7
    v_fma_f32 v186, s50, v186, v7
    v_mfma_f32_16x16x16_bf16 v[204:207], v[40:41], v[48:49], v[204:207]
    v_fma_f32 v187, s50, v187, v7
    v_mul_f32 v224, s52, v224
    v_mfma_f32_16x16x16_bf16 v[156:159], v[36:37], v[52:53], v[156:159]
    v_mul_f32 v225, s52, v225
    v_mul_f32 v226, s52, v226
    v_mfma_f32_16x16x16_bf16 v[196:199], v[40:41], v[52:53], v[196:199]
    v_mul_f32 v227, s52, v227
    s_branch L_cepi
.p2align 6
L_cw3:
    s_barrier
    ds_read_b64_tr_b16 v[20:21], v1 offset:192
    ds_read_b64_tr_b16 v[22:23], v1 offset:2496
    ds_read_b64_tr_b16 v[24:25], v2 offset:480
    ds_read_b64_tr_b16 v[26:27], v2 offset:2784
    ds_read_b128 v[44:47], v5 offset:1024
    ds_read_b128 v[48:51], v5 offset:2048
    ds_read_b128 v[52:55], v5 offset:3072
    ds_read_b128 v[56:59], v5 offset:4096
    ds_read_b128 v[60:63], v5 offset:5120
    s_waitcnt lgkmcnt(0)
    s_mov_b32 s40, 0
.p2align 3
L_c3_0:
    s_waitcnt lgkmcnt(0)
    v_mfma_f32_16x16x32_bf16 v[108:111], v[20:23], v[44:47], v[108:111]
    ds_read_b64_tr_b16 v[28:29], v1 offset:256
    v_mfma_f32_16x16x32_bf16 v[148:151], v[24:27], v[44:47], v[148:151]
    ds_read_b64_tr_b16 v[30:31], v1 offset:2560
    v_mfma_f32_16x16x32_bf16 v[100:103], v[20:23], v[48:51], v[100:103]
    ds_read_b64_tr_b16 v[32:33], v2 offset:544
    v_mfma_f32_16x16x32_bf16 v[140:143], v[24:27], v[48:51], v[140:143]
    ds_read_b64_tr_b16 v[34:35], v2 offset:2848
    v_mfma_f32_16x16x32_bf16 v[92:95], v[20:23], v[52:55], v[92:95]
    ds_read_b64_tr_b16 v[36:37], v2 offset:224
    v_mfma_f32_16x16x32_bf16 v[132:135], v[24:27], v[52:55], v[132:135]
    ds_read_b64_tr_b16 v[38:39], v2 offset:2528
    v_mfma_f32_16x16x32_bf16 v[84:87], v[20:23], v[56:59], v[84:87]
    ds_read_b64_tr_b16 v[40:41], v1 offset:512
    v_mfma_f32_16x16x32_bf16 v[124:127], v[24:27], v[56:59], v[124:127]
    ds_read_b64_tr_b16 v[42:43], v1 offset:2816
    v_mfma_f32_16x16x32_bf16 v[76:79], v[20:23], v[60:63], v[76:79]
    v_mfma_f32_16x16x32_bf16 v[116:119], v[24:27], v[60:63], v[116:119]
    s_waitcnt lgkmcnt(2)
    v_mfma_f32_16x16x32_bf16 v[236:239], v[28:31], v[48:51], v[236:239]
    s_waitcnt lgkmcnt(0)
    v_mfma_f32_16x16x32_bf16 v[244:247], v[32:35], v[48:51], v[244:247]
    s_barrier
    v_mfma_f32_16x16x32_bf16 v[188:191], v[36:39], v[44:47], v[188:191]
    ds_read_b64_tr_b16 v[20:21], v1 offset:18624
    v_mfma_f32_16x16x32_bf16 v[228:231], v[40:43], v[44:47], v[228:231]
    ds_read_b64_tr_b16 v[22:23], v1 offset:20928
    v_mfma_f32_16x16x32_bf16 v[180:183], v[36:39], v[48:51], v[180:183]
    ds_read_b64_tr_b16 v[24:25], v2 offset:18912
    v_mfma_f32_16x16x32_bf16 v[220:223], v[40:43], v[48:51], v[220:223]
    ds_read_b64_tr_b16 v[26:27], v2 offset:21216
    v_mfma_f32_16x16x32_bf16 v[172:175], v[36:39], v[52:55], v[172:175]
    ds_read_b128 v[64:67], v5 offset:6144
    v_mfma_f32_16x16x32_bf16 v[212:215], v[40:43], v[52:55], v[212:215]
    v_mfma_f32_16x16x32_bf16 v[164:167], v[36:39], v[56:59], v[164:167]
    v_mfma_f32_16x16x32_bf16 v[204:207], v[40:43], v[56:59], v[204:207]
    v_mfma_f32_16x16x32_bf16 v[156:159], v[36:39], v[60:63], v[156:159]
    v_mfma_f32_16x16x32_bf16 v[196:199], v[40:43], v[60:63], v[196:199]
    s_waitcnt lgkmcnt(0)
    v_mfma_f32_16x16x32_bf16 v[108:111], v[20:23], v[48:51], v[108:111]
    ds_read_b64_tr_b16 v[28:29], v1 offset:18688
    v_mfma_f32_16x16x32_bf16 v[148:151], v[24:27], v[48:51], v[148:151]
    ds_read_b64_tr_b16 v[30:31], v1 offset:20992
    v_mfma_f32_16x16x32_bf16 v[100:103], v[20:23], v[52:55], v[100:103]
    ds_read_b64_tr_b16 v[32:33], v2 offset:18976
    v_mfma_f32_16x16x32_bf16 v[140:143], v[24:27], v[52:55], v[140:143]
    ds_read_b64_tr_b16 v[34:35], v2 offset:21280
    v_mfma_f32_16x16x32_bf16 v[92:95], v[20:23], v[56:59], v[92:95]
    ds_read_b64_tr_b16 v[36:37], v2 offset:18656
    v_mfma_f32_16x16x32_bf16 v[132:135], v[24:27], v[56:59], v[132:135]
    ds_read_b64_tr_b16 v[38:39], v2 offset:20960
    v_mfma_f32_16x16x32_bf16 v[84:87], v[20:23], v[60:63], v[84:87]
    ds_read_b64_tr_b16 v[40:41], v1 offset:18944
    v_mfma_f32_16x16x32_bf16 v[124:127], v[24:27], v[60:63], v[124:127]
    ds_read_b64_tr_b16 v[42:43], v1 offset:21248
    v_mfma_f32_16x16x32_bf16 v[76:79], v[20:23], v[64:67], v[76:79]
    v_mfma_f32_16x16x32_bf16 v[116:119], v[24:27], v[64:67], v[116:119]
    s_waitcnt lgkmcnt(2)
    v_mfma_f32_16x16x32_bf16 v[236:239], v[28:31], v[52:55], v[236:239]
    s_waitcnt lgkmcnt(0)
    v_mfma_f32_16x16x32_bf16 v[244:247], v[32:35], v[52:55], v[244:247]
    s_barrier
    v_mfma_f32_16x16x32_bf16 v[188:191], v[36:39], v[48:51], v[188:191]
    ds_read_b64_tr_b16 v[20:21], v1 offset:37056
    v_mfma_f32_16x16x32_bf16 v[228:231], v[40:43], v[48:51], v[228:231]
    ds_read_b64_tr_b16 v[22:23], v1 offset:39360
    v_mfma_f32_16x16x32_bf16 v[180:183], v[36:39], v[52:55], v[180:183]
    ds_read_b64_tr_b16 v[24:25], v2 offset:37344
    v_mfma_f32_16x16x32_bf16 v[220:223], v[40:43], v[52:55], v[220:223]
    ds_read_b64_tr_b16 v[26:27], v2 offset:39648
    v_mfma_f32_16x16x32_bf16 v[172:175], v[36:39], v[56:59], v[172:175]
    ds_read_b128 v[68:71], v5 offset:7168
    v_mfma_f32_16x16x32_bf16 v[212:215], v[40:43], v[56:59], v[212:215]
    v_mfma_f32_16x16x32_bf16 v[164:167], v[36:39], v[60:63], v[164:167]
    v_mfma_f32_16x16x32_bf16 v[204:207], v[40:43], v[60:63], v[204:207]
    v_mfma_f32_16x16x32_bf16 v[156:159], v[36:39], v[64:67], v[156:159]
    v_mfma_f32_16x16x32_bf16 v[196:199], v[40:43], v[64:67], v[196:199]
    s_waitcnt lgkmcnt(0)
    v_mfma_f32_16x16x32_bf16 v[108:111], v[20:23], v[52:55], v[108:111]
    ds_read_b64_tr_b16 v[28:29], v1 offset:37120
    v_mfma_f32_16x16x32_bf16 v[148:151], v[24:27], v[52:55], v[148:151]
    ds_read_b64_tr_b16 v[30:31], v1 offset:39424
    v_mfma_f32_16x16x32_bf16 v[100:103], v[20:23], v[56:59], v[100:103]
    ds_read_b64_tr_b16 v[32:33], v2 offset:37408
    v_mfma_f32_16x16x32_bf16 v[140:143], v[24:27], v[56:59], v[140:143]
    ds_read_b64_tr_b16 v[34:35], v2 offset:39712
    v_mfma_f32_16x16x32_bf16 v[92:95], v[20:23], v[60:63], v[92:95]
    ds_read_b64_tr_b16 v[36:37], v2 offset:37088
    v_mfma_f32_16x16x32_bf16 v[132:135], v[24:27], v[60:63], v[132:135]
    ds_read_b64_tr_b16 v[38:39], v2 offset:39392
    v_mfma_f32_16x16x32_bf16 v[84:87], v[20:23], v[64:67], v[84:87]
    ds_read_b64_tr_b16 v[40:41], v1 offset:37376
    v_mfma_f32_16x16x32_bf16 v[124:127], v[24:27], v[64:67], v[124:127]
    ds_read_b64_tr_b16 v[42:43], v1 offset:39680
    v_mfma_f32_16x16x32_bf16 v[76:79], v[20:23], v[68:71], v[76:79]
    v_mfma_f32_16x16x32_bf16 v[116:119], v[24:27], v[68:71], v[116:119]
    s_waitcnt lgkmcnt(2)
    v_mfma_f32_16x16x32_bf16 v[236:239], v[28:31], v[56:59], v[236:239]
    s_waitcnt lgkmcnt(0)
    v_mfma_f32_16x16x32_bf16 v[244:247], v[32:35], v[56:59], v[244:247]
    s_barrier
    v_mfma_f32_16x16x32_bf16 v[188:191], v[36:39], v[52:55], v[188:191]
    ds_read_b64_tr_b16 v[20:21], v3 offset:192
    v_mfma_f32_16x16x32_bf16 v[228:231], v[40:43], v[52:55], v[228:231]
    ds_read_b64_tr_b16 v[22:23], v3 offset:2496
    v_mfma_f32_16x16x32_bf16 v[180:183], v[36:39], v[56:59], v[180:183]
    ds_read_b64_tr_b16 v[24:25], v4 offset:480
    v_mfma_f32_16x16x32_bf16 v[220:223], v[40:43], v[56:59], v[220:223]
    ds_read_b64_tr_b16 v[26:27], v4 offset:2784
    v_mfma_f32_16x16x32_bf16 v[172:175], v[36:39], v[60:63], v[172:175]
    ds_read_b128 v[44:47], v5 offset:8192
    v_mfma_f32_16x16x32_bf16 v[212:215], v[40:43], v[60:63], v[212:215]
    v_mfma_f32_16x16x32_bf16 v[164:167], v[36:39], v[64:67], v[164:167]
    v_mfma_f32_16x16x32_bf16 v[204:207], v[40:43], v[64:67], v[204:207]
    v_mfma_f32_16x16x32_bf16 v[156:159], v[36:39], v[68:71], v[156:159]
    v_mfma_f32_16x16x32_bf16 v[196:199], v[40:43], v[68:71], v[196:199]
    s_waitcnt lgkmcnt(0)
    v_mfma_f32_16x16x32_bf16 v[108:111], v[20:23], v[56:59], v[108:111]
    ds_read_b64_tr_b16 v[28:29], v3 offset:256
    v_mfma_f32_16x16x32_bf16 v[148:151], v[24:27], v[56:59], v[148:151]
    ds_read_b64_tr_b16 v[30:31], v3 offset:2560
    v_mfma_f32_16x16x32_bf16 v[100:103], v[20:23], v[60:63], v[100:103]
    ds_read_b64_tr_b16 v[32:33], v4 offset:544
    v_mfma_f32_16x16x32_bf16 v[140:143], v[24:27], v[60:63], v[140:143]
    ds_read_b64_tr_b16 v[34:35], v4 offset:2848
    v_mfma_f32_16x16x32_bf16 v[92:95], v[20:23], v[64:67], v[92:95]
    ds_read_b64_tr_b16 v[36:37], v4 offset:224
    v_mfma_f32_16x16x32_bf16 v[132:135], v[24:27], v[64:67], v[132:135]
    ds_read_b64_tr_b16 v[38:39], v4 offset:2528
    v_mfma_f32_16x16x32_bf16 v[84:87], v[20:23], v[68:71], v[84:87]
    ds_read_b64_tr_b16 v[40:41], v3 offset:512
    v_mfma_f32_16x16x32_bf16 v[124:127], v[24:27], v[68:71], v[124:127]
    ds_read_b64_tr_b16 v[42:43], v3 offset:2816
    v_mfma_f32_16x16x32_bf16 v[76:79], v[20:23], v[44:47], v[76:79]
    v_mfma_f32_16x16x32_bf16 v[116:119], v[24:27], v[44:47], v[116:119]
    s_waitcnt lgkmcnt(2)
    v_mfma_f32_16x16x32_bf16 v[236:239], v[28:31], v[60:63], v[236:239]
    s_waitcnt lgkmcnt(0)
    v_mfma_f32_16x16x32_bf16 v[244:247], v[32:35], v[60:63], v[244:247]
    s_barrier
    v_mfma_f32_16x16x32_bf16 v[188:191], v[36:39], v[56:59], v[188:191]
    ds_read_b64_tr_b16 v[20:21], v3 offset:18624
    v_mfma_f32_16x16x32_bf16 v[228:231], v[40:43], v[56:59], v[228:231]
    ds_read_b64_tr_b16 v[22:23], v3 offset:20928
    v_mfma_f32_16x16x32_bf16 v[180:183], v[36:39], v[60:63], v[180:183]
    ds_read_b64_tr_b16 v[24:25], v4 offset:18912
    v_mfma_f32_16x16x32_bf16 v[220:223], v[40:43], v[60:63], v[220:223]
    ds_read_b64_tr_b16 v[26:27], v4 offset:21216
    v_mfma_f32_16x16x32_bf16 v[172:175], v[36:39], v[64:67], v[172:175]
    ds_read_b128 v[48:51], v5 offset:9216
    v_mfma_f32_16x16x32_bf16 v[212:215], v[40:43], v[64:67], v[212:215]
    v_mfma_f32_16x16x32_bf16 v[164:167], v[36:39], v[68:71], v[164:167]
    v_mfma_f32_16x16x32_bf16 v[204:207], v[40:43], v[68:71], v[204:207]
    v_mfma_f32_16x16x32_bf16 v[156:159], v[36:39], v[44:47], v[156:159]
    v_mfma_f32_16x16x32_bf16 v[196:199], v[40:43], v[44:47], v[196:199]
    s_waitcnt lgkmcnt(0)
    v_mfma_f32_16x16x32_bf16 v[108:111], v[20:23], v[60:63], v[108:111]
    ds_read_b64_tr_b16 v[28:29], v3 offset:18688
    v_mfma_f32_16x16x32_bf16 v[148:151], v[24:27], v[60:63], v[148:151]
    ds_read_b64_tr_b16 v[30:31], v3 offset:20992
    v_mfma_f32_16x16x32_bf16 v[100:103], v[20:23], v[64:67], v[100:103]
    ds_read_b64_tr_b16 v[32:33], v4 offset:18976
    v_mfma_f32_16x16x32_bf16 v[140:143], v[24:27], v[64:67], v[140:143]
    ds_read_b64_tr_b16 v[34:35], v4 offset:21280
    v_mfma_f32_16x16x32_bf16 v[92:95], v[20:23], v[68:71], v[92:95]
    ds_read_b64_tr_b16 v[36:37], v4 offset:18656
    v_mfma_f32_16x16x32_bf16 v[132:135], v[24:27], v[68:71], v[132:135]
    ds_read_b64_tr_b16 v[38:39], v4 offset:20960
    v_mfma_f32_16x16x32_bf16 v[84:87], v[20:23], v[44:47], v[84:87]
    ds_read_b64_tr_b16 v[40:41], v3 offset:18944
    v_mfma_f32_16x16x32_bf16 v[124:127], v[24:27], v[44:47], v[124:127]
    ds_read_b64_tr_b16 v[42:43], v3 offset:21248
    v_mfma_f32_16x16x32_bf16 v[76:79], v[20:23], v[48:51], v[76:79]
    v_mfma_f32_16x16x32_bf16 v[116:119], v[24:27], v[48:51], v[116:119]
    s_waitcnt lgkmcnt(2)
    v_mfma_f32_16x16x32_bf16 v[236:239], v[28:31], v[64:67], v[236:239]
    s_waitcnt lgkmcnt(0)
    v_mfma_f32_16x16x32_bf16 v[244:247], v[32:35], v[64:67], v[244:247]
    s_barrier
    v_mfma_f32_16x16x32_bf16 v[188:191], v[36:39], v[60:63], v[188:191]
    ds_read_b64_tr_b16 v[20:21], v1 offset:192
    v_mfma_f32_16x16x32_bf16 v[228:231], v[40:43], v[60:63], v[228:231]
    ds_read_b64_tr_b16 v[22:23], v1 offset:2496
    v_mfma_f32_16x16x32_bf16 v[180:183], v[36:39], v[64:67], v[180:183]
    ds_read_b64_tr_b16 v[24:25], v2 offset:480
    v_mfma_f32_16x16x32_bf16 v[220:223], v[40:43], v[64:67], v[220:223]
    ds_read_b64_tr_b16 v[26:27], v2 offset:2784
    v_mfma_f32_16x16x32_bf16 v[172:175], v[36:39], v[68:71], v[172:175]
    ds_read_b128 v[52:55], v5 offset:10240
    v_mfma_f32_16x16x32_bf16 v[212:215], v[40:43], v[68:71], v[212:215]
    v_mfma_f32_16x16x32_bf16 v[164:167], v[36:39], v[44:47], v[164:167]
    v_mfma_f32_16x16x32_bf16 v[204:207], v[40:43], v[44:47], v[204:207]
    v_mfma_f32_16x16x32_bf16 v[156:159], v[36:39], v[48:51], v[156:159]
    v_mfma_f32_16x16x32_bf16 v[196:199], v[40:43], v[48:51], v[196:199]
    s_waitcnt lgkmcnt(0)
    v_mfma_f32_16x16x32_bf16 v[104:107], v[20:23], v[64:67], v[104:107]
    ds_read_b64_tr_b16 v[28:29], v1 offset:256
    v_mfma_f32_16x16x32_bf16 v[144:147], v[24:27], v[64:67], v[144:147]
    ds_read_b64_tr_b16 v[30:31], v1 offset:2560
    v_mfma_f32_16x16x32_bf16 v[96:99], v[20:23], v[68:71], v[96:99]
    ds_read_b64_tr_b16 v[32:33], v2 offset:544
    v_mfma_f32_16x16x32_bf16 v[136:139], v[24:27], v[68:71], v[136:139]
    ds_read_b64_tr_b16 v[34:35], v2 offset:2848
    v_mfma_f32_16x16x32_bf16 v[88:91], v[20:23], v[44:47], v[88:91]
    ds_read_b64_tr_b16 v[36:37], v2 offset:224
    v_mfma_f32_16x16x32_bf16 v[128:131], v[24:27], v[44:47], v[128:131]
    ds_read_b64_tr_b16 v[38:39], v2 offset:2528
    v_mfma_f32_16x16x32_bf16 v[80:83], v[20:23], v[48:51], v[80:83]
    ds_read_b64_tr_b16 v[40:41], v1 offset:512
    v_mfma_f32_16x16x32_bf16 v[120:123], v[24:27], v[48:51], v[120:123]
    ds_read_b64_tr_b16 v[42:43], v1 offset:2816
    v_mfma_f32_16x16x32_bf16 v[72:75], v[20:23], v[52:55], v[72:75]
    v_mfma_f32_16x16x32_bf16 v[112:115], v[24:27], v[52:55], v[112:115]
    s_waitcnt lgkmcnt(2)
    v_mfma_f32_16x16x32_bf16 v[232:235], v[28:31], v[68:71], v[232:235]
    s_waitcnt lgkmcnt(0)
    v_mfma_f32_16x16x32_bf16 v[240:243], v[32:35], v[68:71], v[240:243]
    s_barrier
    v_mfma_f32_16x16x32_bf16 v[184:187], v[36:39], v[64:67], v[184:187]
    ds_read_b64_tr_b16 v[20:21], v1 offset:18624
    v_mfma_f32_16x16x32_bf16 v[224:227], v[40:43], v[64:67], v[224:227]
    ds_read_b64_tr_b16 v[22:23], v1 offset:20928
    v_mfma_f32_16x16x32_bf16 v[176:179], v[36:39], v[68:71], v[176:179]
    ds_read_b64_tr_b16 v[24:25], v2 offset:18912
    v_mfma_f32_16x16x32_bf16 v[216:219], v[40:43], v[68:71], v[216:219]
    ds_read_b64_tr_b16 v[26:27], v2 offset:21216
    v_mfma_f32_16x16x32_bf16 v[168:171], v[36:39], v[44:47], v[168:171]
    ds_read_b128 v[56:59], v5 offset:11264
    v_mfma_f32_16x16x32_bf16 v[208:211], v[40:43], v[44:47], v[208:211]
    v_mfma_f32_16x16x32_bf16 v[160:163], v[36:39], v[48:51], v[160:163]
    v_mfma_f32_16x16x32_bf16 v[200:203], v[40:43], v[48:51], v[200:203]
    v_mfma_f32_16x16x32_bf16 v[152:155], v[36:39], v[52:55], v[152:155]
    v_mfma_f32_16x16x32_bf16 v[192:195], v[40:43], v[52:55], v[192:195]
    s_waitcnt lgkmcnt(0)
    v_mfma_f32_16x16x32_bf16 v[104:107], v[20:23], v[68:71], v[104:107]
    ds_read_b64_tr_b16 v[28:29], v1 offset:18688
    v_mfma_f32_16x16x32_bf16 v[144:147], v[24:27], v[68:71], v[144:147]
    ds_read_b64_tr_b16 v[30:31], v1 offset:20992
    v_mfma_f32_16x16x32_bf16 v[96:99], v[20:23], v[44:47], v[96:99]
    ds_read_b64_tr_b16 v[32:33], v2 offset:18976
    v_mfma_f32_16x16x32_bf16 v[136:139], v[24:27], v[44:47], v[136:139]
    ds_read_b64_tr_b16 v[34:35], v2 offset:21280
    v_mfma_f32_16x16x32_bf16 v[88:91], v[20:23], v[48:51], v[88:91]
    ds_read_b64_tr_b16 v[36:37], v2 offset:18656
    v_mfma_f32_16x16x32_bf16 v[128:131], v[24:27], v[48:51], v[128:131]
    ds_read_b64_tr_b16 v[38:39], v2 offset:20960
    v_mfma_f32_16x16x32_bf16 v[80:83], v[20:23], v[52:55], v[80:83]
    ds_read_b64_tr_b16 v[40:41], v1 offset:18944
    v_mfma_f32_16x16x32_bf16 v[120:123], v[24:27], v[52:55], v[120:123]
    ds_read_b64_tr_b16 v[42:43], v1 offset:21248
    v_mfma_f32_16x16x32_bf16 v[72:75], v[20:23], v[56:59], v[72:75]
    v_mfma_f32_16x16x32_bf16 v[112:115], v[24:27], v[56:59], v[112:115]
    s_waitcnt lgkmcnt(2)
    v_mfma_f32_16x16x32_bf16 v[232:235], v[28:31], v[44:47], v[232:235]
    s_waitcnt lgkmcnt(0)
    v_mfma_f32_16x16x32_bf16 v[240:243], v[32:35], v[44:47], v[240:243]
    s_barrier
    v_mfma_f32_16x16x32_bf16 v[184:187], v[36:39], v[68:71], v[184:187]
    ds_read_b64_tr_b16 v[20:21], v1 offset:37056
    v_mfma_f32_16x16x32_bf16 v[224:227], v[40:43], v[68:71], v[224:227]
    ds_read_b64_tr_b16 v[22:23], v1 offset:39360
    v_mfma_f32_16x16x32_bf16 v[176:179], v[36:39], v[44:47], v[176:179]
    ds_read_b64_tr_b16 v[24:25], v2 offset:37344
    v_mfma_f32_16x16x32_bf16 v[216:219], v[40:43], v[44:47], v[216:219]
    ds_read_b64_tr_b16 v[26:27], v2 offset:39648
    v_mfma_f32_16x16x32_bf16 v[168:171], v[36:39], v[48:51], v[168:171]
    ds_read_b128 v[60:63], v5 offset:12288
    v_mfma_f32_16x16x32_bf16 v[208:211], v[40:43], v[48:51], v[208:211]
    v_mfma_f32_16x16x32_bf16 v[160:163], v[36:39], v[52:55], v[160:163]
    v_mfma_f32_16x16x32_bf16 v[200:203], v[40:43], v[52:55], v[200:203]
    v_mfma_f32_16x16x32_bf16 v[152:155], v[36:39], v[56:59], v[152:155]
    v_mfma_f32_16x16x32_bf16 v[192:195], v[40:43], v[56:59], v[192:195]
    s_waitcnt lgkmcnt(0)
    v_mfma_f32_16x16x32_bf16 v[104:107], v[20:23], v[44:47], v[104:107]
    ds_read_b64_tr_b16 v[28:29], v1 offset:37120
    v_mfma_f32_16x16x32_bf16 v[144:147], v[24:27], v[44:47], v[144:147]
    ds_read_b64_tr_b16 v[30:31], v1 offset:39424
    v_mfma_f32_16x16x32_bf16 v[96:99], v[20:23], v[48:51], v[96:99]
    ds_read_b64_tr_b16 v[32:33], v2 offset:37408
    v_mfma_f32_16x16x32_bf16 v[136:139], v[24:27], v[48:51], v[136:139]
    ds_read_b64_tr_b16 v[34:35], v2 offset:39712
    v_mfma_f32_16x16x32_bf16 v[88:91], v[20:23], v[52:55], v[88:91]
    ds_read_b64_tr_b16 v[36:37], v2 offset:37088
    v_mfma_f32_16x16x32_bf16 v[128:131], v[24:27], v[52:55], v[128:131]
    ds_read_b64_tr_b16 v[38:39], v2 offset:39392
    v_mfma_f32_16x16x32_bf16 v[80:83], v[20:23], v[56:59], v[80:83]
    ds_read_b64_tr_b16 v[40:41], v1 offset:37376
    v_mfma_f32_16x16x32_bf16 v[120:123], v[24:27], v[56:59], v[120:123]
    ds_read_b64_tr_b16 v[42:43], v1 offset:39680
    v_mfma_f32_16x16x32_bf16 v[72:75], v[20:23], v[60:63], v[72:75]
    v_mfma_f32_16x16x32_bf16 v[112:115], v[24:27], v[60:63], v[112:115]
    s_waitcnt lgkmcnt(2)
    v_mfma_f32_16x16x32_bf16 v[232:235], v[28:31], v[48:51], v[232:235]
    s_waitcnt lgkmcnt(0)
    v_mfma_f32_16x16x32_bf16 v[240:243], v[32:35], v[48:51], v[240:243]
    s_barrier
    v_mfma_f32_16x16x32_bf16 v[184:187], v[36:39], v[44:47], v[184:187]
    ds_read_b64_tr_b16 v[20:21], v3 offset:192
    v_mfma_f32_16x16x32_bf16 v[224:227], v[40:43], v[44:47], v[224:227]
    ds_read_b64_tr_b16 v[22:23], v3 offset:2496
    v_mfma_f32_16x16x32_bf16 v[176:179], v[36:39], v[48:51], v[176:179]
    ds_read_b64_tr_b16 v[24:25], v4 offset:480
    v_mfma_f32_16x16x32_bf16 v[216:219], v[40:43], v[48:51], v[216:219]
    ds_read_b64_tr_b16 v[26:27], v4 offset:2784
    v_mfma_f32_16x16x32_bf16 v[168:171], v[36:39], v[52:55], v[168:171]
    ds_read_b128 v[64:67], v5 offset:13312
    v_mfma_f32_16x16x32_bf16 v[208:211], v[40:43], v[52:55], v[208:211]
    v_mfma_f32_16x16x32_bf16 v[160:163], v[36:39], v[56:59], v[160:163]
    v_mfma_f32_16x16x32_bf16 v[200:203], v[40:43], v[56:59], v[200:203]
    v_mfma_f32_16x16x32_bf16 v[152:155], v[36:39], v[60:63], v[152:155]
    v_mfma_f32_16x16x32_bf16 v[192:195], v[40:43], v[60:63], v[192:195]
    s_waitcnt lgkmcnt(0)
    v_mfma_f32_16x16x32_bf16 v[104:107], v[20:23], v[48:51], v[104:107]
    ds_read_b64_tr_b16 v[28:29], v3 offset:256
    v_mfma_f32_16x16x32_bf16 v[144:147], v[24:27], v[48:51], v[144:147]
    ds_read_b64_tr_b16 v[30:31], v3 offset:2560
    v_mfma_f32_16x16x32_bf16 v[96:99], v[20:23], v[52:55], v[96:99]
    ds_read_b64_tr_b16 v[32:33], v4 offset:544
    v_mfma_f32_16x16x32_bf16 v[136:139], v[24:27], v[52:55], v[136:139]
    ds_read_b64_tr_b16 v[34:35], v4 offset:2848
    v_mfma_f32_16x16x32_bf16 v[88:91], v[20:23], v[56:59], v[88:91]
    ds_read_b64_tr_b16 v[36:37], v4 offset:224
    v_mfma_f32_16x16x32_bf16 v[128:131], v[24:27], v[56:59], v[128:131]
    ds_read_b64_tr_b16 v[38:39], v4 offset:2528
    v_mfma_f32_16x16x32_bf16 v[80:83], v[20:23], v[60:63], v[80:83]
    ds_read_b64_tr_b16 v[40:41], v3 offset:512
    v_mfma_f32_16x16x32_bf16 v[120:123], v[24:27], v[60:63], v[120:123]
    ds_read_b64_tr_b16 v[42:43], v3 offset:2816
    v_mfma_f32_16x16x32_bf16 v[72:75], v[20:23], v[64:67], v[72:75]
    v_mfma_f32_16x16x32_bf16 v[112:115], v[24:27], v[64:67], v[112:115]
    s_waitcnt lgkmcnt(2)
    v_mfma_f32_16x16x32_bf16 v[232:235], v[28:31], v[52:55], v[232:235]
    s_waitcnt lgkmcnt(0)
    v_mfma_f32_16x16x32_bf16 v[240:243], v[32:35], v[52:55], v[240:243]
    s_barrier
    v_mfma_f32_16x16x32_bf16 v[184:187], v[36:39], v[48:51], v[184:187]
    ds_read_b64_tr_b16 v[20:21], v3 offset:18624
    v_mfma_f32_16x16x32_bf16 v[224:227], v[40:43], v[48:51], v[224:227]
    ds_read_b64_tr_b16 v[22:23], v3 offset:20928
    v_mfma_f32_16x16x32_bf16 v[176:179], v[36:39], v[52:55], v[176:179]
    ds_read_b64_tr_b16 v[24:25], v4 offset:18912
    v_mfma_f32_16x16x32_bf16 v[216:219], v[40:43], v[52:55], v[216:219]
    ds_read_b64_tr_b16 v[26:27], v4 offset:21216
    v_mfma_f32_16x16x32_bf16 v[168:171], v[36:39], v[56:59], v[168:171]
    ds_read_b128 v[68:71], v5 offset:14336
    v_mfma_f32_16x16x32_bf16 v[208:211], v[40:43], v[56:59], v[208:211]
    v_mfma_f32_16x16x32_bf16 v[160:163], v[36:39], v[60:63], v[160:163]
    v_mfma_f32_16x16x32_bf16 v[200:203], v[40:43], v[60:63], v[200:203]
    v_mfma_f32_16x16x32_bf16 v[152:155], v[36:39], v[64:67], v[152:155]
    v_mfma_f32_16x16x32_bf16 v[192:195], v[40:43], v[64:67], v[192:195]
    s_waitcnt lgkmcnt(0)
    v_mfma_f32_16x16x32_bf16 v[104:107], v[20:23], v[52:55], v[104:107]
    ds_read_b64_tr_b16 v[28:29], v3 offset:18688
    v_mfma_f32_16x16x32_bf16 v[144:147], v[24:27], v[52:55], v[144:147]
    ds_read_b64_tr_b16 v[30:31], v3 offset:20992
    v_mfma_f32_16x16x32_bf16 v[96:99], v[20:23], v[56:59], v[96:99]
    ds_read_b64_tr_b16 v[32:33], v4 offset:18976
    v_mfma_f32_16x16x32_bf16 v[136:139], v[24:27], v[56:59], v[136:139]
    ds_read_b64_tr_b16 v[34:35], v4 offset:21280
    v_mfma_f32_16x16x32_bf16 v[88:91], v[20:23], v[60:63], v[88:91]
    ds_read_b64_tr_b16 v[36:37], v4 offset:18656
    v_mfma_f32_16x16x32_bf16 v[128:131], v[24:27], v[60:63], v[128:131]
    ds_read_b64_tr_b16 v[38:39], v4 offset:20960
    v_mfma_f32_16x16x32_bf16 v[80:83], v[20:23], v[64:67], v[80:83]
    ds_read_b64_tr_b16 v[40:41], v3 offset:18944
    v_mfma_f32_16x16x32_bf16 v[120:123], v[24:27], v[64:67], v[120:123]
    ds_read_b64_tr_b16 v[42:43], v3 offset:21248
    v_mfma_f32_16x16x32_bf16 v[72:75], v[20:23], v[68:71], v[72:75]
    v_mfma_f32_16x16x32_bf16 v[112:115], v[24:27], v[68:71], v[112:115]
    s_waitcnt lgkmcnt(2)
    v_mfma_f32_16x16x32_bf16 v[232:235], v[28:31], v[56:59], v[232:235]
    s_waitcnt lgkmcnt(0)
    v_mfma_f32_16x16x32_bf16 v[240:243], v[32:35], v[56:59], v[240:243]
    s_barrier
    v_xor_b32 v5, 0xdc00, v5
    v_mfma_f32_16x16x32_bf16 v[184:187], v[36:39], v[52:55], v[184:187]
    ds_read_b64_tr_b16 v[20:21], v1 offset:192
    ds_read_b64_tr_b16 v[22:23], v1 offset:2496
    v_mfma_f32_16x16x32_bf16 v[224:227], v[40:43], v[52:55], v[224:227]
    ds_read_b128 v[44:47], v5 offset:1024
    ds_read_b64_tr_b16 v[24:25], v2 offset:480
    v_mfma_f32_16x16x32_bf16 v[176:179], v[36:39], v[56:59], v[176:179]
    ds_read_b64_tr_b16 v[26:27], v2 offset:2784
    ds_read_b128 v[48:51], v5 offset:2048
    v_mfma_f32_16x16x32_bf16 v[216:219], v[40:43], v[56:59], v[216:219]
    ds_read_b128 v[52:55], v5 offset:3072
    ds_read_b128 v[56:59], v5 offset:4096
    v_mfma_f32_16x16x32_bf16 v[168:171], v[36:39], v[60:63], v[168:171]
    v_mfma_f32_16x16x32_bf16 v[208:211], v[40:43], v[60:63], v[208:211]
    ds_read_b128 v[60:63], v5 offset:5120
    v_mfma_f32_16x16x32_bf16 v[160:163], v[36:39], v[64:67], v[160:163]
    s_add_u32 s40, s40, 1
    s_cmp_lt_u32 s40, 4
    v_mfma_f32_16x16x32_bf16 v[200:203], v[40:43], v[64:67], v[200:203]
    v_mfma_f32_16x16x32_bf16 v[152:155], v[36:39], v[68:71], v[152:155]
    v_mfma_f32_16x16x32_bf16 v[192:195], v[40:43], v[68:71], v[192:195]
    s_cbranch_scc1 L_c3_0
    s_waitcnt lgkmcnt(0)
    v_mfma_f32_16x16x32_bf16 v[108:111], v[20:23], v[44:47], v[108:111]
    ds_read_b64_tr_b16 v[28:29], v1 offset:256
    v_mfma_f32_16x16x32_bf16 v[148:151], v[24:27], v[44:47], v[148:151]
    ds_read_b64_tr_b16 v[30:31], v1 offset:2560
    v_mfma_f32_16x16x32_bf16 v[100:103], v[20:23], v[48:51], v[100:103]
    ds_read_b64_tr_b16 v[32:33], v2 offset:544
    v_mfma_f32_16x16x32_bf16 v[140:143], v[24:27], v[48:51], v[140:143]
    ds_read_b64_tr_b16 v[34:35], v2 offset:2848
    v_mfma_f32_16x16x32_bf16 v[92:95], v[20:23], v[52:55], v[92:95]
    ds_read_b64_tr_b16 v[36:37], v2 offset:224
    v_mfma_f32_16x16x32_bf16 v[132:135], v[24:27], v[52:55], v[132:135]
    ds_read_b64_tr_b16 v[38:39], v2 offset:2528
    v_mfma_f32_16x16x32_bf16 v[84:87], v[20:23], v[56:59], v[84:87]
    ds_read_b64_tr_b16 v[40:41], v1 offset:512
    v_mfma_f32_16x16x32_bf16 v[124:127], v[24:27], v[56:59], v[124:127]
    ds_read_b64_tr_b16 v[42:43], v1 offset:2816
    v_mfma_f32_16x16x32_bf16 v[76:79], v[20:23], v[60:63], v[76:79]
    v_mfma_f32_16x16x32_bf16 v[116:119], v[24:27], v[60:63], v[116:119]
    s_waitcnt lgkmcnt(2)
    v_mfma_f32_16x16x32_bf16 v[236:239], v[28:31], v[48:51], v[236:239]
    s_waitcnt lgkmcnt(0)
    v_mfma_f32_16x16x32_bf16 v[244:247], v[32:35], v[48:51], v[244:247]
    s_barrier
    v_mfma_f32_16x16x32_bf16 v[188:191], v[36:39], v[44:47], v[188:191]
    ds_read_b64_tr_b16 v[20:21], v1 offset:18624
    v_mfma_f32_16x16x32_bf16 v[228:231], v[40:43], v[44:47], v[228:231]
    ds_read_b64_tr_b16 v[22:23], v1 offset:20928
    v_mfma_f32_16x16x32_bf16 v[180:183], v[36:39], v[48:51], v[180:183]
    ds_read_b64_tr_b16 v[24:25], v2 offset:18912
    v_mfma_f32_16x16x32_bf16 v[220:223], v[40:43], v[48:51], v[220:223]
    ds_read_b64_tr_b16 v[26:27], v2 offset:21216
    v_mfma_f32_16x16x32_bf16 v[172:175], v[36:39], v[52:55], v[172:175]
    ds_read_b128 v[64:67], v5 offset:6144
    v_mfma_f32_16x16x32_bf16 v[212:215], v[40:43], v[52:55], v[212:215]
    ds_read_b128 v[68:71], v5 offset:7168
    v_mfma_f32_16x16x32_bf16 v[164:167], v[36:39], v[56:59], v[164:167]
    v_mfma_f32_16x16x32_bf16 v[204:207], v[40:43], v[56:59], v[204:207]
    v_mfma_f32_16x16x32_bf16 v[156:159], v[36:39], v[60:63], v[156:159]
    v_mfma_f32_16x16x32_bf16 v[196:199], v[40:43], v[60:63], v[196:199]
    s_waitcnt lgkmcnt(0)
    v_mfma_f32_16x16x32_bf16 v[108:111], v[20:23], v[52:55], v[108:111]
    ds_read_b64_tr_b16 v[28:29], v1 offset:18688
    v_mfma_f32_16x16x32_bf16 v[148:151], v[24:27], v[52:55], v[148:151]
    ds_read_b64_tr_b16 v[30:31], v1 offset:20992
    v_mfma_f32_16x16x32_bf16 v[100:103], v[20:23], v[56:59], v[100:103]
    ds_read_b64_tr_b16 v[32:33], v2 offset:18976
    v_mfma_f32_16x16x32_bf16 v[140:143], v[24:27], v[56:59], v[140:143]
    ds_read_b64_tr_b16 v[34:35], v2 offset:21280
    v_mfma_f32_16x16x32_bf16 v[92:95], v[20:23], v[60:63], v[92:95]
    ds_read_b64_tr_b16 v[36:37], v2 offset:18656
    v_mfma_f32_16x16x32_bf16 v[132:135], v[24:27], v[60:63], v[132:135]
    ds_read_b64_tr_b16 v[38:39], v2 offset:20960
    v_mfma_f32_16x16x32_bf16 v[84:87], v[20:23], v[64:67], v[84:87]
    ds_read_b64_tr_b16 v[40:41], v1 offset:18944
    v_mfma_f32_16x16x32_bf16 v[124:127], v[24:27], v[64:67], v[124:127]
    ds_read_b64_tr_b16 v[42:43], v1 offset:21248
    v_mfma_f32_16x16x32_bf16 v[76:79], v[20:23], v[68:71], v[76:79]
    v_mfma_f32_16x16x32_bf16 v[116:119], v[24:27], v[68:71], v[116:119]
    s_waitcnt lgkmcnt(2)
    v_mfma_f32_16x16x32_bf16 v[236:239], v[28:31], v[56:59], v[236:239]
    s_waitcnt lgkmcnt(0)
    v_mfma_f32_16x16x32_bf16 v[244:247], v[32:35], v[56:59], v[244:247]
    s_barrier
    v_mfma_f32_16x16x32_bf16 v[188:191], v[36:39], v[52:55], v[188:191]
    ds_read_b64_tr_b16 v[20:21], v18 offset:37056
    v_mfma_f32_16x16x32_bf16 v[228:231], v[40:43], v[52:55], v[228:231]
    ds_read_b64 v[44:45], v6 offset:24576
    v_mfma_f32_16x16x32_bf16 v[180:183], v[36:39], v[56:59], v[180:183]
    ds_read_b64_tr_b16 v[24:25], v19 offset:37344
    v_mfma_f32_16x16x32_bf16 v[220:223], v[40:43], v[56:59], v[220:223]
    ds_read_b64 v[48:49], v6 offset:25600
    v_mfma_f32_16x16x32_bf16 v[172:175], v[36:39], v[60:63], v[172:175]
    ds_read_b64 v[52:53], v6 offset:26624
    v_mfma_f32_16x16x32_bf16 v[212:215], v[40:43], v[60:63], v[212:215]
    ds_read_b64 v[56:57], v6 offset:27648
    v_mfma_f32_16x16x32_bf16 v[164:167], v[36:39], v[64:67], v[164:167]
    ds_read_b64 v[60:61], v6 offset:28672
    v_mfma_f32_16x16x32_bf16 v[204:207], v[40:43], v[64:67], v[204:207]
    v_mfma_f32_16x16x32_bf16 v[156:159], v[36:39], v[68:71], v[156:159]
    v_mfma_f32_16x16x32_bf16 v[196:199], v[40:43], v[68:71], v[196:199]
    s_waitcnt lgkmcnt(1)
    v_mfma_f32_16x16x16_bf16 v[108:111], v[20:21], v[44:45], v[108:111]
    ds_read_b64_tr_b16 v[28:29], v18 offset:37120
    v_mfma_f32_16x16x16_bf16 v[148:151], v[24:25], v[44:45], v[148:151]
    ds_read_b64_tr_b16 v[32:33], v19 offset:37408
    v_mfma_f32_16x16x16_bf16 v[100:103], v[20:21], v[48:49], v[100:103]
    ds_read_b64_tr_b16 v[36:37], v19 offset:37088
    v_mfma_f32_16x16x16_bf16 v[140:143], v[24:25], v[48:49], v[140:143]
    ds_read_b64_tr_b16 v[40:41], v18 offset:37376
    v_mfma_f32_16x16x16_bf16 v[92:95], v[20:21], v[52:53], v[92:95]
    v_mfma_f32_16x16x16_bf16 v[132:135], v[24:25], v[52:53], v[132:135]
    v_mfma_f32_16x16x16_bf16 v[84:87], v[20:21], v[56:57], v[84:87]
    v_mfma_f32_16x16x16_bf16 v[124:127], v[24:25], v[56:57], v[124:127]
    s_waitcnt lgkmcnt(0)
    v_mfma_f32_16x16x16_bf16 v[76:79], v[20:21], v[60:61], v[76:79]
    v_mfma_f32_16x16x16_bf16 v[116:119], v[24:25], v[60:61], v[116:119]
    v_mfma_f32_16x16x16_bf16 v[236:239], v[28:29], v[48:49], v[236:239]
    v_mfma_f32_16x16x16_bf16 v[244:247], v[32:33], v[48:49], v[244:247]
    s_barrier
    v_mfma_f32_16x16x16_bf16 v[188:191], v[36:37], v[44:45], v[188:191]
    ds_read_b64_tr_b16 v[20:21], v3 offset:192
    ds_read_b64_tr_b16 v[22:23], v3 offset:2496
    v_mfma_f32_16x16x16_bf16 v[228:231], v[40:41], v[44:45], v[228:231]
    ds_read_b128 v[64:67], v5 offset:6144
    ds_read_b64_tr_b16 v[24:25], v4 offset:480
    v_mfma_f32_16x16x16_bf16 v[180:183], v[36:37], v[48:49], v[180:183]
    ds_read_b64_tr_b16 v[26:27], v4 offset:2784
    v_mfma_f32_16x16x16_bf16 v[220:223], v[40:41], v[48:49], v[220:223]
    ds_read_b128 v[68:71], v5 offset:7168
    v_mfma_f32_16x16x16_bf16 v[172:175], v[36:37], v[52:53], v[172:175]
    ds_read_b128 v[44:47], v5 offset:8192
    v_mfma_f32_16x16x16_bf16 v[212:215], v[40:41], v[52:53], v[212:215]
    ds_read_b128 v[48:51], v5 offset:9216
    v_mfma_f32_16x16x16_bf16 v[164:167], v[36:37], v[56:57], v[164:167]
    ds_read_b128 v[52:55], v5 offset:10240
    v_mfma_f32_16x16x16_bf16 v[204:207], v[40:41], v[56:57], v[204:207]
    v_mfma_f32_16x16x16_bf16 v[156:159], v[36:37], v[60:61], v[156:159]
    v_mfma_f32_16x16x16_bf16 v[196:199], v[40:41], v[60:61], v[196:199]
    s_waitcnt lgkmcnt(1)
    v_mfma_f32_16x16x32_bf16 v[104:107], v[20:23], v[64:67], v[104:107]
    ds_read_b64_tr_b16 v[28:29], v3 offset:256
    v_sub_f32 v184, v184, v188
    v_mfma_f32_16x16x32_bf16 v[144:147], v[24:27], v[64:67], v[144:147]
    ds_read_b64_tr_b16 v[30:31], v3 offset:2560
    v_sub_f32 v185, v185, v189
    v_mfma_f32_16x16x32_bf16 v[96:99], v[20:23], v[68:71], v[96:99]
    ds_read_b64_tr_b16 v[32:33], v4 offset:544
    v_sub_f32 v186, v186, v190
    v_mfma_f32_16x16x32_bf16 v[136:139], v[24:27], v[68:71], v[136:139]
    ds_read_b64_tr_b16 v[34:35], v4 offset:2848
    v_sub_f32 v187, v187, v191
    v_mfma_f32_16x16x32_bf16 v[88:91], v[20:23], v[44:47], v[88:91]
    ds_read_b64_tr_b16 v[36:37], v4 offset:224
    v_sub_f32 v224, v224, v228
    v_mfma_f32_16x16x32_bf16 v[128:131], v[24:27], v[44:47], v[128:131]
    ds_read_b64_tr_b16 v[38:39], v4 offset:2528
    v_sub_f32 v225, v225, v229
    v_mfma_f32_16x16x32_bf16 v[80:83], v[20:23], v[48:51], v[80:83]
    ds_read_b64_tr_b16 v[40:41], v3 offset:512
    v_sub_f32 v226, v226, v230
    v_mfma_f32_16x16x32_bf16 v[120:123], v[24:27], v[48:51], v[120:123]
    ds_read_b64_tr_b16 v[42:43], v3 offset:2816
    s_waitcnt lgkmcnt(4)
    v_mfma_f32_16x16x32_bf16 v[72:75], v[20:23], v[52:55], v[72:75]
    v_sub_f32 v227, v227, v231
    v_sub_f32 v176, v176, v180
    v_mfma_f32_16x16x32_bf16 v[112:115], v[24:27], v[52:55], v[112:115]
    v_sub_f32 v177, v177, v181
    v_sub_f32 v178, v178, v182
    v_mfma_f32_16x16x32_bf16 v[232:235], v[28:31], v[68:71], v[232:235]
    v_sub_f32 v179, v179, v183
    s_waitcnt lgkmcnt(0)
    v_mfma_f32_16x16x32_bf16 v[240:243], v[32:35], v[68:71], v[240:243]
    v_sub_f32 v216, v216, v220
    s_barrier
    v_mfma_f32_16x16x32_bf16 v[184:187], v[36:39], v[64:67], v[184:187]
    ds_read_b64_tr_b16 v[20:21], v3 offset:18624
    v_sub_f32 v217, v217, v221
    v_mfma_f32_16x16x32_bf16 v[224:227], v[40:43], v[64:67], v[224:227]
    ds_read_b64_tr_b16 v[22:23], v3 offset:20928
    v_sub_f32 v168, v168, v172
    v_mfma_f32_16x16x32_bf16 v[176:179], v[36:39], v[68:71], v[176:179]
    ds_read_b64_tr_b16 v[24:25], v4 offset:18912
    v_sub_f32 v208, v208, v212
    v_mfma_f32_16x16x32_bf16 v[216:219], v[40:43], v[68:71], v[216:219]
    ds_read_b64_tr_b16 v[26:27], v4 offset:21216
    v_sub_f32 v160, v160, v164
    v_mfma_f32_16x16x32_bf16 v[168:171], v[36:39], v[44:47], v[168:171]
    ds_read_b128 v[56:59], v5 offset:11264
    v_sub_f32 v200, v200, v204
    v_mfma_f32_16x16x32_bf16 v[208:211], v[40:43], v[44:47], v[208:211]
    ds_read_b128 v[60:63], v5 offset:12288
    v_sub_f32 v192, v192, v196
    v_mfma_f32_16x16x32_bf16 v[160:163], v[36:39], v[48:51], v[160:163]
    v_sub_f32 v218, v218, v222
    v_sub_f32 v219, v219, v223
    v_mfma_f32_16x16x32_bf16 v[200:203], v[40:43], v[48:51], v[200:203]
    v_sub_f32 v169, v169, v173
    v_sub_f32 v170, v170, v174
    v_mfma_f32_16x16x32_bf16 v[152:155], v[36:39], v[52:55], v[152:155]
    v_sub_f32 v171, v171, v175
    v_sub_f32 v209, v209, v213
    v_mfma_f32_16x16x32_bf16 v[192:195], v[40:43], v[52:55], v[192:195]
    v_sub_f32 v210, v210, v214
    s_waitcnt lgkmcnt(0)
    v_mfma_f32_16x16x32_bf16 v[104:107], v[20:23], v[44:47], v[104:107]
    ds_read_b64_tr_b16 v[28:29], v3 offset:18688
    v_sub_f32 v211, v211, v215
    v_mfma_f32_16x16x32_bf16 v[144:147], v[24:27], v[44:47], v[144:147]
    ds_read_b64_tr_b16 v[30:31], v3 offset:20992
    v_sub_f32 v161, v161, v165
    v_mfma_f32_16x16x32_bf16 v[96:99], v[20:23], v[48:51], v[96:99]
    ds_read_b64_tr_b16 v[32:33], v4 offset:18976
    v_sub_f32 v162, v162, v166
    v_mfma_f32_16x16x32_bf16 v[136:139], v[24:27], v[48:51], v[136:139]
    ds_read_b64_tr_b16 v[34:35], v4 offset:21280
    v_sub_f32 v163, v163, v167
    v_mfma_f32_16x16x32_bf16 v[88:91], v[20:23], v[52:55], v[88:91]
    ds_read_b64_tr_b16 v[36:37], v4 offset:18656
    v_sub_f32 v201, v201, v205
    v_mfma_f32_16x16x32_bf16 v[128:131], v[24:27], v[52:55], v[128:131]
    ds_read_b64_tr_b16 v[38:39], v4 offset:20960
    v_sub_f32 v202, v202, v206
    v_mfma_f32_16x16x32_bf16 v[80:83], v[20:23], v[56:59], v[80:83]
    ds_read_b64_tr_b16 v[40:41], v3 offset:18944
    v_sub_f32 v203, v203, v207
    v_mfma_f32_16x16x32_bf16 v[120:123], v[24:27], v[56:59], v[120:123]
    ds_read_b64_tr_b16 v[42:43], v3 offset:21248
    v_sub_f32 v152, v152, v156
    v_mfma_f32_16x16x32_bf16 v[72:75], v[20:23], v[60:63], v[72:75]
    v_sub_f32 v153, v153, v157
    v_sub_f32 v154, v154, v158
    v_mfma_f32_16x16x32_bf16 v[112:115], v[24:27], v[60:63], v[112:115]
    v_sub_f32 v155, v155, v159
    s_waitcnt lgkmcnt(2)
    v_mfma_f32_16x16x32_bf16 v[232:235], v[28:31], v[48:51], v[232:235]
    v_sub_f32 v193, v193, v197
    s_waitcnt lgkmcnt(0)
    v_mfma_f32_16x16x32_bf16 v[240:243], v[32:35], v[48:51], v[240:243]
    v_sub_f32 v194, v194, v198
    s_barrier
    v_mfma_f32_16x16x32_bf16 v[184:187], v[36:39], v[44:47], v[184:187]
    ds_read_b64_tr_b16 v[20:21], v18 offset:192
    v_sub_f32 v195, v195, v199
    v_mfma_f32_16x16x32_bf16 v[224:227], v[40:43], v[44:47], v[224:227]
    ds_read_b64 v[64:65], v6 offset:29696
    v_sub_f32 v104, v104, v108
    v_mfma_f32_16x16x32_bf16 v[176:179], v[36:39], v[48:51], v[176:179]
    ds_read_b64_tr_b16 v[24:25], v19 offset:480
    v_sub_f32 v105, v105, v109
    v_mfma_f32_16x16x32_bf16 v[216:219], v[40:43], v[48:51], v[216:219]
    ds_read_b64 v[68:69], v6 offset:30720
    v_sub_f32 v106, v106, v110
    v_mfma_f32_16x16x32_bf16 v[168:171], v[36:39], v[52:55], v[168:171]
    ds_read_b64 v[44:45], v6 offset:31744
    v_sub_f32 v107, v107, v111
    v_mfma_f32_16x16x32_bf16 v[208:211], v[40:43], v[52:55], v[208:211]
    ds_read_b64 v[48:49], v6 offset:32768
    v_sub_f32 v144, v144, v148
    v_mfma_f32_16x16x32_bf16 v[160:163], v[36:39], v[56:59], v[160:163]
    ds_read_b64 v[52:53], v6 offset:33792
    v_sub_f32 v145, v145, v149
    v_mfma_f32_16x16x32_bf16 v[200:203], v[40:43], v[56:59], v[200:203]
    v_sub_f32 v146, v146, v150
    v_sub_f32 v147, v147, v151
    v_mfma_f32_16x16x32_bf16 v[152:155], v[36:39], v[60:63], v[152:155]
    v_sub_f32 v96, v96, v100
    v_sub_f32 v97, v97, v101
    v_mfma_f32_16x16x32_bf16 v[192:195], v[40:43], v[60:63], v[192:195]
    v_sub_f32 v98, v98, v102
    s_waitcnt lgkmcnt(1)
    v_mfma_f32_16x16x16_bf16 v[104:107], v[20:21], v[64:65], v[104:107]
    ds_read_b64_tr_b16 v[28:29], v18 offset:256
    v_sub_f32 v136, v136, v140
    v_mfma_f32_16x16x16_bf16 v[144:147], v[24:25], v[64:65], v[144:147]
    ds_read_b64_tr_b16 v[32:33], v19 offset:544
    v_sub_f32 v88, v88, v92
    v_mfma_f32_16x16x16_bf16 v[96:99], v[20:21], v[68:69], v[96:99]
    ds_read_b64_tr_b16 v[36:37], v19 offset:224
    v_sub_f32 v128, v128, v132
    v_mfma_f32_16x16x16_bf16 v[136:139], v[24:25], v[68:69], v[136:139]
    ds_read_b64_tr_b16 v[40:41], v18 offset:512
    v_sub_f32 v120, v120, v124
    v_mfma_f32_16x16x16_bf16 v[88:91], v[20:21], v[44:45], v[88:91]
    v_sub_f32 v72, v72, v76
    v_sub_f32 v73, v73, v77
    v_mfma_f32_16x16x16_bf16 v[128:131], v[24:25], v[44:45], v[128:131]
    v_sub_f32 v99, v99, v103
    v_sub_f32 v74, v74, v78
    v_mfma_f32_16x16x16_bf16 v[80:83], v[20:21], v[48:49], v[80:83]
    v_sub_f32 v137, v137, v141
    v_sub_f32 v138, v138, v142
    v_mfma_f32_16x16x16_bf16 v[120:123], v[24:25], v[48:49], v[120:123]
    v_sub_f32 v139, v139, v143
    s_waitcnt lgkmcnt(0)
    v_mfma_f32_16x16x16_bf16 v[72:75], v[20:21], v[52:53], v[72:75]
    v_sub_f32 v89, v89, v93
    v_sub_f32 v90, v90, v94
    v_mfma_f32_16x16x16_bf16 v[112:115], v[24:25], v[52:53], v[112:115]
    v_sub_f32 v91, v91, v95
    v_sub_f32 v129, v129, v133
    v_mfma_f32_16x16x16_bf16 v[232:235], v[28:29], v[68:69], v[232:235]
    v_sub_f32 v130, v130, v134
    v_sub_f32 v131, v131, v135
    v_mfma_f32_16x16x16_bf16 v[240:243], v[32:33], v[68:69], v[240:243]
    s_barrier
    v_xor_b32 v5, 0xdc00, v5
    v_mfma_f32_16x16x16_bf16 v[184:187], v[36:37], v[64:65], v[184:187]
    ds_read_b64_tr_b16 v[20:21], v1 offset:18624
    ds_read_b64_tr_b16 v[22:23], v1 offset:20928
    v_mfma_f32_16x16x16_bf16 v[224:227], v[40:41], v[64:65], v[224:227]
    ds_read_b64_tr_b16 v[24:25], v2 offset:18912
    ds_read_b64_tr_b16 v[26:27], v2 offset:21216
    v_mfma_f32_16x16x16_bf16 v[176:179], v[36:37], v[68:69], v[176:179]
    ds_read_b128 v[56:59], v5 offset:4096
    v_sub_f32 v80, v80, v84
    v_mfma_f32_16x16x16_bf16 v[216:219], v[40:41], v[68:69], v[216:219]
    ds_read_b128 v[60:63], v5 offset:5120
    v_sub_f32 v81, v81, v85
    v_mfma_f32_16x16x16_bf16 v[168:171], v[36:37], v[44:45], v[168:171]
    v_sub_f32 v82, v82, v86
    v_sub_f32 v83, v83, v87
    v_mfma_f32_16x16x16_bf16 v[208:211], v[40:41], v[44:45], v[208:211]
    ds_read_b128 v[44:47], v5 offset:1024
    v_sub_f32 v121, v121, v125
    v_mfma_f32_16x16x16_bf16 v[160:163], v[36:37], v[48:49], v[160:163]
    v_sub_f32 v122, v122, v126
    v_sub_f32 v123, v123, v127
    v_mfma_f32_16x16x16_bf16 v[200:203], v[40:41], v[48:49], v[200:203]
    ds_read_b128 v[48:51], v5 offset:2048
    v_sub_f32 v75, v75, v79
    v_mfma_f32_16x16x16_bf16 v[152:155], v[36:37], v[52:53], v[152:155]
    v_sub_f32 v112, v112, v116
    v_sub_f32 v113, v113, v117
    v_mfma_f32_16x16x16_bf16 v[192:195], v[40:41], v[52:53], v[192:195]
    ds_read_b128 v[52:55], v5 offset:3072
    s_nop 7
    v_sub_f32 v114, v114, v118
    v_sub_f32 v115, v115, v119
    v_sub_f32 v232, v232, v236
    v_sub_f32 v233, v233, v237
    v_sub_f32 v234, v234, v238
    v_sub_f32 v235, v235, v239
    v_sub_f32 v240, v240, v244
    v_sub_f32 v241, v241, v245
    v_sub_f32 v242, v242, v246
    v_sub_f32 v243, v243, v247
    v_pk_fma_f32 v[108:109], v[108:109], s[60:61], v[104:105]
    v_pk_fma_f32 v[110:111], v[110:111], s[60:61], v[106:107]
    v_pk_fma_f32 v[100:101], v[100:101], s[60:61], v[96:97]
    v_pk_fma_f32 v[102:103], v[102:103], s[60:61], v[98:99]
    v_pk_fma_f32 v[92:93], v[92:93], s[60:61], v[88:89]
    v_pk_fma_f32 v[94:95], v[94:95], s[60:61], v[90:91]
    v_pk_fma_f32 v[84:85], v[84:85], s[60:61], v[80:81]
    v_pk_fma_f32 v[86:87], v[86:87], s[60:61], v[82:83]
    v_pk_fma_f32 v[76:77], v[76:77], s[60:61], v[72:73]
    v_pk_fma_f32 v[78:79], v[78:79], s[60:61], v[74:75]
    v_pk_fma_f32 v[148:149], v[148:149], s[60:61], v[144:145]
    v_pk_fma_f32 v[150:151], v[150:151], s[60:61], v[146:147]
    v_pk_fma_f32 v[140:141], v[140:141], s[60:61], v[136:137]
    v_pk_fma_f32 v[142:143], v[142:143], s[60:61], v[138:139]
    v_pk_fma_f32 v[132:133], v[132:133], s[60:61], v[128:129]
    v_pk_fma_f32 v[134:135], v[134:135], s[60:61], v[130:131]
    v_pk_fma_f32 v[124:125], v[124:125], s[60:61], v[120:121]
    v_pk_fma_f32 v[126:127], v[126:127], s[60:61], v[122:123]
    v_pk_fma_f32 v[116:117], v[116:117], s[60:61], v[112:113]
    v_pk_fma_f32 v[118:119], v[118:119], s[60:61], v[114:115]
    v_pk_fma_f32 v[236:237], v[236:237], s[60:61], v[232:233]
    v_pk_fma_f32 v[238:239], v[238:239], s[60:61], v[234:235]
    v_pk_fma_f32 v[244:245], v[244:245], s[60:61], v[240:241]
    v_pk_fma_f32 v[246:247], v[246:247], s[60:61], v[242:243]
    v_pk_fma_f32 v[188:189], v[188:189], s[60:61], v[184:185]
    v_pk_fma_f32 v[190:191], v[190:191], s[60:61], v[186:187]
    v_pk_fma_f32 v[228:229], v[228:229], s[60:61], v[224:225]
    v_pk_fma_f32 v[230:231], v[230:231], s[60:61], v[226:227]
    v_pk_fma_f32 v[180:181], v[180:181], s[60:61], v[176:177]
    v_pk_fma_f32 v[182:183], v[182:183], s[60:61], v[178:179]
    v_pk_fma_f32 v[220:221], v[220:221], s[60:61], v[216:217]
    v_pk_fma_f32 v[222:223], v[222:223], s[60:61], v[218:219]
    v_pk_fma_f32 v[172:173], v[172:173], s[60:61], v[168:169]
    v_pk_fma_f32 v[174:175], v[174:175], s[60:61], v[170:171]
    v_pk_fma_f32 v[212:213], v[212:213], s[60:61], v[208:209]
    v_pk_fma_f32 v[214:215], v[214:215], s[60:61], v[210:211]
    v_pk_fma_f32 v[164:165], v[164:165], s[60:61], v[160:161]
    v_pk_fma_f32 v[166:167], v[166:167], s[60:61], v[162:163]
    v_pk_fma_f32 v[204:205], v[204:205], s[60:61], v[200:201]
    v_pk_fma_f32 v[206:207], v[206:207], s[60:61], v[202:203]
    v_pk_fma_f32 v[156:157], v[156:157], s[60:61], v[152:153]
    v_pk_fma_f32 v[158:159], v[158:159], s[60:61], v[154:155]
    v_pk_fma_f32 v[196:197], v[196:197], s[60:61], v[192:193]
    v_pk_fma_f32 v[198:199], v[198:199], s[60:61], v[194:195]
    s_waitcnt lgkmcnt(0)
    s_mov_b32 s40, 0
.p2align 3
L_c3_46:
    s_waitcnt lgkmcnt(1)
    v_mfma_f32_16x16x32_bf16 v[104:107], v[20:23], v[44:47], v[104:107]
    ds_read_b64_tr_b16 v[28:29], v1 offset:18688
    v_mfma_f32_16x16x32_bf16 v[144:147], v[24:27], v[44:47], v[144:147]
    ds_read_b64_tr_b16 v[30:31], v1 offset:20992
    v_mfma_f32_16x16x32_bf16 v[96:99], v[20:23], v[48:51], v[96:99]
    ds_read_b64_tr_b16 v[32:33], v2 offset:18976
    v_mfma_f32_16x16x32_bf16 v[136:139], v[24:27], v[48:51], v[136:139]
    ds_read_b64_tr_b16 v[34:35], v2 offset:21280
    v_mfma_f32_16x16x32_bf16 v[88:91], v[20:23], v[52:55], v[88:91]
    ds_read_b64_tr_b16 v[36:37], v2 offset:18656
    v_mfma_f32_16x16x32_bf16 v[128:131], v[24:27], v[52:55], v[128:131]
    ds_read_b64_tr_b16 v[38:39], v2 offset:20960
    v_mfma_f32_16x16x32_bf16 v[80:83], v[20:23], v[56:59], v[80:83]
    ds_read_b64_tr_b16 v[40:41], v1 offset:18944
    v_mfma_f32_16x16x32_bf16 v[120:123], v[24:27], v[56:59], v[120:123]
    ds_read_b64_tr_b16 v[42:43], v1 offset:21248
    s_waitcnt lgkmcnt(4)
    v_mfma_f32_16x16x32_bf16 v[72:75], v[20:23], v[60:63], v[72:75]
    v_mfma_f32_16x16x32_bf16 v[112:115], v[24:27], v[60:63], v[112:115]
    v_mfma_f32_16x16x32_bf16 v[232:235], v[28:31], v[48:51], v[232:235]
    s_waitcnt lgkmcnt(0)
    v_mfma_f32_16x16x32_bf16 v[240:243], v[32:35], v[48:51], v[240:243]
    s_barrier
    v_mfma_f32_16x16x32_bf16 v[184:187], v[36:39], v[44:47], v[184:187]
    ds_read_b64_tr_b16 v[20:21], v1 offset:37056
    v_mfma_f32_16x16x32_bf16 v[224:227], v[40:43], v[44:47], v[224:227]
    ds_read_b64_tr_b16 v[22:23], v1 offset:39360
    v_mfma_f32_16x16x32_bf16 v[176:179], v[36:39], v[48:51], v[176:179]
    ds_read_b64_tr_b16 v[24:25], v2 offset:37344
    v_mfma_f32_16x16x32_bf16 v[216:219], v[40:43], v[48:51], v[216:219]
    ds_read_b64_tr_b16 v[26:27], v2 offset:39648
    v_mfma_f32_16x16x32_bf16 v[168:171], v[36:39], v[52:55], v[168:171]
    ds_read_b128 v[64:67], v5 offset:6144
    v_mfma_f32_16x16x32_bf16 v[208:211], v[40:43], v[52:55], v[208:211]
    v_mfma_f32_16x16x32_bf16 v[160:163], v[36:39], v[56:59], v[160:163]
    v_mfma_f32_16x16x32_bf16 v[200:203], v[40:43], v[56:59], v[200:203]
    v_mfma_f32_16x16x32_bf16 v[152:155], v[36:39], v[60:63], v[152:155]
    v_mfma_f32_16x16x32_bf16 v[192:195], v[40:43], v[60:63], v[192:195]
    s_waitcnt lgkmcnt(0)
    v_mfma_f32_16x16x32_bf16 v[104:107], v[20:23], v[48:51], v[104:107]
    ds_read_b64_tr_b16 v[28:29], v1 offset:37120
    v_mfma_f32_16x16x32_bf16 v[144:147], v[24:27], v[48:51], v[144:147]
    ds_read_b64_tr_b16 v[30:31], v1 offset:39424
    v_mfma_f32_16x16x32_bf16 v[96:99], v[20:23], v[52:55], v[96:99]
    ds_read_b64_tr_b16 v[32:33], v2 offset:37408
    v_mfma_f32_16x16x32_bf16 v[136:139], v[24:27], v[52:55], v[136:139]
    ds_read_b64_tr_b16 v[34:35], v2 offset:39712
    v_mfma_f32_16x16x32_bf16 v[88:91], v[20:23], v[56:59], v[88:91]
    ds_read_b64_tr_b16 v[36:37], v2 offset:37088
    v_mfma_f32_16x16x32_bf16 v[128:131], v[24:27], v[56:59], v[128:131]
    ds_read_b64_tr_b16 v[38:39], v2 offset:39392
    v_mfma_f32_16x16x32_bf16 v[80:83], v[20:23], v[60:63], v[80:83]
    ds_read_b64_tr_b16 v[40:41], v1 offset:37376
    v_mfma_f32_16x16x32_bf16 v[120:123], v[24:27], v[60:63], v[120:123]
    ds_read_b64_tr_b16 v[42:43], v1 offset:39680
    v_mfma_f32_16x16x32_bf16 v[72:75], v[20:23], v[64:67], v[72:75]
    v_mfma_f32_16x16x32_bf16 v[112:115], v[24:27], v[64:67], v[112:115]
    s_waitcnt lgkmcnt(2)
    v_mfma_f32_16x16x32_bf16 v[232:235], v[28:31], v[52:55], v[232:235]
    s_waitcnt lgkmcnt(0)
    v_mfma_f32_16x16x32_bf16 v[240:243], v[32:35], v[52:55], v[240:243]
    s_barrier
    v_mfma_f32_16x16x32_bf16 v[184:187], v[36:39], v[48:51], v[184:187]
    ds_read_b64_tr_b16 v[20:21], v3 offset:192
    v_mfma_f32_16x16x32_bf16 v[224:227], v[40:43], v[48:51], v[224:227]
    ds_read_b64_tr_b16 v[22:23], v3 offset:2496
    v_mfma_f32_16x16x32_bf16 v[176:179], v[36:39], v[52:55], v[176:179]
    ds_read_b64_tr_b16 v[24:25], v4 offset:480
    v_mfma_f32_16x16x32_bf16 v[216:219], v[40:43], v[52:55], v[216:219]
    ds_read_b64_tr_b16 v[26:27], v4 offset:2784
    v_mfma_f32_16x16x32_bf16 v[168:171], v[36:39], v[56:59], v[168:171]
    ds_read_b128 v[44:47], v5 offset:7168
    v_mfma_f32_16x16x32_bf16 v[208:211], v[40:43], v[56:59], v[208:211]
    v_mfma_f32_16x16x32_bf16 v[160:163], v[36:39], v[60:63], v[160:163]
    v_mfma_f32_16x16x32_bf16 v[200:203], v[40:43], v[60:63], v[200:203]
    v_mfma_f32_16x16x32_bf16 v[152:155], v[36:39], v[64:67], v[152:155]
    v_mfma_f32_16x16x32_bf16 v[192:195], v[40:43], v[64:67], v[192:195]
    s_waitcnt lgkmcnt(0)
    v_mfma_f32_16x16x32_bf16 v[104:107], v[20:23], v[52:55], v[104:107]
    ds_read_b64_tr_b16 v[28:29], v3 offset:256
    v_mfma_f32_16x16x32_bf16 v[144:147], v[24:27], v[52:55], v[144:147]
    ds_read_b64_tr_b16 v[30:31], v3 offset:2560
    v_mfma_f32_16x16x32_bf16 v[96:99], v[20:23], v[56:59], v[96:99]
    ds_read_b64_tr_b16 v[32:33], v4 offset:544
    v_mfma_f32_16x16x32_bf16 v[136:139], v[24:27], v[56:59], v[136:139]
    ds_read_b64_tr_b16 v[34:35], v4 offset:2848
    v_mfma_f32_16x16x32_bf16 v[88:91], v[20:23], v[60:63], v[88:91]
    ds_read_b64_tr_b16 v[36:37], v4 offset:224
    v_mfma_f32_16x16x32_bf16 v[128:131], v[24:27], v[60:63], v[128:131]
    ds_read_b64_tr_b16 v[38:39], v4 offset:2528
    v_mfma_f32_16x16x32_bf16 v[80:83], v[20:23], v[64:67], v[80:83]
    ds_read_b64_tr_b16 v[40:41], v3 offset:512
    v_mfma_f32_16x16x32_bf16 v[120:123], v[24:27], v[64:67], v[120:123]
    ds_read_b64_tr_b16 v[42:43], v3 offset:2816
    v_mfma_f32_16x16x32_bf16 v[72:75], v[20:23], v[44:47], v[72:75]
    v_mfma_f32_16x16x32_bf16 v[112:115], v[24:27], v[44:47], v[112:115]
    s_waitcnt lgkmcnt(2)
    v_mfma_f32_16x16x32_bf16 v[232:235], v[28:31], v[56:59], v[232:235]
    s_waitcnt lgkmcnt(0)
    v_mfma_f32_16x16x32_bf16 v[240:243], v[32:35], v[56:59], v[240:243]
    s_barrier
    v_mfma_f32_16x16x32_bf16 v[184:187], v[36:39], v[52:55], v[184:187]
    ds_read_b64_tr_b16 v[20:21], v3 offset:18624
    v_mfma_f32_16x16x32_bf16 v[224:227], v[40:43], v[52:55], v[224:227]
    ds_read_b64_tr_b16 v[22:23], v3 offset:20928
    v_mfma_f32_16x16x32_bf16 v[176:179], v[36:39], v[56:59], v[176:179]
    ds_read_b64_tr_b16 v[24:25], v4 offset:18912
    v_mfma_f32_16x16x32_bf16 v[216:219], v[40:43], v[56:59], v[216:219]
    ds_read_b64_tr_b16 v[26:27], v4 offset:21216
    v_mfma_f32_16x16x32_bf16 v[168:171], v[36:39], v[60:63], v[168:171]
    ds_read_b128 v[48:51], v5 offset:8192
    v_mfma_f32_16x16x32_bf16 v[208:211], v[40:43], v[60:63], v[208:211]
    v_mfma_f32_16x16x32_bf16 v[160:163], v[36:39], v[64:67], v[160:163]
    v_mfma_f32_16x16x32_bf16 v[200:203], v[40:43], v[64:67], v[200:203]
    v_mfma_f32_16x16x32_bf16 v[152:155], v[36:39], v[44:47], v[152:155]
    v_mfma_f32_16x16x32_bf16 v[192:195], v[40:43], v[44:47], v[192:195]
    s_waitcnt lgkmcnt(0)
    v_mfma_f32_16x16x32_bf16 v[104:107], v[20:23], v[56:59], v[104:107]
    ds_read_b64_tr_b16 v[28:29], v3 offset:18688
    v_mfma_f32_16x16x32_bf16 v[144:147], v[24:27], v[56:59], v[144:147]
    ds_read_b64_tr_b16 v[30:31], v3 offset:20992
    v_mfma_f32_16x16x32_bf16 v[96:99], v[20:23], v[60:63], v[96:99]
    ds_read_b64_tr_b16 v[32:33], v4 offset:18976
    v_mfma_f32_16x16x32_bf16 v[136:139], v[24:27], v[60:63], v[136:139]
    ds_read_b64_tr_b16 v[34:35], v4 offset:21280
    v_mfma_f32_16x16x32_bf16 v[88:91], v[20:23], v[64:67], v[88:91]
    ds_read_b64_tr_b16 v[36:37], v4 offset:18656
    v_mfma_f32_16x16x32_bf16 v[128:131], v[24:27], v[64:67], v[128:131]
    ds_read_b64_tr_b16 v[38:39], v4 offset:20960
    v_mfma_f32_16x16x32_bf16 v[80:83], v[20:23], v[44:47], v[80:83]
    ds_read_b64_tr_b16 v[40:41], v3 offset:18944
    v_mfma_f32_16x16x32_bf16 v[120:123], v[24:27], v[44:47], v[120:123]
    ds_read_b64_tr_b16 v[42:43], v3 offset:21248
    v_mfma_f32_16x16x32_bf16 v[72:75], v[20:23], v[48:51], v[72:75]
    v_mfma_f32_16x16x32_bf16 v[112:115], v[24:27], v[48:51], v[112:115]
    s_waitcnt lgkmcnt(2)
    v_mfma_f32_16x16x32_bf16 v[232:235], v[28:31], v[60:63], v[232:235]
    s_waitcnt lgkmcnt(0)
    v_mfma_f32_16x16x32_bf16 v[240:243], v[32:35], v[60:63], v[240:243]
    s_barrier
    v_mfma_f32_16x16x32_bf16 v[184:187], v[36:39], v[56:59], v[184:187]
    ds_read_b64_tr_b16 v[20:21], v1 offset:192
    v_mfma_f32_16x16x32_bf16 v[224:227], v[40:43], v[56:59], v[224:227]
    ds_read_b64_tr_b16 v[22:23], v1 offset:2496
    v_mfma_f32_16x16x32_bf16 v[176:179], v[36:39], v[60:63], v[176:179]
    ds_read_b64_tr_b16 v[24:25], v2 offset:480
    v_mfma_f32_16x16x32_bf16 v[216:219], v[40:43], v[60:63], v[216:219]
    ds_read_b64_tr_b16 v[26:27], v2 offset:2784
    v_mfma_f32_16x16x32_bf16 v[168:171], v[36:39], v[64:67], v[168:171]
    ds_read_b128 v[52:55], v5 offset:9216
    v_mfma_f32_16x16x32_bf16 v[208:211], v[40:43], v[64:67], v[208:211]
    v_mfma_f32_16x16x32_bf16 v[160:163], v[36:39], v[44:47], v[160:163]
    v_mfma_f32_16x16x32_bf16 v[200:203], v[40:43], v[44:47], v[200:203]
    v_mfma_f32_16x16x32_bf16 v[152:155], v[36:39], v[48:51], v[152:155]
    v_mfma_f32_16x16x32_bf16 v[192:195], v[40:43], v[48:51], v[192:195]
    s_waitcnt lgkmcnt(0)
    v_mfma_f32_16x16x32_bf16 v[104:107], v[20:23], v[60:63], v[104:107]
    ds_read_b64_tr_b16 v[28:29], v1 offset:256
    v_mfma_f32_16x16x32_bf16 v[144:147], v[24:27], v[60:63], v[144:147]
    ds_read_b64_tr_b16 v[30:31], v1 offset:2560
    v_mfma_f32_16x16x32_bf16 v[96:99], v[20:23], v[64:67], v[96:99]
    ds_read_b64_tr_b16 v[32:33], v2 offset:544
    v_mfma_f32_16x16x32_bf16 v[136:139], v[24:27], v[64:67], v[136:139]
    ds_read_b64_tr_b16 v[34:35], v2 offset:2848
    v_mfma_f32_16x16x32_bf16 v[88:91], v[20:23], v[44:47], v[88:91]
    ds_read_b64_tr_b16 v[36:37], v2 offset:224
    v_mfma_f32_16x16x32_bf16 v[128:131], v[24:27], v[44:47], v[128:131]
    ds_read_b64_tr_b16 v[38:39], v2 offset:2528
    v_mfma_f32_16x16x32_bf16 v[80:83], v[20:23], v[48:51], v[80:83]
    ds_read_b64_tr_b16 v[40:41], v1 offset:512
    v_mfma_f32_16x16x32_bf16 v[120:123], v[24:27], v[48:51], v[120:123]
    ds_read_b64_tr_b16 v[42:43], v1 offset:2816
    v_mfma_f32_16x16x32_bf16 v[72:75], v[20:23], v[52:55], v[72:75]
    v_mfma_f32_16x16x32_bf16 v[112:115], v[24:27], v[52:55], v[112:115]
    s_waitcnt lgkmcnt(2)
    v_mfma_f32_16x16x32_bf16 v[232:235], v[28:31], v[64:67], v[232:235]
    s_waitcnt lgkmcnt(0)
    v_mfma_f32_16x16x32_bf16 v[240:243], v[32:35], v[64:67], v[240:243]
    s_barrier
    v_mfma_f32_16x16x32_bf16 v[184:187], v[36:39], v[60:63], v[184:187]
    ds_read_b64_tr_b16 v[20:21], v1 offset:18624
    ds_read_b64_tr_b16 v[22:23], v1 offset:20928
    v_mfma_f32_16x16x32_bf16 v[224:227], v[40:43], v[60:63], v[224:227]
    ds_read_b128 v[56:59], v5 offset:10240
    ds_read_b64_tr_b16 v[24:25], v2 offset:18912
    v_mfma_f32_16x16x32_bf16 v[176:179], v[36:39], v[64:67], v[176:179]
    ds_read_b64_tr_b16 v[26:27], v2 offset:21216
    v_mfma_f32_16x16x32_bf16 v[216:219], v[40:43], v[64:67], v[216:219]
    ds_read_b128 v[60:63], v5 offset:11264
    v_mfma_f32_16x16x32_bf16 v[168:171], v[36:39], v[44:47], v[168:171]
    ds_read_b128 v[64:67], v5 offset:12288
    v_mfma_f32_16x16x32_bf16 v[208:211], v[40:43], v[44:47], v[208:211]
    ds_read_b128 v[44:47], v5 offset:13312
    v_mfma_f32_16x16x32_bf16 v[160:163], v[36:39], v[48:51], v[160:163]
    v_mfma_f32_16x16x32_bf16 v[200:203], v[40:43], v[48:51], v[200:203]
    ds_read_b128 v[48:51], v5 offset:14336
    v_mfma_f32_16x16x32_bf16 v[152:155], v[36:39], v[52:55], v[152:155]
    v_mfma_f32_16x16x32_bf16 v[192:195], v[40:43], v[52:55], v[192:195]
    s_waitcnt lgkmcnt(1)
    v_mfma_f32_16x16x32_bf16 v[108:111], v[20:23], v[56:59], v[108:111]
    ds_read_b64_tr_b16 v[28:29], v1 offset:18688
    v_mfma_f32_16x16x32_bf16 v[148:151], v[24:27], v[56:59], v[148:151]
    ds_read_b64_tr_b16 v[30:31], v1 offset:20992
    v_mfma_f32_16x16x32_bf16 v[100:103], v[20:23], v[60:63], v[100:103]
    ds_read_b64_tr_b16 v[32:33], v2 offset:18976
    v_mfma_f32_16x16x32_bf16 v[140:143], v[24:27], v[60:63], v[140:143]
    ds_read_b64_tr_b16 v[34:35], v2 offset:21280
    v_mfma_f32_16x16x32_bf16 v[92:95], v[20:23], v[64:67], v[92:95]
    ds_read_b64_tr_b16 v[36:37], v2 offset:18656
    v_mfma_f32_16x16x32_bf16 v[132:135], v[24:27], v[64:67], v[132:135]
    ds_read_b64_tr_b16 v[38:39], v2 offset:20960
    v_mfma_f32_16x16x32_bf16 v[84:87], v[20:23], v[44:47], v[84:87]
    ds_read_b64_tr_b16 v[40:41], v1 offset:18944
    v_mfma_f32_16x16x32_bf16 v[124:127], v[24:27], v[44:47], v[124:127]
    ds_read_b64_tr_b16 v[42:43], v1 offset:21248
    s_waitcnt lgkmcnt(4)
    v_mfma_f32_16x16x32_bf16 v[76:79], v[20:23], v[48:51], v[76:79]
    v_mfma_f32_16x16x32_bf16 v[116:119], v[24:27], v[48:51], v[116:119]
    v_mfma_f32_16x16x32_bf16 v[236:239], v[28:31], v[60:63], v[236:239]
    s_waitcnt lgkmcnt(0)
    v_mfma_f32_16x16x32_bf16 v[244:247], v[32:35], v[60:63], v[244:247]
    s_barrier
    v_mfma_f32_16x16x32_bf16 v[188:191], v[36:39], v[56:59], v[188:191]
    ds_read_b64_tr_b16 v[20:21], v1 offset:37056
    v_mfma_f32_16x16x32_bf16 v[228:231], v[40:43], v[56:59], v[228:231]
    ds_read_b64_tr_b16 v[22:23], v1 offset:39360
    v_mfma_f32_16x16x32_bf16 v[180:183], v[36:39], v[60:63], v[180:183]
    ds_read_b64_tr_b16 v[24:25], v2 offset:37344
    v_mfma_f32_16x16x32_bf16 v[220:223], v[40:43], v[60:63], v[220:223]
    ds_read_b64_tr_b16 v[26:27], v2 offset:39648
    v_mfma_f32_16x16x32_bf16 v[172:175], v[36:39], v[64:67], v[172:175]
    ds_read_b128 v[52:55], v5 offset:15360
    v_mfma_f32_16x16x32_bf16 v[212:215], v[40:43], v[64:67], v[212:215]
    v_mfma_f32_16x16x32_bf16 v[164:167], v[36:39], v[44:47], v[164:167]
    v_mfma_f32_16x16x32_bf16 v[204:207], v[40:43], v[44:47], v[204:207]
    v_mfma_f32_16x16x32_bf16 v[156:159], v[36:39], v[48:51], v[156:159]
    v_mfma_f32_16x16x32_bf16 v[196:199], v[40:43], v[48:51], v[196:199]
    s_waitcnt lgkmcnt(0)
    v_mfma_f32_16x16x32_bf16 v[108:111], v[20:23], v[60:63], v[108:111]
    ds_read_b64_tr_b16 v[28:29], v1 offset:37120
    v_mfma_f32_16x16x32_bf16 v[148:151], v[24:27], v[60:63], v[148:151]
    ds_read_b64_tr_b16 v[30:31], v1 offset:39424
    v_mfma_f32_16x16x32_bf16 v[100:103], v[20:23], v[64:67], v[100:103]
    ds_read_b64_tr_b16 v[32:33], v2 offset:37408
    v_mfma_f32_16x16x32_bf16 v[140:143], v[24:27], v[64:67], v[140:143]
    ds_read_b64_tr_b16 v[34:35], v2 offset:39712
    v_mfma_f32_16x16x32_bf16 v[92:95], v[20:23], v[44:47], v[92:95]
    ds_read_b64_tr_b16 v[36:37], v2 offset:37088
    v_mfma_f32_16x16x32_bf16 v[132:135], v[24:27], v[44:47], v[132:135]
    ds_read_b64_tr_b16 v[38:39], v2 offset:39392
    v_mfma_f32_16x16x32_bf16 v[84:87], v[20:23], v[48:51], v[84:87]
    ds_read_b64_tr_b16 v[40:41], v1 offset:37376
    v_mfma_f32_16x16x32_bf16 v[124:127], v[24:27], v[48:51], v[124:127]
    ds_read_b64_tr_b16 v[42:43], v1 offset:39680
    v_mfma_f32_16x16x32_bf16 v[76:79], v[20:23], v[52:55], v[76:79]
    v_mfma_f32_16x16x32_bf16 v[116:119], v[24:27], v[52:55], v[116:119]
    s_waitcnt lgkmcnt(2)
    v_mfma_f32_16x16x32_bf16 v[236:239], v[28:31], v[64:67], v[236:239]
    s_waitcnt lgkmcnt(0)
    v_mfma_f32_16x16x32_bf16 v[244:247], v[32:35], v[64:67], v[244:247]
    s_barrier
    v_mfma_f32_16x16x32_bf16 v[188:191], v[36:39], v[60:63], v[188:191]
    ds_read_b64_tr_b16 v[20:21], v3 offset:192
    v_mfma_f32_16x16x32_bf16 v[228:231], v[40:43], v[60:63], v[228:231]
    ds_read_b64_tr_b16 v[22:23], v3 offset:2496
    v_mfma_f32_16x16x32_bf16 v[180:183], v[36:39], v[64:67], v[180:183]
    ds_read_b64_tr_b16 v[24:25], v4 offset:480
    v_mfma_f32_16x16x32_bf16 v[220:223], v[40:43], v[64:67], v[220:223]
    ds_read_b64_tr_b16 v[26:27], v4 offset:2784
    v_mfma_f32_16x16x32_bf16 v[172:175], v[36:39], v[44:47], v[172:175]
    ds_read_b128 v[56:59], v5 offset:16384
    v_mfma_f32_16x16x32_bf16 v[212:215], v[40:43], v[44:47], v[212:215]
    v_mfma_f32_16x16x32_bf16 v[164:167], v[36:39], v[48:51], v[164:167]
    v_mfma_f32_16x16x32_bf16 v[204:207], v[40:43], v[48:51], v[204:207]
    v_mfma_f32_16x16x32_bf16 v[156:159], v[36:39], v[52:55], v[156:159]
    v_mfma_f32_16x16x32_bf16 v[196:199], v[40:43], v[52:55], v[196:199]
    s_waitcnt lgkmcnt(0)
    v_mfma_f32_16x16x32_bf16 v[108:111], v[20:23], v[64:67], v[108:111]
    ds_read_b64_tr_b16 v[28:29], v3 offset:256
    v_mfma_f32_16x16x32_bf16 v[148:151], v[24:27], v[64:67], v[148:151]
    ds_read_b64_tr_b16 v[30:31], v3 offset:2560
    v_mfma_f32_16x16x32_bf16 v[100:103], v[20:23], v[44:47], v[100:103]
    ds_read_b64_tr_b16 v[32:33], v4 offset:544
    v_mfma_f32_16x16x32_bf16 v[140:143], v[24:27], v[44:47], v[140:143]
    ds_read_b64_tr_b16 v[34:35], v4 offset:2848
    v_mfma_f32_16x16x32_bf16 v[92:95], v[20:23], v[48:51], v[92:95]
    ds_read_b64_tr_b16 v[36:37], v4 offset:224
    v_mfma_f32_16x16x32_bf16 v[132:135], v[24:27], v[48:51], v[132:135]
    ds_read_b64_tr_b16 v[38:39], v4 offset:2528
    v_mfma_f32_16x16x32_bf16 v[84:87], v[20:23], v[52:55], v[84:87]
    ds_read_b64_tr_b16 v[40:41], v3 offset:512
    v_mfma_f32_16x16x32_bf16 v[124:127], v[24:27], v[52:55], v[124:127]
    ds_read_b64_tr_b16 v[42:43], v3 offset:2816
    v_mfma_f32_16x16x32_bf16 v[76:79], v[20:23], v[56:59], v[76:79]
    v_mfma_f32_16x16x32_bf16 v[116:119], v[24:27], v[56:59], v[116:119]
    s_waitcnt lgkmcnt(2)
    v_mfma_f32_16x16x32_bf16 v[236:239], v[28:31], v[44:47], v[236:239]
    s_waitcnt lgkmcnt(0)
    v_mfma_f32_16x16x32_bf16 v[244:247], v[32:35], v[44:47], v[244:247]
    s_barrier
    v_mfma_f32_16x16x32_bf16 v[188:191], v[36:39], v[64:67], v[188:191]
    ds_read_b64_tr_b16 v[20:21], v3 offset:18624
    v_mfma_f32_16x16x32_bf16 v[228:231], v[40:43], v[64:67], v[228:231]
    ds_read_b64_tr_b16 v[22:23], v3 offset:20928
    v_mfma_f32_16x16x32_bf16 v[180:183], v[36:39], v[44:47], v[180:183]
    ds_read_b64_tr_b16 v[24:25], v4 offset:18912
    v_mfma_f32_16x16x32_bf16 v[220:223], v[40:43], v[44:47], v[220:223]
    ds_read_b64_tr_b16 v[26:27], v4 offset:21216
    v_mfma_f32_16x16x32_bf16 v[172:175], v[36:39], v[48:51], v[172:175]
    ds_read_b128 v[60:63], v5 offset:17408
    v_mfma_f32_16x16x32_bf16 v[212:215], v[40:43], v[48:51], v[212:215]
    v_mfma_f32_16x16x32_bf16 v[164:167], v[36:39], v[52:55], v[164:167]
    v_mfma_f32_16x16x32_bf16 v[204:207], v[40:43], v[52:55], v[204:207]
    v_mfma_f32_16x16x32_bf16 v[156:159], v[36:39], v[56:59], v[156:159]
    v_mfma_f32_16x16x32_bf16 v[196:199], v[40:43], v[56:59], v[196:199]
    s_waitcnt lgkmcnt(0)
    v_mfma_f32_16x16x32_bf16 v[108:111], v[20:23], v[44:47], v[108:111]
    ds_read_b64_tr_b16 v[28:29], v3 offset:18688
    v_mfma_f32_16x16x32_bf16 v[148:151], v[24:27], v[44:47], v[148:151]
    ds_read_b64_tr_b16 v[30:31], v3 offset:20992
    v_mfma_f32_16x16x32_bf16 v[100:103], v[20:23], v[48:51], v[100:103]
    ds_read_b64_tr_b16 v[32:33], v4 offset:18976
    v_mfma_f32_16x16x32_bf16 v[140:143], v[24:27], v[48:51], v[140:143]
    ds_read_b64_tr_b16 v[34:35], v4 offset:21280
    v_mfma_f32_16x16x32_bf16 v[92:95], v[20:23], v[52:55], v[92:95]
    ds_read_b64_tr_b16 v[36:37], v4 offset:18656
    v_mfma_f32_16x16x32_bf16 v[132:135], v[24:27], v[52:55], v[132:135]
    ds_read_b64_tr_b16 v[38:39], v4 offset:20960
    v_mfma_f32_16x16x32_bf16 v[84:87], v[20:23], v[56:59], v[84:87]
    ds_read_b64_tr_b16 v[40:41], v3 offset:18944
    v_mfma_f32_16x16x32_bf16 v[124:127], v[24:27], v[56:59], v[124:127]
    ds_read_b64_tr_b16 v[42:43], v3 offset:21248
    v_mfma_f32_16x16x32_bf16 v[76:79], v[20:23], v[60:63], v[76:79]
    v_mfma_f32_16x16x32_bf16 v[116:119], v[24:27], v[60:63], v[116:119]
    s_waitcnt lgkmcnt(2)
    v_mfma_f32_16x16x32_bf16 v[236:239], v[28:31], v[48:51], v[236:239]
    s_waitcnt lgkmcnt(0)
    v_mfma_f32_16x16x32_bf16 v[244:247], v[32:35], v[48:51], v[244:247]
    s_barrier
    v_mfma_f32_16x16x32_bf16 v[188:191], v[36:39], v[44:47], v[188:191]
    ds_read_b64_tr_b16 v[20:21], v1 offset:192
    v_mfma_f32_16x16x32_bf16 v[228:231], v[40:43], v[44:47], v[228:231]
    ds_read_b64_tr_b16 v[22:23], v1 offset:2496
    v_mfma_f32_16x16x32_bf16 v[180:183], v[36:39], v[48:51], v[180:183]
    ds_read_b64_tr_b16 v[24:25], v2 offset:480
    v_mfma_f32_16x16x32_bf16 v[220:223], v[40:43], v[48:51], v[220:223]
    ds_read_b64_tr_b16 v[26:27], v2 offset:2784
    v_mfma_f32_16x16x32_bf16 v[172:175], v[36:39], v[52:55], v[172:175]
    ds_read_b128 v[64:67], v5 offset:18432
    v_mfma_f32_16x16x32_bf16 v[212:215], v[40:43], v[52:55], v[212:215]
    v_mfma_f32_16x16x32_bf16 v[164:167], v[36:39], v[56:59], v[164:167]
    v_mfma_f32_16x16x32_bf16 v[204:207], v[40:43], v[56:59], v[204:207]
    v_mfma_f32_16x16x32_bf16 v[156:159], v[36:39], v[60:63], v[156:159]
    v_mfma_f32_16x16x32_bf16 v[196:199], v[40:43], v[60:63], v[196:199]
    s_waitcnt lgkmcnt(0)
    v_mfma_f32_16x16x32_bf16 v[108:111], v[20:23], v[48:51], v[108:111]
    ds_read_b64_tr_b16 v[28:29], v1 offset:256
    v_mfma_f32_16x16x32_bf16 v[148:151], v[24:27], v[48:51], v[148:151]
    ds_read_b64_tr_b16 v[30:31], v1 offset:2560
    v_mfma_f32_16x16x32_bf16 v[100:103], v[20:23], v[52:55], v[100:103]
    ds_read_b64_tr_b16 v[32:33], v2 offset:544
    v_mfma_f32_16x16x32_bf16 v[140:143], v[24:27], v[52:55], v[140:143]
    ds_read_b64_tr_b16 v[34:35], v2 offset:2848
    v_mfma_f32_16x16x32_bf16 v[92:95], v[20:23], v[56:59], v[92:95]
    ds_read_b64_tr_b16 v[36:37], v2 offset:224
    v_mfma_f32_16x16x32_bf16 v[132:135], v[24:27], v[56:59], v[132:135]
    ds_read_b64_tr_b16 v[38:39], v2 offset:2528
    v_mfma_f32_16x16x32_bf16 v[84:87], v[20:23], v[60:63], v[84:87]
    ds_read_b64_tr_b16 v[40:41], v1 offset:512
    v_mfma_f32_16x16x32_bf16 v[124:127], v[24:27], v[60:63], v[124:127]
    ds_read_b64_tr_b16 v[42:43], v1 offset:2816
    v_mfma_f32_16x16x32_bf16 v[76:79], v[20:23], v[64:67], v[76:79]
    v_mfma_f32_16x16x32_bf16 v[116:119], v[24:27], v[64:67], v[116:119]
    s_waitcnt lgkmcnt(2)
    v_mfma_f32_16x16x32_bf16 v[236:239], v[28:31], v[52:55], v[236:239]
    s_waitcnt lgkmcnt(0)
    v_mfma_f32_16x16x32_bf16 v[244:247], v[32:35], v[52:55], v[244:247]
    s_barrier
    v_xor_b32 v5, 0xdc00, v5
    v_mfma_f32_16x16x32_bf16 v[188:191], v[36:39], v[48:51], v[188:191]
    ds_read_b64_tr_b16 v[20:21], v1 offset:18624
    ds_read_b64_tr_b16 v[22:23], v1 offset:20928
    v_mfma_f32_16x16x32_bf16 v[228:231], v[40:43], v[48:51], v[228:231]
    ds_read_b128 v[44:47], v5 offset:1024
    ds_read_b64_tr_b16 v[24:25], v2 offset:18912
    v_mfma_f32_16x16x32_bf16 v[180:183], v[36:39], v[52:55], v[180:183]
    ds_read_b64_tr_b16 v[26:27], v2 offset:21216
    ds_read_b128 v[48:51], v5 offset:2048
    v_mfma_f32_16x16x32_bf16 v[220:223], v[40:43], v[52:55], v[220:223]
    ds_read_b128 v[52:55], v5 offset:3072
    v_mfma_f32_16x16x32_bf16 v[172:175], v[36:39], v[56:59], v[172:175]
    v_mfma_f32_16x16x32_bf16 v[212:215], v[40:43], v[56:59], v[212:215]
    ds_read_b128 v[56:59], v5 offset:4096
    v_mfma_f32_16x16x32_bf16 v[164:167], v[36:39], v[60:63], v[164:167]
    s_add_u32 s40, s40, 1
    s_cmp_lt_u32 s40, 4
    v_mfma_f32_16x16x32_bf16 v[204:207], v[40:43], v[60:63], v[204:207]
    ds_read_b128 v[60:63], v5 offset:5120
    v_mfma_f32_16x16x32_bf16 v[156:159], v[36:39], v[64:67], v[156:159]
    v_mfma_f32_16x16x32_bf16 v[196:199], v[40:43], v[64:67], v[196:199]
    s_cbranch_scc1 L_c3_46
    s_waitcnt lgkmcnt(1)
    v_mfma_f32_16x16x32_bf16 v[104:107], v[20:23], v[44:47], v[104:107]
    ds_read_b64_tr_b16 v[28:29], v1 offset:18688
    v_mfma_f32_16x16x32_bf16 v[144:147], v[24:27], v[44:47], v[144:147]
    ds_read_b64_tr_b16 v[30:31], v1 offset:20992
    v_mfma_f32_16x16x32_bf16 v[96:99], v[20:23], v[48:51], v[96:99]
    ds_read_b64_tr_b16 v[32:33], v2 offset:18976
    v_mfma_f32_16x16x32_bf16 v[136:139], v[24:27], v[48:51], v[136:139]
    ds_read_b64_tr_b16 v[34:35], v2 offset:21280
    v_mfma_f32_16x16x32_bf16 v[88:91], v[20:23], v[52:55], v[88:91]
    ds_read_b64_tr_b16 v[36:37], v2 offset:18656
    v_mfma_f32_16x16x32_bf16 v[128:131], v[24:27], v[52:55], v[128:131]
    ds_read_b64_tr_b16 v[38:39], v2 offset:20960
    v_mfma_f32_16x16x32_bf16 v[80:83], v[20:23], v[56:59], v[80:83]
    ds_read_b64_tr_b16 v[40:41], v1 offset:18944
    v_mfma_f32_16x16x32_bf16 v[120:123], v[24:27], v[56:59], v[120:123]
    ds_read_b64_tr_b16 v[42:43], v1 offset:21248
    s_waitcnt lgkmcnt(4)
    v_mfma_f32_16x16x32_bf16 v[72:75], v[20:23], v[60:63], v[72:75]
    v_mfma_f32_16x16x32_bf16 v[112:115], v[24:27], v[60:63], v[112:115]
    v_mfma_f32_16x16x32_bf16 v[232:235], v[28:31], v[48:51], v[232:235]
    s_waitcnt lgkmcnt(0)
    v_mfma_f32_16x16x32_bf16 v[240:243], v[32:35], v[48:51], v[240:243]
    s_barrier
    v_mfma_f32_16x16x32_bf16 v[184:187], v[36:39], v[44:47], v[184:187]
    ds_read_b64_tr_b16 v[20:21], v1 offset:37056
    v_mfma_f32_16x16x32_bf16 v[224:227], v[40:43], v[44:47], v[224:227]
    ds_read_b64_tr_b16 v[22:23], v1 offset:39360
    v_mfma_f32_16x16x32_bf16 v[176:179], v[36:39], v[48:51], v[176:179]
    ds_read_b64_tr_b16 v[24:25], v2 offset:37344
    v_mfma_f32_16x16x32_bf16 v[216:219], v[40:43], v[48:51], v[216:219]
    ds_read_b64_tr_b16 v[26:27], v2 offset:39648
    v_mfma_f32_16x16x32_bf16 v[168:171], v[36:39], v[52:55], v[168:171]
    ds_read_b128 v[64:67], v5 offset:6144
    v_mfma_f32_16x16x32_bf16 v[208:211], v[40:43], v[52:55], v[208:211]
    ds_read_b128 v[68:71], v5 offset:7168
    v_mfma_f32_16x16x32_bf16 v[160:163], v[36:39], v[56:59], v[160:163]
    v_mfma_f32_16x16x32_bf16 v[200:203], v[40:43], v[56:59], v[200:203]
    v_mfma_f32_16x16x32_bf16 v[152:155], v[36:39], v[60:63], v[152:155]
    v_mfma_f32_16x16x32_bf16 v[192:195], v[40:43], v[60:63], v[192:195]
    s_waitcnt lgkmcnt(0)
    v_mfma_f32_16x16x32_bf16 v[104:107], v[20:23], v[52:55], v[104:107]
    ds_read_b64_tr_b16 v[28:29], v1 offset:37120
    v_mfma_f32_16x16x32_bf16 v[144:147], v[24:27], v[52:55], v[144:147]
    ds_read_b64_tr_b16 v[30:31], v1 offset:39424
    v_mfma_f32_16x16x32_bf16 v[96:99], v[20:23], v[56:59], v[96:99]
    ds_read_b64_tr_b16 v[32:33], v2 offset:37408
    v_mfma_f32_16x16x32_bf16 v[136:139], v[24:27], v[56:59], v[136:139]
    ds_read_b64_tr_b16 v[34:35], v2 offset:39712
    v_mfma_f32_16x16x32_bf16 v[88:91], v[20:23], v[60:63], v[88:91]
    ds_read_b64_tr_b16 v[36:37], v2 offset:37088
    v_mfma_f32_16x16x32_bf16 v[128:131], v[24:27], v[60:63], v[128:131]
    ds_read_b64_tr_b16 v[38:39], v2 offset:39392
    v_mfma_f32_16x16x32_bf16 v[80:83], v[20:23], v[64:67], v[80:83]
    ds_read_b64_tr_b16 v[40:41], v1 offset:37376
    v_mfma_f32_16x16x32_bf16 v[120:123], v[24:27], v[64:67], v[120:123]
    ds_read_b64_tr_b16 v[42:43], v1 offset:39680
    v_mfma_f32_16x16x32_bf16 v[72:75], v[20:23], v[68:71], v[72:75]
    v_mfma_f32_16x16x32_bf16 v[112:115], v[24:27], v[68:71], v[112:115]
    s_waitcnt lgkmcnt(2)
    v_mfma_f32_16x16x32_bf16 v[232:235], v[28:31], v[56:59], v[232:235]
    s_waitcnt lgkmcnt(0)
    v_mfma_f32_16x16x32_bf16 v[240:243], v[32:35], v[56:59], v[240:243]
    s_barrier
    v_mfma_f32_16x16x32_bf16 v[184:187], v[36:39], v[52:55], v[184:187]
    ds_read_b64_tr_b16 v[20:21], v18 offset:55488
    v_mfma_f32_16x16x32_bf16 v[224:227], v[40:43], v[52:55], v[224:227]
    ds_read_b64 v[44:45], v6 offset:5120
    v_mfma_f32_16x16x32_bf16 v[176:179], v[36:39], v[56:59], v[176:179]
    ds_read_b64_tr_b16 v[24:25], v19 offset:55776
    v_mfma_f32_16x16x32_bf16 v[216:219], v[40:43], v[56:59], v[216:219]
    ds_read_b64 v[48:49], v6 offset:6144
    v_mfma_f32_16x16x32_bf16 v[168:171], v[36:39], v[60:63], v[168:171]
    ds_read_b64 v[52:53], v6 offset:7168
    v_mfma_f32_16x16x32_bf16 v[208:211], v[40:43], v[60:63], v[208:211]
    ds_read_b64 v[56:57], v6 offset:8192
    v_mfma_f32_16x16x32_bf16 v[160:163], v[36:39], v[64:67], v[160:163]
    ds_read_b64 v[60:61], v6 offset:9216
    v_mfma_f32_16x16x32_bf16 v[200:203], v[40:43], v[64:67], v[200:203]
    v_mfma_f32_16x16x32_bf16 v[152:155], v[36:39], v[68:71], v[152:155]
    v_mfma_f32_16x16x32_bf16 v[192:195], v[40:43], v[68:71], v[192:195]
    s_waitcnt lgkmcnt(1)
    v_mfma_f32_16x16x16_bf16 v[104:107], v[20:21], v[44:45], v[104:107]
    ds_read_b64_tr_b16 v[28:29], v18 offset:55552
    v_mfma_f32_16x16x16_bf16 v[144:147], v[24:25], v[44:45], v[144:147]
    ds_read_b64_tr_b16 v[32:33], v19 offset:55840
    v_mfma_f32_16x16x16_bf16 v[96:99], v[20:21], v[48:49], v[96:99]
    ds_read_b64_tr_b16 v[36:37], v19 offset:55520
    v_mfma_f32_16x16x16_bf16 v[136:139], v[24:25], v[48:49], v[136:139]
    ds_read_b64_tr_b16 v[40:41], v18 offset:55808
    v_mfma_f32_16x16x16_bf16 v[88:91], v[20:21], v[52:53], v[88:91]
    v_mfma_f32_16x16x16_bf16 v[128:131], v[24:25], v[52:53], v[128:131]
    v_mfma_f32_16x16x16_bf16 v[80:83], v[20:21], v[56:57], v[80:83]
    v_mfma_f32_16x16x16_bf16 v[120:123], v[24:25], v[56:57], v[120:123]
    s_waitcnt lgkmcnt(0)
    v_mfma_f32_16x16x16_bf16 v[72:75], v[20:21], v[60:61], v[72:75]
    v_mfma_f32_16x16x16_bf16 v[112:115], v[24:25], v[60:61], v[112:115]
    v_mfma_f32_16x16x16_bf16 v[232:235], v[28:29], v[48:49], v[232:235]
    v_mfma_f32_16x16x16_bf16 v[240:243], v[32:33], v[48:49], v[240:243]
    s_barrier
    v_mfma_f32_16x16x16_bf16 v[184:187], v[36:37], v[44:45], v[184:187]
    ds_read_b64_tr_b16 v[20:21], v3 offset:18624
    ds_read_b64_tr_b16 v[22:23], v3 offset:20928
    v_mfma_f32_16x16x16_bf16 v[224:227], v[40:41], v[44:45], v[224:227]
    ds_read_b128 v[64:67], v5 offset:10240
    ds_read_b64_tr_b16 v[24:25], v4 offset:18912
    v_mfma_f32_16x16x16_bf16 v[176:179], v[36:37], v[48:49], v[176:179]
    ds_read_b64_tr_b16 v[26:27], v4 offset:21216
    v_mfma_f32_16x16x16_bf16 v[216:219], v[40:41], v[48:49], v[216:219]
    ds_read_b128 v[68:71], v5 offset:11264
    v_mfma_f32_16x16x16_bf16 v[168:171], v[36:37], v[52:53], v[168:171]
    ds_read_b128 v[44:47], v5 offset:12288
    v_mfma_f32_16x16x16_bf16 v[208:211], v[40:41], v[52:53], v[208:211]
    ds_read_b128 v[48:51], v5 offset:13312
    v_mfma_f32_16x16x16_bf16 v[160:163], v[36:37], v[56:57], v[160:163]
    ds_read_b128 v[52:55], v5 offset:14336
    v_mfma_f32_16x16x16_bf16 v[200:203], v[40:41], v[56:57], v[200:203]
    v_mfma_f32_16x16x16_bf16 v[152:155], v[36:37], v[60:61], v[152:155]
    v_mfma_f32_16x16x16_bf16 v[192:195], v[40:41], v[60:61], v[192:195]
    s_waitcnt lgkmcnt(1)
    v_mfma_f32_16x16x32_bf16 v[108:111], v[20:23], v[64:67], v[108:111]
    ds_read_b64_tr_b16 v[28:29], v3 offset:18688
    v_fma_f32 v232, s50, v232, v7
    v_mfma_f32_16x16x32_bf16 v[148:151], v[24:27], v[64:67], v[148:151]
    ds_read_b64_tr_b16 v[30:31], v3 offset:20992
    v_fma_f32 v233, s50, v233, v7
    v_mfma_f32_16x16x32_bf16 v[100:103], v[20:23], v[68:71], v[100:103]
    ds_read_b64_tr_b16 v[32:33], v4 offset:18976
    v_fma_f32 v234, s50, v234, v7
    v_mfma_f32_16x16x32_bf16 v[140:143], v[24:27], v[68:71], v[140:143]
    ds_read_b64_tr_b16 v[34:35], v4 offset:21280
    v_fma_f32 v235, s50, v235, v7
    v_mfma_f32_16x16x32_bf16 v[92:95], v[20:23], v[44:47], v[92:95]
    ds_read_b64_tr_b16 v[36:37], v4 offset:18656
    v_mul_f32 v240, s52, v240
    v_mfma_f32_16x16x32_bf16 v[132:135], v[24:27], v[44:47], v[132:135]
    ds_read_b64_tr_b16 v[38:39], v4 offset:20960
    v_mul_f32 v241, s52, v241
    v_mfma_f32_16x16x32_bf16 v[84:87], v[20:23], v[48:51], v[84:87]
    ds_read_b64_tr_b16 v[40:41], v3 offset:18944
    v_mul_f32 v242, s52, v242
    v_mfma_f32_16x16x32_bf16 v[124:127], v[24:27], v[48:51], v[124:127]
    ds_read_b64_tr_b16 v[42:43], v3 offset:21248
    s_waitcnt lgkmcnt(4)
    v_mfma_f32_16x16x32_bf16 v[76:79], v[20:23], v[52:55], v[76:79]
    v_mul_f32 v243, s52, v243
    v_fma_f32 v72, s50, v72, v7
    v_mfma_f32_16x16x32_bf16 v[116:119], v[24:27], v[52:55], v[116:119]
    v_fma_f32 v73, s50, v73, v7
    v_fma_f32 v74, s50, v74, v7
    v_mfma_f32_16x16x32_bf16 v[236:239], v[28:31], v[68:71], v[236:239]
    v_fma_f32 v75, s50, v75, v7
    s_waitcnt lgkmcnt(0)
    v_mfma_f32_16x16x32_bf16 v[244:247], v[32:35], v[68:71], v[244:247]
    v_mul_f32 v112, s52, v112
    s_barrier
    v_mfma_f32_16x16x32_bf16 v[188:191], v[36:39], v[64:67], v[188:191]
    ds_read_b64_tr_b16 v[20:21], v1 offset:192
    v_mul_f32 v113, s52, v113
    v_mfma_f32_16x16x32_bf16 v[228:231], v[40:43], v[64:67], v[228:231]
    ds_read_b64_tr_b16 v[22:23], v1 offset:2496
    v_mul_f32 v114, s52, v114
    v_mfma_f32_16x16x32_bf16 v[180:183], v[36:39], v[68:71], v[180:183]
    ds_read_b64_tr_b16 v[24:25], v2 offset:480
    v_mul_f32 v115, s52, v115
    v_mfma_f32_16x16x32_bf16 v[220:223], v[40:43], v[68:71], v[220:223]
    ds_read_b64_tr_b16 v[26:27], v2 offset:2784
    v_fma_f32 v80, s50, v80, v7
    v_mfma_f32_16x16x32_bf16 v[172:175], v[36:39], v[44:47], v[172:175]
    ds_read_b128 v[56:59], v5 offset:15360
    v_fma_f32 v81, s50, v81, v7
    v_mfma_f32_16x16x32_bf16 v[212:215], v[40:43], v[44:47], v[212:215]
    ds_read_b128 v[60:63], v5 offset:16384
    v_fma_f32 v82, s50, v82, v7
    v_mfma_f32_16x16x32_bf16 v[164:167], v[36:39], v[48:51], v[164:167]
    v_fma_f32 v83, s50, v83, v7
    v_mul_f32 v120, s52, v120
    v_mfma_f32_16x16x32_bf16 v[204:207], v[40:43], v[48:51], v[204:207]
    v_mul_f32 v121, s52, v121
    v_mul_f32 v122, s52, v122
    v_mfma_f32_16x16x32_bf16 v[156:159], v[36:39], v[52:55], v[156:159]
    v_mul_f32 v123, s52, v123
    v_fma_f32 v88, s50, v88, v7
    v_mfma_f32_16x16x32_bf16 v[196:199], v[40:43], v[52:55], v[196:199]
    v_fma_f32 v89, s50, v89, v7
    s_waitcnt lgkmcnt(0)
    v_mfma_f32_16x16x32_bf16 v[108:111], v[20:23], v[44:47], v[108:111]
    ds_read_b64_tr_b16 v[28:29], v1 offset:256
    v_fma_f32 v90, s50, v90, v7
    v_mfma_f32_16x16x32_bf16 v[148:151], v[24:27], v[44:47], v[148:151]
    ds_read_b64_tr_b16 v[30:31], v1 offset:2560
    v_fma_f32 v91, s50, v91, v7
    v_mfma_f32_16x16x32_bf16 v[100:103], v[20:23], v[48:51], v[100:103]
    ds_read_b64_tr_b16 v[32:33], v2 offset:544
    v_mul_f32 v128, s52, v128
    v_mfma_f32_16x16x32_bf16 v[140:143], v[24:27], v[48:51], v[140:143]
    ds_read_b64_tr_b16 v[34:35], v2 offset:2848
    v_mul_f32 v129, s52, v129
    v_mfma_f32_16x16x32_bf16 v[92:95], v[20:23], v[52:55], v[92:95]
    ds_read_b64_tr_b16 v[36:37], v2 offset:224
    v_mul_f32 v130, s52, v130
    v_mfma_f32_16x16x32_bf16 v[132:135], v[24:27], v[52:55], v[132:135]
    ds_read_b64_tr_b16 v[38:39], v2 offset:2528
    v_mul_f32 v131, s52, v131
    v_mfma_f32_16x16x32_bf16 v[84:87], v[20:23], v[56:59], v[84:87]
    ds_read_b64_tr_b16 v[40:41], v1 offset:512
    v_fma_f32 v96, s50, v96, v7
    v_mfma_f32_16x16x32_bf16 v[124:127], v[24:27], v[56:59], v[124:127]
    ds_read_b64_tr_b16 v[42:43], v1 offset:2816
    v_fma_f32 v97, s50, v97, v7
    v_mfma_f32_16x16x32_bf16 v[76:79], v[20:23], v[60:63], v[76:79]
    v_fma_f32 v98, s50, v98, v7
    v_fma_f32 v99, s50, v99, v7
    v_mfma_f32_16x16x32_bf16 v[116:119], v[24:27], v[60:63], v[116:119]
    v_mul_f32 v136, s52, v136
    s_waitcnt lgkmcnt(2)
    v_mfma_f32_16x16x32_bf16 v[236:239], v[28:31], v[48:51], v[236:239]
    v_mul_f32 v137, s52, v137
    s_waitcnt lgkmcnt(0)
    v_mfma_f32_16x16x32_bf16 v[244:247], v[32:35], v[48:51], v[244:247]
    v_mul_f32 v138, s52, v138
    s_barrier
    v_mfma_f32_16x16x32_bf16 v[188:191], v[36:39], v[44:47], v[188:191]
    ds_read_b64_tr_b16 v[20:21], v18 offset:18624
    v_mul_f32 v139, s52, v139
    v_mfma_f32_16x16x32_bf16 v[228:231], v[40:43], v[44:47], v[228:231]
    ds_read_b64 v[64:65], v6 offset:14336
    v_fma_f32 v104, s50, v104, v7
    v_mfma_f32_16x16x32_bf16 v[180:183], v[36:39], v[48:51], v[180:183]
    ds_read_b64_tr_b16 v[24:25], v19 offset:18912
    v_fma_f32 v105, s50, v105, v7
    v_mfma_f32_16x16x32_bf16 v[220:223], v[40:43], v[48:51], v[220:223]
    ds_read_b64 v[68:69], v6 offset:15360
    v_fma_f32 v106, s50, v106, v7
    v_mfma_f32_16x16x32_bf16 v[172:175], v[36:39], v[52:55], v[172:175]
    ds_read_b64 v[44:45], v6 offset:16384
    v_fma_f32 v107, s50, v107, v7
    v_mfma_f32_16x16x32_bf16 v[212:215], v[40:43], v[52:55], v[212:215]
    ds_read_b64 v[48:49], v6 offset:17408
    v_mul_f32 v144, s52, v144
    v_mfma_f32_16x16x32_bf16 v[164:167], v[36:39], v[56:59], v[164:167]
    ds_read_b64 v[52:53], v6 offset:18432
    v_mul_f32 v145, s52, v145
    v_mfma_f32_16x16x32_bf16 v[204:207], v[40:43], v[56:59], v[204:207]
    v_mul_f32 v146, s52, v146
    v_mul_f32 v147, s52, v147
    v_mfma_f32_16x16x32_bf16 v[156:159], v[36:39], v[60:63], v[156:159]
    v_fma_f32 v152, s50, v152, v7
    v_fma_f32 v153, s50, v153, v7
    v_mfma_f32_16x16x32_bf16 v[196:199], v[40:43], v[60:63], v[196:199]
    v_fma_f32 v154, s50, v154, v7
    s_waitcnt lgkmcnt(1)
    v_mfma_f32_16x16x16_bf16 v[108:111], v[20:21], v[64:65], v[108:111]
    ds_read_b64_tr_b16 v[28:29], v18 offset:18688
    v_fma_f32 v155, s50, v155, v7
    v_mfma_f32_16x16x16_bf16 v[148:151], v[24:25], v[64:65], v[148:151]
    ds_read_b64_tr_b16 v[32:33], v19 offset:18976
    v_mul_f32 v192, s52, v192
    v_mfma_f32_16x16x16_bf16 v[100:103], v[20:21], v[68:69], v[100:103]
    ds_read_b64_tr_b16 v[36:37], v19 offset:18656
    v_mul_f32 v193, s52, v193
    v_mfma_f32_16x16x16_bf16 v[140:143], v[24:25], v[68:69], v[140:143]
    ds_read_b64_tr_b16 v[40:41], v18 offset:18944
    v_mul_f32 v194, s52, v194
    v_mfma_f32_16x16x16_bf16 v[92:95], v[20:21], v[44:45], v[92:95]
    v_mul_f32 v195, s52, v195
    v_fma_f32 v160, s50, v160, v7
    v_mfma_f32_16x16x16_bf16 v[132:135], v[24:25], v[44:45], v[132:135]
    v_fma_f32 v161, s50, v161, v7
    v_fma_f32 v162, s50, v162, v7
    v_mfma_f32_16x16x16_bf16 v[84:87], v[20:21], v[48:49], v[84:87]
    v_fma_f32 v163, s50, v163, v7
    v_mul_f32 v200, s52, v200
    v_mfma_f32_16x16x16_bf16 v[124:127], v[24:25], v[48:49], v[124:127]
    v_mul_f32 v201, s52, v201
    s_waitcnt lgkmcnt(0)
    v_mfma_f32_16x16x16_bf16 v[76:79], v[20:21], v[52:53], v[76:79]
    v_mul_f32 v202, s52, v202
    v_mul_f32 v203, s52, v203
    v_mfma_f32_16x16x16_bf16 v[116:119], v[24:25], v[52:53], v[116:119]
    v_fma_f32 v168, s50, v168, v7
    v_fma_f32 v169, s50, v169, v7
    v_mfma_f32_16x16x16_bf16 v[236:239], v[28:29], v[68:69], v[236:239]
    v_fma_f32 v170, s50, v170, v7
    v_fma_f32 v171, s50, v171, v7
    v_mfma_f32_16x16x16_bf16 v[244:247], v[32:33], v[68:69], v[244:247]
    v_mul_f32 v208, s52, v208
    s_barrier
    v_mfma_f32_16x16x16_bf16 v[188:191], v[36:37], v[64:65], v[188:191]
    v_mul_f32 v209, s52, v209
    v_mul_f32 v210, s52, v210
    v_mfma_f32_16x16x16_bf16 v[228:231], v[40:41], v[64:65], v[228:231]
    v_mul_f32 v211, s52, v211
    v_fma_f32 v176, s50, v176, v7
    v_mfma_f32_16x16x16_bf16 v[180:183], v[36:37], v[68:69], v[180:183]
    v_fma_f32 v177, s50, v177, v7
    v_fma_f32 v178, s50, v178, v7
    v_mfma_f32_16x16x16_bf16 v[220:223], v[40:41], v[68:69], v[220:223]
    v_fma_f32 v179, s50, v179, v7
    v_mul_f32 v216, s52, v216
    v_mfma_f32_16x16x16_bf16 v[172:175], v[36:37], v[44:45], v[172:175]
    v_mul_f32 v217, s52, v217
    v_mul_f32 v218, s52, v218
    v_mfma_f32_16x16x16_bf16 v[212:215], v[40:41], v[44:45], v[212:215]
    v_mul_f32 v219, s52, v219
    v_fma_f32 v184, s50, v184, v7
    v_mfma_f32_16x16x16_bf16 v[164:167], v[36:37], v[48:49], v[164:167]
    v_fma_f32 v185, s50, v185, v7
    v_fma_f32 v186, s50, v186, v7
    v_mfma_f32_16x16x16_bf16 v[204:207], v[40:41], v[48:49], v[204:207]
    v_fma_f32 v187, s50, v187, v7
    v_mul_f32 v224, s52, v224
    v_mfma_f32_16x16x16_bf16 v[156:159], v[36:37], v[52:53], v[156:159]
    v_mul_f32 v225, s52, v225
    v_mul_f32 v226, s52, v226
    v_mfma_f32_16x16x16_bf16 v[196:199], v[40:41], v[52:53], v[196:199]
    v_mul_f32 v227, s52, v227
    s_branch L_cepi
.p2align 6
L_cepi:
    s_setprio 1
    v_mov_b32 v32, 0.5
    v_mov_b32 v33, 0.5
    s_cmp_ge_u32 s36, 2
    s_cbranch_scc1 L_nox
    v_pk_fma_f32 v[248:249], v[252:253], s[54:55], v[248:249]
    v_pk_fma_f32 v[250:251], v[254:255], s[54:55], v[250:251]
    v_pk_fma_f32 v[252:253], v[252:253], s[32:33], v[248:249]
    v_pk_fma_f32 v[254:255], v[254:255], s[32:33], v[250:251]
    ds_write_b128 v14, v[248:251]
    ds_write_b128 v14, v[252:255] offset:1024
L_nox:
    v_pk_fma_f32 v[232:233], v[236:237], s[50:51], v[232:233]
    v_pk_fma_f32 v[234:235], v[238:239], s[50:51], v[234:235]
    v_pk_fma_f32 v[240:241], v[244:245], s[52:53], v[240:241]
    v_pk_fma_f32 v[242:243], v[246:247], s[52:53], v[242:243]
    v_pk_fma_f32 v[236:237], v[236:237], s[28:29], v[232:233]
    v_pk_fma_f32 v[238:239], v[238:239], s[28:29], v[234:235]
    v_pk_fma_f32 v[244:245], v[244:245], s[30:31], v[240:241]
    v_pk_fma_f32 v[246:247], v[246:247], s[30:31], v[242:243]
    v_exp_f32_e64 v232, v232 clamp
    v_exp_f32_e64 v233, v233 clamp
    v_exp_f32_e64 v234, v234 clamp
    v_exp_f32_e64 v235, v235 clamp
    v_exp_f32_e64 v236, v236 clamp
    v_exp_f32_e64 v237, v237 clamp
    v_exp_f32_e64 v238, v238 clamp
    v_exp_f32_e64 v239, v239 clamp
    v_pk_fma_f32 v[232:233], v[232:233], s[66:67], v[32:33]
    v_pk_fma_f32 v[234:235], v[234:235], s[66:67], v[32:33]
    v_pk_fma_f32 v[236:237], v[236:237], s[66:67], v[32:33]
    v_pk_fma_f32 v[238:239], v[238:239], s[66:67], v[32:33]
    v_exp_f32 v240, v240
    v_exp_f32 v241, v241
    v_exp_f32 v242, v242
    v_exp_f32 v243, v243
    v_exp_f32 v244, v244
    v_exp_f32 v245, v245
    v_exp_f32 v246, v246
    v_exp_f32 v247, v247
    v_pk_fma_f32 v[240:241], v[232:233], v[240:241], v[232:233]
    v_pk_fma_f32 v[242:243], v[234:235], v[242:243], v[234:235]
    v_pk_fma_f32 v[244:245], v[236:237], v[244:245], v[236:237]
    v_pk_fma_f32 v[246:247], v[238:239], v[246:247], v[238:239]
    v_rcp_f32 v240, v240
    v_rcp_f32 v241, v241
    v_rcp_f32 v242, v242
    v_rcp_f32 v243, v243
    v_rcp_f32 v244, v244
    v_rcp_f32 v245, v245
    v_rcp_f32 v246, v246
    v_rcp_f32 v247, v247
    v_pk_fma_f32 v[232:233], v[232:233], v[240:241], v[240:241] neg_lo:[1,0,0] neg_hi:[1,0,0]
    v_pk_fma_f32 v[234:235], v[234:235], v[242:243], v[242:243] neg_lo:[1,0,0] neg_hi:[1,0,0]
    v_pk_fma_f32 v[236:237], v[236:237], v[244:245], v[244:245] neg_lo:[1,0,0] neg_hi:[1,0,0]
    v_pk_fma_f32 v[238:239], v[238:239], v[246:247], v[246:247] neg_lo:[1,0,0] neg_hi:[1,0,0]
    v_cvt_pk_bf16_f32 v28, v232, v233
    v_cvt_pk_bf16_f32 v29, v234, v235
    ds_write_b64 v13, v[28:29]
    v_cvt_pk_bf16_f32 v30, v236, v237
    v_cvt_pk_bf16_f32 v31, v238, v239
    ds_write_b64 v13, v[30:31] offset:4608
    v_pk_fma_f32 v[72:73], v[76:77], s[50:51], v[72:73]
    v_pk_fma_f32 v[74:75], v[78:79], s[50:51], v[74:75]
    v_pk_fma_f32 v[112:113], v[116:117], s[52:53], v[112:113]
    v_pk_fma_f32 v[114:115], v[118:119], s[52:53], v[114:115]
    v_pk_fma_f32 v[152:153], v[156:157], s[50:51], v[152:153]
    v_pk_fma_f32 v[154:155], v[158:159], s[50:51], v[154:155]
    v_pk_fma_f32 v[192:193], v[196:197], s[52:53], v[192:193]
    v_pk_fma_f32 v[194:195], v[198:199], s[52:53], v[194:195]
    v_pk_fma_f32 v[76:77], v[76:77], s[28:29], v[72:73]
    v_pk_fma_f32 v[78:79], v[78:79], s[28:29], v[74:75]
    v_pk_fma_f32 v[116:117], v[116:117], s[30:31], v[112:113]
    v_pk_fma_f32 v[118:119], v[118:119], s[30:31], v[114:115]
    v_pk_fma_f32 v[156:157], v[156:157], s[28:29], v[152:153]
    v_pk_fma_f32 v[158:159], v[158:159], s[28:29], v[154:155]
    v_pk_fma_f32 v[196:197], v[196:197], s[30:31], v[192:193]
    v_pk_fma_f32 v[198:199], v[198:199], s[30:31], v[194:195]
    v_exp_f32_e64 v72, v72 clamp
    v_exp_f32_e64 v73, v73 clamp
    v_exp_f32_e64 v74, v74 clamp
    v_exp_f32_e64 v75, v75 clamp
    v_exp_f32_e64 v152, v152 clamp
    v_exp_f32_e64 v153, v153 clamp
    v_exp_f32_e64 v154, v154 clamp
    v_exp_f32_e64 v155, v155 clamp
    v_exp_f32_e64 v76, v76 clamp
    v_exp_f32_e64 v77, v77 clamp
    v_exp_f32_e64 v78, v78 clamp
    v_exp_f32_e64 v79, v79 clamp
    v_exp_f32_e64 v156, v156 clamp
    v_exp_f32_e64 v157, v157 clamp
    v_exp_f32_e64 v158, v158 clamp
    v_exp_f32_e64 v159, v159 clamp
    v_pk_fma_f32 v[72:73], v[72:73], s[66:67], v[32:33]
    v_pk_fma_f32 v[74:75], v[74:75], s[66:67], v[32:33]
    v_pk_fma_f32 v[152:153], v[152:153], s[66:67], v[32:33]
    v_pk_fma_f32 v[154:155], v[154:155], s[66:67], v[32:33]
    v_pk_fma_f32 v[76:77], v[76:77], s[66:67], v[32:33]
    v_pk_fma_f32 v[78:79], v[78:79], s[66:67], v[32:33]
    v_pk_fma_f32 v[156:157], v[156:157], s[66:67], v[32:33]
    v_pk_fma_f32 v[158:159], v[158:159], s[66:67], v[32:33]
    v_exp_f32 v112, v112
    v_exp_f32 v113, v113
    v_exp_f32 v114, v114
    v_exp_f32 v115, v115
    v_exp_f32 v192, v192
    v_exp_f32 v193, v193
    v_exp_f32 v194, v194
    v_exp_f32 v195, v195
    v_exp_f32 v116, v116
    v_exp_f32 v117, v117
    v_exp_f32 v118, v118
    v_exp_f32 v119, v119
    v_exp_f32 v196, v196
    v_exp_f32 v197, v197
    v_exp_f32 v198, v198
    v_exp_f32 v199, v199
    v_pk_fma_f32 v[112:113], v[72:73], v[112:113], v[72:73]
    v_pk_fma_f32 v[114:115], v[74:75], v[114:115], v[74:75]
    v_pk_fma_f32 v[192:193], v[152:153], v[192:193], v[152:153]
    v_pk_fma_f32 v[194:195], v[154:155], v[194:195], v[154:155]
    v_pk_fma_f32 v[116:117], v[76:77], v[116:117], v[76:77]
    v_pk_fma_f32 v[118:119], v[78:79], v[118:119], v[78:79]
    v_pk_fma_f32 v[196:197], v[156:157], v[196:197], v[156:157]
    v_pk_fma_f32 v[198:199], v[158:159], v[198:199], v[158:159]
    v_rcp_f32 v112, v112
    v_rcp_f32 v113, v113
    v_rcp_f32 v114, v114
    v_rcp_f32 v115, v115
    v_rcp_f32 v192, v192
    v_rcp_f32 v193, v193
    v_rcp_f32 v194, v194
    v_rcp_f32 v195, v195
    v_rcp_f32 v116, v116
    v_rcp_f32 v117, v117
    v_rcp_f32 v118, v118
    v_rcp_f32 v119, v119
    v_rcp_f32 v196, v196
    v_rcp_f32 v197, v197
    v_rcp_f32 v198, v198
    v_rcp_f32 v199, v199
    v_pk_fma_f32 v[72:73], v[72:73], v[112:113], v[112:113] neg_lo:[1,0,0] neg_hi:[1,0,0]
    v_pk_fma_f32 v[74:75], v[74:75], v[114:115], v[114:115] neg_lo:[1,0,0] neg_hi:[1,0,0]
    v_pk_fma_f32 v[152:153], v[152:153], v[192:193], v[192:193] neg_lo:[1,0,0] neg_hi:[1,0,0]
    v_pk_fma_f32 v[154:155], v[154:155], v[194:195], v[194:195] neg_lo:[1,0,0] neg_hi:[1,0,0]
    v_pk_fma_f32 v[76:77], v[76:77], v[116:117], v[116:117] neg_lo:[1,0,0] neg_hi:[1,0,0]
    v_pk_fma_f32 v[78:79], v[78:79], v[118:119], v[118:119] neg_lo:[1,0,0] neg_hi:[1,0,0]
    v_pk_fma_f32 v[156:157], v[156:157], v[196:197], v[196:197] neg_lo:[1,0,0] neg_hi:[1,0,0]
    v_pk_fma_f32 v[158:159], v[158:159], v[198:199], v[198:199] neg_lo:[1,0,0] neg_hi:[1,0,0]
    v_cvt_pk_bf16_f32 v20, v72, v73
    v_cvt_pk_bf16_f32 v21, v74, v75
    v_cvt_pk_bf16_f32 v22, v152, v153
    v_cvt_pk_bf16_f32 v23, v154, v155
    ds_write_b128 v12, v[20:23] offset:0
    v_cvt_pk_bf16_f32 v24, v76, v77
    v_cvt_pk_bf16_f32 v25, v78, v79
    v_cvt_pk_bf16_f32 v26, v156, v157
    v_cvt_pk_bf16_f32 v27, v158, v159
    ds_write_b128 v12, v[24:27] offset:4608
    v_pk_fma_f32 v[80:81], v[84:85], s[50:51], v[80:81]
    v_pk_fma_f32 v[82:83], v[86:87], s[50:51], v[82:83]
    v_pk_fma_f32 v[120:121], v[124:125], s[52:53], v[120:121]
    v_pk_fma_f32 v[122:123], v[126:127], s[52:53], v[122:123]
    v_pk_fma_f32 v[160:161], v[164:165], s[50:51], v[160:161]
    v_pk_fma_f32 v[162:163], v[166:167], s[50:51], v[162:163]
    v_pk_fma_f32 v[200:201], v[204:205], s[52:53], v[200:201]
    v_pk_fma_f32 v[202:203], v[206:207], s[52:53], v[202:203]
    v_pk_fma_f32 v[84:85], v[84:85], s[28:29], v[80:81]
    v_pk_fma_f32 v[86:87], v[86:87], s[28:29], v[82:83]
    v_pk_fma_f32 v[124:125], v[124:125], s[30:31], v[120:121]
    v_pk_fma_f32 v[126:127], v[126:127], s[30:31], v[122:123]
    v_pk_fma_f32 v[164:165], v[164:165], s[28:29], v[160:161]
    v_pk_fma_f32 v[166:167], v[166:167], s[28:29], v[162:163]
    v_pk_fma_f32 v[204:205], v[204:205], s[30:31], v[200:201]
    v_pk_fma_f32 v[206:207], v[206:207], s[30:31], v[202:203]
    v_exp_f32_e64 v80, v80 clamp
    v_exp_f32_e64 v81, v81 clamp
    v_exp_f32_e64 v82, v82 clamp
    v_exp_f32_e64 v83, v83 clamp
    v_exp_f32_e64 v160, v160 clamp
    v_exp_f32_e64 v161, v161 clamp
    s_waitcnt lgkmcnt(0)
    s_barrier
    ds_read_b64 v[44:45], v15
    ds_read_b64 v[46:47], v15 offset:2048
    v_exp_f32_e64 v162, v162 clamp
    v_exp_f32_e64 v163, v163 clamp
    v_exp_f32_e64 v84, v84 clamp
    v_exp_f32_e64 v85, v85 clamp
    v_exp_f32_e64 v86, v86 clamp
    v_exp_f32_e64 v87, v87 clamp
    v_exp_f32_e64 v164, v164 clamp
    v_exp_f32_e64 v165, v165 clamp
    v_exp_f32_e64 v166, v166 clamp
    v_exp_f32_e64 v167, v167 clamp
    v_fma_f32 v80, v80, s66, 0.5
    v_fma_f32 v81, v81, s66, 0.5
    v_fma_f32 v82, v82, s66, 0.5
    v_fma_f32 v83, v83, s66, 0.5
    v_fma_f32 v160, v160, s66, 0.5
    v_fma_f32 v161, v161, s66, 0.5
    v_fma_f32 v162, v162, s66, 0.5
    v_fma_f32 v163, v163, s66, 0.5
    v_fma_f32 v84, v84, s66, 0.5
    v_fma_f32 v85, v85, s66, 0.5
    v_fma_f32 v86, v86, s66, 0.5
    v_fma_f32 v87, v87, s66, 0.5
    v_fma_f32 v164, v164, s66, 0.5
    v_fma_f32 v165, v165, s66, 0.5
    v_fma_f32 v166, v166, s66, 0.5
    v_fma_f32 v167, v167, s66, 0.5
    v_exp_f32 v120, v120
    v_exp_f32 v121, v121
    v_exp_f32 v122, v122
    v_exp_f32 v123, v123
    s_waitcnt lgkmcnt(0)
    v_exp_f32_e64 v44, v44 clamp
    v_exp_f32_e64 v45, v45 clamp
    v_exp_f32 v200, v200
    v_exp_f32 v201, v201
    v_exp_f32 v202, v202
    v_exp_f32 v203, v203
    v_exp_f32 v124, v124
    v_exp_f32 v125, v125
    v_exp_f32 v126, v126
    v_exp_f32 v127, v127
    v_exp_f32 v204, v204
    v_exp_f32 v205, v205
    v_exp_f32 v206, v206
    v_exp_f32 v207, v207
    v_exp_f32 v46, v46
    v_exp_f32 v47, v47
    v_fma_f32 v44, v44, s66, 0.5
    v_fma_f32 v45, v45, s66, 0.5
    v_fma_f32 v46, v44, v46, v44
    v_fma_f32 v47, v45, v47, v45
    v_fma_f32 v120, v80, v120, v80
    v_fma_f32 v121, v81, v121, v81
    v_fma_f32 v122, v82, v122, v82
    v_fma_f32 v123, v83, v123, v83
    v_fma_f32 v200, v160, v200, v160
    v_fma_f32 v201, v161, v201, v161
    v_fma_f32 v202, v162, v202, v162
    v_fma_f32 v203, v163, v203, v163
    v_fma_f32 v124, v84, v124, v84
    v_fma_f32 v125, v85, v125, v85
    v_fma_f32 v126, v86, v126, v86
    v_fma_f32 v127, v87, v127, v87
    v_fma_f32 v204, v164, v204, v164
    v_fma_f32 v205, v165, v205, v165
    v_fma_f32 v206, v166, v206, v166
    v_fma_f32 v207, v167, v207, v167
    v_rcp_f32 v46, v46
    v_rcp_f32 v47, v47
    v_rcp_f32 v120, v120
    v_rcp_f32 v121, v121
    v_rcp_f32 v122, v122
    v_rcp_f32 v123, v123
    v_rcp_f32 v200, v200
    v_rcp_f32 v201, v201
    v_rcp_f32 v202, v202
    v_rcp_f32 v203, v203
    v_rcp_f32 v124, v124
    v_rcp_f32 v125, v125
    v_rcp_f32 v126, v126
    v_rcp_f32 v127, v127
    v_rcp_f32 v204, v204
    v_rcp_f32 v205, v205
    v_rcp_f32 v206, v206
    v_rcp_f32 v207, v207
    v_fma_f32 v44, -v44, v46, v46
    v_fma_f32 v45, -v45, v47, v47
    v_cvt_pk_bf16_f32 v36, v44, v45
    ds_write_b32 v16, v36
    v_pk_fma_f32 v[80:81], v[80:81], v[120:121], v[120:121] neg_lo:[1,0,0] neg_hi:[1,0,0]
    v_pk_fma_f32 v[82:83], v[82:83], v[122:123], v[122:123] neg_lo:[1,0,0] neg_hi:[1,0,0]
    v_pk_fma_f32 v[160:161], v[160:161], v[200:201], v[200:201] neg_lo:[1,0,0] neg_hi:[1,0,0]
    v_pk_fma_f32 v[162:163], v[162:163], v[202:203], v[202:203] neg_lo:[1,0,0] neg_hi:[1,0,0]
    v_pk_fma_f32 v[84:85], v[84:85], v[124:125], v[124:125] neg_lo:[1,0,0] neg_hi:[1,0,0]
    v_pk_fma_f32 v[86:87], v[86:87], v[126:127], v[126:127] neg_lo:[1,0,0] neg_hi:[1,0,0]
    v_pk_fma_f32 v[164:165], v[164:165], v[204:205], v[204:205] neg_lo:[1,0,0] neg_hi:[1,0,0]
    v_pk_fma_f32 v[166:167], v[166:167], v[206:207], v[206:207] neg_lo:[1,0,0] neg_hi:[1,0,0]
    v_cvt_pk_bf16_f32 v20, v80, v81
    v_cvt_pk_bf16_f32 v21, v82, v83
    v_cvt_pk_bf16_f32 v22, v160, v161
    v_cvt_pk_bf16_f32 v23, v162, v163
    ds_write_b128 v12, v[20:23] offset:9216
    v_cvt_pk_bf16_f32 v24, v84, v85
    v_cvt_pk_bf16_f32 v25, v86, v87
    v_cvt_pk_bf16_f32 v26, v164, v165
    v_cvt_pk_bf16_f32 v27, v166, v167
    ds_write_b128 v12, v[24:27] offset:13824
    v_pk_fma_f32 v[88:89], v[92:93], s[50:51], v[88:89]
    v_pk_fma_f32 v[90:91], v[94:95], s[50:51], v[90:91]
    v_pk_fma_f32 v[128:129], v[132:133], s[52:53], v[128:129]
    v_pk_fma_f32 v[130:131], v[134:135], s[52:53], v[130:131]
    v_pk_fma_f32 v[168:169], v[172:173], s[50:51], v[168:169]
    v_pk_fma_f32 v[170:171], v[174:175], s[50:51], v[170:171]
    v_pk_fma_f32 v[208:209], v[212:213], s[52:53], v[208:209]
    v_pk_fma_f32 v[210:211], v[214:215], s[52:53], v[210:211]
    v_pk_fma_f32 v[92:93], v[92:93], s[28:29], v[88:89]
    v_pk_fma_f32 v[94:95], v[94:95], s[28:29], v[90:91]
    v_pk_fma_f32 v[132:133], v[132:133], s[30:31], v[128:129]
    v_pk_fma_f32 v[134:135], v[134:135], s[30:31], v[130:131]
    v_pk_fma_f32 v[172:173], v[172:173], s[28:29], v[168:169]
    v_pk_fma_f32 v[174:175], v[174:175], s[28:29], v[170:171]
    v_pk_fma_f32 v[212:213], v[212:213], s[30:31], v[208:209]
    v_pk_fma_f32 v[214:215], v[214:215], s[30:31], v[210:211]
    v_exp_f32_e64 v88, v88 clamp
    v_exp_f32_e64 v89, v89 clamp
    v_exp_f32_e64 v90, v90 clamp
    v_exp_f32_e64 v91, v91 clamp
    v_exp_f32_e64 v168, v168 clamp
    v_exp_f32_e64 v169, v169 clamp
    s_waitcnt lgkmcnt(0)
    s_barrier
    v_exp_f32_e64 v170, v170 clamp
    v_exp_f32_e64 v171, v171 clamp
    v_exp_f32_e64 v92, v92 clamp
    v_exp_f32_e64 v93, v93 clamp
    v_exp_f32_e64 v94, v94 clamp
    v_exp_f32_e64 v95, v95 clamp
    v_exp_f32_e64 v172, v172 clamp
    v_exp_f32_e64 v173, v173 clamp
    v_exp_f32_e64 v174, v174 clamp
    v_exp_f32_e64 v175, v175 clamp
    v_pk_fma_f32 v[88:89], v[88:89], s[66:67], v[32:33]
    v_pk_fma_f32 v[90:91], v[90:91], s[66:67], v[32:33]
    v_pk_fma_f32 v[168:169], v[168:169], s[66:67], v[32:33]
    v_pk_fma_f32 v[170:171], v[170:171], s[66:67], v[32:33]
    v_pk_fma_f32 v[92:93], v[92:93], s[66:67], v[32:33]
    v_pk_fma_f32 v[94:95], v[94:95], s[66:67], v[32:33]
    v_pk_fma_f32 v[172:173], v[172:173], s[66:67], v[32:33]
    v_pk_fma_f32 v[174:175], v[174:175], s[66:67], v[32:33]
    v_exp_f32 v128, v128
    v_exp_f32 v129, v129
    v_exp_f32 v130, v130
    v_exp_f32 v131, v131
    v_exp_f32 v208, v208
    v_exp_f32 v209, v209
    v_exp_f32 v210, v210
    v_exp_f32 v211, v211
    v_exp_f32 v132, v132
    v_exp_f32 v133, v133
    v_exp_f32 v134, v134
    v_exp_f32 v135, v135
    v_exp_f32 v212, v212
    v_exp_f32 v213, v213
    v_exp_f32 v214, v214
    v_exp_f32 v215, v215
    v_fma_f32 v128, v88, v128, v88
    v_fma_f32 v129, v89, v129, v89
    v_fma_f32 v130, v90, v130, v90
    v_fma_f32 v131, v91, v131, v91
    v_fma_f32 v208, v168, v208, v168
    v_fma_f32 v209, v169, v209, v169
    v_fma_f32 v210, v170, v210, v170
    v_fma_f32 v211, v171, v211, v171
    v_fma_f32 v132, v92, v132, v92
    v_fma_f32 v133, v93, v133, v93
    v_fma_f32 v134, v94, v134, v94
    v_fma_f32 v135, v95, v135, v95
    v_fma_f32 v212, v172, v212, v172
    v_fma_f32 v213, v173, v213, v173
    v_fma_f32 v214, v174, v214, v174
    v_fma_f32 v215, v175, v215, v175
    v_rcp_f32 v128, v128
    v_rcp_f32 v129, v129
    v_rcp_f32 v130, v130
    v_rcp_f32 v131, v131
    v_rcp_f32 v208, v208
    v_rcp_f32 v209, v209
    v_rcp_f32 v210, v210
    v_rcp_f32 v211, v211
    v_rcp_f32 v132, v132
    v_rcp_f32 v133, v133
    v_rcp_f32 v134, v134
    v_rcp_f32 v135, v135
    v_rcp_f32 v212, v212
    v_rcp_f32 v213, v213
    v_rcp_f32 v214, v214
    v_rcp_f32 v215, v215
    v_pk_fma_f32 v[88:89], v[88:89], v[128:129], v[128:129] neg_lo:[1,0,0] neg_hi:[1,0,0]
    v_pk_fma_f32 v[90:91], v[90:91], v[130:131], v[130:131] neg_lo:[1,0,0] neg_hi:[1,0,0]
    v_pk_fma_f32 v[168:169], v[168:169], v[208:209], v[208:209] neg_lo:[1,0,0] neg_hi:[1,0,0]
    v_pk_fma_f32 v[170:171], v[170:171], v[210:211], v[210:211] neg_lo:[1,0,0] neg_hi:[1,0,0]
    v_pk_fma_f32 v[92:93], v[92:93], v[132:133], v[132:133] neg_lo:[1,0,0] neg_hi:[1,0,0]
    v_pk_fma_f32 v[94:95], v[94:95], v[134:135], v[134:135] neg_lo:[1,0,0] neg_hi:[1,0,0]
    v_pk_fma_f32 v[172:173], v[172:173], v[212:213], v[212:213] neg_lo:[1,0,0] neg_hi:[1,0,0]
    v_pk_fma_f32 v[174:175], v[174:175], v[214:215], v[214:215] neg_lo:[1,0,0] neg_hi:[1,0,0]
    v_cvt_pk_bf16_f32 v20, v88, v89
    v_cvt_pk_bf16_f32 v21, v90, v91
    v_cvt_pk_bf16_f32 v22, v168, v169
    v_cvt_pk_bf16_f32 v23, v170, v171
    ds_write_b128 v12, v[20:23] offset:18432
    v_cvt_pk_bf16_f32 v24, v92, v93
    v_cvt_pk_bf16_f32 v25, v94, v95
    v_cvt_pk_bf16_f32 v26, v172, v173
    v_cvt_pk_bf16_f32 v27, v174, v175
    ds_write_b128 v12, v[24:27] offset:23040
    v_pk_fma_f32 v[96:97], v[100:101], s[50:51], v[96:97]
    v_pk_fma_f32 v[98:99], v[102:103], s[50:51], v[98:99]
    v_pk_fma_f32 v[136:137], v[140:141], s[52:53], v[136:137]
    v_pk_fma_f32 v[138:139], v[142:143], s[52:53], v[138:139]
    v_pk_fma_f32 v[176:177], v[180:181], s[50:51], v[176:177]
    v_pk_fma_f32 v[178:179], v[182:183], s[50:51], v[178:179]
    v_pk_fma_f32 v[216:217], v[220:221], s[52:53], v[216:217]
    v_pk_fma_f32 v[218:219], v[222:223], s[52:53], v[218:219]
    v_pk_fma_f32 v[100:101], v[100:101], s[28:29], v[96:97]
    v_pk_fma_f32 v[102:103], v[102:103], s[28:29], v[98:99]
    v_pk_fma_f32 v[140:141], v[140:141], s[30:31], v[136:137]
    v_pk_fma_f32 v[142:143], v[142:143], s[30:31], v[138:139]
    v_pk_fma_f32 v[180:181], v[180:181], s[28:29], v[176:177]
    v_pk_fma_f32 v[182:183], v[182:183], s[28:29], v[178:179]
    v_pk_fma_f32 v[220:221], v[220:221], s[30:31], v[216:217]
    v_pk_fma_f32 v[222:223], v[222:223], s[30:31], v[218:219]
    v_exp_f32_e64 v96, v96 clamp
    v_exp_f32_e64 v97, v97 clamp
    v_exp_f32_e64 v98, v98 clamp
    v_exp_f32_e64 v99, v99 clamp
    v_exp_f32_e64 v176, v176 clamp
    v_exp_f32_e64 v177, v177 clamp
    s_waitcnt lgkmcnt(0)
    s_barrier
    v_exp_f32_e64 v178, v178 clamp
    v_exp_f32_e64 v179, v179 clamp
    v_exp_f32_e64 v100, v100 clamp
    v_exp_f32_e64 v101, v101 clamp
    v_exp_f32_e64 v102, v102 clamp
    v_exp_f32_e64 v103, v103 clamp
    v_exp_f32_e64 v180, v180 clamp
    v_exp_f32_e64 v181, v181 clamp
    v_exp_f32_e64 v182, v182 clamp
    v_exp_f32_e64 v183, v183 clamp
    v_pk_fma_f32 v[96:97], v[96:97], s[66:67], v[32:33]
    v_pk_fma_f32 v[98:99], v[98:99], s[66:67], v[32:33]
    v_pk_fma_f32 v[176:177], v[176:177], s[66:67], v[32:33]
    v_pk_fma_f32 v[178:179], v[178:179], s[66:67], v[32:33]
    v_pk_fma_f32 v[100:101], v[100:101], s[66:67], v[32:33]
    v_pk_fma_f32 v[102:103], v[102:103], s[66:67], v[32:33]
    v_pk_fma_f32 v[180:181], v[180:181], s[66:67], v[32:33]
    v_pk_fma_f32 v[182:183], v[182:183], s[66:67], v[32:33]
    v_exp_f32 v136, v136
    v_exp_f32 v137, v137
    v_exp_f32 v138, v138
    v_exp_f32 v139, v139
    v_exp_f32 v216, v216
    v_exp_f32 v217, v217
    v_exp_f32 v218, v218
    v_exp_f32 v219, v219
    v_exp_f32 v140, v140
    v_exp_f32 v141, v141
    v_exp_f32 v142, v142
    v_exp_f32 v143, v143
    v_exp_f32 v220, v220
    v_exp_f32 v221, v221
    v_exp_f32 v222, v222
    v_exp_f32 v223, v223
    v_fma_f32 v136, v96, v136, v96
    v_fma_f32 v137, v97, v137, v97
    v_fma_f32 v138, v98, v138, v98
    v_fma_f32 v139, v99, v139, v99
    v_fma_f32 v216, v176, v216, v176
    v_fma_f32 v217, v177, v217, v177
    v_fma_f32 v218, v178, v218, v178
    v_fma_f32 v219, v179, v219, v179
    v_fma_f32 v140, v100, v140, v100
    v_fma_f32 v141, v101, v141, v101
    v_fma_f32 v142, v102, v142, v102
    v_fma_f32 v143, v103, v143, v103
    v_fma_f32 v220, v180, v220, v180
    v_fma_f32 v221, v181, v221, v181
    v_fma_f32 v222, v182, v222, v182
    v_fma_f32 v223, v183, v223, v183
    v_rcp_f32 v136, v136
    v_rcp_f32 v137, v137
    v_rcp_f32 v138, v138
    v_rcp_f32 v139, v139
    v_rcp_f32 v216, v216
    v_rcp_f32 v217, v217
    v_rcp_f32 v218, v218
    v_rcp_f32 v219, v219
    v_rcp_f32 v140, v140
    v_rcp_f32 v141, v141
    v_rcp_f32 v142, v142
    v_rcp_f32 v143, v143
    v_rcp_f32 v220, v220
    v_rcp_f32 v221, v221
    v_rcp_f32 v222, v222
    v_rcp_f32 v223, v223
    v_pk_fma_f32 v[96:97], v[96:97], v[136:137], v[136:137] neg_lo:[1,0,0] neg_hi:[1,0,0]
    v_pk_fma_f32 v[98:99], v[98:99], v[138:139], v[138:139] neg_lo:[1,0,0] neg_hi:[1,0,0]
    v_pk_fma_f32 v[176:177], v[176:177], v[216:217], v[216:217] neg_lo:[1,0,0] neg_hi:[1,0,0]
    v_pk_fma_f32 v[178:179], v[178:179], v[218:219], v[218:219] neg_lo:[1,0,0] neg_hi:[1,0,0]
    v_pk_fma_f32 v[100:101], v[100:101], v[140:141], v[140:141] neg_lo:[1,0,0] neg_hi:[1,0,0]
    v_pk_fma_f32 v[102:103], v[102:103], v[142:143], v[142:143] neg_lo:[1,0,0] neg_hi:[1,0,0]
    v_pk_fma_f32 v[180:181], v[180:181], v[220:221], v[220:221] neg_lo:[1,0,0] neg_hi:[1,0,0]
    v_pk_fma_f32 v[182:183], v[182:183], v[222:223], v[222:223] neg_lo:[1,0,0] neg_hi:[1,0,0]
    v_cvt_pk_bf16_f32 v20, v96, v97
    v_cvt_pk_bf16_f32 v21, v98, v99
    v_cvt_pk_bf16_f32 v22, v176, v177
    v_cvt_pk_bf16_f32 v23, v178, v179
    ds_write_b128 v12, v[20:23] offset:27648
    v_cvt_pk_bf16_f32 v24, v100, v101
    v_cvt_pk_bf16_f32 v25, v102, v103
    v_cvt_pk_bf16_f32 v26, v180, v181
    v_cvt_pk_bf16_f32 v27, v182, v183
    ds_write_b128 v12, v[24:27] offset:32256
    v_pk_fma_f32 v[104:105], v[108:109], s[50:51], v[104:105]
    v_pk_fma_f32 v[106:107], v[110:111], s[50:51], v[106:107]
    v_pk_fma_f32 v[144:145], v[148:149], s[52:53], v[144:145]
    v_pk_fma_f32 v[146:147], v[150:151], s[52:53], v[146:147]
    v_pk_fma_f32 v[184:185], v[188:189], s[50:51], v[184:185]
    v_pk_fma_f32 v[186:187], v[190:191], s[50:51], v[186:187]
    v_pk_fma_f32 v[224:225], v[228:229], s[52:53], v[224:225]
    v_pk_fma_f32 v[226:227], v[230:231], s[52:53], v[226:227]
    v_pk_fma_f32 v[108:109], v[108:109], s[28:29], v[104:105]
    v_pk_fma_f32 v[110:111], v[110:111], s[28:29], v[106:107]
    v_pk_fma_f32 v[148:149], v[148:149], s[30:31], v[144:145]
    v_pk_fma_f32 v[150:151], v[150:151], s[30:31], v[146:147]
    v_pk_fma_f32 v[188:189], v[188:189], s[28:29], v[184:185]
    v_pk_fma_f32 v[190:191], v[190:191], s[28:29], v[186:187]
    v_pk_fma_f32 v[228:229], v[228:229], s[30:31], v[224:225]
    v_pk_fma_f32 v[230:231], v[230:231], s[30:31], v[226:227]
    v_exp_f32_e64 v104, v104 clamp
    v_exp_f32_e64 v105, v105 clamp
    v_exp_f32_e64 v106, v106 clamp
    v_exp_f32_e64 v107, v107 clamp
    v_exp_f32_e64 v184, v184 clamp
    v_exp_f32_e64 v185, v185 clamp
    s_waitcnt lgkmcnt(0)
    s_barrier
    v_exp_f32_e64 v186, v186 clamp
    v_exp_f32_e64 v187, v187 clamp
    v_exp_f32_e64 v108, v108 clamp
    v_exp_f32_e64 v109, v109 clamp
    v_exp_f32_e64 v110, v110 clamp
    v_exp_f32_e64 v111, v111 clamp
    v_exp_f32_e64 v188, v188 clamp
    v_exp_f32_e64 v189, v189 clamp
    v_exp_f32_e64 v190, v190 clamp
    v_exp_f32_e64 v191, v191 clamp
    v_pk_fma_f32 v[104:105], v[104:105], s[66:67], v[32:33]
    v_pk_fma_f32 v[106:107], v[106:107], s[66:67], v[32:33]
    v_pk_fma_f32 v[184:185], v[184:185], s[66:67], v[32:33]
    v_pk_fma_f32 v[186:187], v[186:187], s[66:67], v[32:33]
    v_pk_fma_f32 v[108:109], v[108:109], s[66:67], v[32:33]
    v_pk_fma_f32 v[110:111], v[110:111], s[66:67], v[32:33]
    v_pk_fma_f32 v[188:189], v[188:189], s[66:67], v[32:33]
    v_pk_fma_f32 v[190:191], v[190:191], s[66:67], v[32:33]
    v_exp_f32 v144, v144
    v_exp_f32 v145, v145
    v_exp_f32 v146, v146
    v_exp_f32 v147, v147
    v_exp_f32 v224, v224
    v_exp_f32 v225, v225
    v_exp_f32 v226, v226
    v_exp_f32 v227, v227
    v_exp_f32 v148, v148
    v_exp_f32 v149, v149
    v_exp_f32 v150, v150
    v_exp_f32 v151, v151
    v_exp_f32 v228, v228
    v_exp_f32 v229, v229
    v_exp_f32 v230, v230
    v_exp_f32 v231, v231
    v_fma_f32 v144, v104, v144, v104
    v_fma_f32 v145, v105, v145, v105
    v_fma_f32 v146, v106, v146, v106
    v_fma_f32 v147, v107, v147, v107
    v_fma_f32 v224, v184, v224, v184
    v_fma_f32 v225, v185, v225, v185
    v_fma_f32 v226, v186, v226, v186
    v_fma_f32 v227, v187, v227, v187
    v_fma_f32 v148, v108, v148, v108
    v_fma_f32 v149, v109, v149, v109
    v_fma_f32 v150, v110, v150, v110
    v_fma_f32 v151, v111, v151, v111
    v_fma_f32 v228, v188, v228, v188
    v_fma_f32 v229, v189, v229, v189
    v_fma_f32 v230, v190, v230, v190
    v_fma_f32 v231, v191, v231, v191
    v_rcp_f32 v144, v144
    v_rcp_f32 v145, v145
    v_rcp_f32 v146, v146
    v_rcp_f32 v147, v147
    v_rcp_f32 v224, v224
    v_rcp_f32 v225, v225
    v_rcp_f32 v226, v226
    v_rcp_f32 v227, v227
    v_rcp_f32 v148, v148
    v_rcp_f32 v149, v149
    v_rcp_f32 v150, v150
    v_rcp_f32 v151, v151
    v_rcp_f32 v228, v228
    v_rcp_f32 v229, v229
    v_rcp_f32 v230, v230
    v_rcp_f32 v231, v231
    v_pk_fma_f32 v[104:105], v[104:105], v[144:145], v[144:145] neg_lo:[1,0,0] neg_hi:[1,0,0]
    v_pk_fma_f32 v[106:107], v[106:107], v[146:147], v[146:147] neg_lo:[1,0,0] neg_hi:[1,0,0]
    v_pk_fma_f32 v[184:185], v[184:185], v[224:225], v[224:225] neg_lo:[1,0,0] neg_hi:[1,0,0]
    v_pk_fma_f32 v[186:187], v[186:187], v[226:227], v[226:227] neg_lo:[1,0,0] neg_hi:[1,0,0]
    v_pk_fma_f32 v[108:109], v[108:109], v[148:149], v[148:149] neg_lo:[1,0,0] neg_hi:[1,0,0]
    v_pk_fma_f32 v[110:111], v[110:111], v[150:151], v[150:151] neg_lo:[1,0,0] neg_hi:[1,0,0]
    v_pk_fma_f32 v[188:189], v[188:189], v[228:229], v[228:229] neg_lo:[1,0,0] neg_hi:[1,0,0]
    v_pk_fma_f32 v[190:191], v[190:191], v[230:231], v[230:231] neg_lo:[1,0,0] neg_hi:[1,0,0]
    v_cvt_pk_bf16_f32 v20, v104, v105
    v_cvt_pk_bf16_f32 v21, v106, v107
    v_cvt_pk_bf16_f32 v22, v184, v185
    v_cvt_pk_bf16_f32 v23, v186, v187
    ds_write_b128 v12, v[20:23] offset:36864
    v_cvt_pk_bf16_f32 v24, v108, v109
    v_cvt_pk_bf16_f32 v25, v110, v111
    v_cvt_pk_bf16_f32 v26, v188, v189
    v_cvt_pk_bf16_f32 v27, v190, v191
    ds_write_b128 v12, v[24:27] offset:41472
    s_waitcnt lgkmcnt(0)
    s_barrier
    s_endpgm
L_code_end:
.section .rodata,"a"
.p2align 6
.amdhsa_kernel standalone__autoregressive_conv_wavenet__speech_kernel
  .amdhsa_next_free_vgpr 256
  .amdhsa_next_free_sgpr 102
  .amdhsa_accum_offset 256
  .amdhsa_group_segment_fixed_size 0
  .amdhsa_kernarg_size 48
  .amdhsa_user_sgpr_count 2
  .amdhsa_user_sgpr_kernarg_segment_ptr 1
  .amdhsa_system_sgpr_workgroup_id_x 1
.end_amdhsa_kernel
```
